```python
import torch

def _softmax(x, axis=-1):
    return torch.softmax(x, dim=axis)
def _gelu(x):
    return torch.nn.functional.gelu(x, approximate="tanh")
def _silu(x):
    return torch.nn.functional.silu(x)
def _sigmoid(x):
    return torch.sigmoid(x)
def _layernorm(x, axis=-1, eps=1e-5):
    m = x.mean(dim=axis, keepdim=True)
    v = x.var(dim=axis, keepdim=True, unbiased=False)
    return (x - m) / torch.sqrt(v + eps)
def _scatter_add(tgt, idx, src, axis=0):
    return tgt.clone().index_add_(axis, idx, src)
def _segment_sum(src, seg, n):
    out = torch.zeros((n,) + src.shape[1:], dtype=src.dtype)
    return out.index_add_(0, seg, src)
def _pad(x, pw):
    flat = tuple(v for pair in reversed(pw) for v in pair)
    return torch.nn.functional.pad(x, flat)

kernel_name = 'gated_mix__spectral_fnet__moe_arch_mod__prompt'

def setup_inputs():

    _w = (lambda a: (lambda t: t.to(torch.bfloat16) if t.is_floating_point() else t)(torch.as_tensor(a)))
    def _A_setup():
        B, S, D = 1, 2048, 512
        ns = torch.arange(S)[:, None] * torch.arange(S)[None, :]
        nd = torch.arange(D)[:, None] * torch.arange(D)[None, :]
        Ws_re = torch.cos(-2.0 * torch.pi * ns / S).to(float)
        Ws_im = torch.sin(-2.0 * torch.pi * ns / S).to(float)
        Wd_re = torch.cos(-2.0 * torch.pi * nd / D).to(float)
        Wd_im = torch.sin(-2.0 * torch.pi * nd / D).to(float)
        return {
            "x": _w((lambda *s: torch.randn(*s, dtype=torch.bfloat16) * 0.05)(B, S, D)),
            "dft_seq_re": _w(Ws_re),
            "dft_seq_im": _w(Ws_im),
            "dft_hid_re": _w(Wd_re),
            "dft_hid_im": _w(Wd_im),
        }
    _A_in = _A_setup()

    def _B_setup():
        B, S, D, F, C = 1, 2048, 512, 1792, 1
        return {
            "x": _w((lambda *s: torch.randn(*s, dtype=torch.bfloat16) * 0.05)(B, S, D)),
            "w_r": _w((lambda *s: torch.randn(*s, dtype=torch.bfloat16) * 1.6)(D)),
            "w_gate": _w((lambda *s: torch.randn(*s, dtype=torch.bfloat16) * 1.6)(D, F)),
            "w_up": _w((lambda *s: torch.randn(*s, dtype=torch.bfloat16) * 1.6)(D, F)),
            "w_down": _w((lambda *s: torch.randn(*s, dtype=torch.bfloat16) * 1.6)(F, D)),
        }
    _B_in = _B_setup()

    return {
        "A_x": _A_in["x"],
        "A_dft_seq_re": _A_in["dft_seq_re"],
        "A_dft_seq_im": _A_in["dft_seq_im"],
        "A_dft_hid_re": _A_in["dft_hid_re"],
        "A_dft_hid_im": _A_in["dft_hid_im"],
        "B_x": _B_in["x"],
        "B_w_r": _B_in["w_r"],
        "B_w_gate": _B_in["w_gate"],
        "B_w_up": _B_in["w_up"],
        "B_w_down": _B_in["w_down"],
        "gate_w": _w((lambda *s: torch.randn(*s, dtype=torch.bfloat16) * 0.05)(512) * 16.0),
    }

def reference(A_x, A_dft_seq_re, A_dft_seq_im, A_dft_hid_re, A_dft_hid_im, B_x, B_w_r, B_w_gate, B_w_up, B_w_down, gate_w):
    def _A_ref(x, dft_seq_re, dft_seq_im, dft_hid_re, dft_hid_im):
        a = torch.einsum("bsd,ed->bse", x, dft_hid_re)
        b = torch.einsum("bsd,ed->bse", x, dft_hid_im)
        y = torch.einsum("ts,bse->bte", dft_seq_re, a) - torch.einsum("ts,bse->bte", dft_seq_im, b)
        return y

    def _B_ref(x, w_r, w_gate, w_up, w_down):
        B, S, D = x.shape
        C = 1
        r = x @ w_r
        idx = torch.argsort(-r, axis=-1)[:, :C]
        idx_e = (lambda x, n, axis: torch.repeat_interleave(x, n, dim=axis))(idx.reshape(B, C, 1), D, axis=2)
        x_sel = (lambda x, i, axis: torch.take_along_dim(x, i, dim=axis))(x, idx_e, axis=1)
        g = _silu(x_sel @ w_gate)
        u = x_sel @ w_up
        y = (g * u) @ w_down
        r_sel = _sigmoid((lambda x, i, axis: torch.take_along_dim(x, i, dim=axis))(r, idx, axis=1))
        y = y * r_sel.reshape(B, C, 1)
        b_off = (torch.arange(B) * S).reshape(B, 1)
        flat_idx = (idx + b_off).reshape(B * C)
        zero = (x * 0.0).reshape(B * S, D)
        upd = _scatter_add(zero, flat_idx, y.reshape(B * C, D), axis=0)
        return x + upd.reshape(B, S, D)

    x = A_x
    g = _sigmoid((x * gate_w).sum(-1, keepdims=True))
    a = _A_ref(x, A_dft_seq_re, A_dft_seq_im, A_dft_hid_re, A_dft_hid_im)
    b = _B_ref(x, B_w_r, B_w_gate, B_w_up, B_w_down)
    return g * a + (1 - g) * b
```

```asm
; @launch grid=(192,1,1) block=(512,1,1) lds=100416
.amdgcn_target "amdgcn-amd-amdhsa--gfx950"
.text
.globl gated_mix__spectral_fnet__moe_arch_mod__prompt_kernel
.p2align 8
.type gated_mix__spectral_fnet__moe_arch_mod__prompt_kernel,@function
gated_mix__spectral_fnet__moe_arch_mod__prompt_kernel:
    s_cmp_ge_u32 s2, 192
    s_cbranch_scc1 L_end
    s_load_dwordx2 s[4:5], s[0:1], 0
    s_load_dwordx16 s[16:31], s[0:1], 48
    v_lshrrev_b32 v1, 6, v0
    v_and_b32 v0, 63, v0
    v_readfirstlane_b32 s3, v1
    v_and_b32 v1, 15, v0
    v_lshrrev_b32 v2, 4, v0
    s_mov_b32 s58, 200000
    s_mov_b32 s14, 0xffff0000
    s_mov_b32 s34, 0x200000
    s_mov_b32 s35, 0x20000
    s_mov_b32 s38, 0x1000000
    s_mov_b32 s39, 0x20000
    s_and_b32 s6, s2, 7
    s_cmp_ge_u32 s2, 128
    s_cbranch_scc1 L_notA
    s_mov_b32 s59, 0
    s_lshr_b32 s7, s2, 3
    s_add_u32 s8, s6, 1
    s_sub_u32 s9, 16, s8
    s_and_b32 s65, s7, 7
    s_and_b32 s10, s8, 7
    s_bitcmp1_b32 s7, 3
    s_cselect_b32 s64, s9, s10
    s_and_b32 s61, s7, 1
    s_bitcmp1_b32 s7, 1
    s_cselect_b32 s10, s9, s8
    s_lshr_b32 s11, s7, 2
    s_lshl4_add_u32 s60, s11, s10
    s_lshr_b32 s11, s7, 1
    s_lshl3_add_u32 s11, s11, 8
    s_cmp_eq_u32 s6, 7
    s_cselect_b32 s60, s11, s60
    s_cmp_eq_u32 s2, 127
    s_cselect_b32 s60, 0, s60
    s_cselect_b32 s61, 0, s61
    v_and_b32 v6, 7, v0
    v_and_b32 v7, 1, v2
    v_xor_b32 v6, v6, v7
    v_lshrrev_b32 v7, 3, v0
    v_lshlrev_b32 v7, 14, v7
    v_lshl_add_u32 v4, v6, 4, v7
    s_lshl3_add_u32 s11, s61, s3
    s_lshl_b32 s11, s11, 7
    s_add_u32 s62, s11, s60
    s_sub_u32 s63, 2048, s62
    s_cmp_eq_u32 s62, 0
    s_cselect_b32 s63, 1024, s63
    s_and_b32 s66, s60, 63
    s_lshl_b32 s6, s62, 10
    s_lshl_b32 s7, s63, 10
    v_and_b32 v6, 1, v2
    v_lshlrev_b32 v6, 5, v6
    v_lshl_add_u32 v6, v1, 6, v6
    v_lshrrev_b32 v7, 1, v2
    v_lshl_add_u32 v3, v7, 4, v6
    v_lshlrev_b32 v5, 4, v0
    s_lshl_b32 s8, s64, 10
    s_lshl_b32 s9, s65, 7
    s_add_u32 s8, s8, s9
    s_lshl_b32 s9, s3, 18
    s_add_u32 s8, s8, s9
    s_add_u32 s9, s8, 131072
    s_lshl_b32 s10, s3, 11
    s_mov_b32 m0, s10
    s_waitcnt lgkmcnt(0)
    s_mov_b32 s32, s4
    s_mov_b32 s33, s5
    buffer_load_dwordx4 v[16:19], v3, s[32:35], s6 offen
    buffer_load_dwordx4 v[20:23], v3, s[32:35], s7 offen
    global_load_dwordx4 v[24:27], v3, s[16:17]
    global_load_dwordx4 v[28:31], v3, s[24:25]
    buffer_load_dwordx4 v4, s[32:35], s8 offen lds
    s_add_u32 m0, s10, 1024
    s_load_dword s57, s[30:31], 0
    s_mov_b32 s36, s30
    s_mov_b32 s37, s31
    buffer_load_dwordx4 v4, s[32:35], s9 offen lds
    v_mov_b32 v6, 0
    v_mov_b32 v7, 33792
    ds_write_b32 v7, v6
    s_waitcnt lgkmcnt(0)
    s_barrier
    s_mul_i32 s56, s57, 0x9E3779B1
    s_add_u32 s56, s56, 0x7F4A7C15
    s_lshr_b32 s6, s3, 2
    v_lshl_add_u32 v6, s6, 4, v1
    v_cvt_f32_u32 v6, v6
    v_mul_f32 v6, 0x3c000000, v6
    v_lshlrev_b32 v7, 3, v2
    v_cvt_f32_u32 v7, v7
    v_mul_f32 v7, v7, v6
    v_lshlrev_b32 v8, 31, v1
    v_lshrrev_b32 v9, 16, v8
    v_or_b32 v8, v8, v9
    v_cos_f32 v96, v7
    v_sin_f32 v104, v7
    v_add_f32 v9, v7, v6
    v_cos_f32 v97, v9
    v_sin_f32 v105, v9
    v_add_f32 v9, v9, v6
    v_cos_f32 v98, v9
    v_sin_f32 v106, v9
    v_add_f32 v9, v9, v6
    v_cos_f32 v99, v9
    v_sin_f32 v107, v9
    v_add_f32 v9, v9, v6
    v_cos_f32 v100, v9
    v_sin_f32 v108, v9
    v_add_f32 v9, v9, v6
    v_cos_f32 v101, v9
    v_sin_f32 v109, v9
    v_add_f32 v9, v9, v6
    v_cos_f32 v102, v9
    v_sin_f32 v110, v9
    v_add_f32 v9, v9, v6
    v_cos_f32 v103, v9
    v_sin_f32 v111, v9
    s_nop 0
    v_cvt_pk_bf16_f32 v32, v96, v97
    v_cvt_pk_bf16_f32 v48, -v104, -v105
    v_cvt_pk_bf16_f32 v64, v96, -v105
    v_cvt_pk_bf16_f32 v80, -v104, -v97
    v_cvt_pk_bf16_f32 v33, v98, v99
    v_cvt_pk_bf16_f32 v49, -v106, -v107
    v_cvt_pk_bf16_f32 v65, -v98, v107
    v_cvt_pk_bf16_f32 v81, v106, v99
    v_cvt_pk_bf16_f32 v34, v100, v101
    v_cvt_pk_bf16_f32 v50, -v108, -v109
    v_cvt_pk_bf16_f32 v66, v100, -v109
    v_cvt_pk_bf16_f32 v82, -v108, -v101
    v_cvt_pk_bf16_f32 v35, v102, v103
    v_cvt_pk_bf16_f32 v51, -v110, -v111
    v_cvt_pk_bf16_f32 v67, -v102, v111
    v_cvt_pk_bf16_f32 v83, v110, v103
    v_fmac_f32 v7, 0x42000000, v6
    v_cos_f32 v96, v7
    v_sin_f32 v104, v7
    v_add_f32 v9, v7, v6
    v_cos_f32 v97, v9
    v_sin_f32 v105, v9
    v_add_f32 v9, v9, v6
    v_cos_f32 v98, v9
    v_sin_f32 v106, v9
    v_add_f32 v9, v9, v6
    v_cos_f32 v99, v9
    v_sin_f32 v107, v9
    v_add_f32 v9, v9, v6
    v_cos_f32 v100, v9
    v_sin_f32 v108, v9
    v_add_f32 v9, v9, v6
    v_cos_f32 v101, v9
    v_sin_f32 v109, v9
    v_add_f32 v9, v9, v6
    v_cos_f32 v102, v9
    v_sin_f32 v110, v9
    v_add_f32 v9, v9, v6
    v_cos_f32 v103, v9
    v_sin_f32 v111, v9
    s_nop 0
    v_cvt_pk_bf16_f32 v36, v96, v97
    v_cvt_pk_bf16_f32 v52, -v104, -v105
    v_cvt_pk_bf16_f32 v68, v96, -v105
    v_cvt_pk_bf16_f32 v84, -v104, -v97
    v_cvt_pk_bf16_f32 v37, v98, v99
    v_cvt_pk_bf16_f32 v53, -v106, -v107
    v_cvt_pk_bf16_f32 v69, -v98, v107
    v_cvt_pk_bf16_f32 v85, v106, v99
    v_cvt_pk_bf16_f32 v38, v100, v101
    v_cvt_pk_bf16_f32 v54, -v108, -v109
    v_cvt_pk_bf16_f32 v70, v100, -v109
    v_cvt_pk_bf16_f32 v86, -v108, -v101
    v_cvt_pk_bf16_f32 v39, v102, v103
    v_cvt_pk_bf16_f32 v55, -v110, -v111
    v_cvt_pk_bf16_f32 v71, -v102, v111
    v_cvt_pk_bf16_f32 v87, v110, v103
    v_cmp_eq_f32 vcc, 0, v6
    v_mov_b32 v9, 0xbf803f80
    s_nop 0
    v_cndmask_b32 v48, v48, v9, vcc
    v_cndmask_b32 v49, v49, v9, vcc
    v_cndmask_b32 v50, v50, v9, vcc
    v_cndmask_b32 v51, v51, v9, vcc
    v_cndmask_b32 v52, v52, v9, vcc
    v_cndmask_b32 v53, v53, v9, vcc
    v_cndmask_b32 v54, v54, v9, vcc
    v_cndmask_b32 v55, v55, v9, vcc
    v_xor_b32 v40, v32, v8
    v_xor_b32 v41, v33, v8
    v_xor_b32 v42, v34, v8
    v_xor_b32 v43, v35, v8
    v_xor_b32 v44, v36, v8
    v_xor_b32 v45, v37, v8
    v_xor_b32 v46, v38, v8
    v_xor_b32 v47, v39, v8
    v_xor_b32 v56, v48, v8
    v_xor_b32 v57, v49, v8
    v_xor_b32 v58, v50, v8
    v_xor_b32 v59, v51, v8
    v_xor_b32 v60, v52, v8
    v_xor_b32 v61, v53, v8
    v_xor_b32 v62, v54, v8
    v_xor_b32 v63, v55, v8
    v_xor_b32 v72, v64, v8
    v_xor_b32 v73, v65, v8
    v_xor_b32 v74, v66, v8
    v_xor_b32 v75, v67, v8
    v_xor_b32 v76, v68, v8
    v_xor_b32 v77, v69, v8
    v_xor_b32 v78, v70, v8
    v_xor_b32 v79, v71, v8
    v_xor_b32 v88, v80, v8
    v_xor_b32 v89, v81, v8
    v_xor_b32 v90, v82, v8
    v_xor_b32 v91, v83, v8
    v_xor_b32 v92, v84, v8
    v_xor_b32 v93, v85, v8
    v_xor_b32 v94, v86, v8
    v_xor_b32 v95, v87, v8
    v_bfe_u32 v6, v0, 2, 2
    v_lshl_add_u32 v7, v2, 3, v6
    v_lshlrev_b32 v7, 7, v7
    v_and_b32 v9, 3, v0
    s_bfe_u32 s7, s3, 0x10001
    v_lshl_add_u32 v9, v9, 1, s7
    v_lshrrev_b32 v6, 1, v6
    v_xor_b32 v9, v9, v6
    s_and_b32 s7, s3, 1
    s_lshl_b32 s7, s7, 3
    v_lshl_add_u32 v9, v9, 4, s7
    v_add_u32 v10, v9, v7
    v_mul_u32_u24 v11, 33024, v1
    v_lshl_add_u32 v11, v2, 4, v11
    s_mul_i32 s6, s6, 528384
    s_lshl3_add_u32 s7, s64, s65
    s_lshl_b32 s7, s7, 8
    s_add_u32 s6, s6, s7
    s_and_b32 s7, s3, 3
    s_lshl_b32 s7, s7, 6
    s_add_u32 s6, s6, s7
    s_add_u32 s8, s6, 2097152
    s_add_u32 s9, s8, 1056768
    s_lshl_b32 s10, s2, 3
    v_cmp_gt_u32 vcc, 32, v0
    v_mov_b32 v6, s62
    v_mov_b32 v7, s63
    s_waitcnt vmcnt(2)
    v_cndmask_b32 v6, v7, v6, vcc
    v_dot2_f32_bf16 v12, v16, v24, 0
    v_dot2_f32_bf16 v13, v20, v24, 0
    v_dot2_f32_bf16 v14, v16, v28, 0
    v_dot2_f32_bf16 v15, v20, v28, 0
    v_sub_u32 v6, 0xffff, v6
    s_nop 1
    v_dot2c_f32_bf16 v12, v17, v25
    v_dot2c_f32_bf16 v13, v21, v25
    v_dot2c_f32_bf16 v14, v17, v29
    v_dot2c_f32_bf16 v15, v21, v29
    v_dot2c_f32_bf16 v12, v18, v26
    v_dot2c_f32_bf16 v13, v22, v26
    v_dot2c_f32_bf16 v14, v18, v30
    v_dot2c_f32_bf16 v15, v22, v30
    v_dot2c_f32_bf16 v12, v19, v27
    v_dot2c_f32_bf16 v13, v23, v27
    v_dot2c_f32_bf16 v14, v19, v31
    v_dot2c_f32_bf16 v15, v23, v31
    s_nop 2
    v_permlane32_swap_b32 v12, v13
    v_permlane32_swap_b32 v14, v15
    v_add_f32 v12, v12, v13
    v_add_f32 v14, v14, v15
    s_nop 1
    v_permlane16_swap_b32 v12, v14
    v_add_f32 v12, v12, v14
    s_nop 1
    v_add_f32_dpp v12, v12, v12 row_ror:8 row_mask:0xf bank_mask:0xf
    s_nop 1
    v_add_f32_dpp v12, v12, v12 row_ror:4 row_mask:0xf bank_mask:0xf
    s_nop 1
    v_add_f32_dpp v12, v12, v12 row_ror:2 row_mask:0xf bank_mask:0xf
    s_nop 1
    v_add_f32_dpp v12, v12, v12 row_ror:1 row_mask:0xf bank_mask:0xf
    v_cvt_pk_bf16_f32 v12, v12, v12
    v_and_b32 v12, s14, v12
    v_ashrrev_i32 v7, 31, v12
    v_or_b32 v7, 0x80000000, v7
    v_xor_b32 v7, v7, v12
    v_and_or_b32 v7, v7, s14, v6
    v_mov_b32 v9, 33792
    s_mov_b32 exec_lo, 1
    s_mov_b32 exec_hi, 1
    ds_max_u32 v9, v7
    s_mov_b64 exec, -1
    s_waitcnt vmcnt(0) lgkmcnt(0)
    s_barrier
    s_cmp_lg_u32 s3, 0
    s_cbranch_scc1 L_nokey
    ds_read_b32 v14, v9
    v_mov_b32 v15, s56
    v_lshlrev_b32 v13, 10, v0
    s_add_u32 s6, s10, 65536
    s_add_u32 s7, s10, 131072
    s_waitcnt lgkmcnt(0)
    buffer_store_dwordx2 v[14:15], v13, s[36:39], s6 offen sc1
    buffer_store_dwordx2 v[14:15], v13, s[36:39], s7 offen sc1
L_nokey:
    ds_read_b64_tr_b16 v[96:97], v10 offset:0
    ds_read_b64_tr_b16 v[98:99], v10 offset:512
    ds_read_b64_tr_b16 v[100:101], v10 offset:4096
    ds_read_b64_tr_b16 v[102:103], v10 offset:4608
    ds_read_b64_tr_b16 v[104:105], v10 offset:8192
    ds_read_b64_tr_b16 v[106:107], v10 offset:8704
    ds_read_b64_tr_b16 v[108:109], v10 offset:12288
    ds_read_b64_tr_b16 v[110:111], v10 offset:12800
    s_waitcnt lgkmcnt(6)
    v_mfma_f32_16x16x32_bf16 v[112:115], v[96:99], v[32:35], 0
    v_mfma_f32_16x16x32_bf16 v[116:119], v[96:99], v[48:51], 0
    v_mfma_f32_16x16x32_bf16 v[120:123], v[96:99], v[64:67], 0
    v_mfma_f32_16x16x32_bf16 v[124:127], v[96:99], v[80:83], 0
    s_waitcnt lgkmcnt(4)
    v_mfma_f32_16x16x32_bf16 v[112:115], v[100:103], v[36:39], v[112:115]
    v_mfma_f32_16x16x32_bf16 v[116:119], v[100:103], v[52:55], v[116:119]
    v_mfma_f32_16x16x32_bf16 v[120:123], v[100:103], v[68:71], v[120:123]
    v_mfma_f32_16x16x32_bf16 v[124:127], v[100:103], v[84:87], v[124:127]
    s_waitcnt lgkmcnt(2)
    v_mfma_f32_16x16x32_bf16 v[112:115], v[104:107], v[40:43], v[112:115]
    v_mfma_f32_16x16x32_bf16 v[116:119], v[104:107], v[56:59], v[116:119]
    v_mfma_f32_16x16x32_bf16 v[120:123], v[104:107], v[72:75], v[120:123]
    v_mfma_f32_16x16x32_bf16 v[124:127], v[104:107], v[88:91], v[124:127]
    s_waitcnt lgkmcnt(0)
    v_mfma_f32_16x16x32_bf16 v[112:115], v[108:111], v[44:47], v[112:115]
    v_mfma_f32_16x16x32_bf16 v[116:119], v[108:111], v[60:63], v[116:119]
    v_mfma_f32_16x16x32_bf16 v[120:123], v[108:111], v[76:79], v[120:123]
    v_mfma_f32_16x16x32_bf16 v[124:127], v[108:111], v[92:95], v[124:127]
    s_nop 5
    v_cvt_pk_bf16_f32 v96, v112, v116
    v_cvt_pk_bf16_f32 v97, v113, v117
    v_cvt_pk_bf16_f32 v98, v114, v118
    v_cvt_pk_bf16_f32 v99, v115, v119
    buffer_store_dwordx4 v[96:99], v11, s[36:39], s8 offen sc1
    v_cvt_pk_bf16_f32 v100, v120, v124
    v_cvt_pk_bf16_f32 v101, v121, v125
    v_cvt_pk_bf16_f32 v102, v122, v126
    v_cvt_pk_bf16_f32 v103, v123, v127
    buffer_store_dwordx4 v[100:103], v11, s[36:39], s9 offen sc1
    s_cmp_eq_u32 s3, 4
    s_cbranch_scc1 L_w4a
    v_mul_f32 v13, 0xbfb8aa3b, v12
    v_exp_f32 v13, v13
    s_nop 0
    v_add_f32 v13, 1.0, v13
    v_rcp_f32 v13, v13
    s_nop 0
    v_cvt_pk_bf16_f32 v13, v13, v13
    v_and_b32 v13, s14, v13
    v_sub_f32 v14, 1.0, v13
    v_cvt_pk_bf16_f32 v14, v14, v14
    v_and_b32 v14, s14, v14
    s_nop 0
    v_readlane_b32 s68, v13, 16
    v_readlane_b32 s71, v13, 48
    v_readlane_b32 s72, v14, 16
    v_readlane_b32 s73, v14, 48
    s_xor_b32 s69, s68, 0x80000000
    s_cmp_eq_u32 s62, 0
    s_cselect_b32 s69, 0, s69
    s_cselect_b32 s70, 0, s71
    v_lshlrev_b32 v196, 16, v16
    v_and_b32 v197, s14, v16
    v_lshlrev_b32 v198, 16, v17
    v_and_b32 v199, s14, v17
    v_lshlrev_b32 v200, 16, v18
    v_and_b32 v201, s14, v18
    v_lshlrev_b32 v202, 16, v19
    v_and_b32 v203, s14, v19
    v_mul_f32 v196, s72, v196
    v_mul_f32 v197, s72, v197
    v_mul_f32 v198, s72, v198
    v_mul_f32 v199, s72, v199
    v_mul_f32 v200, s72, v200
    v_mul_f32 v201, s72, v201
    v_mul_f32 v202, s72, v202
    v_mul_f32 v203, s72, v203
    v_lshlrev_b32 v204, 16, v20
    v_and_b32 v205, s14, v20
    v_lshlrev_b32 v206, 16, v21
    v_and_b32 v207, s14, v21
    v_lshlrev_b32 v208, 16, v22
    v_and_b32 v209, s14, v22
    v_lshlrev_b32 v210, 16, v23
    v_and_b32 v211, s14, v23
    v_mul_f32 v204, s73, v204
    v_mul_f32 v205, s73, v205
    v_mul_f32 v206, s73, v206
    v_mul_f32 v207, s73, v207
    v_mul_f32 v208, s73, v208
    v_mul_f32 v209, s73, v209
    v_mul_f32 v210, s73, v210
    v_mul_f32 v211, s73, v211
    s_waitcnt vmcnt(0)
    s_barrier
    s_branch L_consts
L_w4a:
    v_mov_b32 v9, 33792
    ds_read_b32 v14, v9
    v_mov_b32 v15, s56
    v_lshlrev_b32 v13, 10, v0
    s_add_u32 s6, s10, 196608
    s_waitcnt vmcnt(0) lgkmcnt(0)
    s_barrier
    buffer_store_dwordx2 v[14:15], v13, s[36:39], s6 offen sc1
    s_nop 0
    v_mul_f32 v13, 0xbfb8aa3b, v12
    v_exp_f32 v13, v13
    s_nop 0
    v_add_f32 v13, 1.0, v13
    v_rcp_f32 v13, v13
    s_nop 0
    v_cvt_pk_bf16_f32 v13, v13, v13
    v_and_b32 v13, s14, v13
    v_sub_f32 v14, 1.0, v13
    v_cvt_pk_bf16_f32 v14, v14, v14
    v_and_b32 v14, s14, v14
    s_nop 0
    v_readlane_b32 s68, v13, 16
    v_readlane_b32 s71, v13, 48
    v_readlane_b32 s72, v14, 16
    v_readlane_b32 s73, v14, 48
    s_xor_b32 s69, s68, 0x80000000
    s_cmp_eq_u32 s62, 0
    s_cselect_b32 s69, 0, s69
    s_cselect_b32 s70, 0, s71
    v_lshlrev_b32 v196, 16, v16
    v_and_b32 v197, s14, v16
    v_lshlrev_b32 v198, 16, v17
    v_and_b32 v199, s14, v17
    v_lshlrev_b32 v200, 16, v18
    v_and_b32 v201, s14, v18
    v_lshlrev_b32 v202, 16, v19
    v_and_b32 v203, s14, v19
    v_mul_f32 v196, s72, v196
    v_mul_f32 v197, s72, v197
    v_mul_f32 v198, s72, v198
    v_mul_f32 v199, s72, v199
    v_mul_f32 v200, s72, v200
    v_mul_f32 v201, s72, v201
    v_mul_f32 v202, s72, v202
    v_mul_f32 v203, s72, v203
    v_lshlrev_b32 v204, 16, v20
    v_and_b32 v205, s14, v20
    v_lshlrev_b32 v206, 16, v21
    v_and_b32 v207, s14, v21
    v_lshlrev_b32 v208, 16, v22
    v_and_b32 v209, s14, v22
    v_lshlrev_b32 v210, 16, v23
    v_and_b32 v211, s14, v23
    v_mul_f32 v204, s73, v204
    v_mul_f32 v205, s73, v205
    v_mul_f32 v206, s73, v206
    v_mul_f32 v207, s73, v207
    v_mul_f32 v208, s73, v208
    v_mul_f32 v209, s73, v209
    v_mul_f32 v210, s73, v210
    v_mul_f32 v211, s73, v211
L_consts:
    s_mov_b32 s40, s26
    s_mov_b32 s41, s27
    s_mov_b32 s42, 0x200000
    s_mov_b32 s43, 0x20000
    v_lshlrev_b32 v6, 2, v2
    v_cvt_f32_u32 v6, v6
    v_cvt_f32_u32 v7, v1
    v_mul_f32 v7, 0x3d800000, v7
    v_mul_f32 v9, v6, v7
    v_cos_f32 v96, v9
    v_sin_f32 v104, v9
    v_add_f32 v9, v9, v7
    v_cos_f32 v97, v9
    v_sin_f32 v105, v9
    v_add_f32 v9, v9, v7
    v_cos_f32 v98, v9
    v_sin_f32 v106, v9
    v_add_f32 v9, v9, v7
    v_cos_f32 v99, v9
    v_sin_f32 v107, v9
    s_nop 0
    v_cvt_pk_bf16_f32 v180, v96, v104
    v_cvt_pk_bf16_f32 v184, -v104, v96
    v_cvt_pk_bf16_f32 v181, v97, v105
    v_cvt_pk_bf16_f32 v185, -v105, v97
    v_cvt_pk_bf16_f32 v182, v98, v106
    v_cvt_pk_bf16_f32 v186, -v106, v98
    v_cvt_pk_bf16_f32 v183, v99, v107
    v_cvt_pk_bf16_f32 v187, -v107, v99
    v_add_f32 v7, 0x3d800000, v7
    v_mul_f32 v9, v6, v7
    v_cos_f32 v96, v9
    v_sin_f32 v104, v9
    v_add_f32 v9, v9, v7
    v_cos_f32 v97, v9
    v_sin_f32 v105, v9
    v_add_f32 v9, v9, v7
    v_cos_f32 v98, v9
    v_sin_f32 v106, v9
    v_add_f32 v9, v9, v7
    v_cos_f32 v99, v9
    v_sin_f32 v107, v9
    s_nop 0
    v_cvt_pk_bf16_f32 v188, v96, -v104
    v_cvt_pk_bf16_f32 v192, -v104, -v96
    v_cvt_pk_bf16_f32 v189, v97, -v105
    v_cvt_pk_bf16_f32 v193, -v105, -v97
    v_cvt_pk_bf16_f32 v190, v98, -v106
    v_cvt_pk_bf16_f32 v194, -v106, -v98
    v_cvt_pk_bf16_f32 v191, v99, -v107
    v_cvt_pk_bf16_f32 v195, -v107, -v99
    v_lshrrev_b32 v6, 2, v1
    v_lshlrev_b32 v6, 8, v6
    v_lshl_add_u32 v6, v2, 13, v6
    v_and_b32 v7, 3, v1
    v_lshl_add_u32 v212, v7, 4, v6
    v_mul_u32_u24 v6, 4352, v2
    v_bfe_u32 v7, v1, 1, 2
    s_and_b32 s6, s3, 3
    v_xor_b32 v7, s6, v7
    v_lshlrev_b32 v7, 4, v7
    v_lshl_add_u32 v7, v1, 6, v7
    v_add_u32 v213, v6, v7
    s_lshl_b32 s7, s6, 4
    s_add_u32 s7, s7, 1024
    v_lshl_add_u32 v7, v1, 1, s7
    v_add_u32 v7, v7, v6
    v_cmp_gt_u32 vcc, 8, v1
    v_mov_b32 v9, 17472
    v_lshl_add_u32 v9, v0, 1, v9
    v_cndmask_b32 v214, v9, v7, vcc
    s_mul_i32 s7, s3, 2176
    v_bfe_u32 v7, v1, 1, 2
    v_xor_b32 v7, v7, v2
    v_lshlrev_b32 v7, 4, v7
    v_lshl_add_u32 v7, v1, 6, v7
    v_add_u32 v215, s7, v7
    v_sub_u32 v6, 16, v1
    v_bfe_u32 v7, v6, 1, 2
    v_xor_b32 v7, v7, v2
    v_lshlrev_b32 v7, 4, v7
    v_lshl_add_u32 v7, v6, 6, v7
    v_add_u32 v216, s7, v7
    s_cmp_ge_u32 s3, 4
    s_cbranch_scc1 L_zjoin
    v_cvt_f32_u32 v6, v1
    v_mul_f32 v6, 0x3b000000, v6
    s_lshl_b32 s6, s3, 2
    v_lshl_add_u32 v7, v2, 6, s6
    v_cvt_f32_u32 v7, v7
    v_mul_f32 v7, v7, v6
    v_mul_f32 v13, 0x41800000, v6
    v_lshlrev_b32 v8, 31, v1
    v_lshrrev_b32 v9, 16, v8
    v_or_b32 v8, v8, v9
    v_cos_f32 v96, v7
    v_sin_f32 v104, v7
    v_add_f32 v9, v7, v13
    v_cos_f32 v97, v9
    v_sin_f32 v105, v9
    v_add_f32 v9, v9, v13
    v_cos_f32 v98, v9
    v_sin_f32 v106, v9
    v_add_f32 v9, v9, v13
    v_cos_f32 v99, v9
    v_sin_f32 v107, v9
    s_nop 0
    v_cvt_pk_bf16_f32 v128, v96, v97
    v_cvt_pk_bf16_f32 v132, -v104, -v105
    v_cvt_pk_bf16_f32 v129, v98, v99
    v_cvt_pk_bf16_f32 v133, -v106, -v107
    v_xor_b32 v130, v128, v8
    v_xor_b32 v134, v132, v8
    v_xor_b32 v131, v129, v8
    v_xor_b32 v135, v133, v8
    v_add_f32 v7, v7, v6
    v_cos_f32 v96, v7
    v_sin_f32 v104, v7
    v_add_f32 v9, v7, v13
    v_cos_f32 v97, v9
    v_sin_f32 v105, v9
    v_add_f32 v9, v9, v13
    v_cos_f32 v98, v9
    v_sin_f32 v106, v9
    v_add_f32 v9, v9, v13
    v_cos_f32 v99, v9
    v_sin_f32 v107, v9
    s_nop 0
    v_cvt_pk_bf16_f32 v140, v96, v97
    v_cvt_pk_bf16_f32 v144, -v104, -v105
    v_cvt_pk_bf16_f32 v141, v98, v99
    v_cvt_pk_bf16_f32 v145, -v106, -v107
    v_xor_b32 v142, v140, v8
    v_xor_b32 v146, v144, v8
    v_xor_b32 v143, v141, v8
    v_xor_b32 v147, v145, v8
    v_add_f32 v7, v7, v6
    v_cos_f32 v96, v7
    v_sin_f32 v104, v7
    v_add_f32 v9, v7, v13
    v_cos_f32 v97, v9
    v_sin_f32 v105, v9
    v_add_f32 v9, v9, v13
    v_cos_f32 v98, v9
    v_sin_f32 v106, v9
    v_add_f32 v9, v9, v13
    v_cos_f32 v99, v9
    v_sin_f32 v107, v9
    s_nop 0
    v_cvt_pk_bf16_f32 v152, v96, v97
    v_cvt_pk_bf16_f32 v156, -v104, -v105
    v_cvt_pk_bf16_f32 v153, v98, v99
    v_cvt_pk_bf16_f32 v157, -v106, -v107
    v_xor_b32 v154, v152, v8
    v_xor_b32 v158, v156, v8
    v_xor_b32 v155, v153, v8
    v_xor_b32 v159, v157, v8
    v_add_f32 v7, v7, v6
    v_cos_f32 v96, v7
    v_sin_f32 v104, v7
    v_add_f32 v9, v7, v13
    v_cos_f32 v97, v9
    v_sin_f32 v105, v9
    v_add_f32 v9, v9, v13
    v_cos_f32 v98, v9
    v_sin_f32 v106, v9
    v_add_f32 v9, v9, v13
    v_cos_f32 v99, v9
    v_sin_f32 v107, v9
    s_nop 0
    v_cvt_pk_bf16_f32 v164, v96, v97
    v_cvt_pk_bf16_f32 v168, -v104, -v105
    v_cvt_pk_bf16_f32 v165, v98, v99
    v_cvt_pk_bf16_f32 v169, -v106, -v107
    v_xor_b32 v166, v164, v8
    v_xor_b32 v170, v168, v8
    v_xor_b32 v167, v165, v8
    v_xor_b32 v171, v169, v8
    v_lshrrev_b32 v6, 1, v1
    v_add_u32 v7, s6, v6
    v_and_b32 v9, 1, v1
    v_lshl_add_u32 v7, v9, 3, v7
    v_cvt_f32_u32 v7, v7
    v_mul_f32 v7, 0x3d000000, v7
    v_cos_f32 v7, v7
    s_nop 0
    v_cvt_pk_bf16_f32 v7, v7, -v7
    v_cmp_eq_u32 vcc, 0, v6
    s_nop 1
    v_cndmask_b32 v136, 0, v7, vcc
    v_cndmask_b32 v137, 0, v7, vcc
    v_cndmask_b32 v138, 0, v7, vcc
    v_cndmask_b32 v139, 0, v7, vcc
    v_cmp_eq_u32 vcc, 1, v6
    s_nop 1
    v_cndmask_b32 v148, 0, v7, vcc
    v_cndmask_b32 v149, 0, v7, vcc
    v_cndmask_b32 v150, 0, v7, vcc
    v_cndmask_b32 v151, 0, v7, vcc
    v_cmp_eq_u32 vcc, 2, v6
    s_nop 1
    v_cndmask_b32 v160, 0, v7, vcc
    v_cndmask_b32 v161, 0, v7, vcc
    v_cndmask_b32 v162, 0, v7, vcc
    v_cndmask_b32 v163, 0, v7, vcc
    v_cmp_eq_u32 vcc, 3, v6
    s_nop 1
    v_cndmask_b32 v172, 0, v7, vcc
    v_cndmask_b32 v173, 0, v7, vcc
    v_cndmask_b32 v174, 0, v7, vcc
    v_cndmask_b32 v175, 0, v7, vcc
L_zjoin:
    s_cmp_lg_u32 s62, 0
    s_cbranch_scc1 L_nosp1
    v_mov_b32 v184, v180
    v_mov_b32 v192, v188
    v_mov_b32 v185, v181
    v_mov_b32 v193, v189
    v_mov_b32 v186, v182
    v_mov_b32 v194, v190
    v_mov_b32 v187, v183
    v_mov_b32 v195, v191
L_nosp1:
    s_cmp_ge_u32 s3, 4
    s_cbranch_scc1 L_hi
    v_lshrrev_b32 v6, 1, v1
    s_lshl_b32 s6, s61, 10
    s_add_u32 s6, s6, s60
    v_lshl_add_u32 v6, v6, 7, s6
    v_and_b32 v7, 1, v1
    v_lshlrev_b32 v9, 9, v7
    v_lshl_or_b32 v13, v6, 1, v7
    v_cmp_eq_u32 vcc, 1, v13
    v_mov_b32 v13, 0x400
    s_nop 0
    v_cndmask_b32 v6, v6, v13, vcc
    v_cndmask_b32 v9, v9, 0, vcc
    v_lshlrev_b32 v7, 2, v2
    v_mad_u32_u24 v9, v7, v6, v9
    v_cvt_f32_u32 v9, v9
    v_cvt_f32_u32 v6, v6
    v_mul_f32 v9, 0x3a000000, v9
    v_mul_f32 v6, 0x3a000000, v6
    v_cos_f32 v96, v9
    v_sin_f32 v104, v9
    v_add_f32 v9, v9, v6
    v_cos_f32 v97, v9
    v_sin_f32 v105, v9
    v_add_f32 v9, v9, v6
    v_cos_f32 v98, v9
    v_sin_f32 v106, v9
    v_add_f32 v9, v9, v6
    v_cos_f32 v99, v9
    v_sin_f32 v107, v9
    s_cmp_eq_u32 s60, 0
    s_cbranch_scc1 L_g02
    s_cmp_eq_u32 s60, 64
    s_cbranch_scc1 L_g643
    v_cvt_pk_bf16_f32 v176, v96, v104
    v_cvt_pk_bf16_f32 v177, v97, v105
    v_cvt_pk_bf16_f32 v178, v98, v106
    v_cvt_pk_bf16_f32 v179, v99, v107
    s_branch L_gd4
L_g02:
    v_cvt_pk_bf16_f32 v176, v96, 0
    v_cvt_pk_bf16_f32 v177, v97, 0
    v_cvt_pk_bf16_f32 v178, v98, 0
    v_cvt_pk_bf16_f32 v179, v99, 0
    s_branch L_gd4
L_g643:
    v_cvt_pk_bf16_f32 v176, 0, v96
    v_cvt_pk_bf16_f32 v177, 0, v97
    v_cvt_pk_bf16_f32 v178, 0, v98
    v_cvt_pk_bf16_f32 v179, 0, v99
L_gd4:
    s_mul_i32 s6, s66, 33024
    s_lshl_b32 s7, s3, 6
    s_add_u32 s6, s6, s7
    s_add_u32 s6, s6, 2097152
    s_add_u32 s7, s6, 4096
    s_barrier
    buffer_load_dwordx4 v[32:35], v212, s[36:39], s6 offen offset:0 sc1
    buffer_load_dwordx4 v[36:39], v212, s[36:39], s6 offen offset:2048 sc1
    buffer_load_dwordx4 v[40:43], v212, s[36:39], s7 offen offset:0 sc1
    buffer_load_dwordx4 v[44:47], v212, s[36:39], s7 offen offset:2048 sc1
    buffer_load_dwordx4 v[48:51], v212, s[36:39], s6 offen offset:1024 sc1
    buffer_load_dwordx4 v[52:55], v212, s[36:39], s6 offen offset:3072 sc1
    buffer_load_dwordx4 v[56:59], v212, s[36:39], s7 offen offset:1024 sc1
    buffer_load_dwordx4 v[60:63], v212, s[36:39], s7 offen offset:3072 sc1
    s_waitcnt vmcnt(4)
    v_swap_b32 v33, v36
    v_swap_b32 v34, v40
    v_swap_b32 v35, v44
    v_swap_b32 v38, v41
    v_swap_b32 v39, v45
    v_swap_b32 v43, v46
    s_nop 1
    v_mfma_f32_16x16x32_bf16 v[64:67], v[32:35], v[176:179], 0
    v_mfma_f32_16x16x32_bf16 v[72:75], v[36:39], v[176:179], 0
    v_mfma_f32_16x16x32_bf16 v[80:83], v[40:43], v[176:179], 0
    v_mfma_f32_16x16x32_bf16 v[88:91], v[44:47], v[176:179], 0
    s_waitcnt vmcnt(0)
    v_swap_b32 v49, v52
    v_swap_b32 v50, v56
    v_swap_b32 v51, v60
    v_swap_b32 v54, v57
    v_swap_b32 v55, v61
    v_swap_b32 v59, v62
    s_nop 1
    v_mfma_f32_16x16x32_bf16 v[68:71], v[48:51], v[176:179], 0
    v_mfma_f32_16x16x32_bf16 v[76:79], v[52:55], v[176:179], 0
    v_mfma_f32_16x16x32_bf16 v[84:87], v[56:59], v[176:179], 0
    v_mfma_f32_16x16x32_bf16 v[92:95], v[60:63], v[176:179], 0
    s_nop 4
    v_cvt_pk_bf16_f32 v96, v64, v65
    v_cvt_pk_bf16_f32 v97, v66, v67
    v_cvt_pk_bf16_f32 v98, v68, v69
    v_cvt_pk_bf16_f32 v99, v70, v71
    v_cvt_pk_bf16_f32 v100, v72, v73
    v_cvt_pk_bf16_f32 v101, v74, v75
    v_cvt_pk_bf16_f32 v102, v76, v77
    v_cvt_pk_bf16_f32 v103, v78, v79
    v_mfma_f32_16x16x32_bf16 v[32:35], v[96:99], v[128:131], 0
    v_mfma_f32_16x16x32_bf16 v[36:39], v[96:99], v[132:135], 0
    v_mfma_f32_16x16x32_bf16 v[112:115], v[96:99], v[136:139], 0
    v_cvt_pk_bf16_f32 v104, v80, v81
    v_cvt_pk_bf16_f32 v105, v82, v83
    v_cvt_pk_bf16_f32 v106, v84, v85
    v_cvt_pk_bf16_f32 v107, v86, v87
    v_mfma_f32_16x16x32_bf16 v[40:43], v[100:103], v[140:143], 0
    v_mfma_f32_16x16x32_bf16 v[44:47], v[100:103], v[144:147], 0
    v_mfma_f32_16x16x32_bf16 v[112:115], v[100:103], v[148:151], v[112:115]
    v_cvt_pk_bf16_f32 v108, v88, v89
    v_cvt_pk_bf16_f32 v109, v90, v91
    v_cvt_pk_bf16_f32 v110, v92, v93
    v_cvt_pk_bf16_f32 v111, v94, v95
    v_mfma_f32_16x16x32_bf16 v[48:51], v[104:107], v[152:155], 0
    v_mfma_f32_16x16x32_bf16 v[52:55], v[104:107], v[156:159], 0
    v_mfma_f32_16x16x32_bf16 v[112:115], v[104:107], v[160:163], v[112:115]
    s_nop 0
    v_mfma_f32_16x16x32_bf16 v[56:59], v[108:111], v[164:167], 0
    v_mfma_f32_16x16x32_bf16 v[60:63], v[108:111], v[168:171], 0
    v_mfma_f32_16x16x32_bf16 v[112:115], v[108:111], v[172:175], v[112:115]
    v_cvt_pk_bf16_f32 v64, v32, v36
    v_cvt_pk_bf16_f32 v68, v33, v37
    v_cvt_pk_bf16_f32 v72, v34, v38
    v_cvt_pk_bf16_f32 v76, v35, v39
    v_cvt_pk_bf16_f32 v65, v40, v44
    v_cvt_pk_bf16_f32 v69, v41, v45
    v_cvt_pk_bf16_f32 v73, v42, v46
    v_cvt_pk_bf16_f32 v77, v43, v47
    v_cvt_pk_bf16_f32 v66, v48, v52
    v_cvt_pk_bf16_f32 v70, v49, v53
    v_cvt_pk_bf16_f32 v74, v50, v54
    v_cvt_pk_bf16_f32 v78, v51, v55
    v_cvt_pk_bf16_f32 v67, v56, v60
    v_cvt_pk_bf16_f32 v71, v57, v61
    v_cvt_pk_bf16_f32 v75, v58, v62
    v_cvt_pk_bf16_f32 v79, v59, v63
    ds_write_b128 v213, v[64:67] offset:16384
    ds_write_b128 v213, v[68:71] offset:17472
    ds_write_b128 v213, v[72:75] offset:18560
    ds_write_b128 v213, v[76:79] offset:19648
    v_cvt_pk_bf16_f32 v112, v112, v113
    v_cvt_pk_bf16_f32 v114, v114, v115
    ds_write_b16 v214, v112 offset:16384
    ds_write_b16_d16_hi v214, v112 offset:17472
    ds_write_b16 v214, v114 offset:18560
    ds_write_b16_d16_hi v214, v114 offset:19648
    s_branch L_d2
L_hi:
    s_cmp_lg_u32 s3, 4
    s_cbranch_scc1 L_hi2
    s_and_b32 s78, s2, 7
    s_lshl_b32 s78, s78, 13
    s_add_u32 s78, s78, 196608
    s_add_u32 s79, s78, 7168
L_poll5:
    buffer_load_dwordx4 v[32:35], v5, s[36:39], s78 offen sc1
    s_add_u32 s78, s78, 1024
    s_min_u32 s78, s78, s79
    s_waitcnt vmcnt(0)
    v_cmp_ne_u32 vcc, s56, v33
    v_cmp_ne_u32 s[12:13], s56, v35
    s_or_b64 vcc, vcc, s[12:13]
    s_cbranch_vccz L_poll5_ok
    s_sub_u32 s58, s58, 1
    s_cbranch_scc0 L_poll5
    s_mov_b32 s58, 0
L_poll5_ok:
    s_barrier
    v_max_u32 v32, v32, v34
    s_nop 1
    v_max_u32_dpp v32, v32, v32 row_ror:8 row_mask:0xf bank_mask:0xf
    s_nop 1
    v_max_u32_dpp v32, v32, v32 row_ror:4 row_mask:0xf bank_mask:0xf
    s_nop 1
    v_max_u32_dpp v32, v32, v32 row_ror:2 row_mask:0xf bank_mask:0xf
    s_nop 1
    v_max_u32_dpp v32, v32, v32 row_ror:1 row_mask:0xf bank_mask:0xf
    v_mov_b32 v33, v32
    s_nop 1
    v_permlane16_swap_b32 v32, v33
    v_max_u32 v32, v32, v33
    v_mov_b32 v33, v32
    s_nop 1
    v_permlane32_swap_b32 v32, v33
    v_max_u32 v32, v32, v33
    v_mov_b32 v9, 33796
    s_mov_b64 exec, 1
    ds_write_b32 v9, v32
    s_mov_b64 exec, -1
    s_branch L_d2
L_hi2:
    s_barrier
L_d2:
    s_waitcnt lgkmcnt(0)
    s_barrier
    ds_read_b128 v[32:35], v215 offset:16384
    ds_read_b128 v[36:39], v216 offset:16384
    ds_read_b128 v[40:43], v215 offset:17472
    ds_read_b128 v[44:47], v216 offset:17472
    v_mov_b32 v9, 33796
    ds_read_b32 v6, v9
    s_waitcnt lgkmcnt(4)
    v_mfma_f32_16x16x32_bf16 v[48:51], v[32:35], v[180:183], 0
    s_waitcnt lgkmcnt(3)
    v_mfma_f32_16x16x32_bf16 v[52:55], v[36:39], v[188:191], 0
    s_waitcnt lgkmcnt(2)
    v_mfma_f32_16x16x32_bf16 v[56:59], v[40:43], v[184:187], 0
    s_waitcnt lgkmcnt(1)
    v_mfma_f32_16x16x32_bf16 v[60:63], v[44:47], v[192:195], 0
    s_waitcnt lgkmcnt(0)
    v_readfirstlane_b32 s74, v6
    s_lshl_b32 s6, s62, 10
    s_lshl_b32 s7, s63, 10
    s_andn2_b32 s67, 0xffff, s74
    s_nop 0
    v_permlane16_swap_b32 v48, v52
    v_permlane16_swap_b32 v49, v53
    v_permlane16_swap_b32 v50, v54
    v_permlane16_swap_b32 v51, v55
    v_permlane16_swap_b32 v56, v60
    v_permlane16_swap_b32 v57, v61
    v_permlane16_swap_b32 v58, v62
    v_permlane16_swap_b32 v59, v63
    s_cmp_lg_u32 s59, 0
    s_cbranch_scc1 L_zfin
    v_fmac_f32 v196, s68, v48
    v_fmac_f32 v197, s68, v49
    v_fmac_f32 v198, s68, v50
    v_fmac_f32 v199, s68, v51
    v_fmac_f32 v200, s68, v52
    v_fmac_f32 v201, s68, v53
    v_fmac_f32 v202, s68, v54
    v_fmac_f32 v203, s68, v55
    v_fmac_f32 v196, s69, v56
    v_fmac_f32 v197, s69, v57
    v_fmac_f32 v198, s69, v58
    v_fmac_f32 v199, s69, v59
    v_fmac_f32 v200, s69, v60
    v_fmac_f32 v201, s69, v61
    v_fmac_f32 v202, s69, v62
    v_fmac_f32 v203, s69, v63
    v_cvt_pk_bf16_f32 v32, v196, v197
    v_cvt_pk_bf16_f32 v33, v198, v199
    v_cvt_pk_bf16_f32 v34, v200, v201
    v_cvt_pk_bf16_f32 v35, v202, v203
    s_cmp_eq_u32 s62, s67
    s_cbranch_scc1 L_skip6
    buffer_store_dwordx4 v[32:35], v3, s[40:43], s6 offen
L_skip6:
    v_fmac_f32 v204, s70, v48
    v_fmac_f32 v205, s70, v49
    v_fmac_f32 v206, s70, v50
    v_fmac_f32 v207, s70, v51
    v_fmac_f32 v208, s70, v52
    v_fmac_f32 v209, s70, v53
    v_fmac_f32 v210, s70, v54
    v_fmac_f32 v211, s70, v55
    v_fmac_f32 v204, s71, v56
    v_fmac_f32 v205, s71, v57
    v_fmac_f32 v206, s71, v58
    v_fmac_f32 v207, s71, v59
    v_fmac_f32 v208, s71, v60
    v_fmac_f32 v209, s71, v61
    v_fmac_f32 v210, s71, v62
    v_fmac_f32 v211, s71, v63
    v_cvt_pk_bf16_f32 v36, v204, v205
    v_cvt_pk_bf16_f32 v37, v206, v207
    v_cvt_pk_bf16_f32 v38, v208, v209
    v_cvt_pk_bf16_f32 v39, v210, v211
    s_cmp_eq_u32 s63, s67
    s_cbranch_scc1 L_skip7
    buffer_store_dwordx4 v[36:39], v3, s[40:43], s7 offen
L_skip7:
    s_endpgm
L_zfin:
    s_cmp_lg_u32 s3, s75
    s_cbranch_scc1 L_zf1
    s_cmp_lg_u32 s76, 0
    s_cselect_b32 s68, s70, s68
    s_cselect_b32 s69, s71, s69
    s_cselect_b32 s72, s73, s72
    s_cselect_b64 vcc, -1, 0
    v_mul_f32 v48, s68, v48
    v_mul_f32 v49, s68, v49
    v_mul_f32 v50, s68, v50
    v_mul_f32 v51, s68, v51
    v_mul_f32 v52, s68, v52
    v_mul_f32 v53, s68, v53
    v_mul_f32 v54, s68, v54
    v_mul_f32 v55, s68, v55
    v_fmac_f32 v48, s69, v56
    v_fmac_f32 v49, s69, v57
    v_fmac_f32 v50, s69, v58
    v_fmac_f32 v51, s69, v59
    v_fmac_f32 v52, s69, v60
    v_fmac_f32 v53, s69, v61
    v_fmac_f32 v54, s69, v62
    v_fmac_f32 v55, s69, v63
    v_cndmask_b32 v16, v16, v20, vcc
    v_cndmask_b32 v17, v17, v21, vcc
    v_cndmask_b32 v18, v18, v22, vcc
    v_cndmask_b32 v19, v19, v23, vcc
    v_lshlrev_b32 v6, 1, v3
    ds_write_b128 v6, v[48:51] offset:38464
    ds_write_b128 v6, v[52:55] offset:38480
    ds_write_b128 v3, v[16:19] offset:40512
    v_mov_b32 v7, s72
    v_mov_b32 v9, 33800
    ds_write_b32 v9, v7
L_zf1:
    s_lshl3_add_u32 s8, s77, s3
    v_and_b32 v6, 3, v0
    s_lshl_b32 s9, s8, 4
    v_lshl_add_u32 v10, v6, 2, s9
    v_lshlrev_b32 v11, 1, v10
    v_lshrrev_b32 v7, 2, v0
    v_lshlrev_b32 v7, 9, v7
    v_lshl_add_u32 v13, v6, 4, v7
    s_mul_i32 s78, s77, 28672
    s_lshl_b32 s9, s3, 6
    s_add_u32 s78, s78, s9
    s_add_u32 s78, s78, 262144
    s_add_u32 s79, s78, 229376
    s_and_b32 s6, s74, 0xffff0000
    s_xor_b32 s7, s6, 0x80000000
    s_xor_b32 s9, s6, 0xffff0000
    s_bitcmp1_b32 s6, 31
    s_cselect_b32 s6, s7, s9
    v_mov_b32 v14, s6
    v_mul_f32 v14, 0xbfb8aa3b, v14
    v_exp_f32 v14, v14
    s_nop 0
    v_add_f32 v14, 1.0, v14
    v_rcp_f32 v14, v14
    s_nop 0
    v_cvt_pk_bf16_f32 v14, v14, v14
    v_and_b32 v14, s14, v14
    s_waitcnt lgkmcnt(0)
    s_barrier
    ds_read_b64 v[32:33], v11 offset:38464
    ds_read_b32 v34, v10 offset:40512
    v_mov_b32 v9, 33800
    ds_read_b32 v35, v9
    v_mov_b32 v52, 0
    v_mov_b32 v54, 0
    v_mov_b32 v53, s56
    v_mov_b32 v55, s56
L_zp:
    s_add_u32 s6, s78, 8192
    s_add_u32 s7, s78, 16384
    s_add_u32 s8, s78, 24576
    buffer_load_dwordx4 v[40:43], v13, s[36:39], s78 offen sc1
    buffer_load_dwordx4 v[44:47], v13, s[36:39], s6 offen sc1
    buffer_load_dwordx4 v[48:51], v13, s[36:39], s7 offen sc1
    s_mov_b32 exec_hi, 0
    buffer_load_dwordx4 v[52:55], v13, s[36:39], s8 offen sc1
    s_mov_b32 exec_hi, -1
    s_add_u32 s78, s78, 229376
    s_min_u32 s78, s78, s79
    s_waitcnt vmcnt(0)
    v_xor_b32 v36, s56, v41
    v_xor_b32 v37, s56, v43
    v_bitop3_b32 v36, v45, s56, v36 bitop3:0xbe
    v_bitop3_b32 v37, v47, s56, v37 bitop3:0xbe
    v_bitop3_b32 v36, v49, s56, v36 bitop3:0xbe
    v_bitop3_b32 v37, v51, s56, v37 bitop3:0xbe
    v_bitop3_b32 v36, v53, s56, v36 bitop3:0xbe
    v_bitop3_b32 v37, v55, s56, v37 bitop3:0xbe
    v_or_b32 v36, v36, v37
    v_cmp_ne_u32 vcc, 0, v36
    v_add_f32 v40, v40, v44
    s_cbranch_vccz L_zp_ok
    s_sub_u32 s58, s58, 1
    s_cbranch_scc0 L_zp
L_zp_ok:
    v_add_f32 v42, v42, v46
    v_add_f32 v48, v48, v52
    v_add_f32 v50, v50, v54
    v_add_f32 v40, v40, v48
    v_add_f32 v42, v42, v50
    s_nop 0
    v_add_f32_dpp v40, v40, v40 row_ror:4 row_mask:0xf bank_mask:0xf
    v_add_f32_dpp v42, v42, v42 row_ror:4 row_mask:0xf bank_mask:0xf
    s_nop 0
    v_add_f32_dpp v40, v40, v40 row_ror:8 row_mask:0xf bank_mask:0xf
    v_add_f32_dpp v42, v42, v42 row_ror:8 row_mask:0xf bank_mask:0xf
    s_nop 1
    v_permlane16_swap_b32 v40, v42
    v_add_f32 v40, v40, v42
    v_mov_b32 v42, v40
    s_nop 1
    v_permlane32_swap_b32 v40, v42
    v_add_f32 v40, v40, v42
    v_mov_b32 v42, v40
    s_nop 1
    v_permlane16_swap_b32 v40, v42
    s_waitcnt lgkmcnt(0)
    v_cvt_pk_bf16_f32 v41, v40, v42
    v_lshlrev_b32 v40, 16, v41
    v_and_b32 v42, s14, v41
    v_mul_f32 v40, v40, v14
    v_mul_f32 v42, v42, v14
    v_cvt_pk_bf16_f32 v41, v40, v42
    v_lshlrev_b32 v40, 16, v41
    v_and_b32 v42, s14, v41
    v_lshlrev_b32 v36, 16, v34
    v_and_b32 v37, s14, v34
    v_add_f32 v40, v40, v36
    v_add_f32 v42, v42, v37
    v_cvt_pk_bf16_f32 v41, v40, v42
    v_lshlrev_b32 v40, 16, v41
    v_and_b32 v42, s14, v41
    v_fmac_f32 v32, v40, v35
    v_fmac_f32 v33, v42, v35
    v_cvt_pk_bf16_f32 v41, v32, v33
    s_lshl_b32 s6, s67, 10
    s_mov_b64 exec, 15
    buffer_store_dword v41, v10, s[40:43], s6 offen
    s_mov_b64 exec, -1
    s_or_b32 s6, s77, s3
    s_cbranch_scc1 L_zend
    s_mov_b64 exec, 0xff
    v_lshlrev_b32 v6, 2, v0
    s_mov_b32 s6, 4096
L_za:
    buffer_load_dword v7, v6, s[36:39], s6 offen sc1
    s_waitcnt vmcnt(0)
    v_cmp_ne_u32 vcc, s56, v7
    s_nop 0
    s_cbranch_vccz L_za_ok
    s_sub_u32 s58, s58, 1
    s_cbranch_scc0 L_za
L_za_ok:
    s_mov_b64 exec, 1
    s_add_u32 s57, s57, 1
    v_mov_b32 v7, s57
    buffer_store_dword v7, v6, s[36:39], 0 offen sc1
    s_mov_b64 exec, -1
L_zend:
    s_endpgm
L_notA:
    s_cmp_lt_u32 s2, 184
    s_cbranch_scc1 L_F
    s_mov_b32 s59, 1
    s_sub_u32 s77, s2, 184
    v_and_b32 v6, 1, v2
    v_lshlrev_b32 v6, 5, v6
    v_lshl_add_u32 v6, v1, 6, v6
    v_lshrrev_b32 v7, 1, v2
    v_lshl_add_u32 v3, v7, 4, v6
    v_lshlrev_b32 v5, 4, v0
    s_waitcnt lgkmcnt(0)
    s_mov_b32 s32, s4
    s_mov_b32 s33, s5
    s_load_dword s57, s[30:31], 0
    s_mov_b32 s36, s30
    s_mov_b32 s37, s31
    s_mov_b32 s40, s26
    s_mov_b32 s41, s27
    s_mov_b32 s42, 0x200000
    s_mov_b32 s43, 0x20000
    v_lshlrev_b32 v6, 2, v2
    v_cvt_f32_u32 v6, v6
    v_cvt_f32_u32 v7, v1
    v_mul_f32 v7, 0x3d800000, v7
    v_mul_f32 v9, v6, v7
    v_cos_f32 v96, v9
    v_sin_f32 v104, v9
    v_add_f32 v9, v9, v7
    v_cos_f32 v97, v9
    v_sin_f32 v105, v9
    v_add_f32 v9, v9, v7
    v_cos_f32 v98, v9
    v_sin_f32 v106, v9
    v_add_f32 v9, v9, v7
    v_cos_f32 v99, v9
    v_sin_f32 v107, v9
    s_nop 0
    v_cvt_pk_bf16_f32 v180, v96, v104
    v_cvt_pk_bf16_f32 v184, -v104, v96
    v_cvt_pk_bf16_f32 v181, v97, v105
    v_cvt_pk_bf16_f32 v185, -v105, v97
    v_cvt_pk_bf16_f32 v182, v98, v106
    v_cvt_pk_bf16_f32 v186, -v106, v98
    v_cvt_pk_bf16_f32 v183, v99, v107
    v_cvt_pk_bf16_f32 v187, -v107, v99
    v_add_f32 v7, 0x3d800000, v7
    v_mul_f32 v9, v6, v7
    v_cos_f32 v96, v9
    v_sin_f32 v104, v9
    v_add_f32 v9, v9, v7
    v_cos_f32 v97, v9
    v_sin_f32 v105, v9
    v_add_f32 v9, v9, v7
    v_cos_f32 v98, v9
    v_sin_f32 v106, v9
    v_add_f32 v9, v9, v7
    v_cos_f32 v99, v9
    v_sin_f32 v107, v9
    s_nop 0
    v_cvt_pk_bf16_f32 v188, v96, -v104
    v_cvt_pk_bf16_f32 v192, -v104, -v96
    v_cvt_pk_bf16_f32 v189, v97, -v105
    v_cvt_pk_bf16_f32 v193, -v105, -v97
    v_cvt_pk_bf16_f32 v190, v98, -v106
    v_cvt_pk_bf16_f32 v194, -v106, -v98
    v_cvt_pk_bf16_f32 v191, v99, -v107
    v_cvt_pk_bf16_f32 v195, -v107, -v99
    v_lshrrev_b32 v6, 2, v1
    v_lshlrev_b32 v6, 8, v6
    v_lshl_add_u32 v6, v2, 13, v6
    v_and_b32 v7, 3, v1
    v_lshl_add_u32 v212, v7, 4, v6
    v_mul_u32_u24 v6, 4352, v2
    v_bfe_u32 v7, v1, 1, 2
    s_and_b32 s6, s3, 3
    v_xor_b32 v7, s6, v7
    v_lshlrev_b32 v7, 4, v7
    v_lshl_add_u32 v7, v1, 6, v7
    v_add_u32 v213, v6, v7
    s_lshl_b32 s7, s6, 4
    s_add_u32 s7, s7, 1024
    v_lshl_add_u32 v7, v1, 1, s7
    v_add_u32 v7, v7, v6
    v_cmp_gt_u32 vcc, 8, v1
    v_mov_b32 v9, 17472
    v_lshl_add_u32 v9, v0, 1, v9
    v_cndmask_b32 v214, v9, v7, vcc
    s_mul_i32 s7, s3, 2176
    v_bfe_u32 v7, v1, 1, 2
    v_xor_b32 v7, v7, v2
    v_lshlrev_b32 v7, 4, v7
    v_lshl_add_u32 v7, v1, 6, v7
    v_add_u32 v215, s7, v7
    v_sub_u32 v6, 16, v1
    v_bfe_u32 v7, v6, 1, 2
    v_xor_b32 v7, v7, v2
    v_lshlrev_b32 v7, 4, v7
    v_lshl_add_u32 v7, v6, 6, v7
    v_add_u32 v216, s7, v7
    s_cmp_ge_u32 s3, 4
    s_cbranch_scc1 L_z1
    v_cvt_f32_u32 v6, v1
    v_mul_f32 v6, 0x3b000000, v6
    s_lshl_b32 s6, s3, 2
    v_lshl_add_u32 v7, v2, 6, s6
    v_cvt_f32_u32 v7, v7
    v_mul_f32 v7, v7, v6
    v_mul_f32 v13, 0x41800000, v6
    v_lshlrev_b32 v8, 31, v1
    v_lshrrev_b32 v9, 16, v8
    v_or_b32 v8, v8, v9
    v_cos_f32 v96, v7
    v_sin_f32 v104, v7
    v_add_f32 v9, v7, v13
    v_cos_f32 v97, v9
    v_sin_f32 v105, v9
    v_add_f32 v9, v9, v13
    v_cos_f32 v98, v9
    v_sin_f32 v106, v9
    v_add_f32 v9, v9, v13
    v_cos_f32 v99, v9
    v_sin_f32 v107, v9
    s_nop 0
    v_cvt_pk_bf16_f32 v128, v96, v97
    v_cvt_pk_bf16_f32 v132, -v104, -v105
    v_cvt_pk_bf16_f32 v129, v98, v99
    v_cvt_pk_bf16_f32 v133, -v106, -v107
    v_xor_b32 v130, v128, v8
    v_xor_b32 v134, v132, v8
    v_xor_b32 v131, v129, v8
    v_xor_b32 v135, v133, v8
    v_add_f32 v7, v7, v6
    v_cos_f32 v96, v7
    v_sin_f32 v104, v7
    v_add_f32 v9, v7, v13
    v_cos_f32 v97, v9
    v_sin_f32 v105, v9
    v_add_f32 v9, v9, v13
    v_cos_f32 v98, v9
    v_sin_f32 v106, v9
    v_add_f32 v9, v9, v13
    v_cos_f32 v99, v9
    v_sin_f32 v107, v9
    s_nop 0
    v_cvt_pk_bf16_f32 v140, v96, v97
    v_cvt_pk_bf16_f32 v144, -v104, -v105
    v_cvt_pk_bf16_f32 v141, v98, v99
    v_cvt_pk_bf16_f32 v145, -v106, -v107
    v_xor_b32 v142, v140, v8
    v_xor_b32 v146, v144, v8
    v_xor_b32 v143, v141, v8
    v_xor_b32 v147, v145, v8
    v_add_f32 v7, v7, v6
    v_cos_f32 v96, v7
    v_sin_f32 v104, v7
    v_add_f32 v9, v7, v13
    v_cos_f32 v97, v9
    v_sin_f32 v105, v9
    v_add_f32 v9, v9, v13
    v_cos_f32 v98, v9
    v_sin_f32 v106, v9
    v_add_f32 v9, v9, v13
    v_cos_f32 v99, v9
    v_sin_f32 v107, v9
    s_nop 0
    v_cvt_pk_bf16_f32 v152, v96, v97
    v_cvt_pk_bf16_f32 v156, -v104, -v105
    v_cvt_pk_bf16_f32 v153, v98, v99
    v_cvt_pk_bf16_f32 v157, -v106, -v107
    v_xor_b32 v154, v152, v8
    v_xor_b32 v158, v156, v8
    v_xor_b32 v155, v153, v8
    v_xor_b32 v159, v157, v8
    v_add_f32 v7, v7, v6
    v_cos_f32 v96, v7
    v_sin_f32 v104, v7
    v_add_f32 v9, v7, v13
    v_cos_f32 v97, v9
    v_sin_f32 v105, v9
    v_add_f32 v9, v9, v13
    v_cos_f32 v98, v9
    v_sin_f32 v106, v9
    v_add_f32 v9, v9, v13
    v_cos_f32 v99, v9
    v_sin_f32 v107, v9
    s_nop 0
    v_cvt_pk_bf16_f32 v164, v96, v97
    v_cvt_pk_bf16_f32 v168, -v104, -v105
    v_cvt_pk_bf16_f32 v165, v98, v99
    v_cvt_pk_bf16_f32 v169, -v106, -v107
    v_xor_b32 v166, v164, v8
    v_xor_b32 v170, v168, v8
    v_xor_b32 v167, v165, v8
    v_xor_b32 v171, v169, v8
    v_lshrrev_b32 v6, 1, v1
    v_add_u32 v7, s6, v6
    v_and_b32 v9, 1, v1
    v_lshl_add_u32 v7, v9, 3, v7
    v_cvt_f32_u32 v7, v7
    v_mul_f32 v7, 0x3d000000, v7
    v_cos_f32 v7, v7
    s_nop 0
    v_cvt_pk_bf16_f32 v7, v7, -v7
    v_cmp_eq_u32 vcc, 0, v6
    s_nop 1
    v_cndmask_b32 v136, 0, v7, vcc
    v_cndmask_b32 v137, 0, v7, vcc
    v_cndmask_b32 v138, 0, v7, vcc
    v_cndmask_b32 v139, 0, v7, vcc
    v_cmp_eq_u32 vcc, 1, v6
    s_nop 1
    v_cndmask_b32 v148, 0, v7, vcc
    v_cndmask_b32 v149, 0, v7, vcc
    v_cndmask_b32 v150, 0, v7, vcc
    v_cndmask_b32 v151, 0, v7, vcc
    v_cmp_eq_u32 vcc, 2, v6
    s_nop 1
    v_cndmask_b32 v160, 0, v7, vcc
    v_cndmask_b32 v161, 0, v7, vcc
    v_cndmask_b32 v162, 0, v7, vcc
    v_cndmask_b32 v163, 0, v7, vcc
    v_cmp_eq_u32 vcc, 3, v6
    s_nop 1
    v_cndmask_b32 v172, 0, v7, vcc
    v_cndmask_b32 v173, 0, v7, vcc
    v_cndmask_b32 v174, 0, v7, vcc
    v_cndmask_b32 v175, 0, v7, vcc
L_z1:
    s_waitcnt lgkmcnt(0)
    s_mul_i32 s56, s57, 0x9E3779B1
    s_add_u32 s56, s56, 0x7F4A7C15
    s_cmp_lg_u32 s3, 4
    s_cbranch_scc1 L_z2
    s_lshl_b32 s78, s77, 13
    s_add_u32 s78, s78, 131072
    s_add_u32 s79, s78, 7168
    s_branch L_poll8_1
L_poll8:
    s_sleep 6
L_poll8_1:
    buffer_load_dwordx4 v[32:35], v5, s[36:39], s78 offen sc1
    s_add_u32 s78, s78, 1024
    s_min_u32 s78, s78, s79
    s_waitcnt vmcnt(0)
    v_cmp_ne_u32 vcc, s56, v33
    v_cmp_ne_u32 s[12:13], s56, v35
    s_or_b64 vcc, vcc, s[12:13]
    s_cbranch_vccz L_poll8_ok
    s_sub_u32 s58, s58, 1
    s_cbranch_scc0 L_poll8
    s_mov_b32 s58, 0
L_poll8_ok:
    v_max_u32 v32, v32, v34
    s_nop 1
    v_max_u32_dpp v32, v32, v32 row_ror:8 row_mask:0xf bank_mask:0xf
    s_nop 1
    v_max_u32_dpp v32, v32, v32 row_ror:4 row_mask:0xf bank_mask:0xf
    s_nop 1
    v_max_u32_dpp v32, v32, v32 row_ror:2 row_mask:0xf bank_mask:0xf
    s_nop 1
    v_max_u32_dpp v32, v32, v32 row_ror:1 row_mask:0xf bank_mask:0xf
    v_mov_b32 v33, v32
    s_nop 1
    v_permlane16_swap_b32 v32, v33
    v_max_u32 v32, v32, v33
    v_mov_b32 v33, v32
    s_nop 1
    v_permlane32_swap_b32 v32, v33
    v_max_u32 v32, v32, v33
    v_mov_b32 v9, 33792
    s_mov_b64 exec, 1
    ds_write_b32 v9, v32
    s_mov_b64 exec, -1
    s_waitcnt lgkmcnt(0)
L_z2:
    s_barrier
    v_mov_b32 v9, 33792
    ds_read_b32 v6, v9
    s_cmp_lg_u32 s3, 5
    s_cbranch_scc1 L_z3
    s_lshl_b32 s6, s77, 2
    s_add_u32 s6, s6, 4096
    s_mov_b64 exec, 1
    v_mov_b32 v7, s56
    buffer_store_dword v7, v0, s[36:39], s6 offen sc1
    s_mov_b64 exec, -1
L_z3:
    s_waitcnt lgkmcnt(0)
    v_readfirstlane_b32 s74, v6
    s_andn2_b32 s67, 0xffff, s74
    s_and_b32 s67, s67, 2047
    s_and_b32 s6, s67, 127
    s_cmp_gt_u32 s6, 64
    s_cselect_b32 s76, 1, 0
    s_and_b32 s6, s67, 1087
    s_cmp_eq_u32 s6, 1024
    s_cselect_b32 s76, 1, s76
    s_sub_u32 s6, 2048, s67
    s_cmp_lg_u32 s76, 0
    s_cselect_b32 s6, s6, s67
    s_cmp_eq_u32 s6, 1024
    s_cselect_b32 s6, 0, s6
    s_and_b32 s60, s6, 127
    s_lshr_b32 s61, s6, 10
    s_bfe_u32 s75, s6, 0x30007
    s_lshl3_add_u32 s11, s61, s3
    s_lshl_b32 s11, s11, 7
    s_add_u32 s62, s11, s60
    s_sub_u32 s63, 2048, s62
    s_cmp_eq_u32 s62, 0
    s_cselect_b32 s63, 1024, s63
    s_and_b32 s66, s60, 63
    s_lshl_b32 s6, s62, 10
    s_lshl_b32 s7, s63, 10
    buffer_load_dwordx4 v[16:19], v3, s[32:35], s6 offen
    buffer_load_dwordx4 v[20:23], v3, s[32:35], s7 offen
    global_load_dwordx4 v[24:27], v3, s[16:17]
    global_load_dwordx4 v[28:31], v3, s[24:25]
    v_cmp_gt_u32 vcc, 32, v0
    v_mov_b32 v6, s62
    v_mov_b32 v7, s63
    s_waitcnt vmcnt(0)
    v_cndmask_b32 v6, v7, v6, vcc
    v_dot2_f32_bf16 v12, v16, v24, 0
    v_dot2_f32_bf16 v13, v20, v24, 0
    v_dot2_f32_bf16 v14, v16, v28, 0
    v_dot2_f32_bf16 v15, v20, v28, 0
    v_sub_u32 v6, 0xffff, v6
    s_nop 1
    v_dot2c_f32_bf16 v12, v17, v25
    v_dot2c_f32_bf16 v13, v21, v25
    v_dot2c_f32_bf16 v14, v17, v29
    v_dot2c_f32_bf16 v15, v21, v29
    v_dot2c_f32_bf16 v12, v18, v26
    v_dot2c_f32_bf16 v13, v22, v26
    v_dot2c_f32_bf16 v14, v18, v30
    v_dot2c_f32_bf16 v15, v22, v30
    v_dot2c_f32_bf16 v12, v19, v27
    v_dot2c_f32_bf16 v13, v23, v27
    v_dot2c_f32_bf16 v14, v19, v31
    v_dot2c_f32_bf16 v15, v23, v31
    s_nop 2
    v_permlane32_swap_b32 v12, v13
    v_permlane32_swap_b32 v14, v15
    v_add_f32 v12, v12, v13
    v_add_f32 v14, v14, v15
    s_nop 1
    v_permlane16_swap_b32 v12, v14
    v_add_f32 v12, v12, v14
    s_nop 1
    v_add_f32_dpp v12, v12, v12 row_ror:8 row_mask:0xf bank_mask:0xf
    s_nop 1
    v_add_f32_dpp v12, v12, v12 row_ror:4 row_mask:0xf bank_mask:0xf
    s_nop 1
    v_add_f32_dpp v12, v12, v12 row_ror:2 row_mask:0xf bank_mask:0xf
    s_nop 1
    v_add_f32_dpp v12, v12, v12 row_ror:1 row_mask:0xf bank_mask:0xf
    v_cvt_pk_bf16_f32 v12, v12, v12
    v_and_b32 v12, s14, v12
    v_mul_f32 v13, 0xbfb8aa3b, v12
    v_exp_f32 v13, v13
    s_nop 0
    v_add_f32 v13, 1.0, v13
    v_rcp_f32 v13, v13
    s_nop 0
    v_cvt_pk_bf16_f32 v13, v13, v13
    v_and_b32 v13, s14, v13
    v_sub_f32 v14, 1.0, v13
    v_cvt_pk_bf16_f32 v14, v14, v14
    v_and_b32 v14, s14, v14
    s_nop 0
    v_readlane_b32 s68, v13, 16
    v_readlane_b32 s71, v13, 48
    v_readlane_b32 s72, v14, 16
    v_readlane_b32 s73, v14, 48
    s_xor_b32 s69, s68, 0x80000000
    s_cmp_eq_u32 s62, 0
    s_cselect_b32 s69, 0, s69
    s_cselect_b32 s70, 0, s71
    v_lshlrev_b32 v196, 16, v16
    v_and_b32 v197, s14, v16
    v_lshlrev_b32 v198, 16, v17
    v_and_b32 v199, s14, v17
    v_lshlrev_b32 v200, 16, v18
    v_and_b32 v201, s14, v18
    v_lshlrev_b32 v202, 16, v19
    v_and_b32 v203, s14, v19
    v_mul_f32 v196, s72, v196
    v_mul_f32 v197, s72, v197
    v_mul_f32 v198, s72, v198
    v_mul_f32 v199, s72, v199
    v_mul_f32 v200, s72, v200
    v_mul_f32 v201, s72, v201
    v_mul_f32 v202, s72, v202
    v_mul_f32 v203, s72, v203
    v_lshlrev_b32 v204, 16, v20
    v_and_b32 v205, s14, v20
    v_lshlrev_b32 v206, 16, v21
    v_and_b32 v207, s14, v21
    v_lshlrev_b32 v208, 16, v22
    v_and_b32 v209, s14, v22
    v_lshlrev_b32 v210, 16, v23
    v_and_b32 v211, s14, v23
    v_mul_f32 v204, s73, v204
    v_mul_f32 v205, s73, v205
    v_mul_f32 v206, s73, v206
    v_mul_f32 v207, s73, v207
    v_mul_f32 v208, s73, v208
    v_mul_f32 v209, s73, v209
    v_mul_f32 v210, s73, v210
    v_mul_f32 v211, s73, v211
    s_branch L_zjoin
L_F:
    s_sub_u32 s7, s2, 128
    s_lshr_b32 s7, s7, 3
    s_mul_i32 s60, s6, 7
    s_add_u32 s60, s60, s7
    v_lshrrev_b32 v6, 2, v0
    v_mul_u32_u24 v6, 3584, v6
    v_and_b32 v7, 3, v0
    v_lshl_add_u32 v3, v7, 4, v6
    v_lshrrev_b32 v6, 3, v0
    v_lshlrev_b32 v6, 10, v6
    v_and_b32 v8, 7, v0
    v_lshl_add_u32 v4, v8, 4, v6
    s_mul_i32 s8, s3, 229376
    s_lshl_b32 s9, s60, 6
    s_add_u32 s8, s8, s9
    s_lshl_b32 s9, s60, 15
    s_lshl_b32 s10, s3, 7
    s_add_u32 s9, s9, s10
    s_lshl_b32 s10, s3, 13
    s_mov_b32 m0, s10
    s_mov_b32 s46, 0x1c0000
    s_mov_b32 s47, 0x20000
    s_mov_b32 s50, 0x1c0000
    s_mov_b32 s51, 0x20000
    s_mov_b32 s54, 0x1c0000
    s_mov_b32 s55, 0x20000
    s_waitcnt lgkmcnt(0)
    s_mov_b32 s44, s18
    s_mov_b32 s45, s19
    s_mov_b32 s48, s20
    s_mov_b32 s49, s21
    s_mov_b32 s52, s22
    s_mov_b32 s53, s23
    s_nop 0
    buffer_load_dwordx4 v3, s[44:47], s8 offen lds
    s_add_u32 m0, s10, 4096
    s_nop 0
    buffer_load_dwordx4 v3, s[48:51], s8 offen lds
    s_add_u32 m0, s10, 1024
    s_add_u32 s8, s8, 57344
    buffer_load_dwordx4 v3, s[44:47], s8 offen lds
    s_add_u32 m0, s10, 5120
    s_nop 0
    buffer_load_dwordx4 v3, s[48:51], s8 offen lds
    s_add_u32 m0, s10, 2048
    s_add_u32 s8, s8, 57344
    buffer_load_dwordx4 v3, s[44:47], s8 offen lds
    s_add_u32 m0, s10, 6144
    s_nop 0
    buffer_load_dwordx4 v3, s[48:51], s8 offen lds
    s_add_u32 m0, s10, 3072
    s_add_u32 s8, s8, 57344
    buffer_load_dwordx4 v3, s[44:47], s8 offen lds
    s_add_u32 m0, s10, 7168
    s_nop 0
    buffer_load_dwordx4 v3, s[48:51], s8 offen lds
    s_lshl_b32 s11, s3, 12
    s_add_u32 m0, s11, 65536
    s_nop 0
    buffer_load_dwordx4 v4, s[52:55], s9 offen lds
    s_add_u32 m0, s11, 66560
    s_add_u32 s9, s9, 8192
    buffer_load_dwordx4 v4, s[52:55], s9 offen lds
    s_add_u32 m0, s11, 67584
    s_add_u32 s9, s9, 8192
    buffer_load_dwordx4 v4, s[52:55], s9 offen lds
    s_add_u32 m0, s11, 68608
    s_add_u32 s9, s9, 8192
    buffer_load_dwordx4 v4, s[52:55], s9 offen lds
    s_load_dword s57, s[30:31], 0
    s_mov_b32 s36, s30
    s_mov_b32 s37, s31
    v_bfe_u32 v6, v0, 2, 2
    v_lshlrev_b32 v8, 3, v7
    v_lshl_add_u32 v9, v6, 6, v8
    v_and_b32 v10, 1, v2
    v_lshl_add_u32 v9, v10, 5, v9
    v_lshrrev_b32 v10, 1, v2
    v_lshl_add_u32 v9, v10, 12, v9
    v_add_u32 v9, s10, v9
    v_lshl_add_u32 v10, v6, 7, v8
    v_lshl_add_u32 v10, v2, 5, v10
    s_add_u32 s11, s11, 65536
    v_add_u32 v10, s11, v10
    v_lshlrev_b32 v5, 4, v0
    v_lshlrev_b32 v11, 2, v0
    v_add_u32 v11, 98304, v11
    s_lshl_b32 s11, s3, 8
    v_add_u32 v12, s11, v11
    v_lshlrev_b32 v13, 3, v0
    s_and_b32 s78, s2, 7
    s_lshl_b32 s78, s78, 13
    s_add_u32 s78, s78, 65536
    s_add_u32 s79, s78, 7168
    s_waitcnt vmcnt(4) lgkmcnt(0)
    s_mul_i32 s56, s57, 0x9E3779B1
    s_add_u32 s56, s56, 0x7F4A7C15
    ds_read_b64_tr_b16 v[32:33], v9 offset:0
    ds_read_b64_tr_b16 v[34:35], v9 offset:256
    ds_read_b64_tr_b16 v[36:37], v9 offset:512
    ds_read_b64_tr_b16 v[38:39], v9 offset:768
    ds_read_b64_tr_b16 v[40:41], v9 offset:1024
    ds_read_b64_tr_b16 v[42:43], v9 offset:1280
    ds_read_b64_tr_b16 v[44:45], v9 offset:1536
    ds_read_b64_tr_b16 v[46:47], v9 offset:1792
    ds_read_b64_tr_b16 v[48:49], v9 offset:2048
    ds_read_b64_tr_b16 v[50:51], v9 offset:2304
    ds_read_b64_tr_b16 v[52:53], v9 offset:2560
    ds_read_b64_tr_b16 v[54:55], v9 offset:2816
    ds_read_b64_tr_b16 v[56:57], v9 offset:3072
    ds_read_b64_tr_b16 v[58:59], v9 offset:3328
    s_waitcnt lgkmcnt(4)
    ds_read_b64_tr_b16 v[60:61], v9 offset:3584
    ds_read_b64_tr_b16 v[62:63], v9 offset:3840
    s_waitcnt vmcnt(0)
    ds_read_b64_tr_b16 v[64:65], v10 offset:0
    ds_read_b64_tr_b16 v[66:67], v10 offset:512
    ds_read_b64_tr_b16 v[68:69], v10 offset:1024
    ds_read_b64_tr_b16 v[70:71], v10 offset:1536
    ds_read_b64_tr_b16 v[72:73], v10 offset:2048
    ds_read_b64_tr_b16 v[74:75], v10 offset:2560
    ds_read_b64_tr_b16 v[76:77], v10 offset:3072
    ds_read_b64_tr_b16 v[78:79], v10 offset:3584
    v_mov_b32 v14, 100352
    s_cmp_lg_u32 s3, 0
    s_cbranch_scc1 L_f1
L_poll9:
    buffer_load_dwordx4 v[16:19], v5, s[36:39], s78 offen sc1
    s_add_u32 s78, s78, 1024
    s_min_u32 s78, s78, s79
    s_waitcnt vmcnt(0)
    v_cmp_ne_u32 vcc, s56, v17
    v_cmp_ne_u32 s[12:13], s56, v19
    s_or_b64 vcc, vcc, s[12:13]
    s_cbranch_vccz L_poll9_ok
    s_sub_u32 s58, s58, 1
    s_cbranch_scc0 L_poll9
    s_mov_b32 s58, 0
L_poll9_ok:
    v_max_u32 v16, v16, v18
    s_nop 1
    v_max_u32_dpp v16, v16, v16 row_ror:8 row_mask:0xf bank_mask:0xf
    s_nop 1
    v_max_u32_dpp v16, v16, v16 row_ror:4 row_mask:0xf bank_mask:0xf
    s_nop 1
    v_max_u32_dpp v16, v16, v16 row_ror:2 row_mask:0xf bank_mask:0xf
    s_nop 1
    v_max_u32_dpp v16, v16, v16 row_ror:1 row_mask:0xf bank_mask:0xf
    v_mov_b32 v17, v16
    s_nop 1
    v_permlane16_swap_b32 v16, v17
    v_max_u32 v16, v16, v17
    v_mov_b32 v17, v16
    s_nop 1
    v_permlane32_swap_b32 v16, v17
    v_max_u32 v16, v16, v17
    s_mov_b64 exec, 1
    ds_write_b32 v14, v16
    s_mov_b64 exec, -1
L_f1:
    s_waitcnt lgkmcnt(0)
    s_barrier
    ds_read_b32 v16, v14
    s_mul_i32 s8, s3, 28672
    s_lshl_b32 s9, s60, 9
    s_add_u32 s8, s8, s9
    s_add_u32 s8, s8, 262144
    s_lshl_b32 s7, s3, 7
    s_waitcnt lgkmcnt(0)
    v_readfirstlane_b32 s6, v16
    s_andn2_b32 s6, 2047, s6
    s_lshl_b32 s6, s6, 10
    s_add_u32 s6, s6, s7
    s_load_dwordx16 s[64:79], s[4:5], s6
    s_load_dwordx16 s[80:95], s[4:5], s6 offset:64
    v_mov_b32 v16, 0
    v_mov_b32 v17, 0
    v_mov_b32 v18, 0
    v_mov_b32 v19, 0
    s_waitcnt lgkmcnt(0)
    v_dot2c_f32_bf16 v16, s64, v32
    v_dot2c_f32_bf16 v17, s65, v33
    v_dot2c_f32_bf16 v18, s66, v34
    v_dot2c_f32_bf16 v19, s67, v35
    v_dot2c_f32_bf16 v16, s68, v36
    v_dot2c_f32_bf16 v17, s69, v37
    v_dot2c_f32_bf16 v18, s70, v38
    v_dot2c_f32_bf16 v19, s71, v39
    v_dot2c_f32_bf16 v16, s72, v40
    v_dot2c_f32_bf16 v17, s73, v41
    v_dot2c_f32_bf16 v18, s74, v42
    v_dot2c_f32_bf16 v19, s75, v43
    v_dot2c_f32_bf16 v16, s76, v44
    v_dot2c_f32_bf16 v17, s77, v45
    v_dot2c_f32_bf16 v18, s78, v46
    v_dot2c_f32_bf16 v19, s79, v47
    v_dot2c_f32_bf16 v16, s80, v48
    v_dot2c_f32_bf16 v17, s81, v49
    v_dot2c_f32_bf16 v18, s82, v50
    v_dot2c_f32_bf16 v19, s83, v51
    v_dot2c_f32_bf16 v16, s84, v52
    v_dot2c_f32_bf16 v17, s85, v53
    v_dot2c_f32_bf16 v18, s86, v54
    v_dot2c_f32_bf16 v19, s87, v55
    v_dot2c_f32_bf16 v16, s88, v56
    v_dot2c_f32_bf16 v17, s89, v57
    v_dot2c_f32_bf16 v18, s90, v58
    v_dot2c_f32_bf16 v19, s91, v59
    v_dot2c_f32_bf16 v16, s92, v60
    v_dot2c_f32_bf16 v17, s93, v61
    v_dot2c_f32_bf16 v18, s94, v62
    v_dot2c_f32_bf16 v19, s95, v63
    s_nop 1
    v_add_f32 v16, v16, v17
    v_add_f32 v18, v18, v19
    v_add_f32 v16, v16, v18
    ds_write_b32 v12, v16
    s_waitcnt lgkmcnt(0)
    s_barrier
    ds_read2st64_b32 v[16:17], v11 offset0:0 offset1:1
    ds_read2st64_b32 v[18:19], v11 offset0:2 offset1:3
    ds_read2st64_b32 v[20:21], v11 offset0:4 offset1:5
    ds_read2st64_b32 v[22:23], v11 offset0:6 offset1:7
    s_waitcnt lgkmcnt(2)
    v_add_f32 v16, v16, v17
    v_add_f32 v18, v18, v19
    s_waitcnt lgkmcnt(0)
    v_add_f32 v20, v20, v21
    v_add_f32 v22, v22, v23
    v_add_f32 v16, v16, v18
    v_add_f32 v20, v20, v22
    v_add_f32 v16, v16, v20
    v_cvt_pk_bf16_f32 v16, v16, v16
    v_and_b32 v16, s14, v16
    v_mov_b32 v18, v16
    v_mul_f32 v17, 0xbfb8aa3b, v16
    v_exp_f32 v17, v17
    s_nop 0
    v_add_f32 v17, 1.0, v17
    v_rcp_f32 v17, v17
    s_nop 0
    v_permlane32_swap_b32 v18, v16
    v_mul_f32 v17, v17, v18
    v_cvt_pk_bf16_f32 v17, v17, v17
    v_and_b32 v17, s14, v17
    v_mul_f32 v17, v17, v16
    s_nop 1
    v_mov_b32_dpp v18, v17 quad_perm:[1,0,3,2] row_mask:0xf bank_mask:0xf
    v_cvt_pk_bf16_f32 v17, v17, v18
    v_mov_b32 v20, 0
    v_mov_b32 v21, 0
    v_mov_b32 v22, 0
    v_mov_b32 v23, 0
    v_readlane_b32 s64, v17, 0
    v_readlane_b32 s65, v17, 2
    v_readlane_b32 s66, v17, 4
    v_readlane_b32 s67, v17, 6
    v_readlane_b32 s68, v17, 8
    v_readlane_b32 s69, v17, 10
    v_readlane_b32 s70, v17, 12
    v_readlane_b32 s71, v17, 14
    v_readlane_b32 s72, v17, 16
    v_readlane_b32 s73, v17, 18
    v_readlane_b32 s74, v17, 20
    v_readlane_b32 s75, v17, 22
    v_readlane_b32 s76, v17, 24
    v_readlane_b32 s77, v17, 26
    v_readlane_b32 s78, v17, 28
    v_readlane_b32 s79, v17, 30
    v_dot2c_f32_bf16 v20, s64, v64
    v_dot2c_f32_bf16 v21, s65, v65
    v_dot2c_f32_bf16 v22, s66, v66
    v_dot2c_f32_bf16 v23, s67, v67
    v_dot2c_f32_bf16 v20, s68, v68
    v_dot2c_f32_bf16 v21, s69, v69
    v_dot2c_f32_bf16 v22, s70, v70
    v_dot2c_f32_bf16 v23, s71, v71
    v_dot2c_f32_bf16 v20, s72, v72
    v_dot2c_f32_bf16 v21, s73, v73
    v_dot2c_f32_bf16 v22, s74, v74
    v_dot2c_f32_bf16 v23, s75, v75
    v_dot2c_f32_bf16 v20, s76, v76
    v_dot2c_f32_bf16 v21, s77, v77
    v_dot2c_f32_bf16 v22, s78, v78
    v_dot2c_f32_bf16 v23, s79, v79
    v_mov_b32 v25, s56
    s_nop 0
    v_add_f32 v20, v20, v21
    v_add_f32 v22, v22, v23
    v_add_f32 v24, v20, v22
    buffer_store_dwordx2 v[24:25], v13, s[36:39], s8 offen sc1
    s_add_u32 s8, s8, 229376
    buffer_store_dwordx2 v[24:25], v13, s[36:39], s8 offen sc1
    s_endpgm
L_end:
    s_endpgm
.section .rodata,"a"
.p2align 6
.amdhsa_kernel gated_mix__spectral_fnet__moe_arch_mod__prompt_kernel
  .amdhsa_next_free_vgpr 220
  .amdhsa_next_free_sgpr 100
  .amdhsa_accum_offset 220
  .amdhsa_group_segment_fixed_size 0
  .amdhsa_kernarg_size 112
  .amdhsa_user_sgpr_count 2
  .amdhsa_user_sgpr_kernarg_segment_ptr 1
  .amdhsa_system_sgpr_workgroup_id_x 1
.end_amdhsa_kernel
```

```asm
; @launch grid=(256,1,1) block=(576,1,1) lds=86016
.amdgcn_target "amdgcn-amd-amdhsa--gfx950"
.text
.globl gated_mix__spectral_fnet__moe_arch_mod__prompt_kernel
.p2align 8
.type gated_mix__spectral_fnet__moe_arch_mod__prompt_kernel,@function
gated_mix__spectral_fnet__moe_arch_mod__prompt_kernel:
    s_load_dwordx2 s[4:5], s[0:1], 0
    s_load_dwordx16 s[16:31], s[0:1], 48
    v_lshrrev_b32 v1, 6, v0
    v_and_b32 v0, 63, v0
    v_readfirstlane_b32 s3, v1
    v_and_b32 v1, 15, v0
    v_lshrrev_b32 v2, 4, v0
    s_and_b32 s6, s2, 7
    s_sub_u32 s3, s3, 1
    s_min_u32 s3, s3, 8
    s_lshr_b32 s7, s2, 3
    s_cmp_ge_u32 s2, 128
    s_cbranch_scc1 L_notA
    s_add_u32 s8, s6, 1
    s_sub_u32 s9, 15, s6
    s_cmp_eq_u32 s3, 8
    s_cbranch_scc1 L_ah
    s_and_b32 s57, s7, 1
    s_bitcmp1_b32 s7, 1
    s_cselect_b32 s10, s9, s8
    s_lshr_b32 s11, s7, 2
    s_lshl4_add_u32 s56, s11, s10
    v_and_b32 v6, 1, v2
    v_lshlrev_b32 v6, 5, v6
    v_lshl_add_u32 v6, v1, 6, v6
    v_lshrrev_b32 v7, 1, v2
    v_lshl_add_u32 v3, v7, 4, v6
    s_cmp_lg_u32 s6, 7
    s_cbranch_scc1 L_k7
    s_lshr_b32 s11, s7, 1
    s_lshl3_add_u32 s56, s11, 8
    s_mov_b32 s8, 0
    s_cmp_eq_u32 s2, 127
    s_cselect_b32 s56, 0, s56
    s_cselect_b32 s57, 0, s57
L_k7:
    s_lshl3_add_u32 s11, s57, s3
    s_lshl_b32 s11, s11, 7
    s_add_u32 s58, s11, s56
    s_sub_u32 s59, 2048, s58
    s_cmp_eq_u32 s58, 0
    s_cselect_b32 s59, 1024, s59
    s_lshl_b32 s10, s58, 10
    s_lshl_b32 s11, s59, 10
    v_add_u32 v6, s10, v3
    v_add_u32 v7, s11, v3
    s_waitcnt lgkmcnt(0)
    global_load_dwordx4 v[16:19], v6, s[4:5]
    global_load_dwordx4 v[20:23], v7, s[4:5]
    s_bitcmp1_b32 s7, 3
    s_cselect_b32 s8, s9, s8
    s_and_b32 s9, s7, 7
    s_lshl3_add_u32 s51, s8, s9
    s_lshl_b32 s35, s8, 5
    s_add_u32 s35, s35, s9
    s_lshl_b32 s35, s35, 6
    s_lshl_b32 s10, s3, 11
    s_add_u32 s11, s10, s51
    s_lshl_b32 s11, s11, 7
    s_mov_b32 m0, s10
    v_and_b32 v9, 7, v0
    v_bfe_u32 v13, v0, 4, 1
    v_xor_b32 v9, v9, v13
    v_lshrrev_b32 v13, 3, v0
    v_lshl_add_u32 v9, v9, 4, s11
    v_lshl_add_u32 v13, v13, 14, v9
    global_load_lds_dwordx4 v13, s[4:5]
    s_add_u32 m0, s10, 1024
    v_add_u32 v13, 0x20000, v13
    global_load_lds_dwordx4 v13, s[4:5]
    s_lshr_b32 s6, s3, 2
    s_and_b32 s7, s3, 1
    s_bfe_u32 s8, s3, 0x10001
    v_lshl_add_u32 v6, s6, 4, v1
    s_lshl3_add_u32 s9, s8, s7
    s_lshl_b32 s9, s9, 2
    v_cvt_f32_u32 v6, v6
    v_lshl_add_u32 v7, v2, 3, s9
    v_mul_f32 v6, 0x3c000000, v6
    v_cvt_f32_u32 v7, v7
    v_lshlrev_b32 v5, 4, v0
    v_mul_f32 v7, v7, v6
    v_cos_f32 v96, v7
    v_sin_f32 v100, v7
    v_add_f32 v7, v7, v6
    v_cos_f32 v97, v7
    v_sin_f32 v101, v7
    v_add_f32 v7, v7, v6
    v_cos_f32 v98, v7
    v_sin_f32 v102, v7
    v_add_f32 v7, v7, v6
    v_cos_f32 v99, v7
    v_sin_f32 v103, v7
    s_lshl_b32 s10, s6, 13
    s_lshl_b32 s11, s8, 10
    s_lshl3_add_u32 s11, s7, s11
    v_add_u32 v15, s10, v5
    v_add_u32 v9, s11, v15
    v_cvt_pk_bf16_f32 v104, v96, v97
    v_cvt_pk_bf16_f32 v105, v98, v99
    v_cvt_pk_bf16_f32 v106, -v100, -v101
    v_cvt_pk_bf16_f32 v107, -v102, -v103
    v_cmp_eq_f32 vcc, 0, v6
    v_cvt_pk_bf16_f32 v108, v96, -v101
    v_cvt_pk_bf16_f32 v109, -v98, v103
    v_cvt_pk_bf16_f32 v110, -v100, -v97
    v_cvt_pk_bf16_f32 v111, v102, v99
    ds_write_b64 v9, v[104:105] offset:16384
    ds_write_b64 v9, v[108:109] offset:20480
    ds_write_b64 v9, v[110:111] offset:22528
    s_mov_b64 exec, vcc
    v_mov_b32 v106, 0xbf803f80
    v_mov_b32 v107, 0xbf803f80
    s_mov_b64 exec, -1
    ds_write_b64 v9, v[106:107] offset:18432
    s_sub_u32 s10, 0xffff, s58
    s_sub_u32 s11, 0xffff, s59
    v_mov_b32 v4, s10
    v_writelane_b32 v4, s11, 32
    s_lshl3_add_u32 s10, s3, 33792
    v_lshrrev_b32 v9, 3, v0
    v_add_u32 v9, s10, v9
    v_mov_b32 v12, 0
    v_mov_b32 v13, 0
    s_barrier
    ds_read_b128 v[24:27], v3 offset:44672
    s_waitcnt vmcnt(2) lgkmcnt(0)
    v_dot2c_f32_bf16 v12, v16, v24
    v_dot2c_f32_bf16 v13, v20, v24
    v_dot2c_f32_bf16 v12, v17, v25
    v_dot2c_f32_bf16 v13, v21, v25
    v_dot2c_f32_bf16 v12, v18, v26
    v_dot2c_f32_bf16 v13, v22, v26
    v_dot2c_f32_bf16 v12, v19, v27
    v_dot2c_f32_bf16 v13, v23, v27
    s_nop 2
    v_permlane32_swap_b32 v12, v13
    v_add_f32 v12, v12, v13
    v_mov_b32 v13, v12
    s_nop 1
    v_permlane16_swap_b32 v12, v13
    v_add_f32 v12, v12, v13
    s_nop 1
    v_add_f32_dpp v12, v12, v12 row_ror:8 row_mask:0xf bank_mask:0xf
    s_nop 1
    v_add_f32_dpp v12, v12, v12 row_ror:4 row_mask:0xf bank_mask:0xf
    s_nop 1
    v_add_f32_dpp v12, v12, v12 row_ror:2 row_mask:0xf bank_mask:0xf
    s_nop 1
    v_add_f32_dpp v12, v12, v12 row_ror:1 row_mask:0xf bank_mask:0xf
    v_cvt_pk_bf16_f32 v12, v12, v12
    v_and_b32 v12, 0xffff0000, v12
    v_ashrrev_i32 v7, 31, v12
    v_or_b32 v7, 0x80000000, v7
    v_xor_b32 v7, v7, v12
    v_and_b32 v7, 0xffff0000, v7
    v_or_b32 v7, v7, v4
    s_mov_b32 exec_lo, 1
    s_mov_b32 exec_hi, 1
    ds_write_b32 v9, v7
    s_mov_b64 exec, -1
    s_waitcnt lgkmcnt(0)
    s_barrier
    ds_read_b128 v[32:35], v15 offset:16384
    ds_read_b128 v[36:39], v15 offset:17408
    ds_read_b128 v[48:51], v15 offset:18432
    ds_read_b128 v[52:55], v15 offset:19456
    ds_read_b128 v[64:67], v15 offset:20480
    ds_read_b128 v[68:71], v15 offset:21504
    ds_read_b128 v[80:83], v15 offset:22528
    ds_read_b128 v[84:87], v15 offset:23552
    v_lshlrev_b32 v8, 31, v1
    v_lshrrev_b32 v9, 16, v8
    v_or_b32 v8, v8, v9
    v_bfe_u32 v6, v0, 2, 2
    v_lshl_add_u32 v7, v2, 3, v6
    v_and_b32 v9, 3, v0
    v_lshl_add_u32 v9, v9, 1, s8
    v_lshrrev_b32 v6, 1, v6
    v_xor_b32 v9, v9, v6
    s_lshl_b32 s7, s7, 3
    v_lshl_add_u32 v9, v9, 4, s7
    v_lshl_add_u32 v10, v7, 7, v9
    s_waitcnt lgkmcnt(6)
    v_xor_b32 v40, v32, v8
    v_xor_b32 v41, v33, v8
    v_xor_b32 v42, v34, v8
    v_xor_b32 v43, v35, v8
    v_xor_b32 v44, v36, v8
    v_xor_b32 v45, v37, v8
    v_xor_b32 v46, v38, v8
    v_xor_b32 v47, v39, v8
    s_waitcnt lgkmcnt(4)
    v_xor_b32 v56, v48, v8
    v_xor_b32 v57, v49, v8
    v_xor_b32 v58, v50, v8
    v_xor_b32 v59, v51, v8
    v_xor_b32 v60, v52, v8
    v_xor_b32 v61, v53, v8
    v_xor_b32 v62, v54, v8
    v_xor_b32 v63, v55, v8
    s_waitcnt lgkmcnt(2)
    v_xor_b32 v72, v64, v8
    v_xor_b32 v73, v65, v8
    v_xor_b32 v74, v66, v8
    v_xor_b32 v75, v67, v8
    v_xor_b32 v76, v68, v8
    v_xor_b32 v77, v69, v8
    v_xor_b32 v78, v70, v8
    v_xor_b32 v79, v71, v8
    s_waitcnt lgkmcnt(0)
    v_xor_b32 v88, v80, v8
    v_xor_b32 v89, v81, v8
    v_xor_b32 v90, v82, v8
    v_xor_b32 v91, v83, v8
    v_xor_b32 v92, v84, v8
    v_xor_b32 v93, v85, v8
    v_xor_b32 v94, v86, v8
    v_xor_b32 v95, v87, v8
    ds_read_b128 v[24:27], v3 offset:45696
    s_waitcnt vmcnt(0)
    s_barrier
    ds_read_b64_tr_b16 v[96:97], v10 offset:0
    ds_read_b64_tr_b16 v[98:99], v10 offset:512
    ds_read_b64_tr_b16 v[100:101], v10 offset:4096
    ds_read_b64_tr_b16 v[102:103], v10 offset:4608
    ds_read_b64_tr_b16 v[104:105], v10 offset:8192
    ds_read_b64_tr_b16 v[106:107], v10 offset:8704
    ds_read_b64_tr_b16 v[108:109], v10 offset:12288
    ds_read_b64_tr_b16 v[110:111], v10 offset:12800
    s_mov_b32 s36, s30
    s_mov_b32 s37, s31
    s_mov_b32 s38, 0x1000000
    s_mov_b32 s39, 0x20000
    s_mov_b32 s65, 0
    v_mul_u32_u24 v11, 33024, v1
    v_lshl_add_u32 v11, v2, 4, v11
    s_mul_i32 s48, s6, 528384
    s_add_u32 s48, s48, s35
    s_and_b32 s10, s3, 3
    s_lshl_b32 s10, s10, 9
    s_add_u32 s48, s48, s10
    s_add_u32 s48, s48, 2097152
    s_add_u32 s49, s48, 1056768
    s_mov_b32 s55, 0
    s_waitcnt lgkmcnt(6)
    v_mfma_f32_16x16x32_bf16 v[112:115], v[96:99], v[32:35], 0
    v_mfma_f32_16x16x32_bf16 v[116:119], v[96:99], v[48:51], 0
    v_mfma_f32_16x16x32_bf16 v[120:123], v[96:99], v[64:67], 0
    v_mfma_f32_16x16x32_bf16 v[124:127], v[96:99], v[80:83], 0
    s_waitcnt lgkmcnt(4)
    v_mfma_f32_16x16x32_bf16 v[112:115], v[100:103], v[36:39], v[112:115]
    v_mfma_f32_16x16x32_bf16 v[116:119], v[100:103], v[52:55], v[116:119]
    v_mfma_f32_16x16x32_bf16 v[120:123], v[100:103], v[68:71], v[120:123]
    v_mfma_f32_16x16x32_bf16 v[124:127], v[100:103], v[84:87], v[124:127]
    s_waitcnt lgkmcnt(2)
    v_mfma_f32_16x16x32_bf16 v[112:115], v[104:107], v[40:43], v[112:115]
    v_mfma_f32_16x16x32_bf16 v[116:119], v[104:107], v[56:59], v[116:119]
    v_mfma_f32_16x16x32_bf16 v[120:123], v[104:107], v[72:75], v[120:123]
    v_mfma_f32_16x16x32_bf16 v[124:127], v[104:107], v[88:91], v[124:127]
    s_waitcnt lgkmcnt(0)
    v_mfma_f32_16x16x32_bf16 v[112:115], v[108:111], v[44:47], v[112:115]
    v_mfma_f32_16x16x32_bf16 v[116:119], v[108:111], v[60:63], v[116:119]
    v_mfma_f32_16x16x32_bf16 v[120:123], v[108:111], v[76:79], v[120:123]
    v_mfma_f32_16x16x32_bf16 v[124:127], v[108:111], v[92:95], v[124:127]
    v_mov_b32 v12, 0
    v_mov_b32 v13, 0
    s_nop 3
    v_cvt_pk_bf16_f32 v96, v112, v116
    v_cvt_pk_bf16_f32 v97, v113, v117
    v_cvt_pk_bf16_f32 v98, v114, v118
    v_cvt_pk_bf16_f32 v99, v115, v119
    buffer_store_dwordx4 v[96:99], v11, s[36:39], s48 offen sc1
    v_cvt_pk_bf16_f32 v100, v120, v124
    v_cvt_pk_bf16_f32 v101, v121, v125
    v_cvt_pk_bf16_f32 v102, v122, v126
    v_cvt_pk_bf16_f32 v103, v123, v127
    buffer_store_dwordx4 v[100:103], v11, s[36:39], s49 offen sc1
    s_mov_b32 s40, s26
    s_mov_b32 s41, s27
    s_mov_b32 s42, 0x200000
    s_mov_b32 s43, 0x20000
    s_cmp_ge_u32 s3, 4
    s_cbranch_scc1 L_hi0
    v_lshlrev_b32 v6, 4, v1
    v_lshl_add_u32 v10, v2, 13, v6
    v_mul_u32_u24 v6, 4352, v2
    v_bfe_u32 v7, v1, 1, 2
    v_xor_b32 v7, s3, v7
    v_lshl_add_u32 v7, v7, 4, v6
    v_lshl_add_u32 v11, v1, 6, v7
    s_lshl4_add_u32 s7, s3, 1024
    v_mov_b32 v9, 17536
    v_lshl_add_u32 v28, v0, 1, v9
    v_lshl_add_u32 v7, v1, 1, s7
    s_mov_b32 exec_lo, 0x00ff00ff
    s_mov_b32 exec_hi, 0x00ff00ff
    v_add_u32 v28, v7, v6
    s_mov_b64 exec, -1
    v_lshrrev_b32 v6, 1, v1
    s_lshl_b32 s6, s57, 10
    s_add_u32 s6, s6, s56
    v_lshl_add_u32 v6, v6, 7, s6
    v_and_b32 v7, 1, v1
    v_lshlrev_b32 v9, 9, v7
    s_cmp_lg_u32 s56, 0
    s_cbranch_scc1 L_g01
    s_mov_b32 exec_lo, 0x00020002
    s_mov_b32 exec_hi, 0x00020002
    v_mov_b32 v6, 0x400
    v_mov_b32 v9, 0
    s_mov_b64 exec, -1
L_g01:
    v_lshlrev_b32 v7, 2, v2
    v_mad_u32_u24 v9, v7, v6, v9
    v_cvt_f32_u32 v6, v6
    v_cvt_f32_u32 v9, v9
    v_mul_f32 v6, 0x3a000000, v6
    v_mul_f32 v9, 0x3a000000, v9
    v_cos_f32 v64, v9
    v_sin_f32 v68, v9
    v_add_f32 v9, v9, v6
    v_cos_f32 v65, v9
    v_sin_f32 v69, v9
    v_add_f32 v9, v9, v6
    v_cos_f32 v66, v9
    v_sin_f32 v70, v9
    v_add_f32 v9, v9, v6
    v_cos_f32 v67, v9
    v_sin_f32 v71, v9
    s_and_b32 s7, s56, 63
    s_mul_i32 s32, s7, 33024
    v_cvt_pk_bf16_f32 v148, v64, v68
    v_cvt_pk_bf16_f32 v149, v65, v69
    v_cvt_pk_bf16_f32 v150, v66, v70
    v_cvt_pk_bf16_f32 v151, v67, v71
    s_cmp_lg_u32 s7, 0
    s_cbranch_scc1 L_gd2
    s_lshr_b32 s7, s56, 2
    v_and_b32 v148, 0xffff, v148
    v_lshlrev_b32 v148, s7, v148
    v_and_b32 v149, 0xffff, v149
    v_lshlrev_b32 v149, s7, v149
    v_and_b32 v150, 0xffff, v150
    v_lshlrev_b32 v150, s7, v150
    v_and_b32 v151, 0xffff, v151
    v_lshlrev_b32 v151, s7, v151
L_gd2:
    s_lshl_b32 s7, s3, 9
    s_add_u32 s32, s32, s7
    s_add_u32 s32, s32, 2097152
    s_add_u32 s33, s32, 4096
    v_dot2c_f32_bf16 v12, v16, v24
    v_dot2c_f32_bf16 v13, v20, v24
    v_dot2c_f32_bf16 v12, v17, v25
    v_dot2c_f32_bf16 v13, v21, v25
    v_dot2c_f32_bf16 v12, v18, v26
    v_dot2c_f32_bf16 v13, v22, v26
    v_dot2c_f32_bf16 v12, v19, v27
    v_dot2c_f32_bf16 v13, v23, v27
    s_nop 2
    v_permlane32_swap_b32 v12, v13
    v_add_f32 v12, v12, v13
    v_mov_b32 v13, v12
    s_nop 1
    v_permlane16_swap_b32 v12, v13
    v_add_f32 v12, v12, v13
    s_nop 1
    v_add_f32_dpp v12, v12, v12 row_ror:8 row_mask:0xf bank_mask:0xf
    s_nop 1
    v_add_f32_dpp v12, v12, v12 row_ror:4 row_mask:0xf bank_mask:0xf
    s_nop 1
    v_add_f32_dpp v12, v12, v12 row_ror:2 row_mask:0xf bank_mask:0xf
    s_nop 1
    v_add_f32_dpp v12, v12, v12 row_ror:1 row_mask:0xf bank_mask:0xf
    v_cvt_pk_bf16_f32 v12, v12, v12
    v_and_b32 v12, 0xffff0000, v12
    v_mul_f32 v13, 0xbfb8aa3b, v12
    v_exp_f32 v13, v13
    s_nop 0
    v_add_f32 v13, 1.0, v13
    v_rcp_f32 v13, v13
    s_nop 0
    v_cvt_pk_bf16_f32 v13, v13, v13
    v_and_b32 v13, 0xffff0000, v13
    v_sub_f32 v14, 1.0, v13
    v_cvt_pk_bf16_f32 v14, v14, v14
    v_and_b32 v14, 0xffff0000, v14
    v_readlane_b32 s6, v13, 0
    v_readlane_b32 s7, v13, 32
    v_readlane_b32 s8, v14, 0
    v_readlane_b32 s9, v14, 32
    s_xor_b32 s10, s6, 0x80000000
    s_cmp_eq_u32 s58, 0
    s_cselect_b32 s10, 0, s10
    s_cselect_b32 s11, 0, s7
    v_mov_b32 v24, s6
    v_mov_b32 v25, s10
    v_mov_b32 v26, s11
    v_mov_b32 v27, s7
    v_mov_b32 v13, s8
    v_mov_b32 v14, s9
    v_permlane16_swap_b32 v16, v18
    v_permlane16_swap_b32 v17, v19
    v_permlane16_swap_b32 v20, v22
    v_permlane16_swap_b32 v21, v23
    v_lshlrev_b32 v152, 16, v16
    v_and_b32 v153, 0xffff0000, v16
    v_lshlrev_b32 v154, 16, v17
    v_and_b32 v155, 0xffff0000, v17
    v_lshlrev_b32 v156, 16, v18
    v_and_b32 v157, 0xffff0000, v18
    v_lshlrev_b32 v158, 16, v19
    v_and_b32 v159, 0xffff0000, v19
    v_mul_f32 v152, v13, v152
    v_mul_f32 v153, v13, v153
    v_mul_f32 v154, v13, v154
    v_mul_f32 v155, v13, v155
    v_mul_f32 v156, v13, v156
    v_mul_f32 v157, v13, v157
    v_mul_f32 v158, v13, v158
    v_mul_f32 v159, v13, v159
    v_lshlrev_b32 v160, 16, v20
    v_and_b32 v161, 0xffff0000, v20
    v_lshlrev_b32 v162, 16, v21
    v_and_b32 v163, 0xffff0000, v21
    v_lshlrev_b32 v164, 16, v22
    v_and_b32 v165, 0xffff0000, v22
    v_lshlrev_b32 v166, 16, v23
    v_and_b32 v167, 0xffff0000, v23
    v_mul_f32 v160, v14, v160
    v_mul_f32 v161, v14, v161
    v_mul_f32 v162, v14, v162
    v_mul_f32 v163, v14, v163
    v_mul_f32 v164, v14, v164
    v_mul_f32 v165, v14, v165
    v_mul_f32 v166, v14, v166
    v_mul_f32 v167, v14, v167
    s_waitcnt vmcnt(0)
    s_barrier
    v_cvt_f32_u32 v6, v1
    s_lshl_b32 s6, s3, 2
    v_lshl_add_u32 v7, v2, 6, s6
    v_mul_f32 v6, 0x3b000000, v6
    v_cvt_f32_u32 v7, v7
    v_mul_f32 v15, 0x41800000, v6
    v_mul_f32 v7, v7, v6
    v_cos_f32 v64, v7
    v_sin_f32 v68, v7
    v_add_f32 v9, v7, v15
    v_cos_f32 v65, v9
    v_sin_f32 v69, v9
    v_add_f32 v9, v9, v15
    v_cos_f32 v66, v9
    v_sin_f32 v70, v9
    v_add_f32 v9, v9, v15
    v_cos_f32 v67, v9
    v_sin_f32 v71, v9
    v_mov_b32 v108, 0
    v_cvt_pk_bf16_f32 v100, v64, v65
    v_cvt_pk_bf16_f32 v104, -v68, -v69
    v_cvt_pk_bf16_f32 v101, v66, v67
    v_cvt_pk_bf16_f32 v105, -v70, -v71
    v_xor_b32 v102, v100, v8
    v_xor_b32 v106, v104, v8
    v_xor_b32 v103, v101, v8
    v_xor_b32 v107, v105, v8
    v_add_f32 v7, v7, v6
    v_cos_f32 v64, v7
    v_sin_f32 v68, v7
    v_add_f32 v9, v7, v15
    v_cos_f32 v65, v9
    v_sin_f32 v69, v9
    v_add_f32 v9, v9, v15
    v_cos_f32 v66, v9
    v_sin_f32 v70, v9
    v_add_f32 v9, v9, v15
    v_cos_f32 v67, v9
    v_sin_f32 v71, v9
    v_mov_b32 v120, 0
    v_cvt_pk_bf16_f32 v112, v64, v65
    v_cvt_pk_bf16_f32 v116, -v68, -v69
    v_cvt_pk_bf16_f32 v113, v66, v67
    v_cvt_pk_bf16_f32 v117, -v70, -v71
    v_xor_b32 v114, v112, v8
    v_xor_b32 v118, v116, v8
    v_xor_b32 v115, v113, v8
    v_xor_b32 v119, v117, v8
    v_add_f32 v7, v7, v6
    v_cos_f32 v64, v7
    v_sin_f32 v68, v7
    v_add_f32 v9, v7, v15
    v_cos_f32 v65, v9
    v_sin_f32 v69, v9
    v_add_f32 v9, v9, v15
    v_cos_f32 v66, v9
    v_sin_f32 v70, v9
    v_add_f32 v9, v9, v15
    v_cos_f32 v67, v9
    v_sin_f32 v71, v9
    v_mov_b32 v132, 0
    v_cvt_pk_bf16_f32 v124, v64, v65
    v_cvt_pk_bf16_f32 v128, -v68, -v69
    v_cvt_pk_bf16_f32 v125, v66, v67
    v_cvt_pk_bf16_f32 v129, -v70, -v71
    v_xor_b32 v126, v124, v8
    v_xor_b32 v130, v128, v8
    v_xor_b32 v127, v125, v8
    v_xor_b32 v131, v129, v8
    v_add_f32 v7, v7, v6
    v_cos_f32 v64, v7
    v_sin_f32 v68, v7
    v_add_f32 v9, v7, v15
    v_cos_f32 v65, v9
    v_sin_f32 v69, v9
    v_add_f32 v9, v9, v15
    v_cos_f32 v66, v9
    v_sin_f32 v70, v9
    v_add_f32 v9, v9, v15
    v_cos_f32 v67, v9
    v_sin_f32 v71, v9
    v_mov_b32 v144, 0
    v_cvt_pk_bf16_f32 v136, v64, v65
    v_cvt_pk_bf16_f32 v140, -v68, -v69
    v_cvt_pk_bf16_f32 v137, v66, v67
    v_cvt_pk_bf16_f32 v141, -v70, -v71
    v_xor_b32 v138, v136, v8
    v_xor_b32 v142, v140, v8
    v_xor_b32 v139, v137, v8
    v_xor_b32 v143, v141, v8
    v_lshrrev_b32 v6, 1, v1
    v_add_u32 v7, s6, v6
    v_and_b32 v9, 1, v1
    v_lshl_add_u32 v7, v9, 3, v7
    v_cvt_f32_u32 v7, v7
    v_mul_f32 v7, 0x3d000000, v7
    v_cos_f32 v7, v7
    s_mov_b32 exec_lo, 0x30003
    s_mov_b32 exec_hi, 0x30003
    v_cvt_pk_bf16_f32 v108, v7, -v7
    s_mov_b32 exec_lo, 0xc000c
    s_mov_b32 exec_hi, 0xc000c
    v_cvt_pk_bf16_f32 v120, v7, -v7
    s_mov_b32 exec_lo, 0x300030
    s_mov_b32 exec_hi, 0x300030
    v_cvt_pk_bf16_f32 v132, v7, -v7
    s_mov_b32 exec_lo, 0xc000c0
    s_mov_b32 exec_hi, 0xc000c0
    v_cvt_pk_bf16_f32 v144, v7, -v7
    s_mov_b64 exec, -1
    v_mov_b32 v109, v108
    v_mov_b32 v110, v108
    v_mov_b32 v111, v108
    v_mov_b32 v121, v120
    v_mov_b32 v122, v120
    v_mov_b32 v123, v120
    v_mov_b32 v133, v132
    v_mov_b32 v134, v132
    v_mov_b32 v135, v132
    v_mov_b32 v145, v144
    v_mov_b32 v146, v144
    v_mov_b32 v147, v144
    s_barrier
    buffer_load_dwordx4 v[32:35], v10, s[36:39], s32 offen offset:0 sc1
    buffer_load_dwordx4 v[36:39], v10, s[36:39], s32 offen offset:2048 sc1
    buffer_load_dwordx4 v[40:43], v10, s[36:39], s33 offen offset:0 sc1
    buffer_load_dwordx4 v[44:47], v10, s[36:39], s33 offen offset:2048 sc1
    buffer_load_dwordx4 v[48:51], v10, s[36:39], s32 offen offset:256 sc1
    buffer_load_dwordx4 v[52:55], v10, s[36:39], s32 offen offset:2304 sc1
    buffer_load_dwordx4 v[56:59], v10, s[36:39], s33 offen offset:256 sc1
    buffer_load_dwordx4 v[60:63], v10, s[36:39], s33 offen offset:2304 sc1
    s_mul_i32 s7, s3, 2176
    v_bfe_u32 v7, v1, 1, 2
    v_xor_b32 v7, v7, v2
    v_lshl_add_u32 v7, v7, 4, s7
    v_lshl_add_u32 v29, v1, 6, v7
    v_sub_u32 v6, 16, v1
    v_bfe_u32 v7, v6, 1, 2
    v_xor_b32 v7, v7, v2
    v_lshl_add_u32 v7, v7, 4, s7
    v_lshl_add_u32 v30, v6, 6, v7
    s_cmp_eq_u32 s58, 0
    s_cselect_b32 s6, 0, 2048
    v_add_u32 v4, s6, v5
L_zjoin:
    s_waitcnt vmcnt(4)
L_got0:
    v_pk_mov_b32 v[80:81], v[32:33], v[36:37] op_sel:[0,0]
    v_pk_mov_b32 v[82:83], v[40:41], v[44:45] op_sel:[0,0]
    v_pk_mov_b32 v[84:85], v[32:33], v[36:37] op_sel:[1,1]
    v_pk_mov_b32 v[86:87], v[40:41], v[44:45] op_sel:[1,1]
    v_mfma_f32_16x16x32_bf16 v[64:67], v[80:83], v[148:151], 0
    v_pk_mov_b32 v[88:89], v[34:35], v[38:39] op_sel:[0,0]
    v_pk_mov_b32 v[90:91], v[42:43], v[46:47] op_sel:[0,0]
    v_mfma_f32_16x16x32_bf16 v[68:71], v[84:87], v[148:151], 0
    v_pk_mov_b32 v[92:93], v[34:35], v[38:39] op_sel:[1,1]
    v_pk_mov_b32 v[94:95], v[42:43], v[46:47] op_sel:[1,1]
    v_mfma_f32_16x16x32_bf16 v[72:75], v[88:91], v[148:151], 0
    s_nop 1
    v_mfma_f32_16x16x32_bf16 v[76:79], v[92:95], v[148:151], 0
    s_waitcnt vmcnt(0)
L_got1:
    v_pk_mov_b32 v[80:81], v[48:49], v[52:53] op_sel:[0,0]
    v_pk_mov_b32 v[82:83], v[56:57], v[60:61] op_sel:[0,0]
    v_pk_mov_b32 v[84:85], v[48:49], v[52:53] op_sel:[1,1]
    v_pk_mov_b32 v[86:87], v[56:57], v[60:61] op_sel:[1,1]
    v_mfma_f32_16x16x32_bf16 v[32:35], v[80:83], v[148:151], 0
    v_pk_mov_b32 v[88:89], v[50:51], v[54:55] op_sel:[0,0]
    v_pk_mov_b32 v[90:91], v[58:59], v[62:63] op_sel:[0,0]
    v_mfma_f32_16x16x32_bf16 v[36:39], v[84:87], v[148:151], 0
    v_pk_mov_b32 v[92:93], v[50:51], v[54:55] op_sel:[1,1]
    v_pk_mov_b32 v[94:95], v[58:59], v[62:63] op_sel:[1,1]
    v_mfma_f32_16x16x32_bf16 v[40:43], v[88:91], v[148:151], 0
    s_nop 1
    v_mfma_f32_16x16x32_bf16 v[44:47], v[92:95], v[148:151], 0
    s_nop 0
    v_cvt_pk_bf16_f32 v80, v64, v65
    v_cvt_pk_bf16_f32 v81, v66, v67
    v_cvt_pk_bf16_f32 v82, v32, v33
    v_cvt_pk_bf16_f32 v83, v34, v35
    v_cvt_pk_bf16_f32 v84, v68, v69
    v_cvt_pk_bf16_f32 v85, v70, v71
    v_cvt_pk_bf16_f32 v86, v36, v37
    v_cvt_pk_bf16_f32 v87, v38, v39
    v_mfma_f32_16x16x32_bf16 v[64:67], v[80:83], v[100:103], 0
    v_mfma_f32_16x16x32_bf16 v[32:35], v[80:83], v[104:107], 0
    v_mfma_f32_16x16x32_bf16 v[96:99], v[80:83], v[108:111], 0
    v_cvt_pk_bf16_f32 v88, v72, v73
    v_cvt_pk_bf16_f32 v89, v74, v75
    v_cvt_pk_bf16_f32 v90, v40, v41
    v_cvt_pk_bf16_f32 v91, v42, v43
    v_mfma_f32_16x16x32_bf16 v[68:71], v[84:87], v[112:115], 0
    v_mfma_f32_16x16x32_bf16 v[36:39], v[84:87], v[116:119], 0
    v_mfma_f32_16x16x32_bf16 v[96:99], v[84:87], v[120:123], v[96:99]
    v_cvt_pk_bf16_f32 v92, v76, v77
    v_cvt_pk_bf16_f32 v93, v78, v79
    v_cvt_pk_bf16_f32 v94, v44, v45
    v_cvt_pk_bf16_f32 v95, v46, v47
    v_mfma_f32_16x16x32_bf16 v[72:75], v[88:91], v[124:127], 0
    v_mfma_f32_16x16x32_bf16 v[40:43], v[88:91], v[128:131], 0
    v_mfma_f32_16x16x32_bf16 v[96:99], v[88:91], v[132:135], v[96:99]
    v_mfma_f32_16x16x32_bf16 v[76:79], v[92:95], v[136:139], 0
    v_mfma_f32_16x16x32_bf16 v[44:47], v[92:95], v[140:143], 0
    v_mfma_f32_16x16x32_bf16 v[96:99], v[92:95], v[144:147], v[96:99]
    v_cvt_pk_bf16_f32 v48, v64, v32
    v_cvt_pk_bf16_f32 v52, v65, v33
    v_cvt_pk_bf16_f32 v56, v66, v34
    v_cvt_pk_bf16_f32 v60, v67, v35
    v_cvt_pk_bf16_f32 v49, v68, v36
    v_cvt_pk_bf16_f32 v53, v69, v37
    v_cvt_pk_bf16_f32 v57, v70, v38
    v_cvt_pk_bf16_f32 v61, v71, v39
    v_cvt_pk_bf16_f32 v50, v72, v40
    v_cvt_pk_bf16_f32 v54, v73, v41
    v_cvt_pk_bf16_f32 v58, v74, v42
    v_cvt_pk_bf16_f32 v62, v75, v43
    v_cvt_pk_bf16_f32 v51, v76, v44
    ds_write_b128 v11, v[48:51] offset:16384
    v_cvt_pk_bf16_f32 v55, v77, v45
    ds_write_b128 v11, v[52:55] offset:17472
    v_cvt_pk_bf16_f32 v59, v78, v46
    ds_write_b128 v11, v[56:59] offset:18560
    v_cvt_pk_bf16_f32 v63, v79, v47
    ds_write_b128 v11, v[60:63] offset:19648
    v_cvt_pk_bf16_f32 v96, v96, v97
    v_cvt_pk_bf16_f32 v98, v98, v99
    ds_write_b16 v28, v96 offset:16384
    ds_write_b16_d16_hi v28, v96 offset:17472
    ds_write_b16 v28, v98 offset:18560
    ds_write_b16_d16_hi v28, v98 offset:19648
L_d2:
    ds_read_b128 v[64:67], v5 offset:40576
    ds_read_b128 v[68:71], v5 offset:41600
    ds_read_b128 v[72:75], v4 offset:40576
    ds_read_b128 v[76:79], v4 offset:41600
    v_mov_b32 v9, 33856
    ds_read_b32 v6, v9
    s_waitcnt lgkmcnt(0)
    s_barrier
    ds_read_b128 v[32:35], v29 offset:16384
    ds_read_b128 v[36:39], v30 offset:16384
    ds_read_b128 v[40:43], v29 offset:17472
    ds_read_b128 v[44:47], v30 offset:17472
    s_cmp_lg_u32 s55, 0
    s_cbranch_scc1 L_zfin
    v_readfirstlane_b32 s44, v6
    s_lshl_b32 s6, s58, 10
    s_lshl_b32 s7, s59, 10
    s_andn2_b32 s54, 0xffff, s44
    s_waitcnt lgkmcnt(3)
    v_mfma_f32_16x16x32_bf16 v[48:51], v[32:35], v[64:67], 0
    s_waitcnt lgkmcnt(2)
    v_mfma_f32_16x16x32_bf16 v[52:55], v[36:39], v[68:71], 0
    s_waitcnt lgkmcnt(1)
    v_mfma_f32_16x16x32_bf16 v[56:59], v[40:43], v[72:75], 0
    s_waitcnt lgkmcnt(0)
    v_mfma_f32_16x16x32_bf16 v[60:63], v[44:47], v[76:79], 0
    s_nop 1
    v_fmac_f32 v152, v24, v48
    v_fmac_f32 v153, v24, v49
    v_fmac_f32 v154, v24, v50
    v_fmac_f32 v155, v24, v51
    v_fmac_f32 v156, v24, v52
    v_fmac_f32 v157, v24, v53
    v_fmac_f32 v158, v24, v54
    v_fmac_f32 v159, v24, v55
    v_fmac_f32 v160, v26, v48
    v_fmac_f32 v161, v26, v49
    v_fmac_f32 v162, v26, v50
    v_fmac_f32 v163, v26, v51
    v_fmac_f32 v164, v26, v52
    v_fmac_f32 v165, v26, v53
    v_fmac_f32 v166, v26, v54
    v_fmac_f32 v167, v26, v55
    v_fmac_f32 v152, v25, v56
    v_fmac_f32 v153, v25, v57
    v_fmac_f32 v154, v25, v58
    v_fmac_f32 v155, v25, v59
    v_fmac_f32 v156, v25, v60
    v_fmac_f32 v157, v25, v61
    v_fmac_f32 v158, v25, v62
    v_fmac_f32 v159, v25, v63
    v_cvt_pk_bf16_f32 v32, v152, v153
    v_cvt_pk_bf16_f32 v33, v154, v155
    v_cvt_pk_bf16_f32 v34, v156, v157
    v_cvt_pk_bf16_f32 v35, v158, v159
    s_cmp_eq_u32 s58, s54
    s_cbranch_scc1 L_skip3
    v_permlane16_swap_b32 v32, v34
    v_permlane16_swap_b32 v33, v35
    buffer_store_dwordx4 v[32:35], v3, s[40:43], s6 offen nt
L_skip3:
    v_fmac_f32 v160, v27, v56
    v_fmac_f32 v161, v27, v57
    v_fmac_f32 v162, v27, v58
    v_fmac_f32 v163, v27, v59
    v_fmac_f32 v164, v27, v60
    v_fmac_f32 v165, v27, v61
    v_fmac_f32 v166, v27, v62
    v_fmac_f32 v167, v27, v63
    v_cvt_pk_bf16_f32 v36, v160, v161
    v_cvt_pk_bf16_f32 v37, v162, v163
    v_cvt_pk_bf16_f32 v38, v164, v165
    v_cvt_pk_bf16_f32 v39, v166, v167
    s_cmp_eq_u32 s59, s54
    s_cbranch_scc1 L_skip4
    v_permlane16_swap_b32 v36, v38
    v_permlane16_swap_b32 v37, v39
    buffer_store_dwordx4 v[36:39], v3, s[40:43], s7 offen nt
L_skip4:
    s_endpgm
L_hi0:
    s_waitcnt vmcnt(0)
    s_barrier
    s_barrier
    v_dot2c_f32_bf16 v12, v16, v24
    v_dot2c_f32_bf16 v13, v20, v24
    v_dot2c_f32_bf16 v12, v17, v25
    v_dot2c_f32_bf16 v13, v21, v25
    v_dot2c_f32_bf16 v12, v18, v26
    v_dot2c_f32_bf16 v13, v22, v26
    v_dot2c_f32_bf16 v12, v19, v27
    v_dot2c_f32_bf16 v13, v23, v27
    s_nop 2
    v_permlane32_swap_b32 v12, v13
    v_add_f32 v12, v12, v13
    v_mov_b32 v13, v12
    s_nop 1
    v_permlane16_swap_b32 v12, v13
    v_add_f32 v12, v12, v13
    s_nop 1
    v_add_f32_dpp v12, v12, v12 row_ror:8 row_mask:0xf bank_mask:0xf
    s_nop 1
    v_add_f32_dpp v12, v12, v12 row_ror:4 row_mask:0xf bank_mask:0xf
    s_nop 1
    v_add_f32_dpp v12, v12, v12 row_ror:2 row_mask:0xf bank_mask:0xf
    s_nop 1
    v_add_f32_dpp v12, v12, v12 row_ror:1 row_mask:0xf bank_mask:0xf
    v_cvt_pk_bf16_f32 v12, v12, v12
    v_and_b32 v12, 0xffff0000, v12
    v_mul_f32 v13, 0xbfb8aa3b, v12
    v_exp_f32 v13, v13
    s_nop 0
    v_add_f32 v13, 1.0, v13
    v_rcp_f32 v13, v13
    s_nop 0
    v_cvt_pk_bf16_f32 v13, v13, v13
    v_and_b32 v13, 0xffff0000, v13
    v_sub_f32 v14, 1.0, v13
    v_cvt_pk_bf16_f32 v14, v14, v14
    v_and_b32 v14, 0xffff0000, v14
    v_readlane_b32 s6, v13, 0
    v_readlane_b32 s7, v13, 32
    v_readlane_b32 s8, v14, 0
    v_readlane_b32 s9, v14, 32
    s_xor_b32 s10, s6, 0x80000000
    s_cmp_eq_u32 s58, 0
    s_cselect_b32 s10, 0, s10
    s_cselect_b32 s11, 0, s7
    v_mov_b32 v24, s6
    v_mov_b32 v25, s10
    v_mov_b32 v26, s11
    v_mov_b32 v27, s7
    v_mov_b32 v13, s8
    v_mov_b32 v14, s9
    v_permlane16_swap_b32 v16, v18
    v_permlane16_swap_b32 v17, v19
    v_permlane16_swap_b32 v20, v22
    v_permlane16_swap_b32 v21, v23
    v_lshlrev_b32 v152, 16, v16
    v_and_b32 v153, 0xffff0000, v16
    v_lshlrev_b32 v154, 16, v17
    v_and_b32 v155, 0xffff0000, v17
    v_lshlrev_b32 v156, 16, v18
    v_and_b32 v157, 0xffff0000, v18
    v_lshlrev_b32 v158, 16, v19
    v_and_b32 v159, 0xffff0000, v19
    v_mul_f32 v152, v13, v152
    v_mul_f32 v153, v13, v153
    v_mul_f32 v154, v13, v154
    v_mul_f32 v155, v13, v155
    v_mul_f32 v156, v13, v156
    v_mul_f32 v157, v13, v157
    v_mul_f32 v158, v13, v158
    v_mul_f32 v159, v13, v159
    v_lshlrev_b32 v160, 16, v20
    v_and_b32 v161, 0xffff0000, v20
    v_lshlrev_b32 v162, 16, v21
    v_and_b32 v163, 0xffff0000, v21
    v_lshlrev_b32 v164, 16, v22
    v_and_b32 v165, 0xffff0000, v22
    v_lshlrev_b32 v166, 16, v23
    v_and_b32 v167, 0xffff0000, v23
    v_mul_f32 v160, v14, v160
    v_mul_f32 v161, v14, v161
    v_mul_f32 v162, v14, v162
    v_mul_f32 v163, v14, v163
    v_mul_f32 v164, v14, v164
    v_mul_f32 v165, v14, v165
    v_mul_f32 v166, v14, v166
    v_mul_f32 v167, v14, v167
    s_mul_i32 s7, s3, 2176
    v_bfe_u32 v7, v1, 1, 2
    v_xor_b32 v7, v7, v2
    v_lshl_add_u32 v7, v7, 4, s7
    v_lshl_add_u32 v29, v1, 6, v7
    v_sub_u32 v6, 16, v1
    v_bfe_u32 v7, v6, 1, 2
    v_xor_b32 v7, v7, v2
    v_lshl_add_u32 v7, v7, 4, s7
    v_lshl_add_u32 v30, v6, 6, v7
    s_cmp_eq_u32 s58, 0
    s_cselect_b32 s6, 0, 2048
    v_add_u32 v4, s6, v5
    s_branch L_d2
L_ah:
    v_lshlrev_b32 v5, 4, v0
    s_mov_b32 m0, 44672
    v_mov_b32 v31, 0
    s_waitcnt lgkmcnt(0)
    global_load_lds_dwordx4 v5, s[16:17]
    s_mov_b32 m0, 45696
    global_load_dword v30, v31, s[30:31]
    global_load_lds_dwordx4 v5, s[24:25]
    s_mov_b32 s64, 0x9E3779B1
    s_and_b32 s8, s8, 7
    s_bitcmp1_b32 s7, 3
    s_cselect_b32 s8, s9, s8
    s_and_b32 s9, s7, 7
    s_lshl3_add_u32 s51, s8, s9
    s_lshl_b32 s35, s8, 5
    s_add_u32 s35, s35, s9
    s_lshl_b32 s35, s35, 6
    v_mul_u32_u24 v11, 33024, v1
    v_lshl_add_u32 v11, v2, 4, v11
    v_lshlrev_b32 v14, 10, v0
    v_mov_b32 v32, -1
    v_mov_b32 v33, -1
    v_mov_b32 v34, -1
    v_mov_b32 v35, -1
    s_lshl_b32 s50, s2, 3
    s_add_u32 s50, s50, 65536
    s_add_u32 s48, s35, 2097152
    s_mov_b32 s36, s30
    s_mov_b32 s37, s31
    s_mov_b32 s38, 0x1000000
    s_mov_b32 s39, 0x20000
    s_mov_b32 s65, 0
    s_waitcnt vmcnt(0)
    s_barrier
    v_mul_lo_u32 v31, v30, s64
    v_add_u32 v31, 0x7F4A7C15, v31
    v_lshlrev_b32 v6, 2, v2
    v_cvt_f32_u32 v7, v1
    v_cvt_f32_u32 v6, v6
    v_mul_f32 v7, 0x3d800000, v7
    v_mul_f32 v9, v6, v7
    v_cos_f32 v64, v9
    v_sin_f32 v68, v9
    v_add_f32 v9, v9, v7
    v_cos_f32 v65, v9
    v_sin_f32 v69, v9
    v_add_f32 v9, v9, v7
    v_cos_f32 v66, v9
    v_sin_f32 v70, v9
    v_add_f32 v9, v9, v7
    v_cos_f32 v67, v9
    v_sin_f32 v71, v9
    s_nop 0
    v_cvt_pk_bf16_f32 v40, v64, v68
    v_cvt_pk_bf16_f32 v48, -v68, v64
    v_cvt_pk_bf16_f32 v41, v65, v69
    v_cvt_pk_bf16_f32 v49, -v69, v65
    v_cvt_pk_bf16_f32 v42, v66, v70
    v_cvt_pk_bf16_f32 v50, -v70, v66
    v_cvt_pk_bf16_f32 v43, v67, v71
    v_cvt_pk_bf16_f32 v51, -v71, v67
    v_add_f32 v7, 0x3d800000, v7
    v_mul_f32 v9, v6, v7
    v_cos_f32 v64, v9
    v_sin_f32 v68, v9
    v_add_f32 v9, v9, v7
    v_cos_f32 v65, v9
    v_sin_f32 v69, v9
    v_add_f32 v9, v9, v7
    v_cos_f32 v66, v9
    v_sin_f32 v70, v9
    v_add_f32 v9, v9, v7
    v_cos_f32 v67, v9
    v_sin_f32 v71, v9
    s_nop 0
    v_cvt_pk_bf16_f32 v44, v64, -v68
    v_cvt_pk_bf16_f32 v52, -v68, -v64
    v_cvt_pk_bf16_f32 v45, v65, -v69
    v_cvt_pk_bf16_f32 v53, -v69, -v65
    v_cvt_pk_bf16_f32 v46, v66, -v70
    v_cvt_pk_bf16_f32 v54, -v70, -v66
    v_cvt_pk_bf16_f32 v47, v67, -v71
    v_cvt_pk_bf16_f32 v55, -v71, -v67
    ds_write_b128 v5, v[40:43] offset:40576
    ds_write_b128 v5, v[44:47] offset:41600
    ds_write_b128 v5, v[48:51] offset:42624
    ds_write_b128 v5, v[52:55] offset:43648
    v_mov_b32 v9, 33792
    s_barrier
    ds_read_b128 v[40:43], v9 offset:0
    ds_read_b128 v[44:47], v9 offset:16
    ds_read_b128 v[48:51], v9 offset:32
    ds_read_b128 v[52:55], v9 offset:48
    s_mov_b32 exec_lo, -1
    s_mov_b32 exec_hi, 0x0
    s_waitcnt lgkmcnt(2)
    v_max3_u32 v6, v40, v41, v42
    v_max3_u32 v7, v43, v44, v45
    v_max3_u32 v6, v46, v47, v6
    s_waitcnt lgkmcnt(0)
    v_max3_u32 v7, v48, v49, v7
    v_max3_u32 v6, v50, v51, v6
    v_max3_u32 v7, v52, v53, v7
    v_max3_u32 v6, v54, v55, v6
    v_max_u32 v30, v6, v7
    s_mov_b64 exec, 0x3fffffff
    buffer_store_dwordx2 v[30:31], v14, s[36:39], s50 offen sc1
    s_mov_b64 exec, -1
    s_add_u32 s50, s50, 65536
    s_barrier
    s_and_b32 s61, s2, 7
    s_mul_i32 s61, s61, 4096
    s_add_u32 s61, s61, 131072
    s_add_u32 s62, s61, 3072
    s_barrier
    s_mov_b32 exec_lo, -1
    s_mov_b32 exec_hi, 0x0
    buffer_store_dwordx2 v[30:31], v14, s[36:39], s50 offen sc1
    s_mov_b64 exec, -1
    s_waitcnt vmcnt(0)
    s_branch L_poll5_1
L_poll5:
    s_sleep 3
L_poll5_1:
    buffer_load_dwordx4 v[32:35], v5, s[36:39], s61 offen sc1
    s_add_u32 s61, s61, 1024
    s_min_u32 s61, s61, s62
    s_add_u32 s65, s65, 1
    s_lshr_b32 s34, s65, 17
    s_waitcnt vmcnt(0)
    s_cbranch_scc1 L_poll5_ok
    v_cmp_ne_u32 vcc, v31, v33
    v_cmp_ne_u32 s[12:13], v31, v35
    s_or_b64 vcc, vcc, s[12:13]
    s_cbranch_vccnz L_poll5
L_poll5_ok:
    v_max_u32 v32, v32, v34
    s_nop 1
    v_max_u32_dpp v32, v32, v32 row_ror:8 row_mask:0xf bank_mask:0xf
    s_nop 1
    v_max_u32_dpp v32, v32, v32 row_ror:4 row_mask:0xf bank_mask:0xf
    s_nop 1
    v_max_u32_dpp v32, v32, v32 row_ror:2 row_mask:0xf bank_mask:0xf
    s_nop 1
    v_max_u32_dpp v32, v32, v32 row_ror:1 row_mask:0xf bank_mask:0xf
    v_mov_b32 v33, v32
    s_nop 1
    v_permlane16_swap_b32 v32, v33
    v_max_u32 v32, v32, v33
    v_mov_b32 v33, v32
    s_nop 1
    v_permlane32_swap_b32 v32, v33
    v_max_u32 v32, v32, v33
    v_mov_b32 v9, 33856
    s_mov_b64 exec, 1
    ds_write_b32 v9, v32
    s_mov_b64 exec, -1
    s_waitcnt lgkmcnt(0)
    s_barrier
    s_endpgm
L_notA:
    s_lshl4_add_u32 s60, s6, s7
    s_sub_u32 s60, s60, 16
    s_cmp_ge_u32 s2, 256
    s_cbranch_scc1 L_end
    s_cmp_lt_u32 s6, 4
    s_cbranch_scc1 L_F
    s_mul_i32 s60, s6, 12
    s_add_u32 s60, s60, s7
    s_cmp_lt_u32 s7, 28
    s_cbranch_scc1 L_F
    s_mov_b32 s55, 1
    s_lshl2_add_u32 s47, s6, s7
    s_sub_u32 s47, s47, 44
    v_and_b32 v6, 1, v2
    v_lshlrev_b32 v6, 5, v6
    v_lshl_add_u32 v6, v1, 6, v6
    v_lshrrev_b32 v7, 1, v2
    v_lshl_add_u32 v3, v7, 4, v6
    v_lshlrev_b32 v5, 4, v0
    v_lshlrev_b32 v8, 31, v1
    v_lshrrev_b32 v9, 16, v8
    v_or_b32 v8, v8, v9
    s_waitcnt lgkmcnt(0)
    s_mov_b32 s36, s30
    s_mov_b32 s37, s31
    s_mov_b32 s38, 0x1000000
    s_mov_b32 s39, 0x20000
    s_mov_b32 s65, 0
    s_mov_b32 s40, s26
    s_mov_b32 s41, s27
    s_mov_b32 s42, 0x200000
    s_mov_b32 s43, 0x20000
    v_lshlrev_b32 v6, 4, v1
    v_lshl_add_u32 v10, v2, 13, v6
    v_mul_u32_u24 v6, 4352, v2
    v_bfe_u32 v7, v1, 1, 2
    v_xor_b32 v7, s3, v7
    v_lshl_add_u32 v7, v7, 4, v6
    v_lshl_add_u32 v11, v1, 6, v7
    s_lshl4_add_u32 s7, s3, 1024
    v_mov_b32 v9, 17536
    v_lshl_add_u32 v28, v0, 1, v9
    v_lshl_add_u32 v7, v1, 1, s7
    s_mov_b32 exec_lo, 0x00ff00ff
    s_mov_b32 exec_hi, 0x00ff00ff
    v_add_u32 v28, v7, v6
    s_mov_b64 exec, -1
    s_cmp_eq_u32 s3, 8
    s_cbranch_scc1 L_zh
    s_cmp_ge_u32 s3, 4
    s_cbranch_scc1 L_z1
    v_cvt_f32_u32 v6, v1
    s_lshl_b32 s6, s3, 2
    v_lshl_add_u32 v7, v2, 6, s6
    v_mul_f32 v6, 0x3b000000, v6
    v_cvt_f32_u32 v7, v7
    v_mul_f32 v15, 0x41800000, v6
    v_mul_f32 v7, v7, v6
    v_cos_f32 v64, v7
    v_sin_f32 v68, v7
    v_add_f32 v9, v7, v15
    v_cos_f32 v65, v9
    v_sin_f32 v69, v9
    v_add_f32 v9, v9, v15
    v_cos_f32 v66, v9
    v_sin_f32 v70, v9
    v_add_f32 v9, v9, v15
    v_cos_f32 v67, v9
    v_sin_f32 v71, v9
    v_mov_b32 v108, 0
    v_cvt_pk_bf16_f32 v100, v64, v65
    v_cvt_pk_bf16_f32 v104, -v68, -v69
    v_cvt_pk_bf16_f32 v101, v66, v67
    v_cvt_pk_bf16_f32 v105, -v70, -v71
    v_xor_b32 v102, v100, v8
    v_xor_b32 v106, v104, v8
    v_xor_b32 v103, v101, v8
    v_xor_b32 v107, v105, v8
    v_add_f32 v7, v7, v6
    v_cos_f32 v64, v7
    v_sin_f32 v68, v7
    v_add_f32 v9, v7, v15
    v_cos_f32 v65, v9
    v_sin_f32 v69, v9
    v_add_f32 v9, v9, v15
    v_cos_f32 v66, v9
    v_sin_f32 v70, v9
    v_add_f32 v9, v9, v15
    v_cos_f32 v67, v9
    v_sin_f32 v71, v9
    v_mov_b32 v120, 0
    v_cvt_pk_bf16_f32 v112, v64, v65
    v_cvt_pk_bf16_f32 v116, -v68, -v69
    v_cvt_pk_bf16_f32 v113, v66, v67
    v_cvt_pk_bf16_f32 v117, -v70, -v71
    v_xor_b32 v114, v112, v8
    v_xor_b32 v118, v116, v8
    v_xor_b32 v115, v113, v8
    v_xor_b32 v119, v117, v8
    v_add_f32 v7, v7, v6
    v_cos_f32 v64, v7
    v_sin_f32 v68, v7
    v_add_f32 v9, v7, v15
    v_cos_f32 v65, v9
    v_sin_f32 v69, v9
    v_add_f32 v9, v9, v15
    v_cos_f32 v66, v9
    v_sin_f32 v70, v9
    v_add_f32 v9, v9, v15
    v_cos_f32 v67, v9
    v_sin_f32 v71, v9
    v_mov_b32 v132, 0
    v_cvt_pk_bf16_f32 v124, v64, v65
    v_cvt_pk_bf16_f32 v128, -v68, -v69
    v_cvt_pk_bf16_f32 v125, v66, v67
    v_cvt_pk_bf16_f32 v129, -v70, -v71
    v_xor_b32 v126, v124, v8
    v_xor_b32 v130, v128, v8
    v_xor_b32 v127, v125, v8
    v_xor_b32 v131, v129, v8
    v_add_f32 v7, v7, v6
    v_cos_f32 v64, v7
    v_sin_f32 v68, v7
    v_add_f32 v9, v7, v15
    v_cos_f32 v65, v9
    v_sin_f32 v69, v9
    v_add_f32 v9, v9, v15
    v_cos_f32 v66, v9
    v_sin_f32 v70, v9
    v_add_f32 v9, v9, v15
    v_cos_f32 v67, v9
    v_sin_f32 v71, v9
    v_mov_b32 v144, 0
    v_cvt_pk_bf16_f32 v136, v64, v65
    v_cvt_pk_bf16_f32 v140, -v68, -v69
    v_cvt_pk_bf16_f32 v137, v66, v67
    v_cvt_pk_bf16_f32 v141, -v70, -v71
    v_xor_b32 v138, v136, v8
    v_xor_b32 v142, v140, v8
    v_xor_b32 v139, v137, v8
    v_xor_b32 v143, v141, v8
    v_lshrrev_b32 v6, 1, v1
    v_add_u32 v7, s6, v6
    v_and_b32 v9, 1, v1
    v_lshl_add_u32 v7, v9, 3, v7
    v_cvt_f32_u32 v7, v7
    v_mul_f32 v7, 0x3d000000, v7
    v_cos_f32 v7, v7
    s_mov_b32 exec_lo, 0x30003
    s_mov_b32 exec_hi, 0x30003
    v_cvt_pk_bf16_f32 v108, v7, -v7
    s_mov_b32 exec_lo, 0xc000c
    s_mov_b32 exec_hi, 0xc000c
    v_cvt_pk_bf16_f32 v120, v7, -v7
    s_mov_b32 exec_lo, 0x300030
    s_mov_b32 exec_hi, 0x300030
    v_cvt_pk_bf16_f32 v132, v7, -v7
    s_mov_b32 exec_lo, 0xc000c0
    s_mov_b32 exec_hi, 0xc000c0
    v_cvt_pk_bf16_f32 v144, v7, -v7
    s_mov_b64 exec, -1
    v_mov_b32 v109, v108
    v_mov_b32 v110, v108
    v_mov_b32 v111, v108
    v_mov_b32 v121, v120
    v_mov_b32 v122, v120
    v_mov_b32 v123, v120
    v_mov_b32 v133, v132
    v_mov_b32 v134, v132
    v_mov_b32 v135, v132
    v_mov_b32 v145, v144
    v_mov_b32 v146, v144
    v_mov_b32 v147, v144
L_z1:
    s_lshr_b32 s6, s47, 2
    s_and_b32 s7, s47, 3
    s_lshl3_add_u32 s6, s6, s7
    s_lshl_b32 s48, s6, 5
    v_mov_b32 v9, 33792
    v_mov_b32 v12, 0
    v_mov_b32 v13, 0
    s_barrier
    ds_read_b64 v[30:31], v9
    ds_read_b128 v[24:27], v3 offset:45696
    s_waitcnt lgkmcnt(0)
    v_readfirstlane_b32 s44, v30
    s_andn2_b32 s54, 2047, s44
    s_and_b32 s6, s54, 127
    s_cmp_gt_u32 s6, 64
    s_cselect_b32 s46, 1, 0
    s_and_b32 s6, s54, 1087
    s_cmp_eq_u32 s6, 1024
    s_cselect_b32 s46, 1, s46
    s_sub_u32 s6, 2048, s54
    s_cmp_lg_u32 s46, 0
    s_cselect_b32 s6, s6, s54
    s_cmp_eq_u32 s6, 1024
    s_cselect_b32 s6, 0, s6
    s_and_b32 s56, s6, 127
    s_lshr_b32 s57, s6, 10
    s_bfe_u32 s45, s6, 0x30007
    s_lshl3_add_u32 s11, s57, s45
    s_lshl_b32 s11, s11, 7
    s_add_u32 s58, s11, s56
    s_sub_u32 s59, 2048, s58
    s_cmp_eq_u32 s58, 0
    s_cselect_b32 s59, 1024, s59
    s_lshl_b32 s10, s58, 10
    s_lshl_b32 s11, s59, 10
    v_add_u32 v6, s10, v3
    v_add_u32 v7, s11, v3
    global_load_dwordx4 v[16:19], v6, s[4:5]
    global_load_dwordx4 v[20:23], v7, s[4:5]
    s_cmp_ge_u32 s3, 4
    s_cbranch_scc1 L_z4
    v_lshrrev_b32 v6, 1, v1
    s_lshl_b32 s6, s57, 10
    s_add_u32 s6, s6, s56
    v_lshl_add_u32 v6, v6, 7, s6
    v_and_b32 v7, 1, v1
    v_lshlrev_b32 v9, 9, v7
    s_cmp_lg_u32 s56, 0
    s_cbranch_scc1 L_g06
    s_mov_b32 exec_lo, 0x00020002
    s_mov_b32 exec_hi, 0x00020002
    v_mov_b32 v6, 0x400
    v_mov_b32 v9, 0
    s_mov_b64 exec, -1
L_g06:
    v_lshlrev_b32 v7, 2, v2
    v_mad_u32_u24 v9, v7, v6, v9
    v_cvt_f32_u32 v6, v6
    v_cvt_f32_u32 v9, v9
    v_mul_f32 v6, 0x3a000000, v6
    v_mul_f32 v9, 0x3a000000, v9
    v_cos_f32 v64, v9
    v_sin_f32 v68, v9
    v_add_f32 v9, v9, v6
    v_cos_f32 v65, v9
    v_sin_f32 v69, v9
    v_add_f32 v9, v9, v6
    v_cos_f32 v66, v9
    v_sin_f32 v70, v9
    v_add_f32 v9, v9, v6
    v_cos_f32 v67, v9
    v_sin_f32 v71, v9
    s_and_b32 s7, s56, 63
    s_mul_i32 s32, s7, 33024
    v_cvt_pk_bf16_f32 v148, v64, v68
    v_cvt_pk_bf16_f32 v149, v65, v69
    v_cvt_pk_bf16_f32 v150, v66, v70
    v_cvt_pk_bf16_f32 v151, v67, v71
    s_cmp_lg_u32 s7, 0
    s_cbranch_scc1 L_gd7
    s_lshr_b32 s7, s56, 2
    v_and_b32 v148, 0xffff, v148
    v_lshlrev_b32 v148, s7, v148
    v_and_b32 v149, 0xffff, v149
    v_lshlrev_b32 v149, s7, v149
    v_and_b32 v150, 0xffff, v150
    v_lshlrev_b32 v150, s7, v150
    v_and_b32 v151, 0xffff, v151
    v_lshlrev_b32 v151, s7, v151
L_gd7:
    s_lshl_b32 s7, s3, 9
    s_add_u32 s32, s32, s7
    s_add_u32 s32, s32, 2097152
    s_add_u32 s33, s32, 4096
    s_mul_i32 s7, s45, 2176
    v_bfe_u32 v7, v1, 1, 2
    v_xor_b32 v7, v7, v2
    v_lshl_add_u32 v7, v7, 4, s7
    v_lshl_add_u32 v29, v1, 6, v7
    v_sub_u32 v6, 16, v1
    v_bfe_u32 v7, v6, 1, 2
    v_xor_b32 v7, v7, v2
    v_lshl_add_u32 v7, v7, 4, s7
    v_lshl_add_u32 v30, v6, 6, v7
    s_cmp_eq_u32 s58, 0
    s_cselect_b32 s6, 0, 2048
    v_add_u32 v4, s6, v5
    v_subrev_u32 v6, s48, v3
    v_and_b32 v6, 0xffffff7f, v6
    v_cmp_gt_u32 s[14:15], 32, v6
    v_lshlrev_b32 v6, 7, v1
    v_lshl_add_u32 v15, v2, 4, v6
    s_waitcnt vmcnt(0)
    v_dot2c_f32_bf16 v12, v16, v24
    v_dot2c_f32_bf16 v13, v20, v24
    v_dot2c_f32_bf16 v12, v17, v25
    v_dot2c_f32_bf16 v13, v21, v25
    v_dot2c_f32_bf16 v12, v18, v26
    v_dot2c_f32_bf16 v13, v22, v26
    v_dot2c_f32_bf16 v12, v19, v27
    v_dot2c_f32_bf16 v13, v23, v27
    s_nop 2
    v_permlane32_swap_b32 v12, v13
    v_add_f32 v12, v12, v13
    v_mov_b32 v13, v12
    s_nop 1
    v_permlane16_swap_b32 v12, v13
    v_add_f32 v12, v12, v13
    s_nop 1
    v_add_f32_dpp v12, v12, v12 row_ror:8 row_mask:0xf bank_mask:0xf
    s_nop 1
    v_add_f32_dpp v12, v12, v12 row_ror:4 row_mask:0xf bank_mask:0xf
    s_nop 1
    v_add_f32_dpp v12, v12, v12 row_ror:2 row_mask:0xf bank_mask:0xf
    s_nop 1
    v_add_f32_dpp v12, v12, v12 row_ror:1 row_mask:0xf bank_mask:0xf
    v_cvt_pk_bf16_f32 v12, v12, v12
    v_and_b32 v12, 0xffff0000, v12
    v_mul_f32 v13, 0xbfb8aa3b, v12
    v_exp_f32 v13, v13
    s_nop 0
    v_add_f32 v13, 1.0, v13
    v_rcp_f32 v13, v13
    s_nop 0
    v_cvt_pk_bf16_f32 v13, v13, v13
    v_and_b32 v13, 0xffff0000, v13
    v_sub_f32 v14, 1.0, v13
    v_cvt_pk_bf16_f32 v14, v14, v14
    v_and_b32 v14, 0xffff0000, v14
    v_readlane_b32 s6, v13, 0
    v_readlane_b32 s7, v13, 32
    v_readlane_b32 s8, v14, 0
    v_readlane_b32 s9, v14, 32
    s_xor_b32 s10, s6, 0x80000000
    s_cmp_eq_u32 s58, 0
    s_cselect_b32 s10, 0, s10
    s_cselect_b32 s11, 0, s7
    s_cmp_lg_u32 s46, 0
    s_cselect_b32 s6, s11, s6
    s_cselect_b32 s10, s7, s10
    v_mov_b32 v24, s6
    v_mov_b32 v25, s10
    s_barrier
    buffer_load_dwordx4 v[32:35], v10, s[36:39], s32 offen offset:0 sc1
    buffer_load_dwordx4 v[36:39], v10, s[36:39], s32 offen offset:2048 sc1
    buffer_load_dwordx4 v[40:43], v10, s[36:39], s33 offen offset:0 sc1
    buffer_load_dwordx4 v[44:47], v10, s[36:39], s33 offen offset:2048 sc1
    buffer_load_dwordx4 v[48:51], v10, s[36:39], s32 offen offset:256 sc1
    buffer_load_dwordx4 v[52:55], v10, s[36:39], s32 offen offset:2304 sc1
    buffer_load_dwordx4 v[56:59], v10, s[36:39], s33 offen offset:256 sc1
    buffer_load_dwordx4 v[60:63], v10, s[36:39], s33 offen offset:2304 sc1
    s_branch L_zjoin
L_z4:
    s_sub_u32 s6, s3, 4
    s_lshl3_add_u32 s7, s6, s48
    v_and_b32 v6, 3, v0
    v_lshl_add_u32 v10, v6, 1, s7
    s_lshl_b32 s8, s54, 10
    v_add_u32 v7, s8, v10
    global_load_ushort v34, v7, s[4:5]
    global_load_ushort v35, v7, s[4:5] offset:128
    v_lshlrev_b32 v10, 1, v10
    v_lshrrev_b32 v7, 2, v0
    v_lshlrev_b32 v7, 8, v7
    v_lshl_add_u32 v11, v6, 4, v7
    s_mul_i32 s48, s47, 28672
    s_lshl_b32 s6, s6, 6
    s_add_u32 s48, s48, s6
    s_add_u32 s48, s48, 720896
    s_add_u32 s49, s48, 458752
    s_and_b32 s6, s44, 0xffff0000
    s_xor_b32 s7, s6, 0x80000000
    s_xor_b32 s9, s6, 0xffff0000
    s_bitcmp1_b32 s6, 31
    s_cselect_b32 s6, s7, s9
    v_mov_b32 v15, s6
    v_mul_f32 v15, 0xbfb8aa3b, v15
    v_exp_f32 v15, v15
    s_nop 0
    v_add_f32 v15, 1.0, v15
    v_rcp_f32 v15, v15
    s_nop 0
    v_cvt_pk_bf16_f32 v15, v15, v15
    v_and_b32 v15, 0xffff0000, v15
    s_waitcnt vmcnt(0)
    v_dot2c_f32_bf16 v12, v16, v24
    v_dot2c_f32_bf16 v13, v20, v24
    v_dot2c_f32_bf16 v12, v17, v25
    v_dot2c_f32_bf16 v13, v21, v25
    v_dot2c_f32_bf16 v12, v18, v26
    v_dot2c_f32_bf16 v13, v22, v26
    v_dot2c_f32_bf16 v12, v19, v27
    v_dot2c_f32_bf16 v13, v23, v27
    s_nop 2
    v_permlane32_swap_b32 v12, v13
    v_add_f32 v12, v12, v13
    v_mov_b32 v13, v12
    s_nop 1
    v_permlane16_swap_b32 v12, v13
    v_add_f32 v12, v12, v13
    s_nop 1
    v_add_f32_dpp v12, v12, v12 row_ror:8 row_mask:0xf bank_mask:0xf
    s_nop 1
    v_add_f32_dpp v12, v12, v12 row_ror:4 row_mask:0xf bank_mask:0xf
    s_nop 1
    v_add_f32_dpp v12, v12, v12 row_ror:2 row_mask:0xf bank_mask:0xf
    s_nop 1
    v_add_f32_dpp v12, v12, v12 row_ror:1 row_mask:0xf bank_mask:0xf
    v_cvt_pk_bf16_f32 v12, v12, v12
    v_and_b32 v12, 0xffff0000, v12
    v_mul_f32 v13, 0xbfb8aa3b, v12
    v_exp_f32 v13, v13
    s_nop 0
    v_add_f32 v13, 1.0, v13
    v_rcp_f32 v13, v13
    s_nop 0
    v_cvt_pk_bf16_f32 v13, v13, v13
    v_and_b32 v13, 0xffff0000, v13
    v_sub_f32 v14, 1.0, v13
    v_cvt_pk_bf16_f32 v14, v14, v14
    v_and_b32 v14, 0xffff0000, v14
    v_readlane_b32 s6, v13, 0
    v_readlane_b32 s7, v13, 32
    v_readlane_b32 s8, v14, 0
    v_readlane_b32 s9, v14, 32
    s_xor_b32 s10, s6, 0x80000000
    s_cmp_eq_u32 s58, 0
    s_cselect_b32 s10, 0, s10
    s_cselect_b32 s11, 0, s7
    s_cmp_lg_u32 s46, 0
    s_cselect_b32 s8, s9, s8
    v_mov_b32 v36, s8
    v_lshlrev_b32 v34, 16, v34
    v_lshlrev_b32 v35, 16, v35
    v_mov_b32 v4, v5
    v_mov_b32 v29, 0
    v_mov_b32 v30, 0
    s_barrier
    s_sleep 16
L_zp:
    buffer_load_dwordx4 v[40:43], v11, s[36:39], s48 offen sc1
    s_add_u32 s6, s48, 4096
    buffer_load_dwordx4 v[44:47], v11, s[36:39], s6 offen sc1
    s_add_u32 s6, s48, 8192
    buffer_load_dwordx4 v[48:51], v11, s[36:39], s6 offen sc1
    s_add_u32 s6, s48, 12288
    buffer_load_dwordx4 v[52:55], v11, s[36:39], s6 offen sc1
    s_add_u32 s6, s48, 16384
    buffer_load_dwordx4 v[56:59], v11, s[36:39], s6 offen sc1
    s_add_u32 s6, s48, 20480
    buffer_load_dwordx4 v[60:63], v11, s[36:39], s6 offen sc1
    s_add_u32 s6, s48, 24576
    buffer_load_dwordx4 v[64:67], v11, s[36:39], s6 offen sc1
    s_add_u32 s48, s48, 458752
    s_min_u32 s48, s48, s49
    s_add_u32 s65, s65, 1
    s_lshr_b32 s34, s65, 17
    s_cbranch_scc1 L_zp_ok
    s_waitcnt vmcnt(6)
    v_xor_b32 v37, v31, v41
    v_bitop3_b32 v37, v43, v31, v37 bitop3:0xbe
    s_waitcnt vmcnt(5)
    v_bitop3_b32 v37, v45, v31, v37 bitop3:0xbe
    v_add_f32 v40, v40, v44
    v_bitop3_b32 v37, v47, v31, v37 bitop3:0xbe
    v_add_f32 v42, v42, v46
    s_waitcnt vmcnt(4)
    v_bitop3_b32 v37, v49, v31, v37 bitop3:0xbe
    v_add_f32 v40, v40, v48
    v_bitop3_b32 v37, v51, v31, v37 bitop3:0xbe
    v_add_f32 v42, v42, v50
    s_waitcnt vmcnt(3)
    v_bitop3_b32 v37, v53, v31, v37 bitop3:0xbe
    v_add_f32 v40, v40, v52
    v_bitop3_b32 v37, v55, v31, v37 bitop3:0xbe
    v_add_f32 v42, v42, v54
    s_waitcnt vmcnt(2)
    v_bitop3_b32 v37, v57, v31, v37 bitop3:0xbe
    v_add_f32 v40, v40, v56
    v_bitop3_b32 v37, v59, v31, v37 bitop3:0xbe
    v_add_f32 v42, v42, v58
    s_waitcnt vmcnt(1)
    v_bitop3_b32 v37, v61, v31, v37 bitop3:0xbe
    v_add_f32 v40, v40, v60
    v_bitop3_b32 v37, v63, v31, v37 bitop3:0xbe
    v_add_f32 v42, v42, v62
    s_waitcnt vmcnt(0)
    v_bitop3_b32 v37, v65, v31, v37 bitop3:0xbe
    v_add_f32 v40, v40, v64
    v_bitop3_b32 v37, v67, v31, v37 bitop3:0xbe
    v_add_f32 v42, v42, v66
    v_cmp_ne_u32 vcc, 0, v37
    s_nop 0
    s_cbranch_vccnz L_zp
L_zp_ok:
    s_waitcnt vmcnt(0)
    v_add_f32_dpp v40, v40, v40 row_ror:4 row_mask:0xf bank_mask:0xf
    v_add_f32_dpp v42, v42, v42 row_ror:4 row_mask:0xf bank_mask:0xf
    s_nop 0
    v_add_f32_dpp v40, v40, v40 row_ror:8 row_mask:0xf bank_mask:0xf
    v_add_f32_dpp v42, v42, v42 row_ror:8 row_mask:0xf bank_mask:0xf
    s_nop 0
    s_nop 0
    v_permlane16_swap_b32 v40, v42
    v_add_f32 v40, v40, v42
    v_mov_b32 v42, v40
    s_nop 1
    v_permlane32_swap_b32 v40, v42
    v_add_f32 v40, v40, v42
    v_mov_b32 v42, v40
    s_nop 1
    v_permlane16_swap_b32 v40, v42
    v_cvt_pk_bf16_f32 v41, v40, v42
    v_lshlrev_b32 v40, 16, v41
    v_and_b32 v42, 0xffff0000, v41
    v_mul_f32 v40, v40, v15
    v_mul_f32 v42, v42, v15
    v_cvt_pk_bf16_f32 v41, v40, v42
    v_lshlrev_b32 v40, 16, v41
    v_and_b32 v42, 0xffff0000, v41
    v_add_f32 v40, v40, v34
    v_add_f32 v42, v42, v35
    v_cvt_pk_bf16_f32 v41, v40, v42
    v_lshlrev_b32 v40, 16, v41
    v_and_b32 v42, 0xffff0000, v41
    v_mul_f32 v40, v40, v36
    v_mul_f32 v42, v42, v36
    s_mov_b64 exec, 15
    ds_write_b32 v10, v40 offset:38528
    ds_write_b32 v10, v42 offset:38784
    s_waitcnt lgkmcnt(0)
    s_barrier
    s_endpgm
L_zfin:
    s_cmp_lg_u32 s3, 0
    s_cbranch_scc1 L_zend
    ds_read_b128 v[152:155], v15 offset:38528
    ds_read_b128 v[156:159], v15 offset:38592
    s_waitcnt lgkmcnt(5)
    v_mfma_f32_16x16x32_bf16 v[48:51], v[32:35], v[64:67], 0
    s_waitcnt lgkmcnt(4)
    v_mfma_f32_16x16x32_bf16 v[52:55], v[36:39], v[68:71], 0
    s_waitcnt lgkmcnt(3)
    v_mfma_f32_16x16x32_bf16 v[56:59], v[40:43], v[72:75], 0
    s_waitcnt lgkmcnt(2)
    v_mfma_f32_16x16x32_bf16 v[60:63], v[44:47], v[76:79], 0
    s_lshl_b32 s6, s54, 10
    s_waitcnt lgkmcnt(0)
    s_nop 1
    v_fmac_f32 v152, v24, v48
    v_fmac_f32 v153, v24, v49
    v_fmac_f32 v154, v24, v50
    v_fmac_f32 v155, v24, v51
    v_fmac_f32 v156, v24, v52
    v_fmac_f32 v157, v24, v53
    v_fmac_f32 v158, v24, v54
    v_fmac_f32 v159, v24, v55
    v_fmac_f32 v152, v25, v56
    v_fmac_f32 v153, v25, v57
    v_fmac_f32 v154, v25, v58
    v_fmac_f32 v155, v25, v59
    v_fmac_f32 v156, v25, v60
    v_fmac_f32 v157, v25, v61
    v_fmac_f32 v158, v25, v62
    v_fmac_f32 v159, v25, v63
    v_cvt_pk_bf16_f32 v32, v152, v153
    v_cvt_pk_bf16_f32 v33, v154, v155
    v_cvt_pk_bf16_f32 v34, v156, v157
    v_cvt_pk_bf16_f32 v35, v158, v159
    s_nop 1
    v_permlane16_swap_b32 v32, v34
    v_permlane16_swap_b32 v33, v35
    s_mov_b64 exec, s[14:15]
    buffer_store_dwordx4 v[32:35], v3, s[40:43], s6 offen
    s_mov_b64 exec, -1
L_zend:
    s_endpgm
L_zh:
    s_mov_b32 m0, 45696
    v_mov_b32 v31, 0
    global_load_dword v30, v31, s[30:31]
    s_mov_b32 s64, 0x9E3779B1
    global_load_lds_dwordx4 v5, s[24:25]
    v_lshlrev_b32 v6, 2, v2
    v_cvt_f32_u32 v7, v1
    v_cvt_f32_u32 v6, v6
    v_mul_f32 v7, 0x3d800000, v7
    v_mul_f32 v9, v6, v7
    v_cos_f32 v64, v9
    v_sin_f32 v68, v9
    v_add_f32 v9, v9, v7
    v_cos_f32 v65, v9
    v_sin_f32 v69, v9
    v_add_f32 v9, v9, v7
    v_cos_f32 v66, v9
    v_sin_f32 v70, v9
    v_add_f32 v9, v9, v7
    v_cos_f32 v67, v9
    v_sin_f32 v71, v9
    s_nop 0
    v_cvt_pk_bf16_f32 v40, v64, v68
    v_cvt_pk_bf16_f32 v48, -v68, v64
    v_cvt_pk_bf16_f32 v41, v65, v69
    v_cvt_pk_bf16_f32 v49, -v69, v65
    v_cvt_pk_bf16_f32 v42, v66, v70
    v_cvt_pk_bf16_f32 v50, -v70, v66
    v_cvt_pk_bf16_f32 v43, v67, v71
    v_cvt_pk_bf16_f32 v51, -v71, v67
    v_add_f32 v7, 0x3d800000, v7
    v_mul_f32 v9, v6, v7
    v_cos_f32 v64, v9
    v_sin_f32 v68, v9
    v_add_f32 v9, v9, v7
    v_cos_f32 v65, v9
    v_sin_f32 v69, v9
    v_add_f32 v9, v9, v7
    v_cos_f32 v66, v9
    v_sin_f32 v70, v9
    v_add_f32 v9, v9, v7
    v_cos_f32 v67, v9
    v_sin_f32 v71, v9
    s_nop 0
    v_cvt_pk_bf16_f32 v44, v64, -v68
    v_cvt_pk_bf16_f32 v52, -v68, -v64
    v_cvt_pk_bf16_f32 v45, v65, -v69
    v_cvt_pk_bf16_f32 v53, -v69, -v65
    v_cvt_pk_bf16_f32 v46, v66, -v70
    v_cvt_pk_bf16_f32 v54, -v70, -v66
    v_cvt_pk_bf16_f32 v47, v67, -v71
    v_cvt_pk_bf16_f32 v55, -v71, -v67
    ds_write_b128 v5, v[40:43] offset:40576
    ds_write_b128 v5, v[44:47] offset:41600
    ds_write_b128 v5, v[48:51] offset:42624
    ds_write_b128 v5, v[52:55] offset:43648
    s_waitcnt vmcnt(0)
    v_mul_lo_u32 v31, v30, s64
    v_add_u32 v31, 0x7F4A7C15, v31
    s_and_b32 s61, s2, 0
    s_mul_i32 s61, s61, 6144
    s_add_u32 s61, s61, 90112
    s_add_u32 s62, s61, 5120
    s_sleep 24
    s_branch L_poll8_1
L_poll8:
    s_sleep 8
L_poll8_1:
    buffer_load_dwordx4 v[32:35], v5, s[36:39], s61 offen sc1
    s_add_u32 s61, s61, 1024
    s_min_u32 s61, s61, s62
    s_add_u32 s65, s65, 1
    s_lshr_b32 s34, s65, 17
    s_waitcnt vmcnt(0)
    s_cbranch_scc1 L_poll8_ok
    v_cmp_ne_u32 vcc, v31, v33
    v_cmp_ne_u32 s[12:13], v31, v35
    s_or_b64 vcc, vcc, s[12:13]
    s_cbranch_vccnz L_poll8
L_poll8_ok:
    v_max_u32 v32, v32, v34
    s_nop 1
    v_max_u32_dpp v32, v32, v32 row_ror:8 row_mask:0xf bank_mask:0xf
    s_nop 1
    v_max_u32_dpp v32, v32, v32 row_ror:4 row_mask:0xf bank_mask:0xf
    s_nop 1
    v_max_u32_dpp v32, v32, v32 row_ror:2 row_mask:0xf bank_mask:0xf
    s_nop 1
    v_max_u32_dpp v32, v32, v32 row_ror:1 row_mask:0xf bank_mask:0xf
    v_mov_b32 v33, v32
    s_nop 1
    v_permlane16_swap_b32 v32, v33
    v_max_u32 v32, v32, v33
    v_mov_b32 v33, v32
    s_nop 1
    v_permlane32_swap_b32 v32, v33
    v_max_u32 v32, v32, v33
    v_mov_b32 v9, 33792
    s_mov_b64 exec, 1
    ds_write2_b32 v9, v32, v31 offset1:1
    s_mov_b64 exec, -1
    s_waitcnt lgkmcnt(0)
    s_barrier
    s_lshl_b32 s6, s47, 2
    s_add_u32 s6, s6, 4096
    s_mov_b64 exec, 1
    buffer_store_dword v31, v0, s[36:39], s6 offen sc1
    s_mov_b64 exec, -1
    s_and_b32 s61, s2, 7
    s_mul_i32 s61, s61, 4096
    s_add_u32 s61, s61, 131072
    s_add_u32 s62, s61, 3072
    s_waitcnt vmcnt(0)
    s_sleep 16
    s_branch L_poll9_1
L_poll9:
    s_sleep 3
L_poll9_1:
    buffer_load_dwordx4 v[32:35], v5, s[36:39], s61 offen sc1
    s_add_u32 s61, s61, 1024
    s_min_u32 s61, s61, s62
    s_add_u32 s65, s65, 1
    s_lshr_b32 s34, s65, 17
    s_waitcnt vmcnt(0)
    s_cbranch_scc1 L_poll9_ok
    v_cmp_ne_u32 vcc, v31, v33
    v_cmp_ne_u32 s[12:13], v31, v35
    s_or_b64 vcc, vcc, s[12:13]
    s_cbranch_vccnz L_poll9
L_poll9_ok:
    s_barrier
    s_cmp_lg_u32 s47, 0
    s_cbranch_scc1 L_zend
    s_mov_b64 exec, 0xffff
    v_lshlrev_b32 v6, 2, v0
    s_mov_b32 s6, 4096
L_za:
    buffer_load_dword v7, v6, s[36:39], s6 offen sc1
    s_add_u32 s65, s65, 1
    s_lshr_b32 s34, s65, 17
    s_waitcnt vmcnt(0)
    s_cbranch_scc1 L_za_ok
    v_cmp_ne_u32 vcc, v31, v7
    s_nop 0
    s_cbranch_vccnz L_za
L_za_ok:
    s_mov_b64 exec, 1
    v_add_u32 v9, 1, v30
    s_barrier
    buffer_store_dword v9, v6, s[36:39], 0 offen sc1
    s_mov_b64 exec, -1
    s_branch L_zend
L_F:
    v_lshlrev_b32 v5, 4, v0
    s_cmp_eq_u32 s3, 8
    s_cbranch_scc1 L_fh
    s_and_b32 s6, s60, 3
    s_lshr_b32 s7, s3, 1
    s_lshl2_add_u32 s32, s6, s7
    s_mul_i32 s8, s32, 114688
    s_lshr_b32 s33, s60, 2
    s_lshl_b32 s9, s33, 7
    s_add_u32 s8, s8, s9
    v_lshrrev_b32 v6, 3, v0
    v_mul_u32_u24 v6, 3584, v6
    v_and_b32 v7, 7, v0
    v_bfe_u32 v8, v0, 4, 1
    v_lshlrev_b32 v8, 2, v8
    v_xor_b32 v7, v7, v8
    v_lshl_add_u32 v7, v7, 4, s8
    v_add_u32 v3, v6, v7
    s_lshl_b32 s10, s3, 12
    s_mov_b32 m0, s10
    s_lshl3_add_u32 s9, s60, s3
    s_lshl_b32 s9, s9, 11
    s_mul_i32 s11, s3, 2176
    s_bitcmp1_b32 s3, 0
    s_waitcnt lgkmcnt(0)
    s_cselect_b32 s18, s20, s18
    s_cselect_b32 s19, s21, s19
    global_load_lds_dwordx4 v3, s[18:19]
    s_add_u32 m0, s10, 1024
    v_add_u32 v3, 28672, v3
    global_load_lds_dwordx4 v3, s[18:19]
    s_add_u32 m0, s10, 2048
    v_add_u32 v3, 28672, v3
    global_load_lds_dwordx4 v3, s[18:19]
    s_add_u32 m0, s10, 3072
    v_add_u32 v3, 28672, v3
    global_load_lds_dwordx4 v3, s[18:19]
    v_add_u32 v6, s9, v5
    s_add_u32 m0, s11, 32768
    v_add_u32 v7, 1024, v6
    global_load_lds_dwordx4 v6, s[22:23]
    s_add_u32 m0, s11, 33856
    s_nop 0
    global_load_lds_dwordx4 v7, s[22:23]
    s_mov_b32 s36, s30
    s_mov_b32 s37, s31
    s_mov_b32 s38, 0x1000000
    s_mov_b32 s39, 0x20000
    s_mov_b32 s65, 0
    v_bfe_u32 v6, v0, 2, 2
    v_and_b32 v7, 3, v0
    v_lshlrev_b32 v8, 3, v7
    v_lshl_add_u32 v8, v2, 5, v8
    v_and_b32 v9, 2, v6
    v_lshlrev_b32 v9, 5, v9
    v_xor_b32 v9, v9, v8
    v_lshl_add_u32 v9, v6, 7, v9
    v_add_u32 v9, s10, v9
    v_mul_u32_u24 v10, 1088, v6
    v_add_u32 v10, v10, v8
    s_lshl_b32 s11, s3, 8
    v_add_u32 v10, s11, v10
    v_lshlrev_b32 v11, 2, v0
    v_add_u32 v11, 50176, v11
    v_add_u32 v12, s11, v11
    v_mul_u32_u24 v13, 28672, v2
    v_lshl_add_u32 v13, v1, 4, v13
    v_lshlrev_b32 v15, 4, v1
    v_lshl_add_u32 v15, v2, 10, v15
    s_lshl_b32 s32, s32, 6
    s_lshl_b32 s33, s33, 12
    s_add_u32 s33, s33, 196608
    s_lshl_b32 s7, s6, 10
    s_add_u32 s61, s33, s7
    s_add_u32 s62, s61, 114688
    s_lshl_b32 s7, s6, 8
    s_add_u32 s33, s33, s7
    s_mul_i32 s8, s3, 114688
    s_lshl_b32 s9, s60, 8
    s_add_u32 s8, s8, s9
    s_add_u32 s8, s8, 720896
    v_mov_b32 v14, 52224
    v_mov_b32 v16, 0
    v_mov_b32 v17, 0
    v_mov_b32 v24, 0
    v_mov_b32 v25, 0
    v_mov_b32 v26, 0
    v_mov_b32 v27, 0
    s_waitcnt vmcnt(0)
    s_barrier
    ds_read_b64_tr_b16 v[32:33], v9 offset:0
    ds_read_b64_tr_b16 v[34:35], v9 offset:512
    ds_read_b64_tr_b16 v[36:37], v9 offset:1024
    ds_read_b64_tr_b16 v[38:39], v9 offset:1536
    ds_read_b64_tr_b16 v[40:41], v9 offset:2048
    ds_read_b64_tr_b16 v[42:43], v9 offset:2560
    ds_read_b64_tr_b16 v[44:45], v9 offset:3072
    ds_read_b64_tr_b16 v[46:47], v9 offset:3584
    s_waitcnt lgkmcnt(0)
    s_barrier
    ds_read_b64 v[30:31], v14
    s_waitcnt lgkmcnt(0)
    v_readfirstlane_b32 s6, v30
    s_andn2_b32 s6, 2047, s6
    s_lshl_b32 s6, s6, 10
    s_add_u32 s6, s6, s32
    s_load_dwordx16 s[44:59], s[4:5], s6
    v_mov_b32 v29, v31
    s_waitcnt lgkmcnt(0)
    v_dot2c_f32_bf16 v16, s44, v32
    v_dot2c_f32_bf16 v17, s45, v33
    v_dot2c_f32_bf16 v16, s46, v34
    v_dot2c_f32_bf16 v17, s47, v35
    v_dot2c_f32_bf16 v16, s48, v36
    v_dot2c_f32_bf16 v17, s49, v37
    v_dot2c_f32_bf16 v16, s50, v38
    v_dot2c_f32_bf16 v17, s51, v39
    v_dot2c_f32_bf16 v16, s52, v40
    v_dot2c_f32_bf16 v17, s53, v41
    v_dot2c_f32_bf16 v16, s54, v42
    v_dot2c_f32_bf16 v17, s55, v43
    v_dot2c_f32_bf16 v16, s56, v44
    v_dot2c_f32_bf16 v17, s57, v45
    v_dot2c_f32_bf16 v16, s58, v46
    v_dot2c_f32_bf16 v17, s59, v47
    s_nop 2
    v_add_f32 v16, v16, v17
    ds_write_b32 v12, v16
    s_waitcnt lgkmcnt(0)
    s_barrier
    s_cmp_ge_u32 s3, 4
    s_cbranch_scc1 L_fend
    s_lshl_b32 s6, s3, 4
    s_lshl_b64 s[12:13], 0xffff, s6
    ds_read2st64_b32 v[16:17], v11 offset0:0 offset1:2
    ds_read2st64_b32 v[18:19], v11 offset0:4 offset1:6
    ds_read2st64_b32 v[20:21], v11 offset0:1 offset1:3
    ds_read2st64_b32 v[22:23], v11 offset0:5 offset1:7
    s_waitcnt lgkmcnt(2)
    v_add_f32 v16, v16, v17
    v_add_f32 v18, v18, v19
    s_waitcnt lgkmcnt(0)
    v_add_f32 v20, v20, v21
    v_add_f32 v22, v22, v23
    v_add_f32 v28, v16, v18
    s_mov_b64 exec, s[12:13]
    v_add_f32 v30, v20, v22
    buffer_store_dwordx4 v[28:31], v15, s[36:39], s33 offen sc1
    s_add_u32 s33, s33, 114688
    buffer_store_dwordx4 v[28:31], v15, s[36:39], s33 offen sc1
    s_mov_b64 exec, -1
    ds_read_b64_tr_b16 v[48:49], v10 offset:32768
    ds_read_b64_tr_b16 v[50:51], v10 offset:37120
    ds_read_b64_tr_b16 v[52:53], v10 offset:41472
    ds_read_b64_tr_b16 v[54:55], v10 offset:45824
    ds_read_b64_tr_b16 v[56:57], v10 offset:32896
    ds_read_b64_tr_b16 v[58:59], v10 offset:37248
    ds_read_b64_tr_b16 v[60:61], v10 offset:41600
    ds_read_b64_tr_b16 v[62:63], v10 offset:45952
    s_waitcnt vmcnt(0)
L_poll10:
    buffer_load_dwordx4 v[16:19], v5, s[36:39], s61 offen sc1
    s_add_u32 s61, s61, 114688
    s_min_u32 s61, s61, s62
    s_add_u32 s65, s65, 1
    s_lshr_b32 s34, s65, 17
    s_waitcnt vmcnt(0)
    s_cbranch_scc1 L_poll10_ok
    v_cmp_ne_u32 vcc, v31, v17
    v_cmp_ne_u32 s[12:13], v31, v19
    s_or_b64 vcc, vcc, s[12:13]
    s_cbranch_vccnz L_poll10
L_poll10_ok:
    v_permlane16_swap_b32 v16, v18
    v_add_f32 v16, v16, v18
    v_mov_b32 v18, v16
    s_nop 1
    v_permlane32_swap_b32 v16, v18
    v_add_f32 v16, v16, v18
    v_cvt_pk_bf16_f32 v16, v16, v16
    v_and_b32 v16, 0xffff0000, v16
    v_mov_b32 v18, v16
    v_mul_f32 v17, 0xbfb8aa3b, v16
    v_exp_f32 v17, v17
    s_nop 0
    v_add_f32 v17, 1.0, v17
    v_rcp_f32 v17, v17
    s_nop 0
    v_permlane16_swap_b32 v16, v18
    v_mul_f32 v17, v17, v16
    v_cvt_pk_bf16_f32 v17, v17, v17
    v_and_b32 v17, 0xffff0000, v17
    v_mul_f32 v17, v17, v18
    s_nop 1
    v_mov_b32_dpp v18, v17 quad_perm:[1,0,3,2] row_mask:0xf bank_mask:0xf
    v_cvt_pk_bf16_f32 v17, v17, v18
    s_nop 0
    v_readlane_b32 s44, v17, 0
    v_readlane_b32 s45, v17, 2
    v_readlane_b32 s46, v17, 4
    v_readlane_b32 s47, v17, 6
    v_readlane_b32 s48, v17, 8
    v_readlane_b32 s49, v17, 10
    v_readlane_b32 s50, v17, 12
    v_readlane_b32 s51, v17, 14
    s_waitcnt lgkmcnt(0)
    v_dot2c_f32_bf16 v24, s44, v48
    v_dot2c_f32_bf16 v26, s44, v56
    v_dot2c_f32_bf16 v25, s45, v49
    v_dot2c_f32_bf16 v27, s45, v57
    v_dot2c_f32_bf16 v24, s46, v50
    v_dot2c_f32_bf16 v26, s46, v58
    v_dot2c_f32_bf16 v25, s47, v51
    v_dot2c_f32_bf16 v27, s47, v59
    v_dot2c_f32_bf16 v24, s48, v52
    v_dot2c_f32_bf16 v26, s48, v60
    v_dot2c_f32_bf16 v25, s49, v53
    v_dot2c_f32_bf16 v27, s49, v61
    v_dot2c_f32_bf16 v24, s50, v54
    v_dot2c_f32_bf16 v26, s50, v62
    v_dot2c_f32_bf16 v25, s51, v55
    v_dot2c_f32_bf16 v27, s51, v63
    s_nop 1
    v_add_f32 v28, v24, v25
    v_add_f32 v30, v26, v27
    buffer_store_dwordx4 v[28:31], v13, s[36:39], s8 offen sc1
    s_add_u32 s8, s8, 458752
    buffer_store_dwordx4 v[28:31], v13, s[36:39], s8 offen sc1
L_fend:
    s_endpgm
L_fh:
    s_waitcnt lgkmcnt(0)
    v_mov_b32 v31, 0
    global_load_dword v30, v31, s[30:31]
    s_mov_b32 s64, 0x9E3779B1
    s_mov_b32 s36, s30
    s_mov_b32 s37, s31
    s_mov_b32 s38, 0x1000000
    s_mov_b32 s39, 0x20000
    s_mov_b32 s65, 0
    s_and_b32 s61, s2, 7
    s_mul_i32 s61, s61, 3072
    s_add_u32 s61, s61, 65536
    s_add_u32 s62, s61, 2048
    s_waitcnt vmcnt(0)
    v_mul_lo_u32 v31, v30, s64
    v_add_u32 v31, 0x7F4A7C15, v31
    s_barrier
    s_sleep 6
    s_branch L_poll11_1
L_poll11:
    s_sleep 3
L_poll11_1:
    buffer_load_dwordx4 v[20:23], v5, s[36:39], s61 offen sc1
    s_add_u32 s61, s61, 1024
    s_min_u32 s61, s61, s62
    s_add_u32 s65, s65, 1
    s_lshr_b32 s34, s65, 17
    s_waitcnt vmcnt(0)
    s_cbranch_scc1 L_poll11_ok
    v_cmp_ne_u32 vcc, v31, v21
    v_cmp_ne_u32 s[12:13], v31, v23
    s_or_b64 vcc, vcc, s[12:13]
    s_cbranch_vccnz L_poll11
L_poll11_ok:
    v_max_u32 v20, v20, v22
    s_nop 1
    v_max_u32_dpp v20, v20, v20 row_ror:8 row_mask:0xf bank_mask:0xf
    s_nop 1
    v_max_u32_dpp v20, v20, v20 row_ror:4 row_mask:0xf bank_mask:0xf
    s_nop 1
    v_max_u32_dpp v20, v20, v20 row_ror:2 row_mask:0xf bank_mask:0xf
    s_nop 1
    v_max_u32_dpp v20, v20, v20 row_ror:1 row_mask:0xf bank_mask:0xf
    v_mov_b32 v21, v20
    s_nop 1
    v_permlane16_swap_b32 v20, v21
    v_max_u32 v20, v20, v21
    v_mov_b32 v21, v20
    s_nop 1
    v_permlane32_swap_b32 v20, v21
    v_max_u32 v20, v20, v21
    v_mov_b32 v9, 52224
    s_mov_b64 exec, 1
    ds_write2_b32 v9, v20, v31 offset1:1
    s_mov_b64 exec, -1
    s_waitcnt lgkmcnt(0)
    s_barrier
    s_endpgm
L_end:
    s_endpgm
.section .rodata,"a"
.p2align 6
.amdhsa_kernel gated_mix__spectral_fnet__moe_arch_mod__prompt_kernel
  .amdhsa_next_free_vgpr 168
  .amdhsa_next_free_sgpr 100
  .amdhsa_accum_offset 168
  .amdhsa_group_segment_fixed_size 0
  .amdhsa_kernarg_size 112
  .amdhsa_user_sgpr_count 2
  .amdhsa_user_sgpr_kernarg_segment_ptr 1
  .amdhsa_system_sgpr_workgroup_id_x 1
.end_amdhsa_kernel
```

```asm
; @launch grid=(256,1,1) block=(576,1,1) lds=86016
.amdgcn_target "amdgcn-amd-amdhsa--gfx950"
.text
.globl gated_mix__spectral_fnet__moe_arch_mod__prompt_kernel
.p2align 8
.type gated_mix__spectral_fnet__moe_arch_mod__prompt_kernel,@function
gated_mix__spectral_fnet__moe_arch_mod__prompt_kernel:
    s_load_dwordx2 s[4:5], s[0:1], 0
    s_load_dwordx16 s[16:31], s[0:1], 48
    v_lshrrev_b32 v1, 6, v0
    v_and_b32 v0, 63, v0
    v_readfirstlane_b32 s3, v1
    v_and_b32 v1, 15, v0
    v_lshrrev_b32 v2, 4, v0
    s_and_b32 s6, s2, 7
    s_sub_u32 s3, s3, 1
    s_min_u32 s3, s3, 8
    s_lshr_b32 s7, s2, 3
    s_cmp_ge_u32 s2, 128
    s_cbranch_scc1 L_notA
    s_add_u32 s8, s6, 1
    s_sub_u32 s9, 15, s6
    s_cmp_eq_u32 s3, 8
    s_cbranch_scc1 L_ah
    s_and_b32 s57, s7, 1
    s_bitcmp1_b32 s7, 1
    s_cselect_b32 s10, s9, s8
    s_lshr_b32 s11, s7, 2
    s_lshl4_add_u32 s56, s11, s10
    v_and_b32 v6, 1, v2
    v_lshlrev_b32 v6, 5, v6
    v_lshl_add_u32 v6, v1, 6, v6
    v_lshrrev_b32 v7, 1, v2
    v_lshl_add_u32 v3, v7, 4, v6
    s_cmp_lg_u32 s6, 7
    s_cbranch_scc1 L_k7
    s_lshr_b32 s11, s7, 1
    s_lshl3_add_u32 s56, s11, 8
    s_mov_b32 s8, 0
    s_cmp_eq_u32 s2, 127
    s_cselect_b32 s56, 0, s56
    s_cselect_b32 s57, 0, s57
L_k7:
    s_lshl3_add_u32 s11, s57, s3
    s_lshl_b32 s11, s11, 7
    s_add_u32 s58, s11, s56
    s_sub_u32 s59, 2048, s58
    s_cmp_eq_u32 s58, 0
    s_cselect_b32 s59, 1024, s59
    s_lshl_b32 s10, s58, 10
    s_lshl_b32 s11, s59, 10
    v_add_u32 v6, s10, v3
    v_add_u32 v7, s11, v3
    s_waitcnt lgkmcnt(0)
    global_load_dwordx4 v[16:19], v6, s[4:5]
    global_load_dwordx4 v[20:23], v7, s[4:5]
    s_bitcmp1_b32 s7, 3
    s_cselect_b32 s8, s9, s8
    s_and_b32 s9, s7, 7
    s_lshl3_add_u32 s51, s8, s9
    s_lshl_b32 s35, s8, 5
    s_add_u32 s35, s35, s9
    s_lshl_b32 s35, s35, 6
    s_lshr_b32 s6, s3, 2
    s_and_b32 s7, s3, 1
    s_bfe_u32 s8, s3, 0x10001
    v_lshl_add_u32 v6, s6, 4, v1
    s_lshl3_add_u32 s9, s8, s7
    s_lshl_b32 s9, s9, 2
    v_cvt_f32_u32 v6, v6
    v_lshl_add_u32 v7, v2, 3, s9
    v_mul_f32 v6, 0x3c000000, v6
    v_cvt_f32_u32 v7, v7
    v_lshlrev_b32 v5, 4, v0
    v_mul_f32 v7, v7, v6
    v_cos_f32 v96, v7
    v_sin_f32 v100, v7
    v_add_f32 v7, v7, v6
    v_cos_f32 v97, v7
    v_sin_f32 v101, v7
    v_add_f32 v7, v7, v6
    v_cos_f32 v98, v7
    v_sin_f32 v102, v7
    v_add_f32 v7, v7, v6
    v_cos_f32 v99, v7
    v_sin_f32 v103, v7
    s_lshl_b32 s10, s6, 13
    s_lshl_b32 s11, s8, 10
    s_lshl3_add_u32 s11, s7, s11
    v_add_u32 v15, s10, v5
    v_add_u32 v9, s11, v15
    v_cvt_pk_bf16_f32 v104, v96, v97
    v_cvt_pk_bf16_f32 v105, v98, v99
    v_cvt_pk_bf16_f32 v106, -v100, -v101
    v_cvt_pk_bf16_f32 v107, -v102, -v103
    v_cmp_eq_f32 vcc, 0, v6
    v_cvt_pk_bf16_f32 v108, v96, -v101
    v_cvt_pk_bf16_f32 v109, -v98, v103
    v_cvt_pk_bf16_f32 v110, -v100, -v97
    v_cvt_pk_bf16_f32 v111, v102, v99
    ds_write_b64 v9, v[104:105] offset:16384
    ds_write_b64 v9, v[108:109] offset:20480
    ds_write_b64 v9, v[110:111] offset:22528
    s_mov_b64 exec, vcc
    v_mov_b32 v106, 0xbf803f80
    v_mov_b32 v107, 0xbf803f80
    s_mov_b64 exec, -1
    ds_write_b64 v9, v[106:107] offset:18432
    global_load_dwordx4 v[24:27], v3, s[16:17]
    s_lshl_b32 s10, s3, 11
    s_add_u32 s11, s10, s51
    s_lshl_b32 s11, s11, 7
    s_mov_b32 m0, s10
    v_and_b32 v9, 7, v0
    v_bfe_u32 v13, v0, 4, 1
    v_xor_b32 v9, v9, v13
    v_lshrrev_b32 v13, 3, v0
    v_lshl_add_u32 v9, v9, 4, s11
    v_lshl_add_u32 v13, v13, 14, v9
    global_load_lds_dwordx4 v13, s[4:5]
    s_add_u32 m0, s10, 1024
    v_add_u32 v13, 0x20000, v13
    global_load_lds_dwordx4 v13, s[4:5]
    v_mov_b32 v12, 0
    v_mov_b32 v13, 0
    s_waitcnt vmcnt(2)
    v_dot2c_f32_bf16 v12, v16, v24
    v_dot2c_f32_bf16 v13, v20, v24
    v_dot2c_f32_bf16 v12, v17, v25
    v_dot2c_f32_bf16 v13, v21, v25
    v_dot2c_f32_bf16 v12, v18, v26
    v_dot2c_f32_bf16 v13, v22, v26
    v_dot2c_f32_bf16 v12, v19, v27
    v_dot2c_f32_bf16 v13, v23, v27
    s_sub_u32 s10, 0xffff, s58
    s_sub_u32 s11, 0xffff, s59
    v_mov_b32 v4, s10
    v_permlane32_swap_b32 v12, v13
    v_add_f32 v12, v12, v13
    v_mov_b32 v13, v12
    v_writelane_b32 v4, s11, 32
    s_lshl3_add_u32 s10, s3, 33792
    v_permlane16_swap_b32 v12, v13
    v_add_f32 v12, v12, v13
    v_lshrrev_b32 v9, 3, v0
    v_add_u32 v9, s10, v9
    v_add_f32_dpp v12, v12, v12 row_ror:8 row_mask:0xf bank_mask:0xf
    v_bfe_u32 v6, v0, 2, 2
    v_and_b32 v14, 3, v0
    v_add_f32_dpp v12, v12, v12 row_ror:4 row_mask:0xf bank_mask:0xf
    v_lshl_add_u32 v14, v14, 1, s8
    v_lshl_add_u32 v10, v2, 3, v6
    v_add_f32_dpp v12, v12, v12 row_ror:2 row_mask:0xf bank_mask:0xf
    v_lshrrev_b32 v6, 1, v6
    v_xor_b32 v14, v14, v6
    v_add_f32_dpp v12, v12, v12 row_ror:1 row_mask:0xf bank_mask:0xf
    v_cvt_pk_bf16_f32 v12, v12, v12
    v_and_b32 v12, 0xffff0000, v12
    v_ashrrev_i32 v7, 31, v12
    v_or_b32 v7, 0x80000000, v7
    v_xor_b32 v7, v7, v12
    v_and_b32 v7, 0xffff0000, v7
    v_or_b32 v7, v7, v4
    s_mov_b32 exec_lo, 1
    s_mov_b32 exec_hi, 1
    ds_write_b32 v9, v7
    s_mov_b64 exec, -1
    s_lshl_b32 s7, s7, 3
    v_lshl_add_u32 v14, v14, 4, s7
    v_lshl_add_u32 v10, v10, 7, v14
    s_waitcnt vmcnt(0) lgkmcnt(0)
    s_barrier
    ds_read_b64_tr_b16 v[96:97], v10 offset:0
    ds_read_b64_tr_b16 v[98:99], v10 offset:512
    ds_read_b128 v[32:35], v15 offset:16384
    ds_read_b128 v[48:51], v15 offset:18432
    ds_read_b128 v[64:67], v15 offset:20480
    ds_read_b128 v[80:83], v15 offset:22528
    ds_read_b64_tr_b16 v[100:101], v10 offset:4096
    ds_read_b64_tr_b16 v[102:103], v10 offset:4608
    ds_read_b128 v[36:39], v15 offset:17408
    ds_read_b128 v[52:55], v15 offset:19456
    ds_read_b128 v[68:71], v15 offset:21504
    ds_read_b128 v[84:87], v15 offset:23552
    s_waitcnt lgkmcnt(9)
    ds_read_b64_tr_b16 v[104:105], v10 offset:8192
    ds_read_b64_tr_b16 v[106:107], v10 offset:8704
    ds_read_b64_tr_b16 v[108:109], v10 offset:12288
    ds_read_b64_tr_b16 v[110:111], v10 offset:12800
    v_lshlrev_b32 v8, 31, v1
    v_lshrrev_b32 v14, 16, v8
    v_or_b32 v8, v8, v14
    global_load_dwordx4 v[24:27], v3, s[24:25]
    s_waitcnt lgkmcnt(13)
    v_mfma_f32_16x16x32_bf16 v[112:115], v[96:99], v[32:35], 0
    v_xor_b32 v40, v32, v8
    v_xor_b32 v41, v33, v8
    v_xor_b32 v42, v34, v8
    v_xor_b32 v43, v35, v8
    s_waitcnt lgkmcnt(12)
    v_mfma_f32_16x16x32_bf16 v[116:119], v[96:99], v[48:51], 0
    v_xor_b32 v56, v48, v8
    v_xor_b32 v57, v49, v8
    v_xor_b32 v58, v50, v8
    v_xor_b32 v59, v51, v8
    s_waitcnt lgkmcnt(11)
    v_mfma_f32_16x16x32_bf16 v[120:123], v[96:99], v[64:67], 0
    v_xor_b32 v72, v64, v8
    v_xor_b32 v73, v65, v8
    v_xor_b32 v74, v66, v8
    v_xor_b32 v75, v67, v8
    s_waitcnt lgkmcnt(10)
    v_mfma_f32_16x16x32_bf16 v[124:127], v[96:99], v[80:83], 0
    v_xor_b32 v88, v80, v8
    v_xor_b32 v89, v81, v8
    v_xor_b32 v90, v82, v8
    v_xor_b32 v91, v83, v8
    s_waitcnt lgkmcnt(7)
    v_mfma_f32_16x16x32_bf16 v[112:115], v[100:103], v[36:39], v[112:115]
    v_xor_b32 v44, v36, v8
    v_xor_b32 v45, v37, v8
    v_xor_b32 v46, v38, v8
    v_xor_b32 v47, v39, v8
    s_waitcnt lgkmcnt(6)
    v_mfma_f32_16x16x32_bf16 v[116:119], v[100:103], v[52:55], v[116:119]
    v_xor_b32 v60, v52, v8
    v_xor_b32 v61, v53, v8
    v_xor_b32 v62, v54, v8
    v_xor_b32 v63, v55, v8
    s_waitcnt lgkmcnt(5)
    v_mfma_f32_16x16x32_bf16 v[120:123], v[100:103], v[68:71], v[120:123]
    v_xor_b32 v76, v68, v8
    v_xor_b32 v77, v69, v8
    v_xor_b32 v78, v70, v8
    v_xor_b32 v79, v71, v8
    s_waitcnt lgkmcnt(4)
    v_mfma_f32_16x16x32_bf16 v[124:127], v[100:103], v[84:87], v[124:127]
    v_xor_b32 v92, v84, v8
    v_xor_b32 v93, v85, v8
    v_xor_b32 v94, v86, v8
    v_xor_b32 v95, v87, v8
    s_waitcnt lgkmcnt(2)
    v_mfma_f32_16x16x32_bf16 v[112:115], v[104:107], v[40:43], v[112:115]
    s_mul_i32 s48, s6, 528384
    s_add_u32 s48, s48, s35
    v_mfma_f32_16x16x32_bf16 v[116:119], v[104:107], v[56:59], v[116:119]
    s_and_b32 s10, s3, 3
    s_lshl_b32 s10, s10, 9
    v_mfma_f32_16x16x32_bf16 v[120:123], v[104:107], v[72:75], v[120:123]
    s_add_u32 s48, s48, s10
    s_add_u32 s48, s48, 2097152
    v_mfma_f32_16x16x32_bf16 v[124:127], v[104:107], v[88:91], v[124:127]
    s_add_u32 s49, s48, 1056768
    s_mov_b32 s55, 0
    s_waitcnt lgkmcnt(0)
    v_mfma_f32_16x16x32_bf16 v[112:115], v[108:111], v[44:47], v[112:115]
    s_mov_b32 s36, s30
    s_mov_b32 s37, s31
    v_mfma_f32_16x16x32_bf16 v[116:119], v[108:111], v[60:63], v[116:119]
    s_mov_b32 s38, 0x1000000
    s_mov_b32 s39, 0x20000
    v_mfma_f32_16x16x32_bf16 v[120:123], v[108:111], v[76:79], v[120:123]
    s_mov_b32 s65, 0
    v_mul_u32_u24 v11, 33024, v1
    v_mfma_f32_16x16x32_bf16 v[124:127], v[108:111], v[92:95], v[124:127]
    v_lshl_add_u32 v11, v2, 4, v11
    v_mov_b32 v12, 0
    v_mov_b32 v13, 0
    v_cvt_pk_bf16_f32 v96, v112, v116
    v_cvt_pk_bf16_f32 v97, v113, v117
    v_cvt_pk_bf16_f32 v98, v114, v118
    v_cvt_pk_bf16_f32 v99, v115, v119
    buffer_store_dwordx4 v[96:99], v11, s[36:39], s48 offen sc1
    v_cvt_pk_bf16_f32 v100, v120, v124
    v_cvt_pk_bf16_f32 v101, v121, v125
    v_cvt_pk_bf16_f32 v102, v122, v126
    v_cvt_pk_bf16_f32 v103, v123, v127
    buffer_store_dwordx4 v[100:103], v11, s[36:39], s49 offen sc1
L_ta_end:
    s_mov_b32 s40, s26
    s_mov_b32 s41, s27
    s_mov_b32 s42, 0x200000
    s_mov_b32 s43, 0x20000
    s_cmp_ge_u32 s3, 4
    s_cbranch_scc1 L_hi0
    v_lshlrev_b32 v6, 4, v1
    v_lshl_add_u32 v10, v2, 13, v6
    v_mul_u32_u24 v6, 4352, v2
    v_bfe_u32 v7, v1, 1, 2
    v_xor_b32 v7, s3, v7
    v_lshl_add_u32 v7, v7, 4, v6
    v_lshl_add_u32 v11, v1, 6, v7
    s_lshl4_add_u32 s7, s3, 1024
    v_mov_b32 v9, 17536
    v_lshl_add_u32 v28, v0, 1, v9
    v_lshl_add_u32 v7, v1, 1, s7
    s_mov_b32 exec_lo, 0x00ff00ff
    s_mov_b32 exec_hi, 0x00ff00ff
    v_add_u32 v28, v7, v6
    s_mov_b64 exec, -1
    v_lshrrev_b32 v6, 1, v1
    s_lshl_b32 s6, s57, 10
    s_add_u32 s6, s6, s56
    v_lshl_add_u32 v6, v6, 7, s6
    v_and_b32 v7, 1, v1
    v_lshlrev_b32 v9, 9, v7
    s_cmp_lg_u32 s56, 0
    s_cbranch_scc1 L_g01
    s_mov_b32 exec_lo, 0x00020002
    s_mov_b32 exec_hi, 0x00020002
    v_mov_b32 v6, 0x400
    v_mov_b32 v9, 0
    s_mov_b64 exec, -1
L_g01:
    v_lshlrev_b32 v7, 2, v2
    v_mad_u32_u24 v9, v7, v6, v9
    v_cvt_f32_u32 v6, v6
    v_cvt_f32_u32 v9, v9
    v_mul_f32 v6, 0x3a000000, v6
    v_mul_f32 v9, 0x3a000000, v9
    v_cos_f32 v64, v9
    v_sin_f32 v68, v9
    v_add_f32 v9, v9, v6
    v_cos_f32 v65, v9
    v_sin_f32 v69, v9
    v_add_f32 v9, v9, v6
    v_cos_f32 v66, v9
    v_sin_f32 v70, v9
    v_add_f32 v9, v9, v6
    v_cos_f32 v67, v9
    v_sin_f32 v71, v9
    s_and_b32 s7, s56, 63
    s_mul_i32 s32, s7, 33024
    v_cvt_pk_bf16_f32 v148, v64, v68
    v_cvt_pk_bf16_f32 v149, v65, v69
    v_cvt_pk_bf16_f32 v150, v66, v70
    v_cvt_pk_bf16_f32 v151, v67, v71
    s_cmp_lg_u32 s7, 0
    s_cbranch_scc1 L_gd2
    s_lshr_b32 s7, s56, 2
    v_and_b32 v148, 0xffff, v148
    v_lshlrev_b32 v148, s7, v148
    v_and_b32 v149, 0xffff, v149
    v_lshlrev_b32 v149, s7, v149
    v_and_b32 v150, 0xffff, v150
    v_lshlrev_b32 v150, s7, v150
    v_and_b32 v151, 0xffff, v151
    v_lshlrev_b32 v151, s7, v151
L_gd2:
    s_lshl_b32 s7, s3, 9
    s_add_u32 s32, s32, s7
    s_add_u32 s32, s32, 2097152
    s_add_u32 s33, s32, 4096
    s_waitcnt vmcnt(2)
    v_dot2c_f32_bf16 v12, v16, v24
    v_dot2c_f32_bf16 v13, v20, v24
    v_dot2c_f32_bf16 v12, v17, v25
    v_dot2c_f32_bf16 v13, v21, v25
    v_dot2c_f32_bf16 v12, v18, v26
    v_dot2c_f32_bf16 v13, v22, v26
    v_dot2c_f32_bf16 v12, v19, v27
    v_dot2c_f32_bf16 v13, v23, v27
    s_nop 2
    v_permlane32_swap_b32 v12, v13
    v_add_f32 v12, v12, v13
    v_mov_b32 v13, v12
    s_nop 1
    v_permlane16_swap_b32 v12, v13
    v_add_f32 v12, v12, v13
    s_nop 1
    v_add_f32_dpp v12, v12, v12 row_ror:8 row_mask:0xf bank_mask:0xf
    s_nop 1
    v_add_f32_dpp v12, v12, v12 row_ror:4 row_mask:0xf bank_mask:0xf
    s_nop 1
    v_add_f32_dpp v12, v12, v12 row_ror:2 row_mask:0xf bank_mask:0xf
    s_nop 1
    v_add_f32_dpp v12, v12, v12 row_ror:1 row_mask:0xf bank_mask:0xf
    v_cvt_pk_bf16_f32 v12, v12, v12
    v_and_b32 v12, 0xffff0000, v12
    v_mul_f32 v13, 0xbfb8aa3b, v12
    v_exp_f32 v13, v13
    s_nop 0
    v_add_f32 v13, 1.0, v13
    v_rcp_f32 v13, v13
    s_nop 0
    v_cvt_pk_bf16_f32 v13, v13, v13
    v_and_b32 v13, 0xffff0000, v13
    v_sub_f32 v14, 1.0, v13
    v_cvt_pk_bf16_f32 v14, v14, v14
    v_and_b32 v14, 0xffff0000, v14
    v_readlane_b32 s6, v13, 0
    v_readlane_b32 s7, v13, 32
    v_readlane_b32 s8, v14, 0
    v_readlane_b32 s9, v14, 32
    s_xor_b32 s10, s6, 0x80000000
    s_cmp_eq_u32 s58, 0
    s_cselect_b32 s10, 0, s10
    s_cselect_b32 s11, 0, s7
    v_mov_b32 v24, s6
    v_mov_b32 v25, s10
    v_mov_b32 v26, s11
    v_mov_b32 v27, s7
    v_mov_b32 v13, s8
    v_mov_b32 v14, s9
    v_permlane16_swap_b32 v16, v18
    v_permlane16_swap_b32 v17, v19
    v_permlane16_swap_b32 v20, v22
    v_permlane16_swap_b32 v21, v23
    v_lshlrev_b32 v152, 16, v16
    v_and_b32 v153, 0xffff0000, v16
    v_lshlrev_b32 v154, 16, v17
    v_and_b32 v155, 0xffff0000, v17
    v_lshlrev_b32 v156, 16, v18
    v_and_b32 v157, 0xffff0000, v18
    v_lshlrev_b32 v158, 16, v19
    v_and_b32 v159, 0xffff0000, v19
    v_mul_f32 v152, v13, v152
    v_mul_f32 v153, v13, v153
    v_mul_f32 v154, v13, v154
    v_mul_f32 v155, v13, v155
    v_mul_f32 v156, v13, v156
    v_mul_f32 v157, v13, v157
    v_mul_f32 v158, v13, v158
    v_mul_f32 v159, v13, v159
    v_lshlrev_b32 v160, 16, v20
    v_and_b32 v161, 0xffff0000, v20
    v_lshlrev_b32 v162, 16, v21
    v_and_b32 v163, 0xffff0000, v21
    v_lshlrev_b32 v164, 16, v22
    v_and_b32 v165, 0xffff0000, v22
    v_lshlrev_b32 v166, 16, v23
    v_and_b32 v167, 0xffff0000, v23
    v_mul_f32 v160, v14, v160
    v_mul_f32 v161, v14, v161
    v_mul_f32 v162, v14, v162
    v_mul_f32 v163, v14, v163
    v_mul_f32 v164, v14, v164
    v_mul_f32 v165, v14, v165
    v_mul_f32 v166, v14, v166
    v_mul_f32 v167, v14, v167
    s_waitcnt vmcnt(0)
    s_barrier
    v_cvt_f32_u32 v6, v1
    s_lshl_b32 s6, s3, 2
    v_lshl_add_u32 v7, v2, 6, s6
    v_mul_f32 v6, 0x3b000000, v6
    v_cvt_f32_u32 v7, v7
    v_mul_f32 v15, 0x41800000, v6
    v_mul_f32 v7, v7, v6
    v_cos_f32 v64, v7
    v_sin_f32 v68, v7
    v_add_f32 v9, v7, v15
    v_cos_f32 v65, v9
    v_sin_f32 v69, v9
    v_add_f32 v9, v9, v15
    v_cos_f32 v66, v9
    v_sin_f32 v70, v9
    v_add_f32 v9, v9, v15
    v_cos_f32 v67, v9
    v_sin_f32 v71, v9
    v_mov_b32 v108, 0
    v_cvt_pk_bf16_f32 v100, v64, v65
    v_cvt_pk_bf16_f32 v104, -v68, -v69
    v_cvt_pk_bf16_f32 v101, v66, v67
    v_cvt_pk_bf16_f32 v105, -v70, -v71
    v_xor_b32 v102, v100, v8
    v_xor_b32 v106, v104, v8
    v_xor_b32 v103, v101, v8
    v_xor_b32 v107, v105, v8
    v_add_f32 v7, v7, v6
    v_cos_f32 v64, v7
    v_sin_f32 v68, v7
    v_add_f32 v9, v7, v15
    v_cos_f32 v65, v9
    v_sin_f32 v69, v9
    v_add_f32 v9, v9, v15
    v_cos_f32 v66, v9
    v_sin_f32 v70, v9
    v_add_f32 v9, v9, v15
    v_cos_f32 v67, v9
    v_sin_f32 v71, v9
    v_mov_b32 v120, 0
    v_cvt_pk_bf16_f32 v112, v64, v65
    v_cvt_pk_bf16_f32 v116, -v68, -v69
    v_cvt_pk_bf16_f32 v113, v66, v67
    v_cvt_pk_bf16_f32 v117, -v70, -v71
    v_xor_b32 v114, v112, v8
    v_xor_b32 v118, v116, v8
    v_xor_b32 v115, v113, v8
    v_xor_b32 v119, v117, v8
    v_add_f32 v7, v7, v6
    v_cos_f32 v64, v7
    v_sin_f32 v68, v7
    v_add_f32 v9, v7, v15
    v_cos_f32 v65, v9
    v_sin_f32 v69, v9
    v_add_f32 v9, v9, v15
    v_cos_f32 v66, v9
    v_sin_f32 v70, v9
    v_add_f32 v9, v9, v15
    v_cos_f32 v67, v9
    v_sin_f32 v71, v9
    v_mov_b32 v132, 0
    v_cvt_pk_bf16_f32 v124, v64, v65
    v_cvt_pk_bf16_f32 v128, -v68, -v69
    v_cvt_pk_bf16_f32 v125, v66, v67
    v_cvt_pk_bf16_f32 v129, -v70, -v71
    v_xor_b32 v126, v124, v8
    v_xor_b32 v130, v128, v8
    v_xor_b32 v127, v125, v8
    v_xor_b32 v131, v129, v8
    v_add_f32 v7, v7, v6
    v_cos_f32 v64, v7
    v_sin_f32 v68, v7
    v_add_f32 v9, v7, v15
    v_cos_f32 v65, v9
    v_sin_f32 v69, v9
    v_add_f32 v9, v9, v15
    v_cos_f32 v66, v9
    v_sin_f32 v70, v9
    v_add_f32 v9, v9, v15
    v_cos_f32 v67, v9
    v_sin_f32 v71, v9
    v_mov_b32 v144, 0
    v_cvt_pk_bf16_f32 v136, v64, v65
    v_cvt_pk_bf16_f32 v140, -v68, -v69
    v_cvt_pk_bf16_f32 v137, v66, v67
    v_cvt_pk_bf16_f32 v141, -v70, -v71
    v_xor_b32 v138, v136, v8
    v_xor_b32 v142, v140, v8
    v_xor_b32 v139, v137, v8
    v_xor_b32 v143, v141, v8
    v_lshrrev_b32 v6, 1, v1
    v_add_u32 v7, s6, v6
    v_and_b32 v9, 1, v1
    v_lshl_add_u32 v7, v9, 3, v7
    v_cvt_f32_u32 v7, v7
    v_mul_f32 v7, 0x3d000000, v7
    v_cos_f32 v7, v7
    s_mov_b32 exec_lo, 0x30003
    s_mov_b32 exec_hi, 0x30003
    v_cvt_pk_bf16_f32 v108, v7, -v7
    s_mov_b32 exec_lo, 0xc000c
    s_mov_b32 exec_hi, 0xc000c
    v_cvt_pk_bf16_f32 v120, v7, -v7
    s_mov_b32 exec_lo, 0x300030
    s_mov_b32 exec_hi, 0x300030
    v_cvt_pk_bf16_f32 v132, v7, -v7
    s_mov_b32 exec_lo, 0xc000c0
    s_mov_b32 exec_hi, 0xc000c0
    v_cvt_pk_bf16_f32 v144, v7, -v7
    s_mov_b64 exec, -1
    v_mov_b32 v109, v108
    v_mov_b32 v110, v108
    v_mov_b32 v111, v108
    v_mov_b32 v121, v120
    v_mov_b32 v122, v120
    v_mov_b32 v123, v120
    v_mov_b32 v133, v132
    v_mov_b32 v134, v132
    v_mov_b32 v135, v132
    v_mov_b32 v145, v144
    v_mov_b32 v146, v144
    v_mov_b32 v147, v144
    s_barrier
    buffer_load_dwordx4 v[32:35], v10, s[36:39], s32 offen offset:0 sc1
    buffer_load_dwordx4 v[36:39], v10, s[36:39], s32 offen offset:2048 sc1
    buffer_load_dwordx4 v[40:43], v10, s[36:39], s33 offen offset:0 sc1
    buffer_load_dwordx4 v[44:47], v10, s[36:39], s33 offen offset:2048 sc1
    buffer_load_dwordx4 v[48:51], v10, s[36:39], s32 offen offset:256 sc1
    buffer_load_dwordx4 v[52:55], v10, s[36:39], s32 offen offset:2304 sc1
    buffer_load_dwordx4 v[56:59], v10, s[36:39], s33 offen offset:256 sc1
    buffer_load_dwordx4 v[60:63], v10, s[36:39], s33 offen offset:2304 sc1
    s_mul_i32 s7, s3, 2176
    v_bfe_u32 v7, v1, 1, 2
    v_xor_b32 v7, v7, v2
    v_lshl_add_u32 v7, v7, 4, s7
    v_lshl_add_u32 v29, v1, 6, v7
    v_sub_u32 v6, 16, v1
    v_bfe_u32 v7, v6, 1, 2
    v_xor_b32 v7, v7, v2
    v_lshl_add_u32 v7, v7, 4, s7
    v_lshl_add_u32 v30, v6, 6, v7
    s_cmp_eq_u32 s58, 0
    s_cselect_b32 s6, 0, 2048
    v_add_u32 v4, s6, v5
L_zjoin:
    s_waitcnt vmcnt(4)
L_got0:
    v_pk_mov_b32 v[80:81], v[32:33], v[36:37] op_sel:[0,0]
    v_pk_mov_b32 v[82:83], v[40:41], v[44:45] op_sel:[0,0]
    v_pk_mov_b32 v[84:85], v[32:33], v[36:37] op_sel:[1,1]
    v_pk_mov_b32 v[86:87], v[40:41], v[44:45] op_sel:[1,1]
    v_mfma_f32_16x16x32_bf16 v[64:67], v[80:83], v[148:151], 0
    v_pk_mov_b32 v[88:89], v[34:35], v[38:39] op_sel:[0,0]
    v_pk_mov_b32 v[90:91], v[42:43], v[46:47] op_sel:[0,0]
    v_mfma_f32_16x16x32_bf16 v[68:71], v[84:87], v[148:151], 0
    v_pk_mov_b32 v[92:93], v[34:35], v[38:39] op_sel:[1,1]
    v_pk_mov_b32 v[94:95], v[42:43], v[46:47] op_sel:[1,1]
    v_mfma_f32_16x16x32_bf16 v[72:75], v[88:91], v[148:151], 0
    s_nop 1
    v_mfma_f32_16x16x32_bf16 v[76:79], v[92:95], v[148:151], 0
    s_waitcnt vmcnt(0)
L_got1:
    v_pk_mov_b32 v[80:81], v[48:49], v[52:53] op_sel:[0,0]
    v_pk_mov_b32 v[82:83], v[56:57], v[60:61] op_sel:[0,0]
    v_pk_mov_b32 v[84:85], v[48:49], v[52:53] op_sel:[1,1]
    v_pk_mov_b32 v[86:87], v[56:57], v[60:61] op_sel:[1,1]
    v_mfma_f32_16x16x32_bf16 v[32:35], v[80:83], v[148:151], 0
    v_pk_mov_b32 v[88:89], v[50:51], v[54:55] op_sel:[0,0]
    v_pk_mov_b32 v[90:91], v[58:59], v[62:63] op_sel:[0,0]
    v_mfma_f32_16x16x32_bf16 v[36:39], v[84:87], v[148:151], 0
    v_pk_mov_b32 v[92:93], v[50:51], v[54:55] op_sel:[1,1]
    v_pk_mov_b32 v[94:95], v[58:59], v[62:63] op_sel:[1,1]
    v_mfma_f32_16x16x32_bf16 v[40:43], v[88:91], v[148:151], 0
    s_nop 1
    v_mfma_f32_16x16x32_bf16 v[44:47], v[92:95], v[148:151], 0
    s_nop 0
    v_cvt_pk_bf16_f32 v80, v64, v65
    v_cvt_pk_bf16_f32 v81, v66, v67
    v_cvt_pk_bf16_f32 v82, v32, v33
    v_cvt_pk_bf16_f32 v83, v34, v35
    v_cvt_pk_bf16_f32 v84, v68, v69
    v_cvt_pk_bf16_f32 v85, v70, v71
    v_cvt_pk_bf16_f32 v86, v36, v37
    v_cvt_pk_bf16_f32 v87, v38, v39
    v_mfma_f32_16x16x32_bf16 v[64:67], v[80:83], v[100:103], 0
    v_mfma_f32_16x16x32_bf16 v[32:35], v[80:83], v[104:107], 0
    v_mfma_f32_16x16x32_bf16 v[96:99], v[80:83], v[108:111], 0
    v_cvt_pk_bf16_f32 v88, v72, v73
    v_cvt_pk_bf16_f32 v89, v74, v75
    v_cvt_pk_bf16_f32 v90, v40, v41
    v_cvt_pk_bf16_f32 v91, v42, v43
    v_mfma_f32_16x16x32_bf16 v[68:71], v[84:87], v[112:115], 0
    v_mfma_f32_16x16x32_bf16 v[36:39], v[84:87], v[116:119], 0
    v_mfma_f32_16x16x32_bf16 v[96:99], v[84:87], v[120:123], v[96:99]
    v_cvt_pk_bf16_f32 v92, v76, v77
    v_cvt_pk_bf16_f32 v93, v78, v79
    v_cvt_pk_bf16_f32 v94, v44, v45
    v_cvt_pk_bf16_f32 v95, v46, v47
    v_mfma_f32_16x16x32_bf16 v[72:75], v[88:91], v[124:127], 0
    v_mfma_f32_16x16x32_bf16 v[40:43], v[88:91], v[128:131], 0
    v_mfma_f32_16x16x32_bf16 v[96:99], v[88:91], v[132:135], v[96:99]
    v_mfma_f32_16x16x32_bf16 v[76:79], v[92:95], v[136:139], 0
    v_mfma_f32_16x16x32_bf16 v[44:47], v[92:95], v[140:143], 0
    v_mfma_f32_16x16x32_bf16 v[96:99], v[92:95], v[144:147], v[96:99]
    v_cvt_pk_bf16_f32 v48, v64, v32
    v_cvt_pk_bf16_f32 v52, v65, v33
    v_cvt_pk_bf16_f32 v56, v66, v34
    v_cvt_pk_bf16_f32 v60, v67, v35
    v_cvt_pk_bf16_f32 v49, v68, v36
    v_cvt_pk_bf16_f32 v53, v69, v37
    v_cvt_pk_bf16_f32 v57, v70, v38
    v_cvt_pk_bf16_f32 v61, v71, v39
    v_cvt_pk_bf16_f32 v50, v72, v40
    v_cvt_pk_bf16_f32 v54, v73, v41
    v_cvt_pk_bf16_f32 v58, v74, v42
    v_cvt_pk_bf16_f32 v62, v75, v43
    v_cvt_pk_bf16_f32 v51, v76, v44
    ds_write_b128 v11, v[48:51] offset:16384
    v_cvt_pk_bf16_f32 v55, v77, v45
    ds_write_b128 v11, v[52:55] offset:17472
    v_cvt_pk_bf16_f32 v59, v78, v46
    ds_write_b128 v11, v[56:59] offset:18560
    v_cvt_pk_bf16_f32 v63, v79, v47
    ds_write_b128 v11, v[60:63] offset:19648
    v_cvt_pk_bf16_f32 v96, v96, v97
    v_cvt_pk_bf16_f32 v98, v98, v99
    ds_write_b16 v28, v96 offset:16384
    ds_write_b16_d16_hi v28, v96 offset:17472
    ds_write_b16 v28, v98 offset:18560
    ds_write_b16_d16_hi v28, v98 offset:19648
L_d2:
    ds_read_b128 v[64:67], v5 offset:40576
    ds_read_b128 v[68:71], v5 offset:41600
    ds_read_b128 v[72:75], v4 offset:40576
    ds_read_b128 v[76:79], v4 offset:41600
    v_mov_b32 v9, 33856
    ds_read_b32 v6, v9
    s_waitcnt lgkmcnt(0)
    s_barrier
    ds_read_b128 v[32:35], v29 offset:16384
    ds_read_b128 v[36:39], v30 offset:16384
    ds_read_b128 v[40:43], v29 offset:17472
    ds_read_b128 v[44:47], v30 offset:17472
    s_cmp_lg_u32 s55, 0
    s_cbranch_scc1 L_zfin
    v_readfirstlane_b32 s44, v6
    s_lshl_b32 s6, s58, 10
    s_lshl_b32 s7, s59, 10
    s_andn2_b32 s54, 0xffff, s44
    s_waitcnt lgkmcnt(3)
    v_mfma_f32_16x16x32_bf16 v[48:51], v[32:35], v[64:67], 0
    s_waitcnt lgkmcnt(2)
    v_mfma_f32_16x16x32_bf16 v[52:55], v[36:39], v[68:71], 0
    s_waitcnt lgkmcnt(1)
    v_mfma_f32_16x16x32_bf16 v[56:59], v[40:43], v[72:75], 0
    s_waitcnt lgkmcnt(0)
    v_mfma_f32_16x16x32_bf16 v[60:63], v[44:47], v[76:79], 0
    s_nop 1
    v_fmac_f32 v152, v24, v48
    v_fmac_f32 v153, v24, v49
    v_fmac_f32 v154, v24, v50
    v_fmac_f32 v155, v24, v51
    v_fmac_f32 v156, v24, v52
    v_fmac_f32 v157, v24, v53
    v_fmac_f32 v158, v24, v54
    v_fmac_f32 v159, v24, v55
    v_fmac_f32 v160, v26, v48
    v_fmac_f32 v161, v26, v49
    v_fmac_f32 v162, v26, v50
    v_fmac_f32 v163, v26, v51
    v_fmac_f32 v164, v26, v52
    v_fmac_f32 v165, v26, v53
    v_fmac_f32 v166, v26, v54
    v_fmac_f32 v167, v26, v55
    v_fmac_f32 v152, v25, v56
    v_fmac_f32 v153, v25, v57
    v_fmac_f32 v154, v25, v58
    v_fmac_f32 v155, v25, v59
    v_fmac_f32 v156, v25, v60
    v_fmac_f32 v157, v25, v61
    v_fmac_f32 v158, v25, v62
    v_fmac_f32 v159, v25, v63
    v_cvt_pk_bf16_f32 v32, v152, v153
    v_cvt_pk_bf16_f32 v33, v154, v155
    v_cvt_pk_bf16_f32 v34, v156, v157
    v_cvt_pk_bf16_f32 v35, v158, v159
    s_cmp_eq_u32 s58, s54
    s_cbranch_scc1 L_skip3
    v_permlane16_swap_b32 v32, v34
    v_permlane16_swap_b32 v33, v35
    buffer_store_dwordx4 v[32:35], v3, s[40:43], s6 offen nt
L_skip3:
    v_fmac_f32 v160, v27, v56
    v_fmac_f32 v161, v27, v57
    v_fmac_f32 v162, v27, v58
    v_fmac_f32 v163, v27, v59
    v_fmac_f32 v164, v27, v60
    v_fmac_f32 v165, v27, v61
    v_fmac_f32 v166, v27, v62
    v_fmac_f32 v167, v27, v63
    v_cvt_pk_bf16_f32 v36, v160, v161
    v_cvt_pk_bf16_f32 v37, v162, v163
    v_cvt_pk_bf16_f32 v38, v164, v165
    v_cvt_pk_bf16_f32 v39, v166, v167
    s_cmp_eq_u32 s59, s54
    s_cbranch_scc1 L_skip4
    v_permlane16_swap_b32 v36, v38
    v_permlane16_swap_b32 v37, v39
    buffer_store_dwordx4 v[36:39], v3, s[40:43], s7 offen nt
L_skip4:
    s_endpgm
L_hi0:
    s_waitcnt vmcnt(0)
    s_barrier
    s_barrier
    s_waitcnt vmcnt(2)
    v_dot2c_f32_bf16 v12, v16, v24
    v_dot2c_f32_bf16 v13, v20, v24
    v_dot2c_f32_bf16 v12, v17, v25
    v_dot2c_f32_bf16 v13, v21, v25
    v_dot2c_f32_bf16 v12, v18, v26
    v_dot2c_f32_bf16 v13, v22, v26
    v_dot2c_f32_bf16 v12, v19, v27
    v_dot2c_f32_bf16 v13, v23, v27
    s_nop 2
    v_permlane32_swap_b32 v12, v13
    v_add_f32 v12, v12, v13
    v_mov_b32 v13, v12
    s_nop 1
    v_permlane16_swap_b32 v12, v13
    v_add_f32 v12, v12, v13
    s_nop 1
    v_add_f32_dpp v12, v12, v12 row_ror:8 row_mask:0xf bank_mask:0xf
    s_nop 1
    v_add_f32_dpp v12, v12, v12 row_ror:4 row_mask:0xf bank_mask:0xf
    s_nop 1
    v_add_f32_dpp v12, v12, v12 row_ror:2 row_mask:0xf bank_mask:0xf
    s_nop 1
    v_add_f32_dpp v12, v12, v12 row_ror:1 row_mask:0xf bank_mask:0xf
    v_cvt_pk_bf16_f32 v12, v12, v12
    v_and_b32 v12, 0xffff0000, v12
    v_mul_f32 v13, 0xbfb8aa3b, v12
    v_exp_f32 v13, v13
    s_nop 0
    v_add_f32 v13, 1.0, v13
    v_rcp_f32 v13, v13
    s_nop 0
    v_cvt_pk_bf16_f32 v13, v13, v13
    v_and_b32 v13, 0xffff0000, v13
    v_sub_f32 v14, 1.0, v13
    v_cvt_pk_bf16_f32 v14, v14, v14
    v_and_b32 v14, 0xffff0000, v14
    v_readlane_b32 s6, v13, 0
    v_readlane_b32 s7, v13, 32
    v_readlane_b32 s8, v14, 0
    v_readlane_b32 s9, v14, 32
    s_xor_b32 s10, s6, 0x80000000
    s_cmp_eq_u32 s58, 0
    s_cselect_b32 s10, 0, s10
    s_cselect_b32 s11, 0, s7
    v_mov_b32 v24, s6
    v_mov_b32 v25, s10
    v_mov_b32 v26, s11
    v_mov_b32 v27, s7
    v_mov_b32 v13, s8
    v_mov_b32 v14, s9
    v_permlane16_swap_b32 v16, v18
    v_permlane16_swap_b32 v17, v19
    v_permlane16_swap_b32 v20, v22
    v_permlane16_swap_b32 v21, v23
    v_lshlrev_b32 v152, 16, v16
    v_and_b32 v153, 0xffff0000, v16
    v_lshlrev_b32 v154, 16, v17
    v_and_b32 v155, 0xffff0000, v17
    v_lshlrev_b32 v156, 16, v18
    v_and_b32 v157, 0xffff0000, v18
    v_lshlrev_b32 v158, 16, v19
    v_and_b32 v159, 0xffff0000, v19
    v_mul_f32 v152, v13, v152
    v_mul_f32 v153, v13, v153
    v_mul_f32 v154, v13, v154
    v_mul_f32 v155, v13, v155
    v_mul_f32 v156, v13, v156
    v_mul_f32 v157, v13, v157
    v_mul_f32 v158, v13, v158
    v_mul_f32 v159, v13, v159
    v_lshlrev_b32 v160, 16, v20
    v_and_b32 v161, 0xffff0000, v20
    v_lshlrev_b32 v162, 16, v21
    v_and_b32 v163, 0xffff0000, v21
    v_lshlrev_b32 v164, 16, v22
    v_and_b32 v165, 0xffff0000, v22
    v_lshlrev_b32 v166, 16, v23
    v_and_b32 v167, 0xffff0000, v23
    v_mul_f32 v160, v14, v160
    v_mul_f32 v161, v14, v161
    v_mul_f32 v162, v14, v162
    v_mul_f32 v163, v14, v163
    v_mul_f32 v164, v14, v164
    v_mul_f32 v165, v14, v165
    v_mul_f32 v166, v14, v166
    v_mul_f32 v167, v14, v167
    s_mul_i32 s7, s3, 2176
    v_bfe_u32 v7, v1, 1, 2
    v_xor_b32 v7, v7, v2
    v_lshl_add_u32 v7, v7, 4, s7
    v_lshl_add_u32 v29, v1, 6, v7
    v_sub_u32 v6, 16, v1
    v_bfe_u32 v7, v6, 1, 2
    v_xor_b32 v7, v7, v2
    v_lshl_add_u32 v7, v7, 4, s7
    v_lshl_add_u32 v30, v6, 6, v7
    s_cmp_eq_u32 s58, 0
    s_cselect_b32 s6, 0, 2048
    v_add_u32 v4, s6, v5
    s_branch L_d2
L_ah:
    v_lshlrev_b32 v5, 4, v0
    v_mov_b32 v31, 0
    s_mov_b32 s64, 0x9E3779B1
    s_cmp_ge_u32 s7, 1
    s_waitcnt lgkmcnt(0)
    s_cbranch_scc1 L_nowpf
    global_load_dwordx4 v[32:35], v5, s[16:17]
    global_load_dword v30, v31, s[30:31]
    global_load_dwordx4 v[36:39], v5, s[24:25]
L_nowpf:
    v_lshlrev_b32 v14, 10, v0
    s_lshl_b32 s50, s2, 3
    s_add_u32 s50, s50, 65536
    s_mov_b32 s36, s30
    s_mov_b32 s37, s31
    s_mov_b32 s38, 0x1000000
    s_mov_b32 s39, 0x20000
    s_mov_b32 s65, 0
    v_lshlrev_b32 v6, 2, v2
    v_cvt_f32_u32 v7, v1
    v_cvt_f32_u32 v6, v6
    v_mul_f32 v7, 0x3d800000, v7
    v_mul_f32 v9, v6, v7
    v_cos_f32 v64, v9
    v_sin_f32 v68, v9
    v_add_f32 v9, v9, v7
    v_cos_f32 v65, v9
    v_sin_f32 v69, v9
    v_add_f32 v9, v9, v7
    v_cos_f32 v66, v9
    v_sin_f32 v70, v9
    v_add_f32 v9, v9, v7
    v_cos_f32 v67, v9
    v_sin_f32 v71, v9
    s_nop 0
    v_cvt_pk_bf16_f32 v40, v64, v68
    v_cvt_pk_bf16_f32 v48, -v68, v64
    v_cvt_pk_bf16_f32 v41, v65, v69
    v_cvt_pk_bf16_f32 v49, -v69, v65
    v_cvt_pk_bf16_f32 v42, v66, v70
    v_cvt_pk_bf16_f32 v50, -v70, v66
    v_cvt_pk_bf16_f32 v43, v67, v71
    v_cvt_pk_bf16_f32 v51, -v71, v67
    v_add_f32 v7, 0x3d800000, v7
    v_mul_f32 v9, v6, v7
    v_cos_f32 v64, v9
    v_sin_f32 v68, v9
    v_add_f32 v9, v9, v7
    v_cos_f32 v65, v9
    v_sin_f32 v69, v9
    v_add_f32 v9, v9, v7
    v_cos_f32 v66, v9
    v_sin_f32 v70, v9
    v_add_f32 v9, v9, v7
    v_cos_f32 v67, v9
    v_sin_f32 v71, v9
    s_nop 0
    v_cvt_pk_bf16_f32 v44, v64, -v68
    v_cvt_pk_bf16_f32 v52, -v68, -v64
    v_cvt_pk_bf16_f32 v45, v65, -v69
    v_cvt_pk_bf16_f32 v53, -v69, -v65
    v_cvt_pk_bf16_f32 v46, v66, -v70
    v_cvt_pk_bf16_f32 v54, -v70, -v66
    v_cvt_pk_bf16_f32 v47, v67, -v71
    v_cvt_pk_bf16_f32 v55, -v71, -v67
    ds_write_b128 v5, v[40:43] offset:40576
    ds_write_b128 v5, v[44:47] offset:41600
    ds_write_b128 v5, v[48:51] offset:42624
    ds_write_b128 v5, v[52:55] offset:43648
    global_load_dword v30, v31, s[30:31]
    v_mov_b32 v9, 33792
    s_waitcnt vmcnt(0)
    v_mul_lo_u32 v31, v30, s64
    v_add_u32 v31, 0x7F4A7C15, v31
    s_barrier
    ds_read_b128 v[40:43], v9 offset:0
    ds_read_b128 v[44:47], v9 offset:16
    ds_read_b128 v[48:51], v9 offset:32
    ds_read_b128 v[52:55], v9 offset:48
    s_mov_b64 exec, 0x7ffff
    s_waitcnt lgkmcnt(2)
    v_max3_u32 v6, v40, v41, v42
    v_max3_u32 v7, v43, v44, v45
    v_max3_u32 v6, v46, v47, v6
    s_waitcnt lgkmcnt(0)
    v_max3_u32 v7, v48, v49, v7
    v_max3_u32 v6, v50, v51, v6
    v_max3_u32 v7, v52, v53, v7
    v_max3_u32 v6, v54, v55, v6
    v_max_u32 v30, v6, v7
    buffer_store_dwordx2 v[30:31], v14, s[36:39], s50 offen sc1
    s_mov_b64 exec, -1
    s_add_u32 s50, s50, 65536
    s_and_b32 s61, s2, 7
    s_mul_i32 s61, s61, 2048
    s_add_u32 s61, s61, 131072
    s_add_u32 s62, s61, 1024
    s_barrier
    s_mov_b64 exec, 0xffff
    buffer_store_dwordx2 v[30:31], v14, s[36:39], s50 offen sc1
    s_mov_b64 exec, -1
    s_waitcnt vmcnt(0)
    s_sleep 4
    s_branch L_poll5_1
L_poll5:
    s_sleep 3
L_poll5_1:
    buffer_load_dwordx4 v[32:35], v5, s[36:39], s61 offen sc1
    s_add_u32 s61, s61, 1024
    s_min_u32 s61, s61, s62
    s_add_u32 s65, s65, 1
    s_lshr_b32 s34, s65, 17
    s_waitcnt vmcnt(0)
    s_cbranch_scc1 L_poll5_ok
    v_cmp_ne_u32 vcc, v31, v33
    v_cmp_ne_u32 s[12:13], v31, v35
    s_or_b64 vcc, vcc, s[12:13]
    s_cbranch_vccnz L_poll5
L_poll5_ok:
    v_max_u32 v32, v32, v34
    s_nop 1
    v_max_u32_dpp v32, v32, v32 row_ror:8 row_mask:0xf bank_mask:0xf
    s_nop 1
    v_max_u32_dpp v32, v32, v32 row_ror:4 row_mask:0xf bank_mask:0xf
    s_nop 1
    v_max_u32_dpp v32, v32, v32 row_ror:2 row_mask:0xf bank_mask:0xf
    s_nop 1
    v_max_u32_dpp v32, v32, v32 row_ror:1 row_mask:0xf bank_mask:0xf
    v_mov_b32 v33, v32
    s_nop 1
    v_permlane16_swap_b32 v32, v33
    v_max_u32 v32, v32, v33
    v_mov_b32 v33, v32
    s_nop 1
    v_permlane32_swap_b32 v32, v33
    v_max_u32 v32, v32, v33
    v_mov_b32 v9, 33856
    s_mov_b64 exec, 1
    ds_write_b32 v9, v32
    s_mov_b64 exec, -1
    s_waitcnt lgkmcnt(0)
    s_barrier
    s_endpgm
L_notA:
    s_lshl4_add_u32 s60, s6, s7
    s_sub_u32 s60, s60, 16
    s_cmp_ge_u32 s2, 256
    s_cbranch_scc1 L_end
    s_cmp_lt_u32 s6, 4
    s_cbranch_scc1 L_F
    s_mul_i32 s60, s6, 12
    s_add_u32 s60, s60, s7
    s_cmp_lt_u32 s7, 28
    s_cbranch_scc1 L_F
    s_mov_b32 s55, 1
    s_lshl2_add_u32 s47, s6, s7
    s_sub_u32 s47, s47, 44
    v_and_b32 v6, 1, v2
    v_lshlrev_b32 v6, 5, v6
    v_lshl_add_u32 v6, v1, 6, v6
    v_lshrrev_b32 v7, 1, v2
    v_lshl_add_u32 v3, v7, 4, v6
    v_lshlrev_b32 v5, 4, v0
    v_lshlrev_b32 v8, 31, v1
    v_lshrrev_b32 v9, 16, v8
    v_or_b32 v8, v8, v9
    s_waitcnt lgkmcnt(0)
    s_mov_b32 s36, s30
    s_mov_b32 s37, s31
    s_mov_b32 s38, 0x1000000
    s_mov_b32 s39, 0x20000
    s_mov_b32 s65, 0
    s_mov_b32 s40, s26
    s_mov_b32 s41, s27
    s_mov_b32 s42, 0x200000
    s_mov_b32 s43, 0x20000
    v_lshlrev_b32 v6, 4, v1
    v_lshl_add_u32 v10, v2, 13, v6
    v_mul_u32_u24 v6, 4352, v2
    v_bfe_u32 v7, v1, 1, 2
    v_xor_b32 v7, s3, v7
    v_lshl_add_u32 v7, v7, 4, v6
    v_lshl_add_u32 v11, v1, 6, v7
    s_lshl4_add_u32 s7, s3, 1024
    v_mov_b32 v9, 17536
    v_lshl_add_u32 v28, v0, 1, v9
    v_lshl_add_u32 v7, v1, 1, s7
    s_mov_b32 exec_lo, 0x00ff00ff
    s_mov_b32 exec_hi, 0x00ff00ff
    v_add_u32 v28, v7, v6
    s_mov_b64 exec, -1
    s_cmp_eq_u32 s3, 8
    s_cbranch_scc1 L_zh
    s_cmp_ge_u32 s3, 4
    s_cbranch_scc1 L_z0
    v_cvt_f32_u32 v6, v1
    s_lshl_b32 s6, s3, 2
    v_lshl_add_u32 v7, v2, 6, s6
    v_mul_f32 v6, 0x3b000000, v6
    v_cvt_f32_u32 v7, v7
    v_mul_f32 v15, 0x41800000, v6
    v_mul_f32 v7, v7, v6
    v_cos_f32 v64, v7
    v_sin_f32 v68, v7
    v_add_f32 v9, v7, v15
    v_cos_f32 v65, v9
    v_sin_f32 v69, v9
    v_add_f32 v9, v9, v15
    v_cos_f32 v66, v9
    v_sin_f32 v70, v9
    v_add_f32 v9, v9, v15
    v_cos_f32 v67, v9
    v_sin_f32 v71, v9
    v_mov_b32 v108, 0
    v_cvt_pk_bf16_f32 v100, v64, v65
    v_cvt_pk_bf16_f32 v104, -v68, -v69
    v_cvt_pk_bf16_f32 v101, v66, v67
    v_cvt_pk_bf16_f32 v105, -v70, -v71
    v_xor_b32 v102, v100, v8
    v_xor_b32 v106, v104, v8
    v_xor_b32 v103, v101, v8
    v_xor_b32 v107, v105, v8
    v_add_f32 v7, v7, v6
    v_cos_f32 v64, v7
    v_sin_f32 v68, v7
    v_add_f32 v9, v7, v15
    v_cos_f32 v65, v9
    v_sin_f32 v69, v9
    v_add_f32 v9, v9, v15
    v_cos_f32 v66, v9
    v_sin_f32 v70, v9
    v_add_f32 v9, v9, v15
    v_cos_f32 v67, v9
    v_sin_f32 v71, v9
    v_mov_b32 v120, 0
    v_cvt_pk_bf16_f32 v112, v64, v65
    v_cvt_pk_bf16_f32 v116, -v68, -v69
    v_cvt_pk_bf16_f32 v113, v66, v67
    v_cvt_pk_bf16_f32 v117, -v70, -v71
    v_xor_b32 v114, v112, v8
    v_xor_b32 v118, v116, v8
    v_xor_b32 v115, v113, v8
    v_xor_b32 v119, v117, v8
    v_add_f32 v7, v7, v6
    v_cos_f32 v64, v7
    v_sin_f32 v68, v7
    v_add_f32 v9, v7, v15
    v_cos_f32 v65, v9
    v_sin_f32 v69, v9
    v_add_f32 v9, v9, v15
    v_cos_f32 v66, v9
    v_sin_f32 v70, v9
    v_add_f32 v9, v9, v15
    v_cos_f32 v67, v9
    v_sin_f32 v71, v9
    v_mov_b32 v132, 0
    v_cvt_pk_bf16_f32 v124, v64, v65
    v_cvt_pk_bf16_f32 v128, -v68, -v69
    v_cvt_pk_bf16_f32 v125, v66, v67
    v_cvt_pk_bf16_f32 v129, -v70, -v71
    v_xor_b32 v126, v124, v8
    v_xor_b32 v130, v128, v8
    v_xor_b32 v127, v125, v8
    v_xor_b32 v131, v129, v8
    v_add_f32 v7, v7, v6
    v_cos_f32 v64, v7
    v_sin_f32 v68, v7
    v_add_f32 v9, v7, v15
    v_cos_f32 v65, v9
    v_sin_f32 v69, v9
    v_add_f32 v9, v9, v15
    v_cos_f32 v66, v9
    v_sin_f32 v70, v9
    v_add_f32 v9, v9, v15
    v_cos_f32 v67, v9
    v_sin_f32 v71, v9
    v_mov_b32 v144, 0
    v_cvt_pk_bf16_f32 v136, v64, v65
    v_cvt_pk_bf16_f32 v140, -v68, -v69
    v_cvt_pk_bf16_f32 v137, v66, v67
    v_cvt_pk_bf16_f32 v141, -v70, -v71
    v_xor_b32 v138, v136, v8
    v_xor_b32 v142, v140, v8
    v_xor_b32 v139, v137, v8
    v_xor_b32 v143, v141, v8
    v_lshrrev_b32 v6, 1, v1
    v_add_u32 v7, s6, v6
    v_and_b32 v9, 1, v1
    v_lshl_add_u32 v7, v9, 3, v7
    v_cvt_f32_u32 v7, v7
    v_mul_f32 v7, 0x3d000000, v7
    v_cos_f32 v7, v7
    s_mov_b32 exec_lo, 0x30003
    s_mov_b32 exec_hi, 0x30003
    v_cvt_pk_bf16_f32 v108, v7, -v7
    s_mov_b32 exec_lo, 0xc000c
    s_mov_b32 exec_hi, 0xc000c
    v_cvt_pk_bf16_f32 v120, v7, -v7
    s_mov_b32 exec_lo, 0x300030
    s_mov_b32 exec_hi, 0x300030
    v_cvt_pk_bf16_f32 v132, v7, -v7
    s_mov_b32 exec_lo, 0xc000c0
    s_mov_b32 exec_hi, 0xc000c0
    v_cvt_pk_bf16_f32 v144, v7, -v7
    s_mov_b64 exec, -1
    v_mov_b32 v109, v108
    v_mov_b32 v110, v108
    v_mov_b32 v111, v108
    v_mov_b32 v121, v120
    v_mov_b32 v122, v120
    v_mov_b32 v123, v120
    v_mov_b32 v133, v132
    v_mov_b32 v134, v132
    v_mov_b32 v135, v132
    v_mov_b32 v145, v144
    v_mov_b32 v146, v144
    v_mov_b32 v147, v144
    s_branch L_z1
L_z0:
    s_mov_b64 exec, 0
    s_sub_u32 s6, s3, 8
L_tzback:
    s_add_u32 s6, s6, 4
    s_cmp_eq_u32 s6, 0
    s_cbranch_scc1 L_tz0
    s_cmp_eq_u32 s6, 1
    s_cbranch_scc1 L_tz1
    s_cmp_eq_u32 s6, 2
    s_cbranch_scc1 L_tz2
    s_cmp_eq_u32 s6, 3
    s_cbranch_scc1 L_tz3
    s_cmp_eq_u32 s6, 4
    s_cbranch_scc1 L_tz4
    s_cmp_eq_u32 s6, 5
    s_cbranch_scc1 L_tz5
    s_cmp_eq_u32 s6, 6
    s_cbranch_scc1 L_tz6
    s_cmp_eq_u32 s6, 7
    s_cbranch_scc1 L_tz7
    s_cmp_eq_u32 s6, 8
    s_cbranch_scc1 L_tz8
    s_cmp_eq_u32 s6, 9
    s_cbranch_scc1 L_tz9
    s_cmp_eq_u32 s6, 10
    s_cbranch_scc1 L_tz10
    s_cmp_eq_u32 s6, 11
    s_cbranch_scc1 L_tz11
    s_cmp_eq_u32 s6, 12
    s_cbranch_scc1 L_tz12
    s_cmp_eq_u32 s6, 13
    s_cbranch_scc1 L_tz13
    s_mov_b64 exec, -1
L_z1:
    v_mov_b32 v9, 33792
    v_mov_b32 v12, 0
    v_mov_b32 v13, 0
    s_barrier
    ds_read_b64 v[30:31], v9
    ds_read_b128 v[24:27], v3 offset:45696
    s_waitcnt lgkmcnt(0)
    v_readfirstlane_b32 s44, v30
    s_andn2_b32 s54, 2047, s44
    s_and_b32 s6, s54, 127
    s_cmp_gt_u32 s6, 64
    s_cselect_b32 s46, 1, 0
    s_and_b32 s6, s54, 1087
    s_cmp_eq_u32 s6, 1024
    s_cselect_b32 s46, 1, s46
    s_sub_u32 s6, 2048, s54
    s_cmp_lg_u32 s46, 0
    s_cselect_b32 s6, s6, s54
    s_cmp_eq_u32 s6, 1024
    s_cselect_b32 s6, 0, s6
    s_and_b32 s56, s6, 127
    s_lshr_b32 s57, s6, 10
    s_bfe_u32 s45, s6, 0x30007
    s_lshl3_add_u32 s11, s57, s45
    s_lshl_b32 s11, s11, 7
    s_add_u32 s58, s11, s56
    s_sub_u32 s59, 2048, s58
    s_cmp_eq_u32 s58, 0
    s_cselect_b32 s59, 1024, s59
    s_lshl_b32 s10, s58, 10
    s_lshl_b32 s11, s59, 10
    v_add_u32 v6, s10, v3
    v_add_u32 v7, s11, v3
    global_load_dwordx4 v[16:19], v6, s[4:5]
    global_load_dwordx4 v[20:23], v7, s[4:5]
    s_cmp_ge_u32 s3, 4
    s_cbranch_scc1 L_z4
    v_lshrrev_b32 v6, 1, v1
    s_lshl_b32 s6, s57, 10
    s_add_u32 s6, s6, s56
    v_lshl_add_u32 v6, v6, 7, s6
    v_and_b32 v7, 1, v1
    v_lshlrev_b32 v9, 9, v7
    s_cmp_lg_u32 s56, 0
    s_cbranch_scc1 L_g06
    s_mov_b32 exec_lo, 0x00020002
    s_mov_b32 exec_hi, 0x00020002
    v_mov_b32 v6, 0x400
    v_mov_b32 v9, 0
    s_mov_b64 exec, -1
L_g06:
    v_lshlrev_b32 v7, 2, v2
    v_mad_u32_u24 v9, v7, v6, v9
    v_cvt_f32_u32 v6, v6
    v_cvt_f32_u32 v9, v9
    v_mul_f32 v6, 0x3a000000, v6
    v_mul_f32 v9, 0x3a000000, v9
    v_cos_f32 v64, v9
    v_sin_f32 v68, v9
    v_add_f32 v9, v9, v6
    v_cos_f32 v65, v9
    v_sin_f32 v69, v9
    v_add_f32 v9, v9, v6
    v_cos_f32 v66, v9
    v_sin_f32 v70, v9
    v_add_f32 v9, v9, v6
    v_cos_f32 v67, v9
    v_sin_f32 v71, v9
    s_and_b32 s7, s56, 63
    s_mul_i32 s32, s7, 33024
    v_cvt_pk_bf16_f32 v148, v64, v68
    v_cvt_pk_bf16_f32 v149, v65, v69
    v_cvt_pk_bf16_f32 v150, v66, v70
    v_cvt_pk_bf16_f32 v151, v67, v71
    s_cmp_lg_u32 s7, 0
    s_cbranch_scc1 L_gd7
    s_lshr_b32 s7, s56, 2
    v_and_b32 v148, 0xffff, v148
    v_lshlrev_b32 v148, s7, v148
    v_and_b32 v149, 0xffff, v149
    v_lshlrev_b32 v149, s7, v149
    v_and_b32 v150, 0xffff, v150
    v_lshlrev_b32 v150, s7, v150
    v_and_b32 v151, 0xffff, v151
    v_lshlrev_b32 v151, s7, v151
L_gd7:
    s_lshl_b32 s7, s3, 9
    s_add_u32 s32, s32, s7
    s_add_u32 s32, s32, 2097152
    s_add_u32 s33, s32, 4096
    s_mul_i32 s7, s45, 2176
    v_bfe_u32 v7, v1, 1, 2
    v_xor_b32 v7, v7, v2
    v_lshl_add_u32 v7, v7, 4, s7
    v_lshl_add_u32 v29, v1, 6, v7
    v_sub_u32 v6, 16, v1
    v_bfe_u32 v7, v6, 1, 2
    v_xor_b32 v7, v7, v2
    v_lshl_add_u32 v7, v7, 4, s7
    v_lshl_add_u32 v30, v6, 6, v7
    s_cmp_eq_u32 s58, 0
    s_cselect_b32 s6, 0, 2048
    v_add_u32 v4, s6, v5
    v_cmp_eq_u32 s[14:15], s47, v1
    v_lshlrev_b32 v6, 7, v1
    v_lshl_add_u32 v15, v2, 4, v6
    s_waitcnt vmcnt(0)
    v_dot2c_f32_bf16 v12, v16, v24
    v_dot2c_f32_bf16 v13, v20, v24
    v_dot2c_f32_bf16 v12, v17, v25
    v_dot2c_f32_bf16 v13, v21, v25
    v_dot2c_f32_bf16 v12, v18, v26
    v_dot2c_f32_bf16 v13, v22, v26
    v_dot2c_f32_bf16 v12, v19, v27
    v_dot2c_f32_bf16 v13, v23, v27
    s_nop 2
    v_permlane32_swap_b32 v12, v13
    v_add_f32 v12, v12, v13
    v_mov_b32 v13, v12
    s_nop 1
    v_permlane16_swap_b32 v12, v13
    v_add_f32 v12, v12, v13
    s_nop 1
    v_add_f32_dpp v12, v12, v12 row_ror:8 row_mask:0xf bank_mask:0xf
    s_nop 1
    v_add_f32_dpp v12, v12, v12 row_ror:4 row_mask:0xf bank_mask:0xf
    s_nop 1
    v_add_f32_dpp v12, v12, v12 row_ror:2 row_mask:0xf bank_mask:0xf
    s_nop 1
    v_add_f32_dpp v12, v12, v12 row_ror:1 row_mask:0xf bank_mask:0xf
    v_cvt_pk_bf16_f32 v12, v12, v12
    v_and_b32 v12, 0xffff0000, v12
    v_mul_f32 v13, 0xbfb8aa3b, v12
    v_exp_f32 v13, v13
    s_nop 0
    v_add_f32 v13, 1.0, v13
    v_rcp_f32 v13, v13
    s_nop 0
    v_cvt_pk_bf16_f32 v13, v13, v13
    v_and_b32 v13, 0xffff0000, v13
    v_sub_f32 v14, 1.0, v13
    v_cvt_pk_bf16_f32 v14, v14, v14
    v_and_b32 v14, 0xffff0000, v14
    v_readlane_b32 s6, v13, 0
    v_readlane_b32 s7, v13, 32
    v_readlane_b32 s8, v14, 0
    v_readlane_b32 s9, v14, 32
    s_xor_b32 s10, s6, 0x80000000
    s_cmp_eq_u32 s58, 0
    s_cselect_b32 s10, 0, s10
    s_cselect_b32 s11, 0, s7
    s_cmp_lg_u32 s46, 0
    s_cselect_b32 s6, s11, s6
    s_cselect_b32 s10, s7, s10
    v_mov_b32 v24, s6
    v_mov_b32 v25, s10
    s_barrier
    buffer_load_dwordx4 v[32:35], v10, s[36:39], s32 offen offset:0 sc1
    buffer_load_dwordx4 v[36:39], v10, s[36:39], s32 offen offset:2048 sc1
    buffer_load_dwordx4 v[40:43], v10, s[36:39], s33 offen offset:0 sc1
    buffer_load_dwordx4 v[44:47], v10, s[36:39], s33 offen offset:2048 sc1
    buffer_load_dwordx4 v[48:51], v10, s[36:39], s32 offen offset:256 sc1
    buffer_load_dwordx4 v[52:55], v10, s[36:39], s32 offen offset:2304 sc1
    buffer_load_dwordx4 v[56:59], v10, s[36:39], s33 offen offset:256 sc1
    buffer_load_dwordx4 v[60:63], v10, s[36:39], s33 offen offset:2304 sc1
    s_branch L_zjoin
L_z4:
    s_cmp_ge_u32 s3, 6
    s_cbranch_scc1 L_zend
    s_sub_u32 s6, s3, 4
    s_lshl1_add_u32 s7, s47, s6
    s_lshl_b32 s7, s7, 5
    v_and_b32 v6, 7, v0
    v_lshl_add_u32 v10, v6, 2, s7
    s_lshl_b32 s8, s54, 10
    v_add_u32 v7, s8, v10
    global_load_dword v35, v7, s[4:5]
    v_lshlrev_b32 v10, 1, v10
    v_lshrrev_b32 v7, 3, v0
    v_lshlrev_b32 v7, 8, v7
    v_lshl_add_u32 v11, v6, 4, v7
    s_mul_i32 s48, s47, 14336
    s_lshl_b32 s6, s6, 7
    s_add_u32 s48, s48, s6
    s_add_u32 s48, s48, 720896
    s_add_u32 s49, s48, 229376
    s_and_b32 s6, s44, 0xffff0000
    s_xor_b32 s7, s6, 0x80000000
    s_xor_b32 s9, s6, 0xffff0000
    s_bitcmp1_b32 s6, 31
    s_cselect_b32 s6, s7, s9
    v_mov_b32 v15, s6
    v_mul_f32 v15, 0xbfb8aa3b, v15
    v_exp_f32 v15, v15
    s_nop 0
    v_add_f32 v15, 1.0, v15
    v_rcp_f32 v15, v15
    s_nop 0
    v_cvt_pk_bf16_f32 v15, v15, v15
    v_and_b32 v15, 0xffff0000, v15
    s_waitcnt vmcnt(0)
    v_dot2c_f32_bf16 v12, v16, v24
    v_dot2c_f32_bf16 v13, v20, v24
    v_dot2c_f32_bf16 v12, v17, v25
    v_dot2c_f32_bf16 v13, v21, v25
    v_dot2c_f32_bf16 v12, v18, v26
    v_dot2c_f32_bf16 v13, v22, v26
    v_dot2c_f32_bf16 v12, v19, v27
    v_dot2c_f32_bf16 v13, v23, v27
    s_nop 2
    v_permlane32_swap_b32 v12, v13
    v_add_f32 v12, v12, v13
    v_mov_b32 v13, v12
    s_nop 1
    v_permlane16_swap_b32 v12, v13
    v_add_f32 v12, v12, v13
    s_nop 1
    v_add_f32_dpp v12, v12, v12 row_ror:8 row_mask:0xf bank_mask:0xf
    s_nop 1
    v_add_f32_dpp v12, v12, v12 row_ror:4 row_mask:0xf bank_mask:0xf
    s_nop 1
    v_add_f32_dpp v12, v12, v12 row_ror:2 row_mask:0xf bank_mask:0xf
    s_nop 1
    v_add_f32_dpp v12, v12, v12 row_ror:1 row_mask:0xf bank_mask:0xf
    v_cvt_pk_bf16_f32 v12, v12, v12
    v_and_b32 v12, 0xffff0000, v12
    v_mul_f32 v13, 0xbfb8aa3b, v12
    v_exp_f32 v13, v13
    s_nop 0
    v_add_f32 v13, 1.0, v13
    v_rcp_f32 v13, v13
    s_nop 0
    v_cvt_pk_bf16_f32 v13, v13, v13
    v_and_b32 v13, 0xffff0000, v13
    v_sub_f32 v14, 1.0, v13
    v_cvt_pk_bf16_f32 v14, v14, v14
    v_and_b32 v14, 0xffff0000, v14
    v_readlane_b32 s6, v13, 0
    v_readlane_b32 s7, v13, 32
    v_readlane_b32 s8, v14, 0
    v_readlane_b32 s9, v14, 32
    s_xor_b32 s10, s6, 0x80000000
    s_cmp_eq_u32 s58, 0
    s_cselect_b32 s10, 0, s10
    s_cselect_b32 s11, 0, s7
    s_cmp_lg_u32 s46, 0
    s_cselect_b32 s8, s9, s8
    v_mov_b32 v36, s8
    v_lshlrev_b32 v34, 16, v35
    v_and_b32 v35, 0xffff0000, v35
    s_barrier
    s_sleep 24
L_tz_start:
L_zp:
    buffer_load_dwordx4 v[40:43], v11, s[36:39], s48 offen offset:0 sc1
    buffer_load_dwordx4 v[44:47], v11, s[36:39], s48 offen offset:2048 sc1
    s_add_u32 s6, s48, 4096
    buffer_load_dwordx4 v[48:51], v11, s[36:39], s6 offen offset:0 sc1
    buffer_load_dwordx4 v[52:55], v11, s[36:39], s6 offen offset:2048 sc1
    s_add_u32 s6, s48, 8192
    buffer_load_dwordx4 v[56:59], v11, s[36:39], s6 offen offset:0 sc1
    buffer_load_dwordx4 v[60:63], v11, s[36:39], s6 offen offset:2048 sc1
L_tz0:
    s_cbranch_execz L_tzback
    s_add_u32 s6, s48, 12288
    buffer_load_dwordx4 v[64:67], v11, s[36:39], s6 offen offset:0 sc1
    s_add_u32 s48, s48, 229376
    s_min_u32 s48, s48, s49
    s_add_u32 s65, s65, 1
    s_lshr_b32 s34, s65, 17
    s_cbranch_scc1 L_zp_ok
    s_waitcnt vmcnt(6)
    v_bitop3_b32 v37, v41, v43, v31 bitop3:0x7e
    s_waitcnt vmcnt(5)
L_tz1:
    s_cbranch_execz L_tzback
    v_bitop3_b32 v39, v45, v47, v31 bitop3:0x7e
    v_add_f32 v40, v40, v44
    v_add_f32 v42, v42, v46
    s_waitcnt vmcnt(4)
    v_bitop3_b32 v38, v49, v51, v31 bitop3:0x7e
    v_add_f32 v40, v40, v48
    v_add_f32 v42, v42, v50
    v_or3_b32 v37, v37, v38, v39
    s_waitcnt vmcnt(3)
    v_bitop3_b32 v39, v53, v55, v31 bitop3:0x7e
    v_add_f32 v40, v40, v52
L_tz2:
    s_cbranch_execz L_tzback
    v_add_f32 v42, v42, v54
    s_waitcnt vmcnt(2)
    v_bitop3_b32 v38, v57, v59, v31 bitop3:0x7e
    v_add_f32 v40, v40, v56
    v_add_f32 v42, v42, v58
    v_or3_b32 v37, v37, v38, v39
    s_waitcnt vmcnt(1)
    v_bitop3_b32 v39, v61, v63, v31 bitop3:0x7e
    v_add_f32 v40, v40, v60
    v_add_f32 v42, v42, v62
    s_waitcnt vmcnt(0)
    v_bitop3_b32 v38, v65, v67, v31 bitop3:0x7e
L_tz3:
    s_cbranch_execz L_tzback
    v_add_f32 v40, v40, v64
    v_add_f32 v42, v42, v66
    v_or3_b32 v37, v37, v38, v39
    v_cmp_ne_u32 vcc, 0, v37
    s_nop 0
    s_cbranch_vccnz L_zp
L_zp_ok:
    s_waitcnt vmcnt(0)
    v_add_f32_dpp v40, v40, v40 row_ror:8 row_mask:0xf bank_mask:0xf
    v_add_f32_dpp v42, v42, v42 row_ror:8 row_mask:0xf bank_mask:0xf
    s_nop 0
    s_nop 0
L_tz4:
    s_cbranch_execz L_tzback
    v_permlane16_swap_b32 v40, v42
    v_add_f32 v40, v40, v42
    v_mov_b32 v42, v40
    s_nop 1
    v_permlane32_swap_b32 v40, v42
    v_add_f32 v40, v40, v42
    v_mov_b32 v42, v40
    s_nop 1
    v_permlane16_swap_b32 v40, v42
    v_cvt_pk_bf16_f32 v41, v40, v42
    v_lshlrev_b32 v40, 16, v41
    v_and_b32 v42, 0xffff0000, v41
    v_mul_f32 v40, v40, v15
L_tz5:
    s_cbranch_execz L_tzback
    v_mul_f32 v42, v42, v15
    v_cvt_pk_bf16_f32 v41, v40, v42
    v_lshlrev_b32 v40, 16, v41
    v_and_b32 v42, 0xffff0000, v41
    v_add_f32 v40, v40, v34
    v_add_f32 v42, v42, v35
    v_cvt_pk_bf16_f32 v41, v40, v42
    v_lshlrev_b32 v40, 16, v41
    v_and_b32 v42, 0xffff0000, v41
    v_mul_f32 v40, v40, v36
    v_mul_f32 v41, v42, v36
L_tz6:
    s_cbranch_execz L_tzback
    s_mov_b64 exec, 0xff
    ds_write_b64 v10, v[40:41] offset:38528
    s_waitcnt lgkmcnt(0)
    s_barrier
    s_endpgm
L_zfin:
    s_cmp_lg_u32 s3, 0
    s_cbranch_scc1 L_zend
    ds_read_b128 v[152:155], v15 offset:38528
    ds_read_b128 v[156:159], v15 offset:38592
    s_waitcnt lgkmcnt(5)
    v_mfma_f32_16x16x32_bf16 v[48:51], v[32:35], v[64:67], 0
L_tz7:
    s_cbranch_execz L_tzback
    s_waitcnt lgkmcnt(4)
    v_mfma_f32_16x16x32_bf16 v[52:55], v[36:39], v[68:71], 0
    s_waitcnt lgkmcnt(3)
    v_mfma_f32_16x16x32_bf16 v[56:59], v[40:43], v[72:75], 0
    s_waitcnt lgkmcnt(2)
    v_mfma_f32_16x16x32_bf16 v[60:63], v[44:47], v[76:79], 0
    s_lshl_b32 s6, s54, 10
    s_waitcnt lgkmcnt(0)
    s_nop 1
    v_fmac_f32 v152, v24, v48
    v_fmac_f32 v153, v24, v49
L_tz8:
    s_cbranch_execz L_tzback
    v_fmac_f32 v154, v24, v50
    v_fmac_f32 v155, v24, v51
    v_fmac_f32 v156, v24, v52
    v_fmac_f32 v157, v24, v53
    v_fmac_f32 v158, v24, v54
    v_fmac_f32 v159, v24, v55
    v_fmac_f32 v152, v25, v56
    v_fmac_f32 v153, v25, v57
    v_fmac_f32 v154, v25, v58
    v_fmac_f32 v155, v25, v59
    v_fmac_f32 v156, v25, v60
    v_fmac_f32 v157, v25, v61
    v_fmac_f32 v158, v25, v62
    v_fmac_f32 v159, v25, v63
    v_cvt_pk_bf16_f32 v32, v152, v153
L_tz9:
    s_cbranch_execz L_tzback
    v_cvt_pk_bf16_f32 v33, v154, v155
    v_cvt_pk_bf16_f32 v34, v156, v157
    v_cvt_pk_bf16_f32 v35, v158, v159
    s_nop 1
    v_permlane16_swap_b32 v32, v34
    v_permlane16_swap_b32 v33, v35
    s_mov_b64 exec, s[14:15]
    buffer_store_dwordx4 v[32:35], v3, s[40:43], s6 offen
    s_mov_b64 exec, -1
.set L_tz10, L_tzback
.set L_tz11, L_tzback
.set L_tz12, L_tzback
.set L_tz13, L_tzback
L_zend:
    s_endpgm
L_zh:
    v_lshlrev_b32 v6, 2, v2
    v_cvt_f32_u32 v7, v1
    v_cvt_f32_u32 v6, v6
    v_mul_f32 v7, 0x3d800000, v7
    v_mul_f32 v9, v6, v7
    v_cos_f32 v64, v9
    v_sin_f32 v68, v9
    v_add_f32 v9, v9, v7
    v_cos_f32 v65, v9
    v_sin_f32 v69, v9
    v_add_f32 v9, v9, v7
    v_cos_f32 v66, v9
    v_sin_f32 v70, v9
    v_add_f32 v9, v9, v7
    v_cos_f32 v67, v9
    v_sin_f32 v71, v9
    s_nop 0
    v_cvt_pk_bf16_f32 v40, v64, v68
    v_cvt_pk_bf16_f32 v48, -v68, v64
    v_cvt_pk_bf16_f32 v41, v65, v69
    v_cvt_pk_bf16_f32 v49, -v69, v65
    v_cvt_pk_bf16_f32 v42, v66, v70
    v_cvt_pk_bf16_f32 v50, -v70, v66
    v_cvt_pk_bf16_f32 v43, v67, v71
    v_cvt_pk_bf16_f32 v51, -v71, v67
    v_add_f32 v7, 0x3d800000, v7
    v_mul_f32 v9, v6, v7
    v_cos_f32 v64, v9
    v_sin_f32 v68, v9
    v_add_f32 v9, v9, v7
    v_cos_f32 v65, v9
    v_sin_f32 v69, v9
    v_add_f32 v9, v9, v7
    v_cos_f32 v66, v9
    v_sin_f32 v70, v9
    v_add_f32 v9, v9, v7
    v_cos_f32 v67, v9
    v_sin_f32 v71, v9
    s_nop 0
    v_cvt_pk_bf16_f32 v44, v64, -v68
    v_cvt_pk_bf16_f32 v52, -v68, -v64
    v_cvt_pk_bf16_f32 v45, v65, -v69
    v_cvt_pk_bf16_f32 v53, -v69, -v65
    v_cvt_pk_bf16_f32 v46, v66, -v70
    v_cvt_pk_bf16_f32 v54, -v70, -v66
    v_cvt_pk_bf16_f32 v47, v67, -v71
    v_cvt_pk_bf16_f32 v55, -v71, -v67
    ds_write_b128 v5, v[40:43] offset:40576
    ds_write_b128 v5, v[44:47] offset:41600
    ds_write_b128 v5, v[48:51] offset:42624
    ds_write_b128 v5, v[52:55] offset:43648
    s_mov_b32 m0, 45696
    v_mov_b32 v31, 0
    global_load_dword v30, v31, s[30:31]
    s_mov_b32 s64, 0x9E3779B1
    global_load_lds_dwordx4 v5, s[24:25]
    s_waitcnt vmcnt(0)
    v_mul_lo_u32 v31, v30, s64
    v_add_u32 v31, 0x7F4A7C15, v31
    s_and_b32 s61, s2, 0
    s_mul_i32 s61, s61, 3072
    s_add_u32 s61, s61, 81920
    s_add_u32 s62, s61, 2048
    s_sleep 44
    s_branch L_poll8_1
L_poll8:
    s_sleep 8
L_poll8_1:
    buffer_load_dwordx4 v[32:35], v5, s[36:39], s61 offen sc1
    s_add_u32 s61, s61, 1024
    s_min_u32 s61, s61, s62
    s_add_u32 s65, s65, 1
    s_lshr_b32 s34, s65, 17
    s_waitcnt vmcnt(0)
    s_cbranch_scc1 L_poll8_ok
    v_cmp_ne_u32 vcc, v31, v33
    v_cmp_ne_u32 s[12:13], v31, v35
    s_or_b64 vcc, vcc, s[12:13]
    s_cbranch_vccnz L_poll8
L_poll8_ok:
    v_max_u32 v32, v32, v34
    s_nop 1
    v_max_u32_dpp v32, v32, v32 row_ror:8 row_mask:0xf bank_mask:0xf
    s_nop 1
    v_max_u32_dpp v32, v32, v32 row_ror:4 row_mask:0xf bank_mask:0xf
    s_nop 1
    v_max_u32_dpp v32, v32, v32 row_ror:2 row_mask:0xf bank_mask:0xf
    s_nop 1
    v_max_u32_dpp v32, v32, v32 row_ror:1 row_mask:0xf bank_mask:0xf
    v_mov_b32 v33, v32
    s_nop 1
    v_permlane16_swap_b32 v32, v33
    v_max_u32 v32, v32, v33
    v_mov_b32 v33, v32
    s_nop 1
    v_permlane32_swap_b32 v32, v33
    v_max_u32 v32, v32, v33
    v_mov_b32 v9, 33792
    s_mov_b64 exec, 1
    ds_write2_b32 v9, v32, v31 offset1:1
    s_mov_b64 exec, -1
    s_waitcnt lgkmcnt(0)
    s_barrier
    s_lshl_b32 s6, s47, 2
    s_add_u32 s6, s6, 4096
    s_mov_b64 exec, 1
    buffer_store_dword v31, v0, s[36:39], s6 offen sc1
    s_mov_b64 exec, -1
    s_and_b32 s61, s2, 7
    s_mul_i32 s61, s61, 2048
    s_add_u32 s61, s61, 131072
    s_add_u32 s62, s61, 1024
    s_waitcnt vmcnt(0)
    s_sleep 14
    s_branch L_poll9_1
L_poll9:
    s_sleep 3
L_poll9_1:
    buffer_load_dwordx4 v[32:35], v5, s[36:39], s61 offen sc1
    s_add_u32 s61, s61, 1024
    s_min_u32 s61, s61, s62
    s_add_u32 s65, s65, 1
    s_lshr_b32 s34, s65, 17
    s_waitcnt vmcnt(0)
    s_cbranch_scc1 L_poll9_ok
    v_cmp_ne_u32 vcc, v31, v33
    v_cmp_ne_u32 s[12:13], v31, v35
    s_or_b64 vcc, vcc, s[12:13]
    s_cbranch_vccnz L_poll9
L_poll9_ok:
    s_barrier
    s_cmp_lg_u32 s47, 0
    s_cbranch_scc1 L_zend
    s_mov_b64 exec, 0xffff
    v_lshlrev_b32 v6, 2, v0
    s_mov_b32 s6, 4096
L_za:
    buffer_load_dword v7, v6, s[36:39], s6 offen sc1
    s_add_u32 s65, s65, 1
    s_lshr_b32 s34, s65, 17
    s_waitcnt vmcnt(0)
    s_cbranch_scc1 L_za_ok
    v_cmp_ne_u32 vcc, v31, v7
    s_nop 0
    s_cbranch_vccnz L_za
L_za_ok:
    s_mov_b64 exec, 1
    v_add_u32 v9, 1, v30
    s_barrier
    buffer_store_dword v9, v6, s[36:39], 0 offen sc1
    s_mov_b64 exec, -1
    s_branch L_zend
L_F:
    v_lshlrev_b32 v5, 4, v0
    s_cmp_eq_u32 s3, 8
    s_cbranch_scc1 L_fh
    s_and_b32 s6, s60, 3
    s_lshr_b32 s7, s3, 1
    s_lshl2_add_u32 s32, s6, s7
    s_mul_i32 s8, s32, 114688
    s_lshr_b32 s33, s60, 2
    s_lshl_b32 s9, s33, 7
    s_add_u32 s8, s8, s9
    v_lshrrev_b32 v6, 3, v0
    v_mul_u32_u24 v6, 3584, v6
    v_and_b32 v7, 7, v0
    v_bfe_u32 v8, v0, 4, 1
    v_lshlrev_b32 v8, 2, v8
    v_xor_b32 v4, v7, v8
    v_lshl_add_u32 v7, v4, 4, s8
    v_add_u32 v3, v6, v7
    s_lshl_b32 s10, s3, 12
    s_mov_b32 m0, s10
    s_bitcmp1_b32 s3, 0
    s_waitcnt lgkmcnt(0)
    s_cselect_b32 s18, s20, s18
    s_cselect_b32 s19, s21, s19
    s_sleep 6
    global_load_lds_dwordx4 v3, s[18:19]
    s_add_u32 m0, s10, 1024
    v_add_u32 v3, 28672, v3
    global_load_lds_dwordx4 v3, s[18:19]
    s_add_u32 m0, s10, 2048
    v_add_u32 v3, 28672, v3
    global_load_lds_dwordx4 v3, s[18:19]
    s_add_u32 m0, s10, 3072
    v_add_u32 v3, 28672, v3
    global_load_lds_dwordx4 v3, s[18:19]
    s_mov_b32 s36, s30
    s_mov_b32 s37, s31
    s_mov_b32 s38, 0x1000000
    s_mov_b32 s39, 0x20000
    s_mov_b32 s65, 0
    v_bfe_u32 v6, v0, 2, 2
    v_and_b32 v7, 3, v0
    v_lshlrev_b32 v8, 3, v7
    v_lshl_add_u32 v8, v2, 5, v8
    v_and_b32 v9, 2, v6
    v_lshlrev_b32 v9, 5, v9
    v_xor_b32 v9, v9, v8
    v_lshl_add_u32 v9, v6, 7, v9
    v_add_u32 v9, s10, v9
    s_lshl_b32 s11, s3, 8
    v_lshlrev_b32 v11, 2, v0
    v_add_u32 v11, 49152, v11
    v_add_u32 v12, s11, v11
    s_lshl1_add_u32 s7, s33, s7
    s_lshl_b32 s8, s7, 15
    s_and_b32 s9, s3, 1
    s_lshl1_add_u32 s9, s6, s9
    s_lshl_b32 s11, s9, 7
    s_add_u32 s8, s8, s11
    v_lshrrev_b32 v6, 3, v0
    v_lshl_add_u32 v6, v6, 10, s8
    v_lshl_add_u32 v4, v4, 4, v6
    v_lshrrev_b32 v6, 5, v0
    v_mul_u32_u24 v13, 14336, v6
    v_and_b32 v6, 31, v0
    v_lshl_add_u32 v13, v6, 3, v13
    s_mul_i32 s8, s9, 28672
    s_lshl_b32 s7, s7, 8
    s_add_u32 s8, s8, s7
    s_add_u32 s8, s8, 720896
    s_lshl_b32 s32, s32, 6
    s_lshl_b32 s33, s33, 12
    s_add_u32 s61, s33, 196608
    s_add_u32 s62, s61, 114688
    s_lshl_b32 s7, s6, 10
    s_add_u32 s33, s61, s7
    v_mov_b32 v14, 51200
    s_lshr_b32 s7, s3, 1
    s_lshl_b32 s7, s7, 9
    v_lshl_add_u32 v15, v6, 4, s7
    v_lshrrev_b32 v6, 5, v0
    v_lshl_add_u32 v15, v6, 10, v15
    v_mov_b32 v16, 0
    v_mov_b32 v17, 0
    v_mov_b32 v24, 0
    v_mov_b32 v25, 0
    s_waitcnt vmcnt(0)
    s_cmp_ge_u32 s3, 4
    s_cbranch_scc1 L_nowd10
    s_add_u32 m0, s10, 32768
    s_nop 0
    global_load_lds_dwordx4 v4, s[22:23]
    s_add_u32 m0, s10, 33792
    v_add_u32 v4, 0x2000, v4
    global_load_lds_dwordx4 v4, s[22:23]
    s_add_u32 m0, s10, 34816
    v_add_u32 v4, 0x2000, v4
    global_load_lds_dwordx4 v4, s[22:23]
    s_add_u32 m0, s10, 35840
    v_add_u32 v4, 0x2000, v4
    global_load_lds_dwordx4 v4, s[22:23]
L_nowd10:
    ds_read_b64_tr_b16 v[32:33], v9 offset:0
    ds_read_b64_tr_b16 v[34:35], v9 offset:512
    ds_read_b64_tr_b16 v[36:37], v9 offset:1024
    ds_read_b64_tr_b16 v[38:39], v9 offset:1536
    ds_read_b64_tr_b16 v[40:41], v9 offset:2048
    ds_read_b64_tr_b16 v[42:43], v9 offset:2560
    ds_read_b64_tr_b16 v[44:45], v9 offset:3072
    ds_read_b64_tr_b16 v[46:47], v9 offset:3584
    s_waitcnt lgkmcnt(0)
    s_barrier
    ds_read_b64 v[30:31], v14
    s_waitcnt lgkmcnt(0)
    v_readfirstlane_b32 s6, v30
    s_andn2_b32 s6, 2047, s6
    s_lshl_b32 s6, s6, 10
    s_add_u32 s6, s6, s32
    s_load_dwordx16 s[44:59], s[4:5], s6
    v_mov_b32 v29, v31
    s_waitcnt vmcnt(0)
    ds_read_b64_tr_b16 v[48:49], v9 offset:32768
    ds_read_b64_tr_b16 v[50:51], v9 offset:33280
    ds_read_b64_tr_b16 v[52:53], v9 offset:33792
    ds_read_b64_tr_b16 v[54:55], v9 offset:34304
    ds_read_b64_tr_b16 v[56:57], v9 offset:34816
    ds_read_b64_tr_b16 v[58:59], v9 offset:35328
    ds_read_b64_tr_b16 v[60:61], v9 offset:35840
    ds_read_b64_tr_b16 v[62:63], v9 offset:36352
    s_waitcnt lgkmcnt(0)
    v_dot2c_f32_bf16 v16, s44, v32
    v_dot2c_f32_bf16 v17, s45, v33
    v_dot2c_f32_bf16 v16, s46, v34
    v_dot2c_f32_bf16 v17, s47, v35
    v_dot2c_f32_bf16 v16, s48, v36
    v_dot2c_f32_bf16 v17, s49, v37
    v_dot2c_f32_bf16 v16, s50, v38
    v_dot2c_f32_bf16 v17, s51, v39
    v_dot2c_f32_bf16 v16, s52, v40
    v_dot2c_f32_bf16 v17, s53, v41
    v_dot2c_f32_bf16 v16, s54, v42
    v_dot2c_f32_bf16 v17, s55, v43
    v_dot2c_f32_bf16 v16, s56, v44
    v_dot2c_f32_bf16 v17, s57, v45
    v_dot2c_f32_bf16 v16, s58, v46
    v_dot2c_f32_bf16 v17, s59, v47
    s_nop 2
    v_add_f32 v16, v16, v17
    ds_write_b32 v12, v16
    s_waitcnt lgkmcnt(0)
    s_barrier
    s_cmp_ge_u32 s3, 4
    s_cbranch_scc1 L_fend
    s_lshl_b32 s6, s3, 4
    s_lshl_b64 s[12:13], 0xffff, s6
    ds_read2st64_b32 v[16:17], v11 offset0:0 offset1:2
    ds_read2st64_b32 v[18:19], v11 offset0:4 offset1:6
    ds_read2st64_b32 v[20:21], v11 offset0:1 offset1:3
    ds_read2st64_b32 v[22:23], v11 offset0:5 offset1:7
    s_waitcnt lgkmcnt(2)
    v_add_f32 v16, v16, v17
    v_add_f32 v18, v18, v19
    s_waitcnt lgkmcnt(0)
    v_add_f32 v20, v20, v21
    v_add_f32 v22, v22, v23
    v_add_f32 v28, v16, v18
    s_mov_b64 exec, s[12:13]
    v_add_f32 v30, v20, v22
    buffer_store_dwordx4 v[28:31], v5, s[36:39], s33 offen sc1
    s_add_u32 s33, s33, 114688
    buffer_store_dwordx4 v[28:31], v5, s[36:39], s33 offen sc1
    s_mov_b64 exec, -1
    s_sleep 4
L_fx:
    buffer_load_dwordx4 v[64:67], v15, s[36:39], s61 offen offset:0 sc1
    buffer_load_dwordx4 v[68:71], v15, s[36:39], s61 offen offset:2048 sc1
    s_add_u32 s61, s61, 114688
    s_min_u32 s61, s61, s62
    s_add_u32 s65, s65, 1
    s_lshr_b32 s34, s65, 17
    s_cbranch_scc1 L_fx_ok
    s_waitcnt vmcnt(1)
    v_bitop3_b32 v20, v65, v67, v31 bitop3:0x7e
    s_waitcnt vmcnt(0)
    v_add_f32 v16, v64, v68
    v_add_f32 v18, v66, v70
    v_bitop3_b32 v21, v69, v71, v31 bitop3:0x7e
    v_or_b32 v20, v20, v21
    v_cmp_ne_u32 vcc, 0, v20
    v_permlane32_swap_b32 v16, v18
    s_cbranch_vccnz L_fx
L_fx_ok:
    v_add_f32 v16, v16, v18
    v_cvt_pk_bf16_f32 v16, v16, v16
    v_and_b32 v16, 0xffff0000, v16
    v_mov_b32 v18, v16
    v_mul_f32 v17, 0xbfb8aa3b, v16
    v_exp_f32 v17, v17
    s_nop 0
    v_add_f32 v17, 1.0, v17
    v_rcp_f32 v17, v17
    s_nop 0
    v_permlane32_swap_b32 v16, v18
    v_mul_f32 v17, v17, v16
    v_cvt_pk_bf16_f32 v17, v17, v17
    v_and_b32 v17, 0xffff0000, v17
    v_mul_f32 v17, v17, v18
    s_nop 1
    v_mov_b32_dpp v18, v17 quad_perm:[1,0,3,2] row_mask:0xf bank_mask:0xf
    v_cvt_pk_bf16_f32 v17, v17, v18
    s_nop 0
    v_readlane_b32 s44, v17, 0
    v_readlane_b32 s45, v17, 2
    v_readlane_b32 s46, v17, 4
    v_readlane_b32 s47, v17, 6
    v_readlane_b32 s48, v17, 8
    v_readlane_b32 s49, v17, 10
    v_readlane_b32 s50, v17, 12
    v_readlane_b32 s51, v17, 14
    v_readlane_b32 s52, v17, 16
    v_readlane_b32 s53, v17, 18
    v_readlane_b32 s54, v17, 20
    v_readlane_b32 s55, v17, 22
    v_readlane_b32 s56, v17, 24
    v_readlane_b32 s57, v17, 26
    v_readlane_b32 s58, v17, 28
    v_readlane_b32 s59, v17, 30
    v_dot2c_f32_bf16 v24, s44, v48
    v_dot2c_f32_bf16 v25, s45, v49
    v_dot2c_f32_bf16 v24, s46, v50
    v_dot2c_f32_bf16 v25, s47, v51
    v_dot2c_f32_bf16 v24, s48, v52
    v_dot2c_f32_bf16 v25, s49, v53
    v_dot2c_f32_bf16 v24, s50, v54
    v_dot2c_f32_bf16 v25, s51, v55
    v_dot2c_f32_bf16 v24, s52, v56
    v_dot2c_f32_bf16 v25, s53, v57
    v_dot2c_f32_bf16 v24, s54, v58
    v_dot2c_f32_bf16 v25, s55, v59
    v_dot2c_f32_bf16 v24, s56, v60
    v_dot2c_f32_bf16 v25, s57, v61
    v_dot2c_f32_bf16 v24, s58, v62
    v_dot2c_f32_bf16 v25, s59, v63
    s_nop 2
    v_add_f32 v30, v24, v25
    buffer_store_dwordx2 v[30:31], v13, s[36:39], s8 offen sc1
    s_add_u32 s8, s8, 229376
    buffer_store_dwordx2 v[30:31], v13, s[36:39], s8 offen sc1
L_fend:
    s_endpgm
L_fh:
    s_waitcnt lgkmcnt(0)
    v_mov_b32 v31, 0
    global_load_dword v30, v31, s[30:31]
    s_mov_b32 s64, 0x9E3779B1
    s_mov_b32 s36, s30
    s_mov_b32 s37, s31
    s_mov_b32 s38, 0x1000000
    s_mov_b32 s39, 0x20000
    s_mov_b32 s65, 0
    s_and_b32 s61, s2, 7
    s_mul_i32 s61, s61, 2048
    s_add_u32 s61, s61, 65536
    s_add_u32 s62, s61, 1024
    s_sleep 56
    s_waitcnt vmcnt(0)
    v_mul_lo_u32 v31, v30, s64
    v_add_u32 v31, 0x7F4A7C15, v31
    s_branch L_poll11_1
L_poll11:
    s_sleep 3
L_poll11_1:
    buffer_load_dwordx4 v[20:23], v5, s[36:39], s61 offen sc1
    s_add_u32 s61, s61, 1024
    s_min_u32 s61, s61, s62
    s_add_u32 s65, s65, 1
    s_lshr_b32 s34, s65, 17
    s_waitcnt vmcnt(0)
    s_cbranch_scc1 L_poll11_ok
    v_cmp_ne_u32 vcc, v31, v21
    v_cmp_ne_u32 s[12:13], v31, v23
    s_or_b64 vcc, vcc, s[12:13]
    s_cbranch_vccnz L_poll11
L_poll11_ok:
    v_max_u32 v20, v20, v22
    s_nop 1
    v_max_u32_dpp v20, v20, v20 row_ror:8 row_mask:0xf bank_mask:0xf
    s_nop 1
    v_max_u32_dpp v20, v20, v20 row_ror:4 row_mask:0xf bank_mask:0xf
    s_nop 1
    v_max_u32_dpp v20, v20, v20 row_ror:2 row_mask:0xf bank_mask:0xf
    s_nop 1
    v_max_u32_dpp v20, v20, v20 row_ror:1 row_mask:0xf bank_mask:0xf
    v_mov_b32 v21, v20
    s_nop 1
    v_permlane16_swap_b32 v20, v21
    v_max_u32 v20, v20, v21
    v_mov_b32 v21, v20
    s_nop 1
    v_permlane32_swap_b32 v20, v21
    v_max_u32 v20, v20, v21
    v_mov_b32 v9, 51200
    s_mov_b64 exec, 1
    ds_write2_b32 v9, v20, v31 offset1:1
    s_mov_b64 exec, -1
    s_waitcnt lgkmcnt(0)
    s_barrier
    s_endpgm
L_end:
    s_endpgm
.section .rodata,"a"
.p2align 6
.amdhsa_kernel gated_mix__spectral_fnet__moe_arch_mod__prompt_kernel
  .amdhsa_next_free_vgpr 168
  .amdhsa_next_free_sgpr 100
  .amdhsa_accum_offset 168
  .amdhsa_group_segment_fixed_size 0
  .amdhsa_kernarg_size 112
  .amdhsa_user_sgpr_count 2
  .amdhsa_user_sgpr_kernarg_segment_ptr 1
  .amdhsa_system_sgpr_workgroup_id_x 1
.end_amdhsa_kernel
```

```asm
; @launch grid=(256,1,1) block=(576,1,1) lds=86016
.amdgcn_target "amdgcn-amd-amdhsa--gfx950"
.text
.globl gated_mix__spectral_fnet__moe_arch_mod__prompt_kernel
.p2align 8
.type gated_mix__spectral_fnet__moe_arch_mod__prompt_kernel,@function
gated_mix__spectral_fnet__moe_arch_mod__prompt_kernel:
    s_load_dwordx2 s[4:5], s[0:1], 0
    s_load_dwordx16 s[16:31], s[0:1], 48
    v_lshrrev_b32 v1, 6, v0
    v_and_b32 v0, 63, v0
    v_readfirstlane_b32 s3, v1
    v_and_b32 v1, 15, v0
    v_lshrrev_b32 v2, 4, v0
    s_and_b32 s6, s2, 7
    s_sub_u32 s3, s3, 1
    s_min_u32 s3, s3, 8
    s_lshr_b32 s7, s2, 3
    s_cmp_ge_u32 s2, 128
    s_cbranch_scc1 L_notA
    s_add_u32 s8, s6, 1
    s_sub_u32 s9, 15, s6
    s_cmp_eq_u32 s3, 8
    s_cbranch_scc1 L_ah
    s_and_b32 s57, s7, 1
    s_bitcmp1_b32 s7, 1
    s_cselect_b32 s10, s9, s8
    s_lshr_b32 s11, s7, 2
    s_lshl4_add_u32 s56, s11, s10
    v_lshlrev_b32 v5, 4, v0
    v_mov_b32 v3, 0
    s_cmp_lg_u32 s6, 7
    s_cbranch_scc1 L_k7
    s_lshr_b32 s11, s7, 1
    s_lshl3_add_u32 s56, s11, 8
    s_mov_b32 s8, 0
    s_cmp_eq_u32 s2, 127
    s_cselect_b32 s56, 0, s56
    s_cselect_b32 s57, 0, s57
L_k7:
    s_lshl3_add_u32 s11, s57, s3
    s_lshl_b32 s11, s11, 7
    s_add_u32 s58, s11, s56
    s_sub_u32 s59, 2048, s58
    s_cmp_eq_u32 s58, 0
    s_cselect_b32 s59, 1024, s59
    s_lshl_b32 s10, s58, 10
    s_lshl_b32 s11, s59, 10
    v_add_u32 v6, s10, v5
    v_add_u32 v7, s11, v5
    s_waitcnt lgkmcnt(0)
    global_load_dwordx4 v[16:19], v6, s[4:5]
    global_load_dwordx4 v[20:23], v7, s[4:5]
    s_bitcmp1_b32 s7, 3
    s_cselect_b32 s8, s9, s8
    s_and_b32 s9, s7, 7
    s_lshl3_add_u32 s51, s8, s9
    s_lshl_b32 s35, s8, 5
    s_add_u32 s35, s35, s9
    s_lshl_b32 s35, s35, 6
    s_lshr_b32 s6, s3, 2
    s_and_b32 s7, s3, 1
    s_bfe_u32 s8, s3, 0x10001
    v_lshl_add_u32 v6, s6, 4, v1
    s_lshl3_add_u32 s9, s8, s7
    s_lshl_b32 s9, s9, 2
    v_cvt_f32_u32 v6, v6
    v_lshl_add_u32 v7, v2, 3, s9
    v_mul_f32 v6, 0x3c000000, v6
    v_cvt_f32_u32 v7, v7
    v_mul_f32 v7, v7, v6
    v_cos_f32 v96, v7
    v_sin_f32 v100, v7
    v_add_f32 v7, v7, v6
    v_cos_f32 v97, v7
    v_sin_f32 v101, v7
    v_add_f32 v7, v7, v6
    v_cos_f32 v98, v7
    v_sin_f32 v102, v7
    v_add_f32 v7, v7, v6
    v_cos_f32 v99, v7
    v_sin_f32 v103, v7
    s_lshl_b32 s10, s6, 13
    s_lshl_b32 s11, s8, 10
    s_lshl3_add_u32 s11, s7, s11
    v_add_u32 v15, s10, v5
    v_add_u32 v9, s11, v15
    v_cvt_pk_bf16_f32 v104, v96, v97
    v_cvt_pk_bf16_f32 v105, v98, v99
    v_cvt_pk_bf16_f32 v106, -v100, -v101
    v_cvt_pk_bf16_f32 v107, -v102, -v103
    v_cmp_eq_f32 vcc, 0, v6
    v_cvt_pk_bf16_f32 v108, v96, -v101
    v_cvt_pk_bf16_f32 v109, -v98, v103
    v_cvt_pk_bf16_f32 v110, -v100, -v97
    v_cvt_pk_bf16_f32 v111, v102, v99
    ds_write_b64 v9, v[104:105] offset:16384
    ds_write_b64 v9, v[108:109] offset:20480
    ds_write_b64 v9, v[110:111] offset:22528
    s_mov_b64 exec, vcc
    v_mov_b32 v106, 0xbf803f80
    v_mov_b32 v107, 0xbf803f80
    s_mov_b64 exec, -1
    ds_write_b64 v9, v[106:107] offset:18432
    global_load_dwordx4 v[24:27], v5, s[16:17]
    s_lshl_b32 s10, s3, 11
    s_add_u32 s11, s10, s51
    s_lshl_b32 s11, s11, 7
    s_mov_b32 m0, s10
    v_and_b32 v9, 7, v0
    v_bfe_u32 v13, v0, 4, 1
    v_xor_b32 v9, v9, v13
    v_lshrrev_b32 v13, 3, v0
    v_lshl_add_u32 v9, v9, 4, s11
    v_lshl_add_u32 v13, v13, 14, v9
    global_load_lds_dwordx4 v13, s[4:5]
    s_add_u32 m0, s10, 1024
    v_add_u32 v13, 0x20000, v13
    global_load_lds_dwordx4 v13, s[4:5]
    v_mov_b32 v12, 0
    v_mov_b32 v13, 0
    s_waitcnt vmcnt(2)
    v_dot2c_f32_bf16 v12, v16, v24
    v_dot2c_f32_bf16 v13, v20, v24
    v_dot2c_f32_bf16 v12, v17, v25
    v_dot2c_f32_bf16 v13, v21, v25
    v_dot2c_f32_bf16 v12, v18, v26
    v_dot2c_f32_bf16 v13, v22, v26
    v_dot2c_f32_bf16 v12, v19, v27
    v_dot2c_f32_bf16 v13, v23, v27
    s_sub_u32 s10, 0xffff, s58
    s_sub_u32 s11, 0xffff, s59
    v_mov_b32 v4, s10
    v_permlane32_swap_b32 v12, v13
    v_add_f32 v12, v12, v13
    v_mov_b32 v13, v12
    v_writelane_b32 v4, s11, 32
    s_lshl3_add_u32 s10, s3, 33792
    v_permlane16_swap_b32 v12, v13
    v_add_f32 v12, v12, v13
    v_lshrrev_b32 v9, 3, v0
    v_add_u32 v9, s10, v9
    v_add_f32_dpp v12, v12, v12 row_ror:8 row_mask:0xf bank_mask:0xf
    v_bfe_u32 v6, v0, 2, 2
    v_and_b32 v14, 3, v0
    v_add_f32_dpp v12, v12, v12 row_ror:4 row_mask:0xf bank_mask:0xf
    v_lshl_add_u32 v14, v14, 1, s8
    v_lshl_add_u32 v10, v2, 3, v6
    v_add_f32_dpp v12, v12, v12 row_ror:2 row_mask:0xf bank_mask:0xf
    v_lshrrev_b32 v6, 1, v6
    v_xor_b32 v14, v14, v6
    v_add_f32_dpp v12, v12, v12 row_ror:1 row_mask:0xf bank_mask:0xf
    v_cvt_pk_bf16_f32 v12, v12, v12
    v_and_b32 v12, 0xffff0000, v12
    v_ashrrev_i32 v7, 31, v12
    v_or_b32 v7, 0x80000000, v7
    v_xor_b32 v7, v7, v12
    v_and_b32 v7, 0xffff0000, v7
    v_or_b32 v7, v7, v4
    s_mov_b32 exec_lo, 1
    s_mov_b32 exec_hi, 1
    ds_write_b32 v9, v7
    s_mov_b64 exec, -1
    s_lshl_b32 s7, s7, 3
    v_lshl_add_u32 v14, v14, 4, s7
    v_lshl_add_u32 v10, v10, 7, v14
    v_lshlrev_b32 v9, 4, v2
    s_waitcnt vmcnt(0) lgkmcnt(0)
    s_barrier
    ds_read_b128 v[28:31], v9 offset:33920
    ds_read_b64_tr_b16 v[96:97], v10 offset:0
    ds_read_b64_tr_b16 v[98:99], v10 offset:512
    ds_read_b128 v[32:35], v15 offset:16384
    ds_read_b128 v[48:51], v15 offset:18432
    ds_read_b128 v[64:67], v15 offset:20480
    ds_read_b128 v[80:83], v15 offset:22528
    ds_read_b64_tr_b16 v[100:101], v10 offset:4096
    ds_read_b64_tr_b16 v[102:103], v10 offset:4608
    ds_read_b128 v[36:39], v15 offset:17408
    ds_read_b128 v[52:55], v15 offset:19456
    ds_read_b128 v[68:71], v15 offset:21504
    ds_read_b128 v[84:87], v15 offset:23552
    s_waitcnt lgkmcnt(9)
    ds_read_b64_tr_b16 v[104:105], v10 offset:8192
    ds_read_b64_tr_b16 v[106:107], v10 offset:8704
    ds_read_b64_tr_b16 v[108:109], v10 offset:12288
    ds_read_b64_tr_b16 v[110:111], v10 offset:12800
    v_lshlrev_b32 v8, 31, v1
    v_lshrrev_b32 v14, 16, v8
    v_or_b32 v8, v8, v14
    global_load_dwordx4 v[24:27], v5, s[24:25]
    s_waitcnt lgkmcnt(13)
    v_mfma_f32_16x16x32_bf16 v[112:115], v[96:99], v[32:35], 0
    v_xor_b32 v40, v32, v8
    v_xor_b32 v41, v33, v8
    v_xor_b32 v42, v34, v8
    v_xor_b32 v43, v35, v8
    s_waitcnt lgkmcnt(12)
    v_mfma_f32_16x16x32_bf16 v[116:119], v[96:99], v[48:51], 0
    v_xor_b32 v56, v48, v8
    v_xor_b32 v57, v49, v8
    v_xor_b32 v58, v50, v8
    v_xor_b32 v59, v51, v8
    s_waitcnt lgkmcnt(11)
    v_mfma_f32_16x16x32_bf16 v[120:123], v[96:99], v[64:67], 0
    v_xor_b32 v72, v64, v8
    v_xor_b32 v73, v65, v8
    v_xor_b32 v74, v66, v8
    v_xor_b32 v75, v67, v8
    s_waitcnt lgkmcnt(10)
    v_mfma_f32_16x16x32_bf16 v[124:127], v[96:99], v[80:83], 0
    v_xor_b32 v88, v80, v8
    v_xor_b32 v89, v81, v8
    v_xor_b32 v90, v82, v8
    v_xor_b32 v91, v83, v8
    s_waitcnt lgkmcnt(7)
    v_mfma_f32_16x16x32_bf16 v[112:115], v[100:103], v[36:39], v[112:115]
    v_xor_b32 v44, v36, v8
    v_xor_b32 v45, v37, v8
    v_xor_b32 v46, v38, v8
    v_xor_b32 v47, v39, v8
    s_waitcnt lgkmcnt(6)
    v_mfma_f32_16x16x32_bf16 v[116:119], v[100:103], v[52:55], v[116:119]
    v_xor_b32 v60, v52, v8
    v_xor_b32 v61, v53, v8
    v_xor_b32 v62, v54, v8
    v_xor_b32 v63, v55, v8
    s_waitcnt lgkmcnt(5)
    v_mfma_f32_16x16x32_bf16 v[120:123], v[100:103], v[68:71], v[120:123]
    v_xor_b32 v76, v68, v8
    v_xor_b32 v77, v69, v8
    v_xor_b32 v78, v70, v8
    v_xor_b32 v79, v71, v8
    s_waitcnt lgkmcnt(4)
    v_mfma_f32_16x16x32_bf16 v[124:127], v[100:103], v[84:87], v[124:127]
    v_xor_b32 v92, v84, v8
    v_xor_b32 v93, v85, v8
    v_xor_b32 v94, v86, v8
    v_xor_b32 v95, v87, v8
    s_waitcnt lgkmcnt(2)
    v_mfma_f32_16x16x32_bf16 v[112:115], v[104:107], v[40:43], v[112:115]
    s_mul_i32 s44, s6, 528384
    s_add_u32 s44, s44, s35
    v_mfma_f32_16x16x32_bf16 v[116:119], v[104:107], v[56:59], v[116:119]
    s_and_b32 s10, s3, 3
    s_lshl_b32 s10, s10, 9
    v_mfma_f32_16x16x32_bf16 v[120:123], v[104:107], v[72:75], v[120:123]
    s_add_u32 s44, s44, s10
    s_add_u32 s44, s44, 2097152
    v_mfma_f32_16x16x32_bf16 v[124:127], v[104:107], v[88:91], v[124:127]
    s_mov_b32 s36, s30
    s_mov_b32 s37, s31
    s_waitcnt lgkmcnt(0)
    v_mfma_f32_16x16x32_bf16 v[112:115], v[108:111], v[44:47], v[112:115]
    s_mov_b32 s38, 0x1000000
    s_mov_b32 s39, 0x20000
    v_mfma_f32_16x16x32_bf16 v[116:119], v[108:111], v[60:63], v[116:119]
    s_add_u32 s45, s44, 1056768
    s_mov_b32 s11, 0xfffefffe
    v_mfma_f32_16x16x32_bf16 v[120:123], v[108:111], v[76:79], v[120:123]
    v_mul_u32_u24 v11, 33024, v1
    v_lshl_add_u32 v11, v2, 4, v11
    v_mfma_f32_16x16x32_bf16 v[124:127], v[108:111], v[92:95], v[124:127]
    v_mov_b32 v12, 0
    v_mov_b32 v13, 0
    v_cvt_pk_bf16_f32 v96, v112, v116
    v_cvt_pk_bf16_f32 v97, v113, v117
    v_cvt_pk_bf16_f32 v98, v114, v118
    v_cvt_pk_bf16_f32 v99, v115, v119
    v_and_or_b32 v96, v96, s11, v28
    v_and_or_b32 v97, v97, s11, v29
    v_and_or_b32 v98, v98, s11, v30
    v_and_or_b32 v99, v99, s11, v31
    buffer_store_dwordx4 v[96:99], v11, s[36:39], s44 offen sc1
    v_cvt_pk_bf16_f32 v100, v120, v124
    v_cvt_pk_bf16_f32 v101, v121, v125
    v_cvt_pk_bf16_f32 v102, v122, v126
    v_cvt_pk_bf16_f32 v103, v123, v127
    v_and_or_b32 v100, v100, s11, v28
    v_and_or_b32 v101, v101, s11, v29
    v_and_or_b32 v102, v102, s11, v30
    v_and_or_b32 v103, v103, s11, v31
    buffer_store_dwordx4 v[100:103], v11, s[36:39], s45 offen sc1
    s_mov_b32 s65, 0
    s_mov_b32 s55, 0
L_ta_end:
    s_mov_b32 s40, s26
    s_mov_b32 s41, s27
    s_mov_b32 s42, 0x200000
    s_mov_b32 s43, 0x20000
    s_cmp_ge_u32 s3, 4
    s_cbranch_scc1 L_hi0
    v_lshlrev_b32 v6, 4, v1
    v_lshl_add_u32 v10, v2, 13, v6
    v_mul_u32_u24 v6, 4352, v2
    v_bfe_u32 v7, v1, 1, 2
    v_xor_b32 v7, s3, v7
    v_lshl_add_u32 v7, v7, 4, v6
    v_lshl_add_u32 v11, v1, 6, v7
    s_lshl4_add_u32 s7, s3, 1024
    v_mov_b32 v9, 17600
    v_lshl_add_u32 v28, v0, 1, v9
    v_lshl_add_u32 v7, v1, 1, s7
    s_mov_b32 exec_lo, 0x00ff00ff
    s_mov_b32 exec_hi, 0x00ff00ff
    v_add_u32 v28, v7, v6
    s_mov_b64 exec, -1
    v_lshrrev_b32 v6, 1, v1
    s_lshl_b32 s6, s57, 10
    s_add_u32 s6, s6, s56
    v_lshl_add_u32 v6, v6, 7, s6
    v_and_b32 v7, 1, v1
    v_lshlrev_b32 v9, 9, v7
    s_cmp_lg_u32 s56, 0
    s_cbranch_scc1 L_g01
    s_mov_b32 exec_lo, 0x00020002
    s_mov_b32 exec_hi, 0x00020002
    v_mov_b32 v6, 0x400
    v_mov_b32 v9, 0
    s_mov_b64 exec, -1
L_g01:
    v_lshlrev_b32 v7, 2, v2
    v_mad_u32_u24 v9, v7, v6, v9
    v_cvt_f32_u32 v6, v6
    v_cvt_f32_u32 v9, v9
    v_mul_f32 v6, 0x3a000000, v6
    v_mul_f32 v9, 0x3a000000, v9
    v_cos_f32 v64, v9
    v_sin_f32 v68, v9
    v_add_f32 v9, v9, v6
    v_cos_f32 v65, v9
    v_sin_f32 v69, v9
    v_add_f32 v9, v9, v6
    v_cos_f32 v66, v9
    v_sin_f32 v70, v9
    v_add_f32 v9, v9, v6
    v_cos_f32 v67, v9
    v_sin_f32 v71, v9
    s_and_b32 s7, s56, 63
    s_mul_i32 s32, s7, 33024
    v_cvt_pk_bf16_f32 v148, v64, v68
    v_cvt_pk_bf16_f32 v149, v65, v69
    v_cvt_pk_bf16_f32 v150, v66, v70
    v_cvt_pk_bf16_f32 v151, v67, v71
    s_cmp_lg_u32 s7, 0
    s_cbranch_scc1 L_gd2
    s_lshr_b32 s7, s56, 2
    v_and_b32 v148, 0xffff, v148
    v_lshlrev_b32 v148, s7, v148
    v_and_b32 v149, 0xffff, v149
    v_lshlrev_b32 v149, s7, v149
    v_and_b32 v150, 0xffff, v150
    v_lshlrev_b32 v150, s7, v150
    v_and_b32 v151, 0xffff, v151
    v_lshlrev_b32 v151, s7, v151
L_gd2:
    s_lshl_b32 s7, s3, 9
    s_add_u32 s32, s32, s7
    s_add_u32 s32, s32, 2097152
    s_add_u32 s33, s32, 4096
    v_and_b32 v6, 3, v1
    v_lshlrev_b32 v6, 4, v6
    ds_read_b128 v[96:99], v6 offset:33920
    s_waitcnt lgkmcnt(0)
    v_cvt_f32_u32 v6, v1
    s_lshl_b32 s6, s3, 2
    v_lshl_add_u32 v7, v2, 6, s6
    v_mul_f32 v6, 0x3b000000, v6
    v_cvt_f32_u32 v7, v7
    v_mul_f32 v15, 0x41800000, v6
    v_mul_f32 v7, v7, v6
    v_cos_f32 v64, v7
    v_sin_f32 v68, v7
    v_add_f32 v9, v7, v15
    v_cos_f32 v65, v9
    v_sin_f32 v69, v9
    v_add_f32 v9, v9, v15
    v_cos_f32 v66, v9
    v_sin_f32 v70, v9
    v_add_f32 v9, v9, v15
    v_cos_f32 v67, v9
    v_sin_f32 v71, v9
    v_mov_b32 v108, 0
    v_cvt_pk_bf16_f32 v100, v64, v65
    v_cvt_pk_bf16_f32 v104, -v68, -v69
    v_cvt_pk_bf16_f32 v101, v66, v67
    v_cvt_pk_bf16_f32 v105, -v70, -v71
    v_xor_b32 v102, v100, v8
    v_xor_b32 v106, v104, v8
    v_xor_b32 v103, v101, v8
    v_xor_b32 v107, v105, v8
    v_add_f32 v7, v7, v6
    v_cos_f32 v64, v7
    v_sin_f32 v68, v7
    v_add_f32 v9, v7, v15
    v_cos_f32 v65, v9
    v_sin_f32 v69, v9
    v_add_f32 v9, v9, v15
    v_cos_f32 v66, v9
    v_sin_f32 v70, v9
    v_add_f32 v9, v9, v15
    v_cos_f32 v67, v9
    v_sin_f32 v71, v9
    v_mov_b32 v120, 0
    v_cvt_pk_bf16_f32 v112, v64, v65
    v_cvt_pk_bf16_f32 v116, -v68, -v69
    v_cvt_pk_bf16_f32 v113, v66, v67
    v_cvt_pk_bf16_f32 v117, -v70, -v71
    v_xor_b32 v114, v112, v8
    v_xor_b32 v118, v116, v8
    v_xor_b32 v115, v113, v8
    v_xor_b32 v119, v117, v8
    v_add_f32 v7, v7, v6
    v_cos_f32 v64, v7
    v_sin_f32 v68, v7
    v_add_f32 v9, v7, v15
    v_cos_f32 v65, v9
    v_sin_f32 v69, v9
    v_add_f32 v9, v9, v15
    v_cos_f32 v66, v9
    v_sin_f32 v70, v9
    v_add_f32 v9, v9, v15
    v_cos_f32 v67, v9
    v_sin_f32 v71, v9
    v_mov_b32 v132, 0
    v_cvt_pk_bf16_f32 v124, v64, v65
    v_cvt_pk_bf16_f32 v128, -v68, -v69
    v_cvt_pk_bf16_f32 v125, v66, v67
    v_cvt_pk_bf16_f32 v129, -v70, -v71
    v_xor_b32 v126, v124, v8
    v_xor_b32 v130, v128, v8
    v_xor_b32 v127, v125, v8
    v_xor_b32 v131, v129, v8
    v_add_f32 v7, v7, v6
    v_cos_f32 v64, v7
    v_sin_f32 v68, v7
    v_add_f32 v9, v7, v15
    v_cos_f32 v65, v9
    v_sin_f32 v69, v9
    v_add_f32 v9, v9, v15
    v_cos_f32 v66, v9
    v_sin_f32 v70, v9
    v_add_f32 v9, v9, v15
    v_cos_f32 v67, v9
    v_sin_f32 v71, v9
    v_mov_b32 v144, 0
    v_cvt_pk_bf16_f32 v136, v64, v65
    v_cvt_pk_bf16_f32 v140, -v68, -v69
    v_cvt_pk_bf16_f32 v137, v66, v67
    v_cvt_pk_bf16_f32 v141, -v70, -v71
    v_xor_b32 v138, v136, v8
    v_xor_b32 v142, v140, v8
    v_xor_b32 v139, v137, v8
    v_xor_b32 v143, v141, v8
    v_lshrrev_b32 v6, 1, v1
    v_add_u32 v7, s6, v6
    v_and_b32 v9, 1, v1
    v_lshl_add_u32 v7, v9, 3, v7
    v_cvt_f32_u32 v7, v7
    v_mul_f32 v7, 0x3d000000, v7
    v_cos_f32 v7, v7
    s_mov_b32 exec_lo, 0x30003
    s_mov_b32 exec_hi, 0x30003
    v_cvt_pk_bf16_f32 v108, v7, -v7
    s_mov_b32 exec_lo, 0xc000c
    s_mov_b32 exec_hi, 0xc000c
    v_cvt_pk_bf16_f32 v120, v7, -v7
    s_mov_b32 exec_lo, 0x300030
    s_mov_b32 exec_hi, 0x300030
    v_cvt_pk_bf16_f32 v132, v7, -v7
    s_mov_b32 exec_lo, 0xc000c0
    s_mov_b32 exec_hi, 0xc000c0
    v_cvt_pk_bf16_f32 v144, v7, -v7
    s_mov_b64 exec, -1
    v_mov_b32 v109, v108
    v_mov_b32 v110, v108
    v_mov_b32 v111, v108
    v_mov_b32 v121, v120
    v_mov_b32 v122, v120
    v_mov_b32 v123, v120
    v_mov_b32 v133, v132
    v_mov_b32 v134, v132
    v_mov_b32 v135, v132
    v_mov_b32 v145, v144
    v_mov_b32 v146, v144
    v_mov_b32 v147, v144
    s_waitcnt vmcnt(0)
    s_barrier
    s_sleep 4
    buffer_load_dwordx4 v[32:35], v10, s[36:39], s32 offen offset:0 sc1
    buffer_load_dwordx4 v[36:39], v10, s[36:39], s32 offen offset:2048 sc1
    buffer_load_dwordx4 v[40:43], v10, s[36:39], s33 offen offset:0 sc1
    buffer_load_dwordx4 v[44:47], v10, s[36:39], s33 offen offset:2048 sc1
    buffer_load_dwordx4 v[48:51], v10, s[36:39], s32 offen offset:256 sc1
    buffer_load_dwordx4 v[52:55], v10, s[36:39], s32 offen offset:2304 sc1
    buffer_load_dwordx4 v[56:59], v10, s[36:39], s33 offen offset:256 sc1
    buffer_load_dwordx4 v[60:63], v10, s[36:39], s33 offen offset:2304 sc1
    s_waitcnt vmcnt(10)
    v_dot2c_f32_bf16 v12, v16, v24
    v_dot2c_f32_bf16 v13, v20, v24
    v_dot2c_f32_bf16 v12, v17, v25
    v_dot2c_f32_bf16 v13, v21, v25
    v_dot2c_f32_bf16 v12, v18, v26
    v_dot2c_f32_bf16 v13, v22, v26
    v_dot2c_f32_bf16 v12, v19, v27
    v_dot2c_f32_bf16 v13, v23, v27
    s_nop 2
    v_permlane32_swap_b32 v12, v13
    v_add_f32 v12, v12, v13
    v_mov_b32 v13, v12
    s_nop 1
    v_permlane16_swap_b32 v12, v13
    v_add_f32 v12, v12, v13
    s_nop 1
    v_add_f32_dpp v12, v12, v12 row_ror:8 row_mask:0xf bank_mask:0xf
    s_nop 1
    v_add_f32_dpp v12, v12, v12 row_ror:4 row_mask:0xf bank_mask:0xf
    s_nop 1
    v_add_f32_dpp v12, v12, v12 row_ror:2 row_mask:0xf bank_mask:0xf
    s_nop 1
    v_add_f32_dpp v12, v12, v12 row_ror:1 row_mask:0xf bank_mask:0xf
    v_cvt_pk_bf16_f32 v12, v12, v12
    v_and_b32 v12, 0xffff0000, v12
    s_lshl_b32 s6, s3, 11
    v_add_u32 v6, s6, v5
    ds_write_b128 v6, v[16:19] offset:48832
    ds_write_b128 v6, v[20:23] offset:49856
    v_lshl_add_u32 v7, v1, 6, s6
    v_lshl_add_u32 v7, v2, 3, v7
    s_waitcnt lgkmcnt(0)
    ds_read_b64 v[16:17], v7 offset:48832
    ds_read_b64 v[18:19], v7 offset:48864
    ds_read_b64 v[20:21], v7 offset:49856
    ds_read_b64 v[22:23], v7 offset:49888
    v_and_b32 v6, 1, v2
    v_lshlrev_b32 v6, 5, v6
    v_lshl_add_u32 v6, v1, 6, v6
    v_lshrrev_b32 v7, 1, v2
    v_lshl_add_u32 v3, v7, 4, v6
    v_mul_f32 v13, 0xbfb8aa3b, v12
    v_exp_f32 v13, v13
    s_nop 0
    v_add_f32 v13, 1.0, v13
    v_rcp_f32 v13, v13
    s_nop 0
    v_cvt_pk_bf16_f32 v13, v13, v13
    v_and_b32 v13, 0xffff0000, v13
    v_sub_f32 v14, 1.0, v13
    v_cvt_pk_bf16_f32 v14, v14, v14
    v_and_b32 v14, 0xffff0000, v14
    v_readlane_b32 s6, v13, 0
    v_readlane_b32 s7, v13, 32
    v_readlane_b32 s8, v14, 0
    v_readlane_b32 s9, v14, 32
    s_xor_b32 s10, s6, 0x80000000
    s_cmp_eq_u32 s58, 0
    s_cselect_b32 s10, 0, s10
    s_cselect_b32 s11, 0, s7
    v_mov_b32 v24, s6
    v_mov_b32 v25, s10
    v_mov_b32 v26, s11
    v_mov_b32 v27, s7
    v_mov_b32 v13, s8
    v_mov_b32 v14, s9
    s_waitcnt lgkmcnt(0)
    v_lshlrev_b32 v152, 16, v16
    v_and_b32 v153, 0xffff0000, v16
    v_lshlrev_b32 v154, 16, v17
    v_and_b32 v155, 0xffff0000, v17
    v_lshlrev_b32 v156, 16, v18
    v_and_b32 v157, 0xffff0000, v18
    v_lshlrev_b32 v158, 16, v19
    v_and_b32 v159, 0xffff0000, v19
    v_mul_f32 v152, v13, v152
    v_mul_f32 v153, v13, v153
    v_mul_f32 v154, v13, v154
    v_mul_f32 v155, v13, v155
    v_mul_f32 v156, v13, v156
    v_mul_f32 v157, v13, v157
    v_mul_f32 v158, v13, v158
    v_mul_f32 v159, v13, v159
    v_lshlrev_b32 v160, 16, v20
    v_and_b32 v161, 0xffff0000, v20
    v_lshlrev_b32 v162, 16, v21
    v_and_b32 v163, 0xffff0000, v21
    v_lshlrev_b32 v164, 16, v22
    v_and_b32 v165, 0xffff0000, v22
    v_lshlrev_b32 v166, 16, v23
    v_and_b32 v167, 0xffff0000, v23
    v_mul_f32 v160, v14, v160
    v_mul_f32 v161, v14, v161
    v_mul_f32 v162, v14, v162
    v_mul_f32 v163, v14, v163
    v_mul_f32 v164, v14, v164
    v_mul_f32 v165, v14, v165
    v_mul_f32 v166, v14, v166
    v_mul_f32 v167, v14, v167
    s_mul_i32 s7, s3, 2176
    v_bfe_u32 v7, v1, 1, 2
    v_xor_b32 v7, v7, v2
    v_lshl_add_u32 v7, v7, 4, s7
    v_lshl_add_u32 v29, v1, 6, v7
    v_sub_u32 v6, 16, v1
    v_bfe_u32 v7, v6, 1, 2
    v_xor_b32 v7, v7, v2
    v_lshl_add_u32 v7, v7, 4, s7
    v_lshl_add_u32 v30, v6, 6, v7
    s_cmp_eq_u32 s58, 0
    s_cselect_b32 s6, 0, 2048
    v_add_u32 v4, s6, v5
L_zjoin:
    s_waitcnt vmcnt(4)
    v_bitop3_b32 v6, v32, v36, v96 bitop3:0x7e
    v_bitop3_b32 v9, v40, v44, v96 bitop3:0x7e
    v_or_b32 v6, v6, v9
L_tb0:
    s_cbranch_execz L_tbback
    v_bitop3_b32 v7, v33, v37, v97 bitop3:0x7e
    v_bitop3_b32 v9, v41, v45, v97 bitop3:0x7e
    v_or3_b32 v6, v6, v7, v9
    v_bitop3_b32 v7, v34, v38, v98 bitop3:0x7e
    v_bitop3_b32 v9, v42, v46, v98 bitop3:0x7e
    v_or3_b32 v6, v6, v7, v9
    v_bitop3_b32 v7, v35, v39, v99 bitop3:0x7e
    v_bitop3_b32 v9, v43, v47, v99 bitop3:0x7e
    v_or3_b32 v6, v6, v7, v9
    v_and_b32 v6, 0x10001, v6
    v_cmp_ne_u32 vcc, 0, v6
    s_nop 0
    s_cbranch_vccnz L_retry0
L_got0:
    v_pk_mov_b32 v[80:81], v[32:33], v[36:37] op_sel:[0,0]
    v_pk_mov_b32 v[82:83], v[40:41], v[44:45] op_sel:[0,0]
    v_pk_mov_b32 v[84:85], v[32:33], v[36:37] op_sel:[1,1]
    v_pk_mov_b32 v[86:87], v[40:41], v[44:45] op_sel:[1,1]
L_tb1:
    s_cbranch_execz L_tbback
    v_mfma_f32_16x16x32_bf16 v[64:67], v[80:83], v[148:151], 0
    v_pk_mov_b32 v[88:89], v[34:35], v[38:39] op_sel:[0,0]
    v_pk_mov_b32 v[90:91], v[42:43], v[46:47] op_sel:[0,0]
    v_mfma_f32_16x16x32_bf16 v[68:71], v[84:87], v[148:151], 0
    v_pk_mov_b32 v[92:93], v[34:35], v[38:39] op_sel:[1,1]
    v_pk_mov_b32 v[94:95], v[42:43], v[46:47] op_sel:[1,1]
    v_mfma_f32_16x16x32_bf16 v[72:75], v[88:91], v[148:151], 0
    s_nop 1
    v_mfma_f32_16x16x32_bf16 v[76:79], v[92:95], v[148:151], 0
    s_waitcnt vmcnt(0)
    v_bitop3_b32 v6, v48, v52, v96 bitop3:0x7e
    v_bitop3_b32 v9, v56, v60, v96 bitop3:0x7e
    v_or_b32 v6, v6, v9
    v_bitop3_b32 v7, v49, v53, v97 bitop3:0x7e
    v_bitop3_b32 v9, v57, v61, v97 bitop3:0x7e
    v_or3_b32 v6, v6, v7, v9
    v_bitop3_b32 v7, v50, v54, v98 bitop3:0x7e
L_tb2:
    s_cbranch_execz L_tbback
    v_bitop3_b32 v9, v58, v62, v98 bitop3:0x7e
    v_or3_b32 v6, v6, v7, v9
    v_bitop3_b32 v7, v51, v55, v99 bitop3:0x7e
    v_bitop3_b32 v9, v59, v63, v99 bitop3:0x7e
    v_or3_b32 v6, v6, v7, v9
    v_and_b32 v6, 0x10001, v6
    v_cmp_ne_u32 vcc, 0, v6
    s_nop 0
    s_cbranch_vccnz L_retry1
L_got1:
    v_pk_mov_b32 v[80:81], v[48:49], v[52:53] op_sel:[0,0]
    v_pk_mov_b32 v[82:83], v[56:57], v[60:61] op_sel:[0,0]
    v_pk_mov_b32 v[84:85], v[48:49], v[52:53] op_sel:[1,1]
    v_pk_mov_b32 v[86:87], v[56:57], v[60:61] op_sel:[1,1]
    v_mfma_f32_16x16x32_bf16 v[32:35], v[80:83], v[148:151], 0
    v_pk_mov_b32 v[88:89], v[50:51], v[54:55] op_sel:[0,0]
    v_pk_mov_b32 v[90:91], v[58:59], v[62:63] op_sel:[0,0]
    v_mfma_f32_16x16x32_bf16 v[36:39], v[84:87], v[148:151], 0
L_tb3:
    s_cbranch_execz L_tbback
    v_pk_mov_b32 v[92:93], v[50:51], v[54:55] op_sel:[1,1]
    v_pk_mov_b32 v[94:95], v[58:59], v[62:63] op_sel:[1,1]
    v_mfma_f32_16x16x32_bf16 v[40:43], v[88:91], v[148:151], 0
    s_nop 1
    v_mfma_f32_16x16x32_bf16 v[44:47], v[92:95], v[148:151], 0
    s_nop 0
    v_cvt_pk_bf16_f32 v80, v64, v65
    v_cvt_pk_bf16_f32 v81, v66, v67
    v_cvt_pk_bf16_f32 v82, v32, v33
    v_cvt_pk_bf16_f32 v83, v34, v35
    v_cvt_pk_bf16_f32 v84, v68, v69
    v_cvt_pk_bf16_f32 v85, v70, v71
    v_cvt_pk_bf16_f32 v86, v36, v37
    v_cvt_pk_bf16_f32 v87, v38, v39
    v_mfma_f32_16x16x32_bf16 v[64:67], v[80:83], v[100:103], 0
    v_mfma_f32_16x16x32_bf16 v[32:35], v[80:83], v[104:107], 0
    v_mfma_f32_16x16x32_bf16 v[96:99], v[80:83], v[108:111], 0
L_tb4:
    s_cbranch_execz L_tbback
    v_cvt_pk_bf16_f32 v88, v72, v73
    v_cvt_pk_bf16_f32 v89, v74, v75
    v_cvt_pk_bf16_f32 v90, v40, v41
    v_cvt_pk_bf16_f32 v91, v42, v43
    v_mfma_f32_16x16x32_bf16 v[68:71], v[84:87], v[112:115], 0
    v_mfma_f32_16x16x32_bf16 v[36:39], v[84:87], v[116:119], 0
    v_mfma_f32_16x16x32_bf16 v[96:99], v[84:87], v[120:123], v[96:99]
    v_cvt_pk_bf16_f32 v92, v76, v77
    v_cvt_pk_bf16_f32 v93, v78, v79
    v_cvt_pk_bf16_f32 v94, v44, v45
    v_cvt_pk_bf16_f32 v95, v46, v47
    v_mfma_f32_16x16x32_bf16 v[72:75], v[88:91], v[124:127], 0
    v_mfma_f32_16x16x32_bf16 v[40:43], v[88:91], v[128:131], 0
    v_mfma_f32_16x16x32_bf16 v[96:99], v[88:91], v[132:135], v[96:99]
    v_mfma_f32_16x16x32_bf16 v[76:79], v[92:95], v[136:139], 0
L_tb5:
    s_cbranch_execz L_tbback
    v_mfma_f32_16x16x32_bf16 v[44:47], v[92:95], v[140:143], 0
    v_mfma_f32_16x16x32_bf16 v[96:99], v[92:95], v[144:147], v[96:99]
    v_cvt_pk_bf16_f32 v48, v64, v32
    v_cvt_pk_bf16_f32 v52, v65, v33
    v_cvt_pk_bf16_f32 v56, v66, v34
    v_cvt_pk_bf16_f32 v60, v67, v35
    v_cvt_pk_bf16_f32 v49, v68, v36
    v_cvt_pk_bf16_f32 v53, v69, v37
    v_cvt_pk_bf16_f32 v57, v70, v38
    v_cvt_pk_bf16_f32 v61, v71, v39
    v_cvt_pk_bf16_f32 v50, v72, v40
    v_cvt_pk_bf16_f32 v54, v73, v41
    v_cvt_pk_bf16_f32 v58, v74, v42
    v_cvt_pk_bf16_f32 v62, v75, v43
    v_cvt_pk_bf16_f32 v51, v76, v44
    ds_write_b128 v11, v[48:51] offset:16384
L_tb6:
    s_cbranch_execz L_tbback
    v_cvt_pk_bf16_f32 v55, v77, v45
    ds_write_b128 v11, v[52:55] offset:17472
    v_cvt_pk_bf16_f32 v59, v78, v46
    ds_write_b128 v11, v[56:59] offset:18560
    v_cvt_pk_bf16_f32 v63, v79, v47
    ds_write_b128 v11, v[60:63] offset:19648
    v_cvt_pk_bf16_f32 v96, v96, v97
    v_cvt_pk_bf16_f32 v98, v98, v99
    ds_write_b16 v28, v96 offset:16384
    ds_write_b16_d16_hi v28, v96 offset:17472
    ds_write_b16 v28, v98 offset:18560
    ds_write_b16_d16_hi v28, v98 offset:19648
L_d2:
    ds_read_b128 v[64:67], v5 offset:42688
    ds_read_b128 v[68:71], v5 offset:43712
    ds_read_b128 v[72:75], v4 offset:42688
L_tb7:
    s_cbranch_execz L_tbback
    ds_read_b128 v[76:79], v4 offset:43712
    v_mov_b32 v9, 33856
    s_waitcnt lgkmcnt(0)
    s_barrier
    ds_read_b32 v6, v9
    ds_read_b128 v[32:35], v29 offset:16384
    ds_read_b128 v[36:39], v30 offset:16384
    ds_read_b128 v[40:43], v29 offset:17472
    ds_read_b128 v[44:47], v30 offset:17472
    s_cmp_lg_u32 s55, 0
    s_cbranch_scc1 L_zfin
    s_lshl_b32 s6, s58, 10
    s_lshl_b32 s7, s59, 10
    s_waitcnt lgkmcnt(3)
    v_mfma_f32_16x16x32_bf16 v[48:51], v[32:35], v[64:67], 0
    s_waitcnt lgkmcnt(2)
    v_mfma_f32_16x16x32_bf16 v[52:55], v[36:39], v[68:71], 0
    s_waitcnt lgkmcnt(1)
    v_mfma_f32_16x16x32_bf16 v[56:59], v[40:43], v[72:75], 0
    s_waitcnt lgkmcnt(0)
    v_mfma_f32_16x16x32_bf16 v[60:63], v[44:47], v[76:79], 0
L_tb8:
    s_cbranch_execz L_tbback
    v_readfirstlane_b32 s44, v6
    s_andn2_b32 s54, 0xffff, s44
    v_fmac_f32 v152, v24, v48
    v_fmac_f32 v153, v24, v49
    v_fmac_f32 v154, v24, v50
    v_fmac_f32 v155, v24, v51
    v_fmac_f32 v156, v24, v52
    v_fmac_f32 v157, v24, v53
    v_fmac_f32 v158, v24, v54
    v_fmac_f32 v159, v24, v55
    v_fmac_f32 v160, v26, v48
    v_fmac_f32 v161, v26, v49
    v_fmac_f32 v162, v26, v50
    v_fmac_f32 v163, v26, v51
    v_fmac_f32 v164, v26, v52
    v_fmac_f32 v165, v26, v53
    v_fmac_f32 v166, v26, v54
    v_fmac_f32 v167, v26, v55
    v_fmac_f32 v152, v25, v56
    v_fmac_f32 v153, v25, v57
    v_fmac_f32 v154, v25, v58
    v_fmac_f32 v155, v25, v59
    v_fmac_f32 v156, v25, v60
    v_fmac_f32 v157, v25, v61
    v_fmac_f32 v158, v25, v62
    v_fmac_f32 v159, v25, v63
    v_cvt_pk_bf16_f32 v32, v152, v153
    v_cvt_pk_bf16_f32 v33, v154, v155
L_tb9:
    s_cbranch_execz L_tbback
    v_cvt_pk_bf16_f32 v34, v156, v157
    v_cvt_pk_bf16_f32 v35, v158, v159
    s_cmp_eq_u32 s58, s54
    s_cbranch_scc1 L_skip3
    v_permlane16_swap_b32 v32, v34
    v_permlane16_swap_b32 v33, v35
    buffer_store_dwordx4 v[32:35], v3, s[40:43], s6 offen nt
L_skip3:
    v_fmac_f32 v160, v27, v56
    v_fmac_f32 v161, v27, v57
    v_fmac_f32 v162, v27, v58
    v_fmac_f32 v163, v27, v59
    v_fmac_f32 v164, v27, v60
    v_fmac_f32 v165, v27, v61
    v_fmac_f32 v166, v27, v62
    v_fmac_f32 v167, v27, v63
    v_cvt_pk_bf16_f32 v36, v160, v161
    v_cvt_pk_bf16_f32 v37, v162, v163
    v_cvt_pk_bf16_f32 v38, v164, v165
    v_cvt_pk_bf16_f32 v39, v166, v167
    s_cmp_eq_u32 s59, s54
    s_cbranch_scc1 L_skip4
    v_permlane16_swap_b32 v36, v38
    v_permlane16_swap_b32 v37, v39
    buffer_store_dwordx4 v[36:39], v3, s[40:43], s7 offen nt
L_skip4:
L_tb_end:
    s_endpgm
L_retry0:
    s_sleep 3
    buffer_load_dwordx4 v[32:35], v10, s[36:39], s32 offen offset:0 sc1
    buffer_load_dwordx4 v[36:39], v10, s[36:39], s32 offen offset:2048 sc1
    buffer_load_dwordx4 v[40:43], v10, s[36:39], s33 offen offset:0 sc1
    buffer_load_dwordx4 v[44:47], v10, s[36:39], s33 offen offset:2048 sc1
    s_add_u32 s65, s65, 1
    s_lshr_b32 s34, s65, 17
    s_waitcnt vmcnt(0)
    s_cbranch_scc1 L_got0
    v_bitop3_b32 v6, v32, v36, v96 bitop3:0x7e
    v_bitop3_b32 v9, v40, v44, v96 bitop3:0x7e
    v_or_b32 v6, v6, v9
    v_bitop3_b32 v7, v33, v37, v97 bitop3:0x7e
    v_bitop3_b32 v9, v41, v45, v97 bitop3:0x7e
    v_or3_b32 v6, v6, v7, v9
    v_bitop3_b32 v7, v34, v38, v98 bitop3:0x7e
    v_bitop3_b32 v9, v42, v46, v98 bitop3:0x7e
    v_or3_b32 v6, v6, v7, v9
    v_bitop3_b32 v7, v35, v39, v99 bitop3:0x7e
    v_bitop3_b32 v9, v43, v47, v99 bitop3:0x7e
    v_or3_b32 v6, v6, v7, v9
    v_and_b32 v6, 0x10001, v6
    v_cmp_ne_u32 vcc, 0, v6
    s_nop 0
    s_cbranch_vccnz L_retry0
    s_branch L_got0
L_retry1:
    s_sleep 3
    buffer_load_dwordx4 v[48:51], v10, s[36:39], s32 offen offset:256 sc1
    buffer_load_dwordx4 v[52:55], v10, s[36:39], s32 offen offset:2304 sc1
    buffer_load_dwordx4 v[56:59], v10, s[36:39], s33 offen offset:256 sc1
    buffer_load_dwordx4 v[60:63], v10, s[36:39], s33 offen offset:2304 sc1
    s_add_u32 s65, s65, 1
    s_lshr_b32 s34, s65, 17
    s_waitcnt vmcnt(0)
    s_cbranch_scc1 L_got1
    v_bitop3_b32 v6, v48, v52, v96 bitop3:0x7e
    v_bitop3_b32 v9, v56, v60, v96 bitop3:0x7e
    v_or_b32 v6, v6, v9
    v_bitop3_b32 v7, v49, v53, v97 bitop3:0x7e
    v_bitop3_b32 v9, v57, v61, v97 bitop3:0x7e
    v_or3_b32 v6, v6, v7, v9
    v_bitop3_b32 v7, v50, v54, v98 bitop3:0x7e
    v_bitop3_b32 v9, v58, v62, v98 bitop3:0x7e
    v_or3_b32 v6, v6, v7, v9
    v_bitop3_b32 v7, v51, v55, v99 bitop3:0x7e
    v_bitop3_b32 v9, v59, v63, v99 bitop3:0x7e
    v_or3_b32 v6, v6, v7, v9
    v_and_b32 v6, 0x10001, v6
    v_cmp_ne_u32 vcc, 0, v6
    s_nop 0
    s_cbranch_vccnz L_retry1
    s_branch L_got1
L_hi0:
    s_waitcnt vmcnt(0)
    s_barrier
L_hi1:
    s_mov_b64 exec, 0
    s_sub_u32 s53, s3, 8
L_tbback:
    s_add_u32 s53, s53, 4
    s_cmp_eq_u32 s53, 0
    s_cbranch_scc1 L_tb0
    s_cmp_eq_u32 s53, 1
    s_cbranch_scc1 L_tb1
    s_cmp_eq_u32 s53, 2
    s_cbranch_scc1 L_tb2
    s_cmp_eq_u32 s53, 3
    s_cbranch_scc1 L_tb3
    s_cmp_eq_u32 s53, 4
    s_cbranch_scc1 L_tb4
    s_cmp_eq_u32 s53, 5
    s_cbranch_scc1 L_tb5
    s_cmp_eq_u32 s53, 6
    s_cbranch_scc1 L_tb6
    s_cmp_eq_u32 s53, 7
    s_cbranch_scc1 L_tb7
    s_cmp_eq_u32 s53, 8
    s_cbranch_scc1 L_tb8
    s_cmp_eq_u32 s53, 9
    s_cbranch_scc1 L_tb9
    s_mov_b64 exec, -1
    s_cmp_lg_u32 s55, 0
    s_cbranch_scc1 L_z0b
    s_waitcnt vmcnt(2)
    v_dot2c_f32_bf16 v12, v16, v24
    v_dot2c_f32_bf16 v13, v20, v24
    v_dot2c_f32_bf16 v12, v17, v25
    v_dot2c_f32_bf16 v13, v21, v25
    v_dot2c_f32_bf16 v12, v18, v26
    v_dot2c_f32_bf16 v13, v22, v26
    v_dot2c_f32_bf16 v12, v19, v27
    v_dot2c_f32_bf16 v13, v23, v27
    s_nop 2
    v_permlane32_swap_b32 v12, v13
    v_add_f32 v12, v12, v13
    v_mov_b32 v13, v12
    s_nop 1
    v_permlane16_swap_b32 v12, v13
    v_add_f32 v12, v12, v13
    s_nop 1
    v_add_f32_dpp v12, v12, v12 row_ror:8 row_mask:0xf bank_mask:0xf
    s_nop 1
    v_add_f32_dpp v12, v12, v12 row_ror:4 row_mask:0xf bank_mask:0xf
    s_nop 1
    v_add_f32_dpp v12, v12, v12 row_ror:2 row_mask:0xf bank_mask:0xf
    s_nop 1
    v_add_f32_dpp v12, v12, v12 row_ror:1 row_mask:0xf bank_mask:0xf
    v_cvt_pk_bf16_f32 v12, v12, v12
    v_and_b32 v12, 0xffff0000, v12
    s_lshl_b32 s6, s3, 11
    v_add_u32 v6, s6, v5
    ds_write_b128 v6, v[16:19] offset:48832
    ds_write_b128 v6, v[20:23] offset:49856
    v_lshl_add_u32 v7, v1, 6, s6
    v_lshl_add_u32 v7, v2, 3, v7
    s_waitcnt lgkmcnt(0)
    ds_read_b64 v[16:17], v7 offset:48832
    ds_read_b64 v[18:19], v7 offset:48864
    ds_read_b64 v[20:21], v7 offset:49856
    ds_read_b64 v[22:23], v7 offset:49888
    v_and_b32 v6, 1, v2
    v_lshlrev_b32 v6, 5, v6
    v_lshl_add_u32 v6, v1, 6, v6
    v_lshrrev_b32 v7, 1, v2
    v_lshl_add_u32 v3, v7, 4, v6
    v_mul_f32 v13, 0xbfb8aa3b, v12
    v_exp_f32 v13, v13
    s_nop 0
    v_add_f32 v13, 1.0, v13
    v_rcp_f32 v13, v13
    s_nop 0
    v_cvt_pk_bf16_f32 v13, v13, v13
    v_and_b32 v13, 0xffff0000, v13
    v_sub_f32 v14, 1.0, v13
    v_cvt_pk_bf16_f32 v14, v14, v14
    v_and_b32 v14, 0xffff0000, v14
    v_readlane_b32 s6, v13, 0
    v_readlane_b32 s7, v13, 32
    v_readlane_b32 s8, v14, 0
    v_readlane_b32 s9, v14, 32
    s_xor_b32 s10, s6, 0x80000000
    s_cmp_eq_u32 s58, 0
    s_cselect_b32 s10, 0, s10
    s_cselect_b32 s11, 0, s7
    v_mov_b32 v24, s6
    v_mov_b32 v25, s10
    v_mov_b32 v26, s11
    v_mov_b32 v27, s7
    v_mov_b32 v13, s8
    v_mov_b32 v14, s9
    s_waitcnt lgkmcnt(0)
    v_lshlrev_b32 v152, 16, v16
    v_and_b32 v153, 0xffff0000, v16
    v_lshlrev_b32 v154, 16, v17
    v_and_b32 v155, 0xffff0000, v17
    v_lshlrev_b32 v156, 16, v18
    v_and_b32 v157, 0xffff0000, v18
    v_lshlrev_b32 v158, 16, v19
    v_and_b32 v159, 0xffff0000, v19
    v_mul_f32 v152, v13, v152
    v_mul_f32 v153, v13, v153
    v_mul_f32 v154, v13, v154
    v_mul_f32 v155, v13, v155
    v_mul_f32 v156, v13, v156
    v_mul_f32 v157, v13, v157
    v_mul_f32 v158, v13, v158
    v_mul_f32 v159, v13, v159
    v_lshlrev_b32 v160, 16, v20
    v_and_b32 v161, 0xffff0000, v20
    v_lshlrev_b32 v162, 16, v21
    v_and_b32 v163, 0xffff0000, v21
    v_lshlrev_b32 v164, 16, v22
    v_and_b32 v165, 0xffff0000, v22
    v_lshlrev_b32 v166, 16, v23
    v_and_b32 v167, 0xffff0000, v23
    v_mul_f32 v160, v14, v160
    v_mul_f32 v161, v14, v161
    v_mul_f32 v162, v14, v162
    v_mul_f32 v163, v14, v163
    v_mul_f32 v164, v14, v164
    v_mul_f32 v165, v14, v165
    v_mul_f32 v166, v14, v166
    v_mul_f32 v167, v14, v167
    s_mul_i32 s7, s3, 2176
    v_bfe_u32 v7, v1, 1, 2
    v_xor_b32 v7, v7, v2
    v_lshl_add_u32 v7, v7, 4, s7
    v_lshl_add_u32 v29, v1, 6, v7
    v_sub_u32 v6, 16, v1
    v_bfe_u32 v7, v6, 1, 2
    v_xor_b32 v7, v7, v2
    v_lshl_add_u32 v7, v7, 4, s7
    v_lshl_add_u32 v30, v6, 6, v7
    s_cmp_eq_u32 s58, 0
    s_cselect_b32 s6, 0, 2048
    v_add_u32 v4, s6, v5
    s_branch L_d2
L_ah:
    v_lshlrev_b32 v5, 4, v0
    v_mov_b32 v31, 0
    s_mov_b32 s64, 0x9E3779B1
    s_cmp_ge_u32 s7, 1
    s_waitcnt lgkmcnt(0)
    s_cbranch_scc1 L_nowpf
    global_load_dwordx4 v[32:35], v5, s[16:17]
    global_load_dword v30, v31, s[30:31]
    global_load_dwordx4 v[36:39], v5, s[24:25]
L_nowpf:
    v_lshlrev_b32 v14, 10, v0
    s_lshl_b32 s50, s2, 3
    s_add_u32 s50, s50, 65536
    s_mov_b32 s36, s30
    s_mov_b32 s37, s31
    s_mov_b32 s38, 0x1000000
    s_mov_b32 s39, 0x20000
    s_mov_b32 s65, 0
    v_lshlrev_b32 v6, 2, v2
    v_cvt_f32_u32 v7, v1
    v_cvt_f32_u32 v6, v6
    v_mul_f32 v7, 0x3d800000, v7
    v_mul_f32 v9, v6, v7
    v_cos_f32 v64, v9
    v_sin_f32 v68, v9
    v_add_f32 v9, v9, v7
    v_cos_f32 v65, v9
    v_sin_f32 v69, v9
    v_add_f32 v9, v9, v7
    v_cos_f32 v66, v9
    v_sin_f32 v70, v9
    v_add_f32 v9, v9, v7
    v_cos_f32 v67, v9
    v_sin_f32 v71, v9
    s_nop 0
    v_cvt_pk_bf16_f32 v40, v64, v68
    v_cvt_pk_bf16_f32 v48, -v68, v64
    v_cvt_pk_bf16_f32 v41, v65, v69
    v_cvt_pk_bf16_f32 v49, -v69, v65
    v_cvt_pk_bf16_f32 v42, v66, v70
    v_cvt_pk_bf16_f32 v50, -v70, v66
    v_cvt_pk_bf16_f32 v43, v67, v71
    v_cvt_pk_bf16_f32 v51, -v71, v67
    v_add_f32 v7, 0x3d800000, v7
    v_mul_f32 v9, v6, v7
    v_cos_f32 v64, v9
    v_sin_f32 v68, v9
    v_add_f32 v9, v9, v7
    v_cos_f32 v65, v9
    v_sin_f32 v69, v9
    v_add_f32 v9, v9, v7
    v_cos_f32 v66, v9
    v_sin_f32 v70, v9
    v_add_f32 v9, v9, v7
    v_cos_f32 v67, v9
    v_sin_f32 v71, v9
    s_nop 0
    v_cvt_pk_bf16_f32 v44, v64, -v68
    v_cvt_pk_bf16_f32 v52, -v68, -v64
    v_cvt_pk_bf16_f32 v45, v65, -v69
    v_cvt_pk_bf16_f32 v53, -v69, -v65
    v_cvt_pk_bf16_f32 v46, v66, -v70
    v_cvt_pk_bf16_f32 v54, -v70, -v66
    v_cvt_pk_bf16_f32 v47, v67, -v71
    v_cvt_pk_bf16_f32 v55, -v71, -v67
    ds_write_b128 v5, v[40:43] offset:42688
    ds_write_b128 v5, v[44:47] offset:43712
    ds_write_b128 v5, v[48:51] offset:44736
    ds_write_b128 v5, v[52:55] offset:45760
    global_load_dword v30, v31, s[30:31]
    v_mov_b32 v9, 33792
    s_waitcnt vmcnt(0)
    v_mul_lo_u32 v31, v30, s64
    v_add_u32 v31, 0x7F4A7C15, v31
    v_lshlrev_b32 v6, 1, v1
    v_lshrrev_b32 v6, v6, v31
    v_lshlrev_b32 v7, 15, v6
    v_and_b32 v6, 1, v6
    v_and_b32 v7, 0x10000, v7
    v_or_b32 v6, v6, v7
    v_lshlrev_b32 v7, 2, v1
    ds_write_b32 v7, v6 offset:33920
    s_waitcnt lgkmcnt(0)
    v_mov_b32 v9, 33792
    s_barrier
    ds_read_b128 v[40:43], v9 offset:0
    ds_read_b128 v[44:47], v9 offset:16
    ds_read_b128 v[48:51], v9 offset:32
    ds_read_b128 v[52:55], v9 offset:48
    s_mov_b64 exec, 0x3fffff
    s_waitcnt lgkmcnt(2)
    v_max3_u32 v6, v40, v41, v42
    v_max3_u32 v7, v43, v44, v45
    v_max3_u32 v6, v46, v47, v6
    s_waitcnt lgkmcnt(0)
    v_max3_u32 v7, v48, v49, v7
    v_max3_u32 v6, v50, v51, v6
    v_max3_u32 v7, v52, v53, v7
    v_max3_u32 v6, v54, v55, v6
    v_max_u32 v30, v6, v7
    buffer_store_dwordx2 v[30:31], v14, s[36:39], s50 offen sc1
    s_mov_b64 exec, -1
    s_and_b32 s61, s2, 0
    s_mul_i32 s61, s61, 3072
    s_add_u32 s61, s61, 84992
    s_add_u32 s62, s61, 2048
    s_waitcnt vmcnt(0)
    s_barrier
    s_sleep 10
    s_branch L_poll5_1
L_poll5:
    s_sleep 3
L_poll5_1:
    buffer_load_dwordx4 v[32:35], v5, s[36:39], s61 offen sc1
    s_add_u32 s61, s61, 1024
    s_min_u32 s61, s61, s62
    s_add_u32 s65, s65, 1
    s_lshr_b32 s34, s65, 17
    s_waitcnt vmcnt(0)
    s_cbranch_scc1 L_poll5_ok
    v_cmp_ne_u32 vcc, v31, v33
    v_cmp_ne_u32 s[12:13], v31, v35
    s_or_b64 vcc, vcc, s[12:13]
    s_cbranch_vccnz L_poll5
L_poll5_ok:
    v_max_u32 v32, v32, v34
    s_nop 1
    v_max_u32_dpp v32, v32, v32 row_ror:8 row_mask:0xf bank_mask:0xf
    s_nop 1
    v_max_u32_dpp v32, v32, v32 row_ror:4 row_mask:0xf bank_mask:0xf
    s_nop 1
    v_max_u32_dpp v32, v32, v32 row_ror:2 row_mask:0xf bank_mask:0xf
    s_nop 1
    v_max_u32_dpp v32, v32, v32 row_ror:1 row_mask:0xf bank_mask:0xf
    v_mov_b32 v33, v32
    s_nop 1
    v_permlane16_swap_b32 v32, v33
    v_max_u32 v32, v32, v33
    v_mov_b32 v33, v32
    s_nop 1
    v_permlane32_swap_b32 v32, v33
    v_max_u32 v32, v32, v33
    v_mov_b32 v9, 33856
    s_mov_b64 exec, 1
    ds_write_b32 v9, v32
    s_mov_b64 exec, -1
    s_waitcnt lgkmcnt(0)
    s_barrier
    s_endpgm
L_notA:
    s_lshl4_add_u32 s60, s6, s7
    s_sub_u32 s60, s60, 16
    s_cmp_ge_u32 s2, 256
    s_cbranch_scc1 L_end
    s_cmp_lt_u32 s6, 4
    s_cbranch_scc1 L_F
    s_mul_i32 s60, s6, 12
    s_add_u32 s60, s60, s7
    s_cmp_lt_u32 s7, 28
    s_cbranch_scc1 L_F
    s_mov_b32 s55, 1
    s_lshl2_add_u32 s47, s6, s7
    s_sub_u32 s47, s47, 44
    v_and_b32 v6, 1, v2
    v_lshlrev_b32 v6, 5, v6
    v_lshl_add_u32 v6, v1, 6, v6
    v_lshrrev_b32 v7, 1, v2
    v_lshl_add_u32 v3, v7, 4, v6
    v_lshlrev_b32 v5, 4, v0
    v_lshlrev_b32 v8, 31, v1
    v_lshrrev_b32 v9, 16, v8
    v_or_b32 v8, v8, v9
    s_waitcnt lgkmcnt(0)
    s_mov_b32 s36, s30
    s_mov_b32 s37, s31
    s_mov_b32 s38, 0x1000000
    s_mov_b32 s39, 0x20000
    s_mov_b32 s65, 0
    s_mov_b32 s40, s26
    s_mov_b32 s41, s27
    s_mov_b32 s42, 0x200000
    s_mov_b32 s43, 0x20000
    v_lshlrev_b32 v6, 4, v1
    v_lshl_add_u32 v10, v2, 13, v6
    v_mul_u32_u24 v6, 4352, v2
    v_bfe_u32 v7, v1, 1, 2
    v_xor_b32 v7, s3, v7
    v_lshl_add_u32 v7, v7, 4, v6
    v_lshl_add_u32 v11, v1, 6, v7
    s_lshl4_add_u32 s7, s3, 1024
    v_mov_b32 v9, 17600
    v_lshl_add_u32 v28, v0, 1, v9
    v_lshl_add_u32 v7, v1, 1, s7
    s_mov_b32 exec_lo, 0x00ff00ff
    s_mov_b32 exec_hi, 0x00ff00ff
    v_add_u32 v28, v7, v6
    s_mov_b64 exec, -1
    s_cmp_eq_u32 s3, 8
    s_cbranch_scc1 L_zh
    s_cmp_ge_u32 s3, 4
    s_cbranch_scc1 L_z0
    v_cvt_f32_u32 v6, v1
    s_lshl_b32 s6, s3, 2
    v_lshl_add_u32 v7, v2, 6, s6
    v_mul_f32 v6, 0x3b000000, v6
    v_cvt_f32_u32 v7, v7
    v_mul_f32 v15, 0x41800000, v6
    v_mul_f32 v7, v7, v6
    v_cos_f32 v64, v7
    v_sin_f32 v68, v7
    v_add_f32 v9, v7, v15
    v_cos_f32 v65, v9
    v_sin_f32 v69, v9
    v_add_f32 v9, v9, v15
    v_cos_f32 v66, v9
    v_sin_f32 v70, v9
    v_add_f32 v9, v9, v15
    v_cos_f32 v67, v9
    v_sin_f32 v71, v9
    v_mov_b32 v108, 0
    v_cvt_pk_bf16_f32 v100, v64, v65
    v_cvt_pk_bf16_f32 v104, -v68, -v69
    v_cvt_pk_bf16_f32 v101, v66, v67
    v_cvt_pk_bf16_f32 v105, -v70, -v71
    v_xor_b32 v102, v100, v8
    v_xor_b32 v106, v104, v8
    v_xor_b32 v103, v101, v8
    v_xor_b32 v107, v105, v8
    v_add_f32 v7, v7, v6
    v_cos_f32 v64, v7
    v_sin_f32 v68, v7
    v_add_f32 v9, v7, v15
    v_cos_f32 v65, v9
    v_sin_f32 v69, v9
    v_add_f32 v9, v9, v15
    v_cos_f32 v66, v9
    v_sin_f32 v70, v9
    v_add_f32 v9, v9, v15
    v_cos_f32 v67, v9
    v_sin_f32 v71, v9
    v_mov_b32 v120, 0
    v_cvt_pk_bf16_f32 v112, v64, v65
    v_cvt_pk_bf16_f32 v116, -v68, -v69
    v_cvt_pk_bf16_f32 v113, v66, v67
    v_cvt_pk_bf16_f32 v117, -v70, -v71
    v_xor_b32 v114, v112, v8
    v_xor_b32 v118, v116, v8
    v_xor_b32 v115, v113, v8
    v_xor_b32 v119, v117, v8
    v_add_f32 v7, v7, v6
    v_cos_f32 v64, v7
    v_sin_f32 v68, v7
    v_add_f32 v9, v7, v15
    v_cos_f32 v65, v9
    v_sin_f32 v69, v9
    v_add_f32 v9, v9, v15
    v_cos_f32 v66, v9
    v_sin_f32 v70, v9
    v_add_f32 v9, v9, v15
    v_cos_f32 v67, v9
    v_sin_f32 v71, v9
    v_mov_b32 v132, 0
    v_cvt_pk_bf16_f32 v124, v64, v65
    v_cvt_pk_bf16_f32 v128, -v68, -v69
    v_cvt_pk_bf16_f32 v125, v66, v67
    v_cvt_pk_bf16_f32 v129, -v70, -v71
    v_xor_b32 v126, v124, v8
    v_xor_b32 v130, v128, v8
    v_xor_b32 v127, v125, v8
    v_xor_b32 v131, v129, v8
    v_add_f32 v7, v7, v6
    v_cos_f32 v64, v7
    v_sin_f32 v68, v7
    v_add_f32 v9, v7, v15
    v_cos_f32 v65, v9
    v_sin_f32 v69, v9
    v_add_f32 v9, v9, v15
    v_cos_f32 v66, v9
    v_sin_f32 v70, v9
    v_add_f32 v9, v9, v15
    v_cos_f32 v67, v9
    v_sin_f32 v71, v9
    v_mov_b32 v144, 0
    v_cvt_pk_bf16_f32 v136, v64, v65
    v_cvt_pk_bf16_f32 v140, -v68, -v69
    v_cvt_pk_bf16_f32 v137, v66, v67
    v_cvt_pk_bf16_f32 v141, -v70, -v71
    v_xor_b32 v138, v136, v8
    v_xor_b32 v142, v140, v8
    v_xor_b32 v139, v137, v8
    v_xor_b32 v143, v141, v8
    v_lshrrev_b32 v6, 1, v1
    v_add_u32 v7, s6, v6
    v_and_b32 v9, 1, v1
    v_lshl_add_u32 v7, v9, 3, v7
    v_cvt_f32_u32 v7, v7
    v_mul_f32 v7, 0x3d000000, v7
    v_cos_f32 v7, v7
    s_mov_b32 exec_lo, 0x30003
    s_mov_b32 exec_hi, 0x30003
    v_cvt_pk_bf16_f32 v108, v7, -v7
    s_mov_b32 exec_lo, 0xc000c
    s_mov_b32 exec_hi, 0xc000c
    v_cvt_pk_bf16_f32 v120, v7, -v7
    s_mov_b32 exec_lo, 0x300030
    s_mov_b32 exec_hi, 0x300030
    v_cvt_pk_bf16_f32 v132, v7, -v7
    s_mov_b32 exec_lo, 0xc000c0
    s_mov_b32 exec_hi, 0xc000c0
    v_cvt_pk_bf16_f32 v144, v7, -v7
    s_mov_b64 exec, -1
    v_mov_b32 v109, v108
    v_mov_b32 v110, v108
    v_mov_b32 v111, v108
    v_mov_b32 v121, v120
    v_mov_b32 v122, v120
    v_mov_b32 v123, v120
    v_mov_b32 v133, v132
    v_mov_b32 v134, v132
    v_mov_b32 v135, v132
    v_mov_b32 v145, v144
    v_mov_b32 v146, v144
    v_mov_b32 v147, v144
    s_branch L_z1
L_z0:
    s_branch L_hi1
L_z0b:
    s_mov_b64 exec, 0
    s_sub_u32 s53, s3, 8
L_tzback:
    s_add_u32 s53, s53, 4
    s_cmp_eq_u32 s53, 0
    s_cbranch_scc1 L_tz0
    s_cmp_eq_u32 s53, 1
    s_cbranch_scc1 L_tz1
    s_cmp_eq_u32 s53, 2
    s_cbranch_scc1 L_tz2
    s_cmp_eq_u32 s53, 3
    s_cbranch_scc1 L_tz3
    s_cmp_eq_u32 s53, 4
    s_cbranch_scc1 L_tz4
    s_cmp_eq_u32 s53, 5
    s_cbranch_scc1 L_tz5
    s_cmp_eq_u32 s53, 6
    s_cbranch_scc1 L_tz6
    s_cmp_eq_u32 s53, 7
    s_cbranch_scc1 L_tz7
    s_mov_b64 exec, -1
L_z1:
    v_mov_b32 v9, 33792
    v_mov_b32 v12, 0
    v_mov_b32 v13, 0
    s_barrier
    ds_read_b64 v[30:31], v9
    ds_read_b128 v[24:27], v5 offset:47808
    s_waitcnt lgkmcnt(0)
    v_readfirstlane_b32 s44, v30
    s_andn2_b32 s54, 2047, s44
    s_and_b32 s6, s54, 127
    s_cmp_gt_u32 s6, 64
    s_cselect_b32 s46, 1, 0
    s_and_b32 s6, s54, 1087
    s_cmp_eq_u32 s6, 1024
    s_cselect_b32 s46, 1, s46
    s_sub_u32 s6, 2048, s54
    s_cmp_lg_u32 s46, 0
    s_cselect_b32 s6, s6, s54
    s_cmp_eq_u32 s6, 1024
    s_cselect_b32 s6, 0, s6
    s_and_b32 s56, s6, 127
    s_lshr_b32 s57, s6, 10
    s_bfe_u32 s45, s6, 0x30007
    s_lshl3_add_u32 s11, s57, s45
    s_lshl_b32 s11, s11, 7
    s_add_u32 s58, s11, s56
    s_sub_u32 s59, 2048, s58
    s_cmp_eq_u32 s58, 0
    s_cselect_b32 s59, 1024, s59
    s_lshl_b32 s10, s58, 10
    s_lshl_b32 s11, s59, 10
    v_add_u32 v6, s10, v5
    v_add_u32 v7, s11, v5
    s_cmp_ge_u32 s3, 4
    s_cbranch_scc1 L_z4
    v_lshrrev_b32 v6, 1, v1
    s_lshl_b32 s6, s57, 10
    s_add_u32 s6, s6, s56
    v_lshl_add_u32 v6, v6, 7, s6
    v_and_b32 v7, 1, v1
    v_lshlrev_b32 v9, 9, v7
    s_cmp_lg_u32 s56, 0
    s_cbranch_scc1 L_g06
    s_mov_b32 exec_lo, 0x00020002
    s_mov_b32 exec_hi, 0x00020002
    v_mov_b32 v6, 0x400
    v_mov_b32 v9, 0
    s_mov_b64 exec, -1
L_g06:
    v_lshlrev_b32 v7, 2, v2
    v_mad_u32_u24 v9, v7, v6, v9
    v_cvt_f32_u32 v6, v6
    v_cvt_f32_u32 v9, v9
    v_mul_f32 v6, 0x3a000000, v6
    v_mul_f32 v9, 0x3a000000, v9
    v_cos_f32 v64, v9
    v_sin_f32 v68, v9
    v_add_f32 v9, v9, v6
    v_cos_f32 v65, v9
    v_sin_f32 v69, v9
    v_add_f32 v9, v9, v6
    v_cos_f32 v66, v9
    v_sin_f32 v70, v9
    v_add_f32 v9, v9, v6
    v_cos_f32 v67, v9
    v_sin_f32 v71, v9
    s_and_b32 s7, s56, 63
    s_mul_i32 s32, s7, 33024
    v_cvt_pk_bf16_f32 v148, v64, v68
    v_cvt_pk_bf16_f32 v149, v65, v69
    v_cvt_pk_bf16_f32 v150, v66, v70
    v_cvt_pk_bf16_f32 v151, v67, v71
    s_cmp_lg_u32 s7, 0
    s_cbranch_scc1 L_gd7
    s_lshr_b32 s7, s56, 2
    v_and_b32 v148, 0xffff, v148
    v_lshlrev_b32 v148, s7, v148
    v_and_b32 v149, 0xffff, v149
    v_lshlrev_b32 v149, s7, v149
    v_and_b32 v150, 0xffff, v150
    v_lshlrev_b32 v150, s7, v150
    v_and_b32 v151, 0xffff, v151
    v_lshlrev_b32 v151, s7, v151
L_gd7:
    s_lshl_b32 s7, s3, 9
    s_add_u32 s32, s32, s7
    s_add_u32 s32, s32, 2097152
    s_add_u32 s33, s32, 4096
    v_and_b32 v6, 3, v1
    v_lshlrev_b32 v6, 4, v6
    ds_read_b128 v[96:99], v6 offset:33920
    s_waitcnt lgkmcnt(0)
    buffer_load_dwordx4 v[32:35], v10, s[36:39], s32 offen offset:0 sc1
    buffer_load_dwordx4 v[36:39], v10, s[36:39], s32 offen offset:2048 sc1
    buffer_load_dwordx4 v[40:43], v10, s[36:39], s33 offen offset:0 sc1
    buffer_load_dwordx4 v[44:47], v10, s[36:39], s33 offen offset:2048 sc1
    buffer_load_dwordx4 v[48:51], v10, s[36:39], s32 offen offset:256 sc1
    buffer_load_dwordx4 v[52:55], v10, s[36:39], s32 offen offset:2304 sc1
    buffer_load_dwordx4 v[56:59], v10, s[36:39], s33 offen offset:256 sc1
    buffer_load_dwordx4 v[60:63], v10, s[36:39], s33 offen offset:2304 sc1
    s_mul_i32 s7, s45, 2176
    v_bfe_u32 v7, v1, 1, 2
    v_xor_b32 v7, v7, v2
    v_lshl_add_u32 v7, v7, 4, s7
    v_lshl_add_u32 v29, v1, 6, v7
    v_sub_u32 v6, 16, v1
    v_bfe_u32 v7, v6, 1, 2
    v_xor_b32 v7, v7, v2
    v_lshl_add_u32 v7, v7, 4, s7
    v_lshl_add_u32 v30, v6, 6, v7
    s_cmp_eq_u32 s58, 0
    s_cselect_b32 s6, 0, 2048
    v_add_u32 v4, s6, v5
    v_lshlrev_b32 v6, 7, v1
    v_lshl_add_u32 v15, v2, 4, v6
    s_branch L_zjoin
L_z4:
    s_cmp_ge_u32 s3, 6
    s_cbranch_scc1 L_zend2
    global_load_dwordx4 v[16:19], v6, s[4:5]
    global_load_dwordx4 v[20:23], v7, s[4:5]
    s_sub_u32 s6, s3, 4
    s_lshl1_add_u32 s7, s47, s6
    s_lshl_b32 s7, s7, 5
    v_and_b32 v6, 7, v0
    v_lshl_add_u32 v10, v6, 2, s7
    s_lshl_b32 s8, s54, 10
    v_add_u32 v7, s8, v10
    global_load_dword v35, v7, s[4:5]
    v_lshlrev_b32 v10, 1, v10
    v_lshrrev_b32 v7, 3, v0
    v_lshlrev_b32 v7, 8, v7
    v_lshl_add_u32 v11, v6, 4, v7
    s_mul_i32 s48, s47, 14336
    s_lshl_b32 s6, s6, 7
    s_add_u32 s48, s48, s6
    s_add_u32 s48, s48, 720896
    s_add_u32 s49, s48, 229376
    s_and_b32 s6, s44, 0xffff0000
    s_xor_b32 s7, s6, 0x80000000
    s_xor_b32 s9, s6, 0xffff0000
    s_bitcmp1_b32 s6, 31
    s_cselect_b32 s6, s7, s9
    v_mov_b32 v15, s6
    v_mul_f32 v15, 0xbfb8aa3b, v15
    v_exp_f32 v15, v15
    s_nop 0
    v_add_f32 v15, 1.0, v15
    v_rcp_f32 v15, v15
    s_nop 0
    v_cvt_pk_bf16_f32 v15, v15, v15
    v_and_b32 v15, 0xffff0000, v15
    s_waitcnt vmcnt(0)
    v_dot2c_f32_bf16 v12, v16, v24
    v_dot2c_f32_bf16 v13, v20, v24
    v_dot2c_f32_bf16 v12, v17, v25
    v_dot2c_f32_bf16 v13, v21, v25
    v_dot2c_f32_bf16 v12, v18, v26
    v_dot2c_f32_bf16 v13, v22, v26
    v_dot2c_f32_bf16 v12, v19, v27
    v_dot2c_f32_bf16 v13, v23, v27
    s_nop 2
    v_permlane32_swap_b32 v12, v13
    v_add_f32 v12, v12, v13
    v_mov_b32 v13, v12
    s_nop 1
    v_permlane16_swap_b32 v12, v13
    v_add_f32 v12, v12, v13
    s_nop 1
    v_add_f32_dpp v12, v12, v12 row_ror:8 row_mask:0xf bank_mask:0xf
    s_nop 1
    v_add_f32_dpp v12, v12, v12 row_ror:4 row_mask:0xf bank_mask:0xf
    s_nop 1
    v_add_f32_dpp v12, v12, v12 row_ror:2 row_mask:0xf bank_mask:0xf
    s_nop 1
    v_add_f32_dpp v12, v12, v12 row_ror:1 row_mask:0xf bank_mask:0xf
    v_cvt_pk_bf16_f32 v12, v12, v12
    v_and_b32 v12, 0xffff0000, v12
    v_mul_f32 v13, 0xbfb8aa3b, v12
    v_exp_f32 v13, v13
    s_nop 0
    v_add_f32 v13, 1.0, v13
    v_rcp_f32 v13, v13
    s_nop 0
    v_cvt_pk_bf16_f32 v13, v13, v13
    v_and_b32 v13, 0xffff0000, v13
    v_sub_f32 v14, 1.0, v13
    v_cvt_pk_bf16_f32 v14, v14, v14
    v_and_b32 v14, 0xffff0000, v14
    v_readlane_b32 s6, v13, 0
    v_readlane_b32 s7, v13, 32
    v_readlane_b32 s8, v14, 0
    v_readlane_b32 s9, v14, 32
    s_xor_b32 s10, s6, 0x80000000
    s_cmp_eq_u32 s58, 0
    s_cselect_b32 s10, 0, s10
    s_cselect_b32 s11, 0, s7
    s_cmp_lg_u32 s46, 0
    s_cselect_b32 s8, s9, s8
    s_cselect_b32 s6, s11, s6
    s_cselect_b32 s10, s7, s10
    v_mov_b32 v36, s8
    v_mov_b32 v24, s6
    v_mov_b32 v25, s10
    v_lshlrev_b32 v34, 16, v35
    v_and_b32 v35, 0xffff0000, v35
    s_barrier
    s_sleep 10
    v_mov_b32 v9, 33864
L_tz_start:
L_zp:
    buffer_load_dwordx4 v[40:43], v11, s[36:39], s48 offen offset:0 sc1
    buffer_load_dwordx4 v[44:47], v11, s[36:39], s48 offen offset:2048 sc1
    s_add_u32 s6, s48, 4096
    buffer_load_dwordx4 v[48:51], v11, s[36:39], s6 offen offset:0 sc1
    buffer_load_dwordx4 v[52:55], v11, s[36:39], s6 offen offset:2048 sc1
    s_add_u32 s6, s48, 8192
    buffer_load_dwordx4 v[56:59], v11, s[36:39], s6 offen offset:0 sc1
L_tz0:
    s_cbranch_execz L_tzback
    buffer_load_dwordx4 v[60:63], v11, s[36:39], s6 offen offset:2048 sc1
    s_add_u32 s6, s48, 12288
    buffer_load_dwordx4 v[64:67], v11, s[36:39], s6 offen offset:0 sc1
    s_add_u32 s48, s48, 229376
    s_min_u32 s48, s48, s49
    s_add_u32 s65, s65, 1
    s_lshr_b32 s34, s65, 17
    s_cbranch_scc1 L_zp_ok
    s_waitcnt vmcnt(6)
    v_bitop3_b32 v37, v41, v43, v31 bitop3:0x7e
    s_waitcnt vmcnt(5)
    v_bitop3_b32 v39, v45, v47, v31 bitop3:0x7e
    v_add_f32 v40, v40, v44
    v_add_f32 v42, v42, v46
    s_waitcnt vmcnt(4)
    v_bitop3_b32 v38, v49, v51, v31 bitop3:0x7e
    v_add_f32 v40, v40, v48
    v_add_f32 v42, v42, v50
    v_or3_b32 v37, v37, v38, v39
    s_waitcnt vmcnt(3)
    v_bitop3_b32 v39, v53, v55, v31 bitop3:0x7e
    v_add_f32 v40, v40, v52
L_tz1:
    s_cbranch_execz L_tzback
    v_add_f32 v42, v42, v54
    s_waitcnt vmcnt(2)
    v_bitop3_b32 v38, v57, v59, v31 bitop3:0x7e
    v_add_f32 v40, v40, v56
    v_add_f32 v42, v42, v58
    v_or3_b32 v37, v37, v38, v39
    s_waitcnt vmcnt(1)
    v_bitop3_b32 v39, v61, v63, v31 bitop3:0x7e
    v_add_f32 v40, v40, v60
    v_add_f32 v42, v42, v62
    s_waitcnt vmcnt(0)
    v_bitop3_b32 v38, v65, v67, v31 bitop3:0x7e
    v_add_f32 v40, v40, v64
    v_add_f32 v42, v42, v66
    v_or3_b32 v37, v37, v38, v39
    v_cmp_ne_u32 vcc, 0, v37
    s_nop 0
    s_cbranch_vccnz L_zp
L_zp_ok:
    ds_read_b32 v12, v9
    ds_read_b64 v[32:33], v10 offset:38592
    ds_read_b64 v[16:17], v10 offset:40640
    v_lshrrev_b32 v11, 1, v10
    s_lshl_b32 s8, s54, 10
L_tz2:
    s_cbranch_execz L_tzback
    s_waitcnt vmcnt(0)
    v_add_f32_dpp v40, v40, v40 row_ror:8 row_mask:0xf bank_mask:0xf
    v_add_f32_dpp v42, v42, v42 row_ror:8 row_mask:0xf bank_mask:0xf
    s_nop 0
    s_nop 0
    v_permlane16_swap_b32 v40, v42
    v_add_f32 v40, v40, v42
    v_mov_b32 v42, v40
    s_nop 1
    v_permlane32_swap_b32 v40, v42
    v_add_f32 v40, v40, v42
    v_mov_b32 v42, v40
    s_nop 1
    v_permlane16_swap_b32 v40, v42
    v_cvt_pk_bf16_f32 v41, v40, v42
    v_lshlrev_b32 v40, 16, v41
    v_and_b32 v42, 0xffff0000, v41
    v_mul_f32 v40, v40, v15
    v_mul_f32 v42, v42, v15
    v_cvt_pk_bf16_f32 v41, v40, v42
    v_lshlrev_b32 v40, 16, v41
    v_and_b32 v42, 0xffff0000, v41
    v_add_f32 v40, v40, v34
    v_add_f32 v42, v42, v35
    v_cvt_pk_bf16_f32 v41, v40, v42
L_tz3:
    s_cbranch_execz L_tzback
    v_lshlrev_b32 v40, 16, v41
    v_and_b32 v42, 0xffff0000, v41
L_zw:
    s_waitcnt lgkmcnt(0)
    v_cmp_eq_u32 vcc, 0, v12
    v_mul_f32 v32, v24, v32
    v_mul_f32 v33, v24, v33
    s_cbranch_vccz L_zw_ok
    s_add_u32 s65, s65, 1
    s_lshr_b32 s34, s65, 17
    s_cbranch_scc1 L_zw_ok
    ds_read_b32 v12, v9
    ds_read_b64 v[32:33], v10 offset:38592
    ds_read_b64 v[16:17], v10 offset:40640
    s_branch L_zw
L_zw_ok:
    v_fmac_f32 v32, v25, v16
    v_fmac_f32 v33, v25, v17
    v_fmac_f32 v32, v40, v36
    v_fmac_f32 v33, v42, v36
    v_cvt_pk_bf16_f32 v32, v32, v33
    s_mov_b64 exec, 0xff
    buffer_store_dword v32, v11, s[40:43], s8 offen
    s_mov_b64 exec, -1
    s_barrier
L_tz4:
    s_cbranch_execz L_tzback
    s_endpgm
L_zfin:
    s_cmp_lg_u32 s3, 0
    s_cbranch_scc1 L_zend
    s_waitcnt lgkmcnt(3)
    v_mfma_f32_16x16x32_bf16 v[48:51], v[32:35], v[64:67], 0
    s_waitcnt lgkmcnt(2)
    v_mfma_f32_16x16x32_bf16 v[52:55], v[36:39], v[68:71], 0
    s_waitcnt lgkmcnt(1)
    v_mfma_f32_16x16x32_bf16 v[56:59], v[40:43], v[72:75], 0
    s_waitcnt lgkmcnt(0)
    v_mfma_f32_16x16x32_bf16 v[60:63], v[44:47], v[76:79], 0
    s_nop 2
    ds_write_b128 v15, v[48:51] offset:38592
    ds_write_b128 v15, v[52:55] offset:38656
    s_nop 1
    ds_write_b128 v15, v[56:59] offset:40640
    ds_write_b128 v15, v[60:63] offset:40704
    v_mov_b32 v9, 33864
    s_waitcnt lgkmcnt(0)
    ds_write_b32 v9, v9
    s_waitcnt lgkmcnt(0)
.set L_tz5, L_tzback
.set L_tz6, L_tzback
.set L_tz7, L_tzback
L_zend:
    s_endpgm
L_zend2:
    s_endpgm
L_zh:
    v_mov_b32 v9, 33864
    v_mov_b32 v6, 0
    ds_write_b32 v9, v6
    v_lshlrev_b32 v6, 2, v2
    v_cvt_f32_u32 v7, v1
    v_cvt_f32_u32 v6, v6
    v_mul_f32 v7, 0x3d800000, v7
    v_mul_f32 v9, v6, v7
    v_cos_f32 v64, v9
    v_sin_f32 v68, v9
    v_add_f32 v9, v9, v7
    v_cos_f32 v65, v9
    v_sin_f32 v69, v9
    v_add_f32 v9, v9, v7
    v_cos_f32 v66, v9
    v_sin_f32 v70, v9
    v_add_f32 v9, v9, v7
    v_cos_f32 v67, v9
    v_sin_f32 v71, v9
    s_nop 0
    v_cvt_pk_bf16_f32 v40, v64, v68
    v_cvt_pk_bf16_f32 v48, -v68, v64
    v_cvt_pk_bf16_f32 v41, v65, v69
    v_cvt_pk_bf16_f32 v49, -v69, v65
    v_cvt_pk_bf16_f32 v42, v66, v70
    v_cvt_pk_bf16_f32 v50, -v70, v66
    v_cvt_pk_bf16_f32 v43, v67, v71
    v_cvt_pk_bf16_f32 v51, -v71, v67
    v_add_f32 v7, 0x3d800000, v7
    v_mul_f32 v9, v6, v7
    v_cos_f32 v64, v9
    v_sin_f32 v68, v9
    v_add_f32 v9, v9, v7
    v_cos_f32 v65, v9
    v_sin_f32 v69, v9
    v_add_f32 v9, v9, v7
    v_cos_f32 v66, v9
    v_sin_f32 v70, v9
    v_add_f32 v9, v9, v7
    v_cos_f32 v67, v9
    v_sin_f32 v71, v9
    s_nop 0
    v_cvt_pk_bf16_f32 v44, v64, -v68
    v_cvt_pk_bf16_f32 v52, -v68, -v64
    v_cvt_pk_bf16_f32 v45, v65, -v69
    v_cvt_pk_bf16_f32 v53, -v69, -v65
    v_cvt_pk_bf16_f32 v46, v66, -v70
    v_cvt_pk_bf16_f32 v54, -v70, -v66
    v_cvt_pk_bf16_f32 v47, v67, -v71
    v_cvt_pk_bf16_f32 v55, -v71, -v67
    ds_write_b128 v5, v[40:43] offset:42688
    ds_write_b128 v5, v[44:47] offset:43712
    ds_write_b128 v5, v[48:51] offset:44736
    ds_write_b128 v5, v[52:55] offset:45760
    s_mov_b32 m0, 47808
    v_mov_b32 v31, 0
    global_load_dword v30, v31, s[30:31]
    s_mov_b32 s64, 0x9E3779B1
    global_load_lds_dwordx4 v5, s[24:25]
    s_waitcnt vmcnt(0)
    v_mul_lo_u32 v31, v30, s64
    v_add_u32 v31, 0x7F4A7C15, v31
    v_lshlrev_b32 v6, 1, v1
    v_lshrrev_b32 v6, v6, v31
    v_lshlrev_b32 v7, 15, v6
    v_and_b32 v6, 1, v6
    v_and_b32 v7, 0x10000, v7
    v_or_b32 v6, v6, v7
    v_lshlrev_b32 v7, 2, v1
    ds_write_b32 v7, v6 offset:33920
    s_waitcnt lgkmcnt(0)
    s_and_b32 s61, s2, 0
    s_mul_i32 s61, s61, 3072
    s_add_u32 s61, s61, 81920
    s_add_u32 s62, s61, 2048
    s_sleep 30
    s_branch L_poll8_1
L_poll8:
    s_sleep 8
L_poll8_1:
    buffer_load_dwordx4 v[32:35], v5, s[36:39], s61 offen sc1
    s_add_u32 s61, s61, 1024
    s_min_u32 s61, s61, s62
    s_add_u32 s65, s65, 1
    s_lshr_b32 s34, s65, 17
    s_waitcnt vmcnt(0)
    s_cbranch_scc1 L_poll8_ok
    v_cmp_ne_u32 vcc, v31, v33
    v_cmp_ne_u32 s[12:13], v31, v35
    s_or_b64 vcc, vcc, s[12:13]
    s_cbranch_vccnz L_poll8
L_poll8_ok:
    v_max_u32 v32, v32, v34
    s_nop 1
    v_max_u32_dpp v32, v32, v32 row_ror:8 row_mask:0xf bank_mask:0xf
    s_nop 1
    v_max_u32_dpp v32, v32, v32 row_ror:4 row_mask:0xf bank_mask:0xf
    s_nop 1
    v_max_u32_dpp v32, v32, v32 row_ror:2 row_mask:0xf bank_mask:0xf
    s_nop 1
    v_max_u32_dpp v32, v32, v32 row_ror:1 row_mask:0xf bank_mask:0xf
    v_mov_b32 v33, v32
    s_nop 1
    v_permlane16_swap_b32 v32, v33
    v_max_u32 v32, v32, v33
    v_mov_b32 v33, v32
    s_nop 1
    v_permlane32_swap_b32 v32, v33
    v_max_u32 v32, v32, v33
    v_mov_b32 v9, 33792
    s_mov_b64 exec, 1
    ds_write2_b32 v9, v32, v31 offset1:1
    s_mov_b64 exec, -1
    s_waitcnt lgkmcnt(0)
    s_barrier
    s_lshl_b32 s6, s47, 2
    s_add_u32 s6, s6, 4096
    s_mov_b64 exec, 1
    buffer_store_dword v31, v0, s[36:39], s6 offen sc1
    s_mov_b64 exec, -1
    s_cmp_lg_u32 s47, 0
    s_cbranch_scc1 L_zend
    s_mov_b64 exec, 0xffff
    v_lshlrev_b32 v6, 2, v0
    s_mov_b32 s6, 4096
    s_barrier
L_za:
    buffer_load_dword v7, v6, s[36:39], s6 offen sc1
    s_add_u32 s65, s65, 1
    s_lshr_b32 s34, s65, 17
    s_waitcnt vmcnt(0)
    s_cbranch_scc1 L_za_ok
    v_cmp_ne_u32 vcc, v31, v7
    s_nop 0
    s_cbranch_vccnz L_za
L_za_ok:
    s_mov_b64 exec, 1
    v_add_u32 v9, 1, v30
    s_barrier
    buffer_store_dword v9, v6, s[36:39], 0 offen sc1
    s_mov_b64 exec, -1
    s_branch L_zend
L_F:
    v_lshlrev_b32 v5, 4, v0
    s_cmp_eq_u32 s3, 8
    s_cbranch_scc1 L_fh
    s_and_b32 s6, s60, 3
    s_lshr_b32 s7, s3, 1
    s_lshl2_add_u32 s32, s6, s7
    s_mul_i32 s8, s32, 114688
    s_lshr_b32 s33, s60, 2
    s_lshl_b32 s9, s33, 7
    s_add_u32 s8, s8, s9
    v_lshrrev_b32 v6, 3, v0
    v_mul_u32_u24 v6, 3584, v6
    v_and_b32 v7, 7, v0
    v_bfe_u32 v8, v0, 4, 1
    v_lshlrev_b32 v8, 2, v8
    v_xor_b32 v4, v7, v8
    v_lshl_add_u32 v7, v4, 4, s8
    v_add_u32 v3, v6, v7
    s_lshl_b32 s10, s3, 12
    s_mov_b32 m0, s10
    s_bitcmp1_b32 s3, 0
    s_waitcnt lgkmcnt(0)
    s_cselect_b32 s18, s20, s18
    s_cselect_b32 s19, s21, s19
    global_load_lds_dwordx4 v3, s[18:19]
    s_add_u32 m0, s10, 1024
    v_add_u32 v3, 28672, v3
    global_load_lds_dwordx4 v3, s[18:19]
    s_add_u32 m0, s10, 2048
    v_add_u32 v3, 28672, v3
    global_load_lds_dwordx4 v3, s[18:19]
    s_add_u32 m0, s10, 3072
    v_add_u32 v3, 28672, v3
    global_load_lds_dwordx4 v3, s[18:19]
    s_mov_b32 s36, s30
    s_mov_b32 s37, s31
    s_mov_b32 s38, 0x1000000
    s_mov_b32 s39, 0x20000
    s_mov_b32 s65, 0
    v_bfe_u32 v6, v0, 2, 2
    v_and_b32 v7, 3, v0
    v_lshlrev_b32 v8, 3, v7
    v_lshl_add_u32 v8, v2, 5, v8
    v_and_b32 v9, 2, v6
    v_lshlrev_b32 v9, 5, v9
    v_xor_b32 v9, v9, v8
    v_lshl_add_u32 v9, v6, 7, v9
    v_add_u32 v9, s10, v9
    s_lshl_b32 s11, s3, 8
    v_lshlrev_b32 v11, 2, v0
    v_add_u32 v11, 49152, v11
    v_add_u32 v12, s11, v11
    s_lshl1_add_u32 s7, s33, s7
    s_lshl_b32 s8, s7, 15
    s_and_b32 s9, s3, 1
    s_lshl1_add_u32 s9, s6, s9
    s_lshl_b32 s11, s9, 7
    s_add_u32 s8, s8, s11
    v_lshrrev_b32 v6, 3, v0
    v_lshl_add_u32 v6, v6, 10, s8
    v_lshl_add_u32 v4, v4, 4, v6
    v_lshrrev_b32 v6, 5, v0
    v_mul_u32_u24 v13, 14336, v6
    v_and_b32 v6, 31, v0
    v_lshl_add_u32 v13, v6, 3, v13
    s_mul_i32 s8, s9, 28672
    s_lshl_b32 s7, s7, 8
    s_add_u32 s8, s8, s7
    s_add_u32 s8, s8, 720896
    s_lshl_b32 s32, s32, 6
    s_lshl_b32 s33, s33, 12
    s_add_u32 s61, s33, 196608
    s_add_u32 s62, s61, 114688
    s_lshl_b32 s7, s6, 10
    s_add_u32 s33, s61, s7
    v_mov_b32 v14, 51200
    s_lshr_b32 s7, s3, 1
    s_lshl_b32 s7, s7, 9
    v_lshl_add_u32 v15, v6, 4, s7
    v_lshrrev_b32 v6, 5, v0
    v_lshl_add_u32 v15, v6, 10, v15
    v_mov_b32 v16, 0
    v_mov_b32 v17, 0
    v_mov_b32 v24, 0
    v_mov_b32 v25, 0
    s_waitcnt vmcnt(0)
    s_cmp_ge_u32 s3, 4
    s_cbranch_scc1 L_nowd9
    s_add_u32 m0, s10, 32768
    s_nop 0
    global_load_lds_dwordx4 v4, s[22:23]
    s_add_u32 m0, s10, 33792
    v_add_u32 v4, 0x2000, v4
    global_load_lds_dwordx4 v4, s[22:23]
    s_add_u32 m0, s10, 34816
    v_add_u32 v4, 0x2000, v4
    global_load_lds_dwordx4 v4, s[22:23]
    s_add_u32 m0, s10, 35840
    v_add_u32 v4, 0x2000, v4
    global_load_lds_dwordx4 v4, s[22:23]
L_nowd9:
    ds_read_b64_tr_b16 v[32:33], v9 offset:0
    ds_read_b64_tr_b16 v[34:35], v9 offset:512
    ds_read_b64_tr_b16 v[36:37], v9 offset:1024
    ds_read_b64_tr_b16 v[38:39], v9 offset:1536
    ds_read_b64_tr_b16 v[40:41], v9 offset:2048
    ds_read_b64_tr_b16 v[42:43], v9 offset:2560
    ds_read_b64_tr_b16 v[44:45], v9 offset:3072
    ds_read_b64_tr_b16 v[46:47], v9 offset:3584
    s_mov_b64 exec, 0
    s_sub_u32 s53, s3, 8
L_tfback:
    s_add_u32 s53, s53, 8
    s_cmp_eq_u32 s53, 0
    s_cbranch_scc1 L_tf0
    s_cmp_eq_u32 s53, 1
    s_cbranch_scc1 L_tf1
    s_cmp_eq_u32 s53, 2
    s_cbranch_scc1 L_tf2
    s_cmp_eq_u32 s53, 3
    s_cbranch_scc1 L_tf3
    s_cmp_eq_u32 s53, 4
    s_cbranch_scc1 L_tf4
    s_cmp_eq_u32 s53, 5
    s_cbranch_scc1 L_tf5
    s_cmp_eq_u32 s53, 6
    s_cbranch_scc1 L_tf6
    s_cmp_eq_u32 s53, 7
    s_cbranch_scc1 L_tf7
    s_mov_b64 exec, -1
    s_waitcnt lgkmcnt(0)
    s_barrier
L_tf_start:
    ds_read_b64 v[30:31], v14
    s_waitcnt lgkmcnt(0)
    v_readfirstlane_b32 s6, v30
    s_andn2_b32 s6, 2047, s6
    s_lshl_b32 s6, s6, 10
    s_add_u32 s6, s6, s32
    s_load_dwordx16 s[44:59], s[4:5], s6
    v_mov_b32 v29, v31
    s_waitcnt vmcnt(0)
    ds_read_b64_tr_b16 v[48:49], v9 offset:32768
    ds_read_b64_tr_b16 v[50:51], v9 offset:33280
L_tf0:
    s_cbranch_execz L_tfback
    ds_read_b64_tr_b16 v[52:53], v9 offset:33792
    ds_read_b64_tr_b16 v[54:55], v9 offset:34304
    ds_read_b64_tr_b16 v[56:57], v9 offset:34816
    ds_read_b64_tr_b16 v[58:59], v9 offset:35328
    ds_read_b64_tr_b16 v[60:61], v9 offset:35840
    ds_read_b64_tr_b16 v[62:63], v9 offset:36352
    s_waitcnt lgkmcnt(0)
    v_dot2c_f32_bf16 v16, s44, v32
    v_dot2c_f32_bf16 v17, s45, v33
    v_dot2c_f32_bf16 v16, s46, v34
    v_dot2c_f32_bf16 v17, s47, v35
    v_dot2c_f32_bf16 v16, s48, v36
    v_dot2c_f32_bf16 v17, s49, v37
    v_dot2c_f32_bf16 v16, s50, v38
    v_dot2c_f32_bf16 v17, s51, v39
    v_dot2c_f32_bf16 v16, s52, v40
    v_dot2c_f32_bf16 v17, s53, v41
    v_dot2c_f32_bf16 v16, s54, v42
    v_dot2c_f32_bf16 v17, s55, v43
    v_dot2c_f32_bf16 v16, s56, v44
    v_dot2c_f32_bf16 v17, s57, v45
    v_dot2c_f32_bf16 v16, s58, v46
    v_dot2c_f32_bf16 v17, s59, v47
    s_nop 2
L_tf1:
    s_cbranch_execz L_tfback
    v_add_f32 v16, v16, v17
    ds_write_b32 v12, v16
    s_waitcnt lgkmcnt(0)
    s_barrier
    s_lshl_b32 s6, s3, 4
    s_lshl_b64 s[12:13], 0xffff, s6
    ds_read2st64_b32 v[16:17], v11 offset0:0 offset1:2
    ds_read2st64_b32 v[18:19], v11 offset0:4 offset1:6
    ds_read2st64_b32 v[20:21], v11 offset0:1 offset1:3
    ds_read2st64_b32 v[22:23], v11 offset0:5 offset1:7
    s_waitcnt lgkmcnt(2)
    v_add_f32 v16, v16, v17
    v_add_f32 v18, v18, v19
    s_waitcnt lgkmcnt(0)
    v_add_f32 v20, v20, v21
    v_add_f32 v22, v22, v23
    v_add_f32 v28, v16, v18
    s_mov_b64 exec, s[12:13]
    v_add_f32 v30, v20, v22
    s_cmp_ge_u32 s3, 4
    s_cbranch_scc1 L_f5
    buffer_store_dwordx4 v[28:31], v5, s[36:39], s33 offen
    s_mov_b64 exec, -1
    s_sleep 3
L_fx:
L_tf2:
    s_cbranch_execz L_tfback
    buffer_load_dwordx4 v[64:67], v15, s[36:39], s61 offen offset:0 sc1
    buffer_load_dwordx4 v[68:71], v15, s[36:39], s61 offen offset:2048 sc1
    s_cmp_ge_u32 s65, 4
    s_cselect_b32 s6, 114688, 0
    s_add_u32 s61, s61, s6
    s_min_u32 s61, s61, s62
    s_add_u32 s65, s65, 1
    s_lshr_b32 s34, s65, 17
    s_cbranch_scc1 L_fx_ok
    s_waitcnt vmcnt(1)
    v_bitop3_b32 v20, v65, v67, v31 bitop3:0x7e
    s_waitcnt vmcnt(0)
    v_add_f32 v16, v64, v68
    v_add_f32 v18, v66, v70
    v_bitop3_b32 v21, v69, v71, v31 bitop3:0x7e
    v_or_b32 v20, v20, v21
    v_cmp_ne_u32 vcc, 0, v20
    v_permlane32_swap_b32 v16, v18
    s_cbranch_vccnz L_fx
L_fx_ok:
    v_add_f32 v16, v16, v18
    v_cvt_pk_bf16_f32 v16, v16, v16
    v_and_b32 v16, 0xffff0000, v16
    v_mov_b32 v18, v16
    v_mul_f32 v17, 0xbfb8aa3b, v16
L_tf3:
    s_cbranch_execz L_tfback
    v_exp_f32 v17, v17
    s_nop 0
    v_add_f32 v17, 1.0, v17
    v_rcp_f32 v17, v17
    s_nop 0
    v_permlane32_swap_b32 v16, v18
    v_mul_f32 v17, v17, v16
    v_cvt_pk_bf16_f32 v17, v17, v17
    v_and_b32 v17, 0xffff0000, v17
    v_mul_f32 v17, v17, v18
    s_nop 1
    v_mov_b32_dpp v18, v17 quad_perm:[1,0,3,2] row_mask:0xf bank_mask:0xf
    v_cvt_pk_bf16_f32 v17, v17, v18
    s_nop 0
    v_readlane_b32 s44, v17, 0
    v_readlane_b32 s45, v17, 2
    v_readlane_b32 s46, v17, 4
    v_readlane_b32 s47, v17, 6
    v_readlane_b32 s48, v17, 8
    v_readlane_b32 s49, v17, 10
L_tf4:
    s_cbranch_execz L_tfback
    v_readlane_b32 s50, v17, 12
    v_readlane_b32 s51, v17, 14
    v_readlane_b32 s52, v17, 16
    v_readlane_b32 s53, v17, 18
    v_readlane_b32 s54, v17, 20
    v_readlane_b32 s55, v17, 22
    v_readlane_b32 s56, v17, 24
    v_readlane_b32 s57, v17, 26
    v_readlane_b32 s58, v17, 28
    v_readlane_b32 s59, v17, 30
    v_dot2c_f32_bf16 v24, s44, v48
    v_dot2c_f32_bf16 v25, s45, v49
    v_dot2c_f32_bf16 v24, s46, v50
    v_dot2c_f32_bf16 v25, s47, v51
    v_dot2c_f32_bf16 v24, s48, v52
    v_dot2c_f32_bf16 v25, s49, v53
    v_dot2c_f32_bf16 v24, s50, v54
    v_dot2c_f32_bf16 v25, s51, v55
    v_dot2c_f32_bf16 v24, s52, v56
    v_dot2c_f32_bf16 v25, s53, v57
    v_dot2c_f32_bf16 v24, s54, v58
L_tf5:
    s_cbranch_execz L_tfback
    v_dot2c_f32_bf16 v25, s55, v59
    v_dot2c_f32_bf16 v24, s56, v60
    v_dot2c_f32_bf16 v25, s57, v61
    v_dot2c_f32_bf16 v24, s58, v62
    v_dot2c_f32_bf16 v25, s59, v63
    s_nop 2
    v_add_f32 v30, v24, v25
    buffer_store_dwordx2 v[30:31], v13, s[36:39], s8 offen sc1
    s_add_u32 s8, s8, 229376
    buffer_store_dwordx2 v[30:31], v13, s[36:39], s8 offen sc1
.set L_tf6, L_tfback
.set L_tf7, L_tfback
L_fend:
    s_endpgm
L_f5:
    s_add_u32 s33, s33, 114688
    buffer_store_dwordx4 v[28:31], v5, s[36:39], s33 offen sc1
    s_mov_b64 exec, -1
    s_endpgm
L_fh:
    s_waitcnt lgkmcnt(0)
    v_mov_b32 v31, 0
    global_load_dword v30, v31, s[30:31]
    s_mov_b32 s64, 0x9E3779B1
    s_mov_b32 s36, s30
    s_mov_b32 s37, s31
    s_mov_b32 s38, 0x1000000
    s_mov_b32 s39, 0x20000
    s_mov_b32 s65, 0
    s_and_b32 s61, s2, 7
    s_mul_i32 s61, s61, 2048
    s_add_u32 s61, s61, 65536
    s_add_u32 s62, s61, 1024
    s_sleep 40
    s_waitcnt vmcnt(0)
    v_mul_lo_u32 v31, v30, s64
    v_add_u32 v31, 0x7F4A7C15, v31
    s_branch L_poll10_1
L_poll10:
    s_sleep 3
L_poll10_1:
    buffer_load_dwordx4 v[20:23], v5, s[36:39], s61 offen sc1
    s_add_u32 s61, s61, 1024
    s_min_u32 s61, s61, s62
    s_add_u32 s65, s65, 1
    s_lshr_b32 s34, s65, 17
    s_waitcnt vmcnt(0)
    s_cbranch_scc1 L_poll10_ok
    v_cmp_ne_u32 vcc, v31, v21
    v_cmp_ne_u32 s[12:13], v31, v23
    s_or_b64 vcc, vcc, s[12:13]
    s_cbranch_vccnz L_poll10
L_poll10_ok:
    v_max_u32 v20, v20, v22
    s_nop 1
    v_max_u32_dpp v20, v20, v20 row_ror:8 row_mask:0xf bank_mask:0xf
    s_nop 1
    v_max_u32_dpp v20, v20, v20 row_ror:4 row_mask:0xf bank_mask:0xf
    s_nop 1
    v_max_u32_dpp v20, v20, v20 row_ror:2 row_mask:0xf bank_mask:0xf
    s_nop 1
    v_max_u32_dpp v20, v20, v20 row_ror:1 row_mask:0xf bank_mask:0xf
    v_mov_b32 v21, v20
    s_nop 1
    v_permlane16_swap_b32 v20, v21
    v_max_u32 v20, v20, v21
    v_mov_b32 v21, v20
    s_nop 1
    v_permlane32_swap_b32 v20, v21
    v_max_u32 v20, v20, v21
    v_mov_b32 v9, 51200
    s_mov_b64 exec, 1
    ds_write2_b32 v9, v20, v31 offset1:1
    s_mov_b64 exec, -1
    s_waitcnt lgkmcnt(0)
    s_barrier
    s_endpgm
L_end:
    s_endpgm
.section .rodata,"a"
.p2align 6
.amdhsa_kernel gated_mix__spectral_fnet__moe_arch_mod__prompt_kernel
  .amdhsa_next_free_vgpr 168
  .amdhsa_next_free_sgpr 102
  .amdhsa_accum_offset 168
  .amdhsa_group_segment_fixed_size 0
  .amdhsa_kernarg_size 112
  .amdhsa_user_sgpr_count 2
  .amdhsa_user_sgpr_kernarg_segment_ptr 1
  .amdhsa_system_sgpr_workgroup_id_x 1
.end_amdhsa_kernel
```

```asm
; @launch grid=(256,1,1) block=(576,1,1) lds=86016
.amdgcn_target "amdgcn-amd-amdhsa--gfx950"
.text
.globl gated_mix__spectral_fnet__moe_arch_mod__prompt_kernel
.p2align 8
.type gated_mix__spectral_fnet__moe_arch_mod__prompt_kernel,@function
gated_mix__spectral_fnet__moe_arch_mod__prompt_kernel:
    s_load_dwordx2 s[4:5], s[0:1], 0
    s_load_dwordx16 s[16:31], s[0:1], 48
    v_lshrrev_b32 v1, 6, v0
    v_and_b32 v0, 63, v0
    v_readfirstlane_b32 s3, v1
    v_and_b32 v1, 15, v0
    v_lshrrev_b32 v2, 4, v0
    s_and_b32 s6, s2, 7
    s_sub_u32 s3, s3, 1
    s_min_u32 s3, s3, 8
    s_lshr_b32 s7, s2, 3
    s_cmp_ge_u32 s2, 128
    s_cbranch_scc1 L_notA
    s_add_u32 s8, s6, 1
    s_sub_u32 s9, 15, s6
    s_cmp_eq_u32 s3, 8
    s_cbranch_scc1 L_ah
    s_and_b32 s57, s7, 1
    s_bitcmp1_b32 s7, 1
    s_cselect_b32 s10, s9, s8
    s_lshr_b32 s11, s7, 2
    s_lshl4_add_u32 s56, s11, s10
    v_lshlrev_b32 v5, 4, v0
    v_mov_b32 v3, 0
    s_cmp_lg_u32 s6, 7
    s_cbranch_scc1 L_k7
    s_lshr_b32 s11, s7, 1
    s_lshl3_add_u32 s56, s11, 8
    s_mov_b32 s8, 0
    s_cmp_eq_u32 s2, 127
    s_cselect_b32 s56, 0, s56
    s_cselect_b32 s57, 0, s57
L_k7:
    s_lshl3_add_u32 s11, s57, s3
    s_lshl_b32 s11, s11, 7
    s_add_u32 s58, s11, s56
    s_sub_u32 s59, 2048, s58
    s_cmp_eq_u32 s58, 0
    s_cselect_b32 s59, 1024, s59
    s_lshl_b32 s10, s58, 10
    s_lshl_b32 s11, s59, 10
    v_add_u32 v6, s10, v5
    v_add_u32 v7, s11, v5
    s_waitcnt lgkmcnt(0)
    global_load_dwordx4 v[16:19], v6, s[4:5]
    global_load_dwordx4 v[20:23], v7, s[4:5]
    s_bitcmp1_b32 s7, 3
    s_cselect_b32 s8, s9, s8
    s_and_b32 s9, s7, 7
    s_lshl3_add_u32 s51, s8, s9
    s_lshl_b32 s35, s8, 5
    s_add_u32 s35, s35, s9
    s_lshl_b32 s35, s35, 6
    s_lshr_b32 s6, s3, 2
    s_and_b32 s7, s3, 1
    s_bfe_u32 s8, s3, 0x10001
    v_lshl_add_u32 v6, s6, 4, v1
    s_lshl3_add_u32 s9, s8, s7
    s_lshl_b32 s9, s9, 2
    v_cvt_f32_u32 v6, v6
    v_lshl_add_u32 v7, v2, 3, s9
    v_mul_f32 v6, 0x3c000000, v6
    v_cvt_f32_u32 v7, v7
    v_mul_f32 v7, v7, v6
    v_cos_f32 v96, v7
    v_sin_f32 v100, v7
    v_add_f32 v7, v7, v6
    v_cos_f32 v97, v7
    v_sin_f32 v101, v7
    v_add_f32 v7, v7, v6
    v_cos_f32 v98, v7
    v_sin_f32 v102, v7
    v_add_f32 v7, v7, v6
    v_cos_f32 v99, v7
    v_sin_f32 v103, v7
    s_lshl_b32 s10, s6, 13
    s_lshl_b32 s11, s8, 10
    s_lshl3_add_u32 s11, s7, s11
    v_add_u32 v15, s10, v5
    v_add_u32 v9, s11, v15
    v_cvt_pk_bf16_f32 v104, v96, v97
    v_cvt_pk_bf16_f32 v105, v98, v99
    v_cvt_pk_bf16_f32 v106, -v100, -v101
    v_cvt_pk_bf16_f32 v107, -v102, -v103
    v_cmp_eq_f32 vcc, 0, v6
    v_cvt_pk_bf16_f32 v108, v96, -v101
    v_cvt_pk_bf16_f32 v109, -v98, v103
    v_cvt_pk_bf16_f32 v110, -v100, -v97
    v_cvt_pk_bf16_f32 v111, v102, v99
    ds_write_b64 v9, v[104:105] offset:16384
    ds_write_b64 v9, v[108:109] offset:20480
    ds_write_b64 v9, v[110:111] offset:22528
    s_mov_b64 exec, vcc
    v_mov_b32 v106, 0xbf803f80
    v_mov_b32 v107, 0xbf803f80
    s_mov_b64 exec, -1
    ds_write_b64 v9, v[106:107] offset:18432
    global_load_dwordx4 v[24:27], v5, s[16:17]
    s_lshl_b32 s10, s3, 11
    s_add_u32 s11, s10, s51
    s_lshl_b32 s11, s11, 7
    s_mov_b32 m0, s10
    v_and_b32 v9, 7, v0
    v_bfe_u32 v13, v0, 4, 1
    v_xor_b32 v9, v9, v13
    v_lshrrev_b32 v13, 3, v0
    v_lshl_add_u32 v9, v9, 4, s11
    v_lshl_add_u32 v13, v13, 14, v9
    global_load_lds_dwordx4 v13, s[4:5]
    s_add_u32 m0, s10, 1024
    v_add_u32 v13, 0x20000, v13
    global_load_lds_dwordx4 v13, s[4:5]
    v_mov_b32 v12, 0
    v_mov_b32 v13, 0
    s_waitcnt vmcnt(2)
    v_dot2c_f32_bf16 v12, v16, v24
    v_dot2c_f32_bf16 v13, v20, v24
    v_dot2c_f32_bf16 v12, v17, v25
    v_dot2c_f32_bf16 v13, v21, v25
    v_dot2c_f32_bf16 v12, v18, v26
    v_dot2c_f32_bf16 v13, v22, v26
    v_dot2c_f32_bf16 v12, v19, v27
    v_dot2c_f32_bf16 v13, v23, v27
    s_sub_u32 s10, 0xffff, s58
    s_sub_u32 s11, 0xffff, s59
    v_mov_b32 v4, s10
    v_permlane32_swap_b32 v12, v13
    v_add_f32 v12, v12, v13
    v_mov_b32 v13, v12
    v_writelane_b32 v4, s11, 32
    s_lshl3_add_u32 s10, s3, 33792
    v_permlane16_swap_b32 v12, v13
    v_add_f32 v12, v12, v13
    v_lshrrev_b32 v9, 3, v0
    v_add_u32 v9, s10, v9
    v_add_f32_dpp v12, v12, v12 row_ror:8 row_mask:0xf bank_mask:0xf
    v_bfe_u32 v6, v0, 2, 2
    v_and_b32 v14, 3, v0
    v_add_f32_dpp v12, v12, v12 row_ror:4 row_mask:0xf bank_mask:0xf
    v_lshl_add_u32 v14, v14, 1, s8
    v_lshl_add_u32 v10, v2, 3, v6
    v_add_f32_dpp v12, v12, v12 row_ror:2 row_mask:0xf bank_mask:0xf
    v_lshrrev_b32 v6, 1, v6
    v_xor_b32 v14, v14, v6
    v_add_f32_dpp v12, v12, v12 row_ror:1 row_mask:0xf bank_mask:0xf
    v_cvt_pk_bf16_f32 v12, v12, v12
    v_and_b32 v12, 0xffff0000, v12
    v_ashrrev_i32 v7, 31, v12
    v_or_b32 v7, 0x80000000, v7
    v_xor_b32 v7, v7, v12
    v_and_b32 v7, 0xffff0000, v7
    v_or_b32 v7, v7, v4
    s_mov_b32 exec_lo, 1
    s_mov_b32 exec_hi, 1
    ds_write_b32 v9, v7
    s_mov_b64 exec, -1
    s_lshl_b32 s7, s7, 3
    v_lshl_add_u32 v14, v14, 4, s7
    v_lshl_add_u32 v10, v10, 7, v14
    v_lshlrev_b32 v9, 4, v2
    s_waitcnt vmcnt(0) lgkmcnt(0)
    s_barrier
    ds_read_b128 v[28:31], v9 offset:33920
    ds_read_b64_tr_b16 v[96:97], v10 offset:0
    ds_read_b64_tr_b16 v[98:99], v10 offset:512
    ds_read_b128 v[32:35], v15 offset:16384
    ds_read_b128 v[48:51], v15 offset:18432
    ds_read_b128 v[64:67], v15 offset:20480
    ds_read_b128 v[80:83], v15 offset:22528
    ds_read_b64_tr_b16 v[100:101], v10 offset:4096
    ds_read_b64_tr_b16 v[102:103], v10 offset:4608
    ds_read_b128 v[36:39], v15 offset:17408
    ds_read_b128 v[52:55], v15 offset:19456
    ds_read_b128 v[68:71], v15 offset:21504
    ds_read_b128 v[84:87], v15 offset:23552
    s_waitcnt lgkmcnt(9)
    ds_read_b64_tr_b16 v[104:105], v10 offset:8192
    ds_read_b64_tr_b16 v[106:107], v10 offset:8704
    ds_read_b64_tr_b16 v[108:109], v10 offset:12288
    ds_read_b64_tr_b16 v[110:111], v10 offset:12800
    v_lshlrev_b32 v8, 31, v1
    v_lshrrev_b32 v14, 16, v8
    v_or_b32 v8, v8, v14
    global_load_dwordx4 v[24:27], v5, s[24:25]
    s_waitcnt lgkmcnt(13)
    v_mfma_f32_16x16x32_bf16 v[112:115], v[96:99], v[32:35], 0
    v_xor_b32 v40, v32, v8
    v_xor_b32 v41, v33, v8
    v_xor_b32 v42, v34, v8
    v_xor_b32 v43, v35, v8
    s_waitcnt lgkmcnt(12)
    v_mfma_f32_16x16x32_bf16 v[116:119], v[96:99], v[48:51], 0
    v_xor_b32 v56, v48, v8
    v_xor_b32 v57, v49, v8
    v_xor_b32 v58, v50, v8
    v_xor_b32 v59, v51, v8
    s_waitcnt lgkmcnt(11)
    v_mfma_f32_16x16x32_bf16 v[120:123], v[96:99], v[64:67], 0
    v_xor_b32 v72, v64, v8
    v_xor_b32 v73, v65, v8
    v_xor_b32 v74, v66, v8
    v_xor_b32 v75, v67, v8
    s_waitcnt lgkmcnt(10)
    v_mfma_f32_16x16x32_bf16 v[124:127], v[96:99], v[80:83], 0
    v_xor_b32 v88, v80, v8
    v_xor_b32 v89, v81, v8
    v_xor_b32 v90, v82, v8
    v_xor_b32 v91, v83, v8
    s_waitcnt lgkmcnt(7)
    v_mfma_f32_16x16x32_bf16 v[112:115], v[100:103], v[36:39], v[112:115]
    v_xor_b32 v44, v36, v8
    v_xor_b32 v45, v37, v8
    v_xor_b32 v46, v38, v8
    v_xor_b32 v47, v39, v8
    s_waitcnt lgkmcnt(6)
    v_mfma_f32_16x16x32_bf16 v[116:119], v[100:103], v[52:55], v[116:119]
    v_xor_b32 v60, v52, v8
    v_xor_b32 v61, v53, v8
    v_xor_b32 v62, v54, v8
    v_xor_b32 v63, v55, v8
    s_waitcnt lgkmcnt(5)
    v_mfma_f32_16x16x32_bf16 v[120:123], v[100:103], v[68:71], v[120:123]
    v_xor_b32 v76, v68, v8
    v_xor_b32 v77, v69, v8
    v_xor_b32 v78, v70, v8
    v_xor_b32 v79, v71, v8
    s_waitcnt lgkmcnt(4)
    v_mfma_f32_16x16x32_bf16 v[124:127], v[100:103], v[84:87], v[124:127]
    v_xor_b32 v92, v84, v8
    v_xor_b32 v93, v85, v8
    v_xor_b32 v94, v86, v8
    v_xor_b32 v95, v87, v8
    s_waitcnt lgkmcnt(2)
    v_mfma_f32_16x16x32_bf16 v[112:115], v[104:107], v[40:43], v[112:115]
    s_mul_i32 s44, s6, 528384
    s_add_u32 s44, s44, s35
    v_mfma_f32_16x16x32_bf16 v[116:119], v[104:107], v[56:59], v[116:119]
    s_and_b32 s10, s3, 3
    s_lshl_b32 s10, s10, 9
    v_mfma_f32_16x16x32_bf16 v[120:123], v[104:107], v[72:75], v[120:123]
    s_add_u32 s44, s44, s10
    s_add_u32 s44, s44, 2097152
    v_mfma_f32_16x16x32_bf16 v[124:127], v[104:107], v[88:91], v[124:127]
    s_mov_b32 s36, s30
    s_mov_b32 s37, s31
    s_waitcnt lgkmcnt(0)
    v_mfma_f32_16x16x32_bf16 v[112:115], v[108:111], v[44:47], v[112:115]
    s_mov_b32 s38, 0x1000000
    s_mov_b32 s39, 0x20000
    v_mfma_f32_16x16x32_bf16 v[116:119], v[108:111], v[60:63], v[116:119]
    s_add_u32 s45, s44, 1056768
    s_mov_b32 s11, 0xfffefffe
    v_mfma_f32_16x16x32_bf16 v[120:123], v[108:111], v[76:79], v[120:123]
    s_mov_b32 s10, 0x07060302
    v_mul_u32_u24 v11, 33024, v1
    v_mfma_f32_16x16x32_bf16 v[124:127], v[108:111], v[92:95], v[124:127]
    v_lshl_add_u32 v11, v2, 4, v11
    v_mov_b32 v12, 0
    v_mov_b32 v13, 0
    v_add_u32 v112, 0x10000, v112
    v_add_u32 v113, 0x10000, v113
    v_add_u32 v114, 0x10000, v114
    v_add_u32 v115, 0x10000, v115
    v_add_u32 v116, 0x10000, v116
    v_add_u32 v117, 0x10000, v117
    v_add_u32 v118, 0x10000, v118
    v_add_u32 v119, 0x10000, v119
    v_perm_b32 v96, v116, v112, s10
    v_perm_b32 v97, v117, v113, s10
    v_perm_b32 v98, v118, v114, s10
    v_perm_b32 v99, v119, v115, s10
    v_and_or_b32 v96, v96, s11, v28
    v_and_or_b32 v97, v97, s11, v29
    v_and_or_b32 v98, v98, s11, v30
    v_and_or_b32 v99, v99, s11, v31
    buffer_store_dwordx4 v[96:99], v11, s[36:39], s44 offen sc1
    v_add_u32 v120, 0x10000, v120
    v_add_u32 v121, 0x10000, v121
    v_add_u32 v122, 0x10000, v122
    v_add_u32 v123, 0x10000, v123
    v_add_u32 v124, 0x10000, v124
    v_add_u32 v125, 0x10000, v125
    v_add_u32 v126, 0x10000, v126
    v_add_u32 v127, 0x10000, v127
    v_perm_b32 v100, v124, v120, s10
    v_perm_b32 v101, v125, v121, s10
    v_perm_b32 v102, v126, v122, s10
    v_perm_b32 v103, v127, v123, s10
    v_and_or_b32 v100, v100, s11, v28
    v_and_or_b32 v101, v101, s11, v29
    v_and_or_b32 v102, v102, s11, v30
    v_and_or_b32 v103, v103, s11, v31
    buffer_store_dwordx4 v[100:103], v11, s[36:39], s45 offen sc1
    s_mov_b32 s65, 0
    s_mov_b32 s55, 0
L_ta_end:
    s_mov_b32 s40, s26
    s_mov_b32 s41, s27
    s_mov_b32 s42, 0x200000
    s_mov_b32 s43, 0x20000
    s_cmp_ge_u32 s3, 4
    s_cbranch_scc1 L_hi0
    v_lshlrev_b32 v6, 4, v1
    v_lshl_add_u32 v10, v2, 13, v6
    v_mul_u32_u24 v6, 4352, v2
    v_bfe_u32 v7, v1, 1, 2
    v_xor_b32 v7, s3, v7
    v_lshl_add_u32 v7, v7, 4, v6
    v_lshl_add_u32 v11, v1, 6, v7
    s_lshl4_add_u32 s7, s3, 1024
    v_mov_b32 v9, 17600
    v_lshl_add_u32 v28, v0, 1, v9
    v_lshl_add_u32 v7, v1, 1, s7
    s_mov_b32 exec_lo, 0x00ff00ff
    s_mov_b32 exec_hi, 0x00ff00ff
    v_add_u32 v28, v7, v6
    s_mov_b64 exec, -1
    v_lshrrev_b32 v6, 1, v1
    s_lshl_b32 s6, s57, 10
    s_add_u32 s6, s6, s56
    v_lshl_add_u32 v6, v6, 7, s6
    v_and_b32 v7, 1, v1
    v_lshlrev_b32 v9, 9, v7
    s_cmp_lg_u32 s56, 0
    s_cbranch_scc1 L_g01
    s_mov_b32 exec_lo, 0x00020002
    s_mov_b32 exec_hi, 0x00020002
    v_mov_b32 v6, 0x400
    v_mov_b32 v9, 0
    s_mov_b64 exec, -1
L_g01:
    v_lshlrev_b32 v7, 2, v2
    v_mad_u32_u24 v9, v7, v6, v9
    v_cvt_f32_u32 v6, v6
    v_cvt_f32_u32 v9, v9
    v_mul_f32 v6, 0x3a000000, v6
    v_mul_f32 v9, 0x3a000000, v9
    v_cos_f32 v64, v9
    v_sin_f32 v68, v9
    v_add_f32 v9, v9, v6
    v_cos_f32 v65, v9
    v_sin_f32 v69, v9
    v_add_f32 v9, v9, v6
    v_cos_f32 v66, v9
    v_sin_f32 v70, v9
    v_add_f32 v9, v9, v6
    v_cos_f32 v67, v9
    v_sin_f32 v71, v9
    s_and_b32 s7, s56, 63
    s_mul_i32 s32, s7, 33024
    v_cvt_pk_bf16_f32 v148, v64, v68
    v_cvt_pk_bf16_f32 v149, v65, v69
    v_cvt_pk_bf16_f32 v150, v66, v70
    v_cvt_pk_bf16_f32 v151, v67, v71
    s_cmp_lg_u32 s7, 0
    s_cbranch_scc1 L_gd2
    s_lshr_b32 s7, s56, 2
    v_and_b32 v148, 0xffff, v148
    v_lshlrev_b32 v148, s7, v148
    v_and_b32 v149, 0xffff, v149
    v_lshlrev_b32 v149, s7, v149
    v_and_b32 v150, 0xffff, v150
    v_lshlrev_b32 v150, s7, v150
    v_and_b32 v151, 0xffff, v151
    v_lshlrev_b32 v151, s7, v151
L_gd2:
    s_lshl_b32 s7, s3, 9
    s_add_u32 s32, s32, s7
    s_add_u32 s32, s32, 2097152
    s_add_u32 s33, s32, 4096
    v_and_b32 v6, 3, v1
    v_lshlrev_b32 v6, 4, v6
    ds_read_b128 v[96:99], v6 offset:33920
    s_waitcnt lgkmcnt(0)
    v_cvt_f32_u32 v6, v1
    s_lshl_b32 s6, s3, 2
    v_lshl_add_u32 v7, v2, 6, s6
    v_mul_f32 v6, 0x3b000000, v6
    v_cvt_f32_u32 v7, v7
    v_mul_f32 v15, 0x41800000, v6
    v_mul_f32 v7, v7, v6
    v_cos_f32 v64, v7
    v_sin_f32 v68, v7
    v_add_f32 v9, v7, v15
    v_cos_f32 v65, v9
    v_sin_f32 v69, v9
    v_add_f32 v9, v9, v15
    v_cos_f32 v66, v9
    v_sin_f32 v70, v9
    v_add_f32 v9, v9, v15
    v_cos_f32 v67, v9
    v_sin_f32 v71, v9
    v_mov_b32 v108, 0
    v_cvt_pk_bf16_f32 v100, v64, v65
    v_cvt_pk_bf16_f32 v104, -v68, -v69
    v_cvt_pk_bf16_f32 v101, v66, v67
    v_cvt_pk_bf16_f32 v105, -v70, -v71
    v_xor_b32 v102, v100, v8
    v_xor_b32 v106, v104, v8
    v_xor_b32 v103, v101, v8
    v_xor_b32 v107, v105, v8
    v_add_f32 v7, v7, v6
    v_cos_f32 v64, v7
    v_sin_f32 v68, v7
    v_add_f32 v9, v7, v15
    v_cos_f32 v65, v9
    v_sin_f32 v69, v9
    v_add_f32 v9, v9, v15
    v_cos_f32 v66, v9
    v_sin_f32 v70, v9
    v_add_f32 v9, v9, v15
    v_cos_f32 v67, v9
    v_sin_f32 v71, v9
    v_mov_b32 v120, 0
    v_cvt_pk_bf16_f32 v112, v64, v65
    v_cvt_pk_bf16_f32 v116, -v68, -v69
    v_cvt_pk_bf16_f32 v113, v66, v67
    v_cvt_pk_bf16_f32 v117, -v70, -v71
    v_xor_b32 v114, v112, v8
    v_xor_b32 v118, v116, v8
    v_xor_b32 v115, v113, v8
    v_xor_b32 v119, v117, v8
    v_add_f32 v7, v7, v6
    v_cos_f32 v64, v7
    v_sin_f32 v68, v7
    v_add_f32 v9, v7, v15
    v_cos_f32 v65, v9
    v_sin_f32 v69, v9
    v_add_f32 v9, v9, v15
    v_cos_f32 v66, v9
    v_sin_f32 v70, v9
    v_add_f32 v9, v9, v15
    v_cos_f32 v67, v9
    v_sin_f32 v71, v9
    v_mov_b32 v132, 0
    v_cvt_pk_bf16_f32 v124, v64, v65
    v_cvt_pk_bf16_f32 v128, -v68, -v69
    v_cvt_pk_bf16_f32 v125, v66, v67
    v_cvt_pk_bf16_f32 v129, -v70, -v71
    v_xor_b32 v126, v124, v8
    v_xor_b32 v130, v128, v8
    v_xor_b32 v127, v125, v8
    v_xor_b32 v131, v129, v8
    v_add_f32 v7, v7, v6
    v_cos_f32 v64, v7
    v_sin_f32 v68, v7
    v_add_f32 v9, v7, v15
    v_cos_f32 v65, v9
    v_sin_f32 v69, v9
    v_add_f32 v9, v9, v15
    v_cos_f32 v66, v9
    v_sin_f32 v70, v9
    v_add_f32 v9, v9, v15
    v_cos_f32 v67, v9
    v_sin_f32 v71, v9
    v_mov_b32 v144, 0
    v_cvt_pk_bf16_f32 v136, v64, v65
    v_cvt_pk_bf16_f32 v140, -v68, -v69
    v_cvt_pk_bf16_f32 v137, v66, v67
    v_cvt_pk_bf16_f32 v141, -v70, -v71
    v_xor_b32 v138, v136, v8
    v_xor_b32 v142, v140, v8
    v_xor_b32 v139, v137, v8
    v_xor_b32 v143, v141, v8
    v_lshrrev_b32 v6, 1, v1
    v_add_u32 v7, s6, v6
    v_and_b32 v9, 1, v1
    v_lshl_add_u32 v7, v9, 3, v7
    v_cvt_f32_u32 v7, v7
    v_mul_f32 v7, 0x3d000000, v7
    v_cos_f32 v7, v7
    s_mov_b32 exec_lo, 0x30003
    s_mov_b32 exec_hi, 0x30003
    v_cvt_pk_bf16_f32 v108, v7, -v7
    s_mov_b32 exec_lo, 0xc000c
    s_mov_b32 exec_hi, 0xc000c
    v_cvt_pk_bf16_f32 v120, v7, -v7
    s_mov_b32 exec_lo, 0x300030
    s_mov_b32 exec_hi, 0x300030
    v_cvt_pk_bf16_f32 v132, v7, -v7
    s_mov_b32 exec_lo, 0xc000c0
    s_mov_b32 exec_hi, 0xc000c0
    v_cvt_pk_bf16_f32 v144, v7, -v7
    s_mov_b64 exec, -1
    v_mov_b32 v109, v108
    v_mov_b32 v110, v108
    v_mov_b32 v111, v108
    v_mov_b32 v121, v120
    v_mov_b32 v122, v120
    v_mov_b32 v123, v120
    v_mov_b32 v133, v132
    v_mov_b32 v134, v132
    v_mov_b32 v135, v132
    v_mov_b32 v145, v144
    v_mov_b32 v146, v144
    v_mov_b32 v147, v144
    s_waitcnt vmcnt(0)
    s_barrier
    s_sleep 4
    buffer_load_dwordx4 v[32:35], v10, s[36:39], s32 offen offset:0 sc1
    buffer_load_dwordx4 v[36:39], v10, s[36:39], s32 offen offset:2048 sc1
    buffer_load_dwordx4 v[40:43], v10, s[36:39], s33 offen offset:0 sc1
    buffer_load_dwordx4 v[44:47], v10, s[36:39], s33 offen offset:2048 sc1
    buffer_load_dwordx4 v[48:51], v10, s[36:39], s32 offen offset:256 sc1
    buffer_load_dwordx4 v[52:55], v10, s[36:39], s32 offen offset:2304 sc1
    buffer_load_dwordx4 v[56:59], v10, s[36:39], s33 offen offset:256 sc1
    buffer_load_dwordx4 v[60:63], v10, s[36:39], s33 offen offset:2304 sc1
    s_waitcnt vmcnt(10)
    v_dot2c_f32_bf16 v12, v16, v24
    v_dot2c_f32_bf16 v13, v20, v24
    v_dot2c_f32_bf16 v12, v17, v25
    v_dot2c_f32_bf16 v13, v21, v25
    v_dot2c_f32_bf16 v12, v18, v26
    v_dot2c_f32_bf16 v13, v22, v26
    v_dot2c_f32_bf16 v12, v19, v27
    v_dot2c_f32_bf16 v13, v23, v27
    s_nop 2
    v_permlane32_swap_b32 v12, v13
    v_add_f32 v12, v12, v13
    v_mov_b32 v13, v12
    s_nop 1
    v_permlane16_swap_b32 v12, v13
    v_add_f32 v12, v12, v13
    s_nop 1
    v_add_f32_dpp v12, v12, v12 row_ror:8 row_mask:0xf bank_mask:0xf
    s_nop 1
    v_add_f32_dpp v12, v12, v12 row_ror:4 row_mask:0xf bank_mask:0xf
    s_nop 1
    v_add_f32_dpp v12, v12, v12 row_ror:2 row_mask:0xf bank_mask:0xf
    s_nop 1
    v_add_f32_dpp v12, v12, v12 row_ror:1 row_mask:0xf bank_mask:0xf
    v_cvt_pk_bf16_f32 v12, v12, v12
    v_and_b32 v12, 0xffff0000, v12
    s_lshl_b32 s6, s3, 11
    v_add_u32 v6, s6, v5
    ds_write_b128 v6, v[16:19] offset:48832
    ds_write_b128 v6, v[20:23] offset:49856
    v_lshl_add_u32 v7, v1, 6, s6
    v_lshl_add_u32 v7, v2, 3, v7
    s_waitcnt lgkmcnt(0)
    ds_read_b64 v[16:17], v7 offset:48832
    ds_read_b64 v[18:19], v7 offset:48864
    ds_read_b64 v[20:21], v7 offset:49856
    ds_read_b64 v[22:23], v7 offset:49888
    v_and_b32 v6, 1, v2
    v_lshlrev_b32 v6, 5, v6
    v_lshl_add_u32 v6, v1, 6, v6
    v_lshrrev_b32 v7, 1, v2
    v_lshl_add_u32 v3, v7, 4, v6
    v_mul_f32 v13, 0xbfb8aa3b, v12
    v_exp_f32 v13, v13
    s_nop 0
    v_add_f32 v13, 1.0, v13
    v_rcp_f32 v13, v13
    s_nop 0
    v_cvt_pk_bf16_f32 v13, v13, v13
    v_and_b32 v13, 0xffff0000, v13
    v_sub_f32 v14, 1.0, v13
    v_cvt_pk_bf16_f32 v14, v14, v14
    v_and_b32 v14, 0xffff0000, v14
    v_readlane_b32 s6, v13, 0
    v_readlane_b32 s7, v13, 32
    v_readlane_b32 s8, v14, 0
    v_readlane_b32 s9, v14, 32
    s_xor_b32 s10, s6, 0x80000000
    s_cmp_eq_u32 s58, 0
    s_cselect_b32 s10, 0, s10
    s_cselect_b32 s11, 0, s7
    v_mov_b32 v24, s6
    v_mov_b32 v25, s10
    v_mov_b32 v26, s11
    v_mov_b32 v27, s7
    v_mov_b32 v13, s8
    v_mov_b32 v14, s9
    s_waitcnt lgkmcnt(0)
    v_lshlrev_b32 v152, 16, v16
    v_and_b32 v153, 0xffff0000, v16
    v_lshlrev_b32 v154, 16, v17
    v_and_b32 v155, 0xffff0000, v17
    v_lshlrev_b32 v156, 16, v18
    v_and_b32 v157, 0xffff0000, v18
    v_lshlrev_b32 v158, 16, v19
    v_and_b32 v159, 0xffff0000, v19
    v_mul_f32 v152, v13, v152
    v_mul_f32 v153, v13, v153
    v_mul_f32 v154, v13, v154
    v_mul_f32 v155, v13, v155
    v_mul_f32 v156, v13, v156
    v_mul_f32 v157, v13, v157
    v_mul_f32 v158, v13, v158
    v_mul_f32 v159, v13, v159
    v_lshlrev_b32 v160, 16, v20
    v_and_b32 v161, 0xffff0000, v20
    v_lshlrev_b32 v162, 16, v21
    v_and_b32 v163, 0xffff0000, v21
    v_lshlrev_b32 v164, 16, v22
    v_and_b32 v165, 0xffff0000, v22
    v_lshlrev_b32 v166, 16, v23
    v_and_b32 v167, 0xffff0000, v23
    v_mul_f32 v160, v14, v160
    v_mul_f32 v161, v14, v161
    v_mul_f32 v162, v14, v162
    v_mul_f32 v163, v14, v163
    v_mul_f32 v164, v14, v164
    v_mul_f32 v165, v14, v165
    v_mul_f32 v166, v14, v166
    v_mul_f32 v167, v14, v167
    s_mul_i32 s7, s3, 2176
    v_bfe_u32 v7, v1, 1, 2
    v_xor_b32 v7, v7, v2
    v_lshl_add_u32 v7, v7, 4, s7
    v_lshl_add_u32 v29, v1, 6, v7
    v_sub_u32 v6, 16, v1
    v_bfe_u32 v7, v6, 1, 2
    v_xor_b32 v7, v7, v2
    v_lshl_add_u32 v7, v7, 4, s7
    v_lshl_add_u32 v30, v6, 6, v7
    s_cmp_eq_u32 s58, 0
    s_cselect_b32 s6, 0, 2048
    v_add_u32 v4, s6, v5
L_zjoin:
    s_waitcnt vmcnt(4)
L_got0:
    v_xor_b32 v80, v32, v96
    v_xor_b32 v81, v36, v96
    v_xor_b32 v82, v40, v96
L_tb0:
    s_cbranch_execz L_tbback
    v_xor_b32 v83, v44, v96
    v_or3_b32 v6, v80, v81, v82
    v_or_b32 v6, v6, v83
    v_mfma_f32_16x16x32_bf16 v[64:67], v[80:83], v[148:151], 0
    v_xor_b32 v84, v33, v97
    v_xor_b32 v85, v37, v97
    v_xor_b32 v86, v41, v97
    v_xor_b32 v87, v45, v97
    v_or3_b32 v6, v6, v84, v85
    v_or3_b32 v6, v6, v86, v87
    v_mfma_f32_16x16x32_bf16 v[68:71], v[84:87], v[148:151], 0
    v_xor_b32 v88, v34, v98
    v_xor_b32 v89, v38, v98
    v_xor_b32 v90, v42, v98
    v_xor_b32 v91, v46, v98
    v_or3_b32 v6, v6, v88, v89
    v_or3_b32 v6, v6, v90, v91
    v_mfma_f32_16x16x32_bf16 v[72:75], v[88:91], v[148:151], 0
    v_xor_b32 v92, v35, v99
    v_xor_b32 v93, v39, v99
    v_xor_b32 v94, v43, v99
    v_xor_b32 v95, v47, v99
    v_or3_b32 v6, v6, v92, v93
L_tb1:
    s_cbranch_execz L_tbback
    v_or3_b32 v6, v6, v94, v95
    v_and_b32 v6, 0x10001, v6
    v_cmp_ne_u32 vcc, 0, v6
    v_mfma_f32_16x16x32_bf16 v[76:79], v[92:95], v[148:151], 0
    s_cbranch_vccnz L_retry0
L_fail0:
    s_waitcnt vmcnt(0)
L_got1:
    v_xor_b32 v80, v48, v96
    v_xor_b32 v81, v52, v96
    v_xor_b32 v82, v56, v96
    v_xor_b32 v83, v60, v96
    v_or3_b32 v6, v80, v81, v82
    v_or_b32 v6, v6, v83
    v_mfma_f32_16x16x32_bf16 v[32:35], v[80:83], v[148:151], 0
    v_xor_b32 v84, v49, v97
    v_xor_b32 v85, v53, v97
    v_xor_b32 v86, v57, v97
    v_xor_b32 v87, v61, v97
    v_or3_b32 v6, v6, v84, v85
    v_or3_b32 v6, v6, v86, v87
    v_mfma_f32_16x16x32_bf16 v[36:39], v[84:87], v[148:151], 0
    v_xor_b32 v88, v50, v98
    v_xor_b32 v89, v54, v98
L_tb2:
    s_cbranch_execz L_tbback
    v_xor_b32 v90, v58, v98
    v_xor_b32 v91, v62, v98
    v_or3_b32 v6, v6, v88, v89
    v_or3_b32 v6, v6, v90, v91
    v_mfma_f32_16x16x32_bf16 v[40:43], v[88:91], v[148:151], 0
    v_xor_b32 v92, v51, v99
    v_xor_b32 v93, v55, v99
    v_xor_b32 v94, v59, v99
    v_xor_b32 v95, v63, v99
    v_or3_b32 v6, v6, v92, v93
    v_or3_b32 v6, v6, v94, v95
    v_and_b32 v6, 0x10001, v6
    v_cmp_ne_u32 vcc, 0, v6
    v_mfma_f32_16x16x32_bf16 v[44:47], v[92:95], v[148:151], 0
    s_cbranch_vccnz L_retry1
L_fail1:
    v_cvt_pk_bf16_f32 v80, v64, v65
    v_cvt_pk_bf16_f32 v81, v66, v67
    v_cvt_pk_bf16_f32 v82, v32, v33
    v_cvt_pk_bf16_f32 v83, v34, v35
    v_cvt_pk_bf16_f32 v84, v68, v69
L_tb3:
    s_cbranch_execz L_tbback
    v_cvt_pk_bf16_f32 v85, v70, v71
    v_cvt_pk_bf16_f32 v86, v36, v37
    v_cvt_pk_bf16_f32 v87, v38, v39
    v_mfma_f32_16x16x32_bf16 v[64:67], v[80:83], v[100:103], 0
    v_mfma_f32_16x16x32_bf16 v[32:35], v[80:83], v[104:107], 0
    v_mfma_f32_16x16x32_bf16 v[96:99], v[80:83], v[108:111], 0
    v_cvt_pk_bf16_f32 v88, v72, v73
    v_cvt_pk_bf16_f32 v89, v74, v75
    v_cvt_pk_bf16_f32 v90, v40, v41
    v_cvt_pk_bf16_f32 v91, v42, v43
    v_mfma_f32_16x16x32_bf16 v[68:71], v[84:87], v[112:115], 0
    v_mfma_f32_16x16x32_bf16 v[36:39], v[84:87], v[116:119], 0
    v_mfma_f32_16x16x32_bf16 v[96:99], v[84:87], v[120:123], v[96:99]
    v_cvt_pk_bf16_f32 v92, v76, v77
    v_cvt_pk_bf16_f32 v93, v78, v79
L_tb4:
    s_cbranch_execz L_tbback
    v_cvt_pk_bf16_f32 v94, v44, v45
    v_cvt_pk_bf16_f32 v95, v46, v47
    v_mfma_f32_16x16x32_bf16 v[72:75], v[88:91], v[124:127], 0
    v_mfma_f32_16x16x32_bf16 v[40:43], v[88:91], v[128:131], 0
    v_mfma_f32_16x16x32_bf16 v[96:99], v[88:91], v[132:135], v[96:99]
    v_mfma_f32_16x16x32_bf16 v[76:79], v[92:95], v[136:139], 0
    v_mfma_f32_16x16x32_bf16 v[44:47], v[92:95], v[140:143], 0
    v_mfma_f32_16x16x32_bf16 v[96:99], v[92:95], v[144:147], v[96:99]
    v_cvt_pk_bf16_f32 v48, v64, v32
    v_cvt_pk_bf16_f32 v52, v65, v33
    v_cvt_pk_bf16_f32 v56, v66, v34
    v_cvt_pk_bf16_f32 v60, v67, v35
    v_cvt_pk_bf16_f32 v49, v68, v36
    v_cvt_pk_bf16_f32 v53, v69, v37
    v_cvt_pk_bf16_f32 v57, v70, v38
    v_cvt_pk_bf16_f32 v61, v71, v39
L_tb5:
    s_cbranch_execz L_tbback
    v_cvt_pk_bf16_f32 v50, v72, v40
    v_cvt_pk_bf16_f32 v54, v73, v41
    v_cvt_pk_bf16_f32 v58, v74, v42
    v_cvt_pk_bf16_f32 v62, v75, v43
    v_cvt_pk_bf16_f32 v51, v76, v44
    ds_write_b128 v11, v[48:51] offset:16384
    v_cvt_pk_bf16_f32 v55, v77, v45
    ds_write_b128 v11, v[52:55] offset:17472
    v_cvt_pk_bf16_f32 v59, v78, v46
    ds_write_b128 v11, v[56:59] offset:18560
    v_cvt_pk_bf16_f32 v63, v79, v47
    ds_write_b128 v11, v[60:63] offset:19648
    v_cvt_pk_bf16_f32 v96, v96, v97
    v_cvt_pk_bf16_f32 v98, v98, v99
    ds_write_b16 v28, v96 offset:16384
L_tb6:
    s_cbranch_execz L_tbback
    ds_write_b16_d16_hi v28, v96 offset:17472
    ds_write_b16 v28, v98 offset:18560
    ds_write_b16_d16_hi v28, v98 offset:19648
L_d2:
    ds_read_b128 v[64:67], v5 offset:42688
    ds_read_b128 v[68:71], v5 offset:43712
    ds_read_b128 v[72:75], v4 offset:42688
    ds_read_b128 v[76:79], v4 offset:43712
    v_mov_b32 v9, 33856
    s_waitcnt lgkmcnt(0)
    s_barrier
    ds_read_b32 v6, v9
    ds_read_b128 v[32:35], v29 offset:16384
    ds_read_b128 v[36:39], v30 offset:16384
    ds_read_b128 v[40:43], v29 offset:17472
    ds_read_b128 v[44:47], v30 offset:17472
    s_cmp_lg_u32 s55, 0
    s_cbranch_scc1 L_zfin
    s_lshl_b32 s6, s58, 10
L_tb7:
    s_cbranch_execz L_tbback
    s_lshl_b32 s7, s59, 10
    s_waitcnt lgkmcnt(3)
    v_mfma_f32_16x16x32_bf16 v[48:51], v[32:35], v[64:67], 0
    s_waitcnt lgkmcnt(2)
    v_mfma_f32_16x16x32_bf16 v[52:55], v[36:39], v[68:71], 0
    s_waitcnt lgkmcnt(1)
    v_mfma_f32_16x16x32_bf16 v[56:59], v[40:43], v[72:75], 0
    s_waitcnt lgkmcnt(0)
    v_mfma_f32_16x16x32_bf16 v[60:63], v[44:47], v[76:79], 0
    v_readfirstlane_b32 s44, v6
    s_andn2_b32 s54, 0xffff, s44
    v_fmac_f32 v152, v24, v48
    v_fmac_f32 v153, v24, v49
    v_fmac_f32 v154, v24, v50
    v_fmac_f32 v155, v24, v51
    v_fmac_f32 v156, v24, v52
    v_fmac_f32 v157, v24, v53
    v_fmac_f32 v158, v24, v54
    v_fmac_f32 v159, v24, v55
    v_fmac_f32 v160, v26, v48
    v_fmac_f32 v161, v26, v49
    v_fmac_f32 v162, v26, v50
    v_fmac_f32 v163, v26, v51
    v_fmac_f32 v164, v26, v52
    v_fmac_f32 v165, v26, v53
    v_fmac_f32 v166, v26, v54
L_tb8:
    s_cbranch_execz L_tbback
    v_fmac_f32 v167, v26, v55
    v_fmac_f32 v152, v25, v56
    v_fmac_f32 v153, v25, v57
    v_fmac_f32 v154, v25, v58
    v_fmac_f32 v155, v25, v59
    v_fmac_f32 v156, v25, v60
    v_fmac_f32 v157, v25, v61
    v_fmac_f32 v158, v25, v62
    v_fmac_f32 v159, v25, v63
    v_cvt_pk_bf16_f32 v32, v152, v153
    v_cvt_pk_bf16_f32 v33, v154, v155
    v_cvt_pk_bf16_f32 v34, v156, v157
    v_cvt_pk_bf16_f32 v35, v158, v159
    s_cmp_eq_u32 s58, s54
    s_cbranch_scc1 L_skip3
    v_permlane16_swap_b32 v32, v34
    v_permlane16_swap_b32 v33, v35
    buffer_store_dwordx4 v[32:35], v3, s[40:43], s6 offen nt
L_skip3:
    v_fmac_f32 v160, v27, v56
    v_fmac_f32 v161, v27, v57
    v_fmac_f32 v162, v27, v58
    v_fmac_f32 v163, v27, v59
    v_fmac_f32 v164, v27, v60
    v_fmac_f32 v165, v27, v61
    v_fmac_f32 v166, v27, v62
    v_fmac_f32 v167, v27, v63
L_tb9:
    s_cbranch_execz L_tbback
    v_cvt_pk_bf16_f32 v36, v160, v161
    v_cvt_pk_bf16_f32 v37, v162, v163
    v_cvt_pk_bf16_f32 v38, v164, v165
    v_cvt_pk_bf16_f32 v39, v166, v167
    s_cmp_eq_u32 s59, s54
    s_cbranch_scc1 L_skip4
    v_permlane16_swap_b32 v36, v38
    v_permlane16_swap_b32 v37, v39
    buffer_store_dwordx4 v[36:39], v3, s[40:43], s7 offen nt
L_skip4:
L_tb_end:
    s_endpgm
L_retry0:
    s_sleep 3
    s_add_u32 s65, s65, 1
    s_lshr_b32 s34, s65, 17
    s_cbranch_scc1 L_fail0
    buffer_load_dwordx4 v[32:35], v10, s[36:39], s32 offen offset:0 sc1
    buffer_load_dwordx4 v[36:39], v10, s[36:39], s32 offen offset:2048 sc1
    buffer_load_dwordx4 v[40:43], v10, s[36:39], s33 offen offset:0 sc1
    buffer_load_dwordx4 v[44:47], v10, s[36:39], s33 offen offset:2048 sc1
    s_waitcnt vmcnt(0)
    s_branch L_got0
L_retry1:
    s_sleep 3
    s_add_u32 s65, s65, 1
    s_lshr_b32 s34, s65, 17
    s_cbranch_scc1 L_fail1
    buffer_load_dwordx4 v[48:51], v10, s[36:39], s32 offen offset:256 sc1
    buffer_load_dwordx4 v[52:55], v10, s[36:39], s32 offen offset:2304 sc1
    buffer_load_dwordx4 v[56:59], v10, s[36:39], s33 offen offset:256 sc1
    buffer_load_dwordx4 v[60:63], v10, s[36:39], s33 offen offset:2304 sc1
    s_waitcnt vmcnt(0)
    s_branch L_got1
L_hi0:
    s_waitcnt vmcnt(0)
    s_barrier
L_hi1:
    s_mov_b64 exec, 0
    s_sub_u32 s53, s3, 8
L_tbback:
    s_add_u32 s53, s53, 4
    s_cmp_eq_u32 s53, 0
    s_cbranch_scc1 L_tb0
    s_cmp_eq_u32 s53, 1
    s_cbranch_scc1 L_tb1
    s_cmp_eq_u32 s53, 2
    s_cbranch_scc1 L_tb2
    s_cmp_eq_u32 s53, 3
    s_cbranch_scc1 L_tb3
    s_cmp_eq_u32 s53, 4
    s_cbranch_scc1 L_tb4
    s_cmp_eq_u32 s53, 5
    s_cbranch_scc1 L_tb5
    s_cmp_eq_u32 s53, 6
    s_cbranch_scc1 L_tb6
    s_cmp_eq_u32 s53, 7
    s_cbranch_scc1 L_tb7
    s_cmp_eq_u32 s53, 8
    s_cbranch_scc1 L_tb8
    s_cmp_eq_u32 s53, 9
    s_cbranch_scc1 L_tb9
    s_mov_b64 exec, -1
    s_cmp_lg_u32 s55, 0
    s_cbranch_scc1 L_z0b
    s_waitcnt vmcnt(2)
    v_dot2c_f32_bf16 v12, v16, v24
    v_dot2c_f32_bf16 v13, v20, v24
    v_dot2c_f32_bf16 v12, v17, v25
    v_dot2c_f32_bf16 v13, v21, v25
    v_dot2c_f32_bf16 v12, v18, v26
    v_dot2c_f32_bf16 v13, v22, v26
    v_dot2c_f32_bf16 v12, v19, v27
    v_dot2c_f32_bf16 v13, v23, v27
    s_nop 2
    v_permlane32_swap_b32 v12, v13
    v_add_f32 v12, v12, v13
    v_mov_b32 v13, v12
    s_nop 1
    v_permlane16_swap_b32 v12, v13
    v_add_f32 v12, v12, v13
    s_nop 1
    v_add_f32_dpp v12, v12, v12 row_ror:8 row_mask:0xf bank_mask:0xf
    s_nop 1
    v_add_f32_dpp v12, v12, v12 row_ror:4 row_mask:0xf bank_mask:0xf
    s_nop 1
    v_add_f32_dpp v12, v12, v12 row_ror:2 row_mask:0xf bank_mask:0xf
    s_nop 1
    v_add_f32_dpp v12, v12, v12 row_ror:1 row_mask:0xf bank_mask:0xf
    v_cvt_pk_bf16_f32 v12, v12, v12
    v_and_b32 v12, 0xffff0000, v12
    s_lshl_b32 s6, s3, 11
    v_add_u32 v6, s6, v5
    ds_write_b128 v6, v[16:19] offset:48832
    ds_write_b128 v6, v[20:23] offset:49856
    v_lshl_add_u32 v7, v1, 6, s6
    v_lshl_add_u32 v7, v2, 3, v7
    s_waitcnt lgkmcnt(0)
    ds_read_b64 v[16:17], v7 offset:48832
    ds_read_b64 v[18:19], v7 offset:48864
    ds_read_b64 v[20:21], v7 offset:49856
    ds_read_b64 v[22:23], v7 offset:49888
    v_and_b32 v6, 1, v2
    v_lshlrev_b32 v6, 5, v6
    v_lshl_add_u32 v6, v1, 6, v6
    v_lshrrev_b32 v7, 1, v2
    v_lshl_add_u32 v3, v7, 4, v6
    v_mul_f32 v13, 0xbfb8aa3b, v12
    v_exp_f32 v13, v13
    s_nop 0
    v_add_f32 v13, 1.0, v13
    v_rcp_f32 v13, v13
    s_nop 0
    v_cvt_pk_bf16_f32 v13, v13, v13
    v_and_b32 v13, 0xffff0000, v13
    v_sub_f32 v14, 1.0, v13
    v_cvt_pk_bf16_f32 v14, v14, v14
    v_and_b32 v14, 0xffff0000, v14
    v_readlane_b32 s6, v13, 0
    v_readlane_b32 s7, v13, 32
    v_readlane_b32 s8, v14, 0
    v_readlane_b32 s9, v14, 32
    s_xor_b32 s10, s6, 0x80000000
    s_cmp_eq_u32 s58, 0
    s_cselect_b32 s10, 0, s10
    s_cselect_b32 s11, 0, s7
    v_mov_b32 v24, s6
    v_mov_b32 v25, s10
    v_mov_b32 v26, s11
    v_mov_b32 v27, s7
    v_mov_b32 v13, s8
    v_mov_b32 v14, s9
    s_waitcnt lgkmcnt(0)
    v_lshlrev_b32 v152, 16, v16
    v_and_b32 v153, 0xffff0000, v16
    v_lshlrev_b32 v154, 16, v17
    v_and_b32 v155, 0xffff0000, v17
    v_lshlrev_b32 v156, 16, v18
    v_and_b32 v157, 0xffff0000, v18
    v_lshlrev_b32 v158, 16, v19
    v_and_b32 v159, 0xffff0000, v19
    v_mul_f32 v152, v13, v152
    v_mul_f32 v153, v13, v153
    v_mul_f32 v154, v13, v154
    v_mul_f32 v155, v13, v155
    v_mul_f32 v156, v13, v156
    v_mul_f32 v157, v13, v157
    v_mul_f32 v158, v13, v158
    v_mul_f32 v159, v13, v159
    v_lshlrev_b32 v160, 16, v20
    v_and_b32 v161, 0xffff0000, v20
    v_lshlrev_b32 v162, 16, v21
    v_and_b32 v163, 0xffff0000, v21
    v_lshlrev_b32 v164, 16, v22
    v_and_b32 v165, 0xffff0000, v22
    v_lshlrev_b32 v166, 16, v23
    v_and_b32 v167, 0xffff0000, v23
    v_mul_f32 v160, v14, v160
    v_mul_f32 v161, v14, v161
    v_mul_f32 v162, v14, v162
    v_mul_f32 v163, v14, v163
    v_mul_f32 v164, v14, v164
    v_mul_f32 v165, v14, v165
    v_mul_f32 v166, v14, v166
    v_mul_f32 v167, v14, v167
    s_mul_i32 s7, s3, 2176
    v_bfe_u32 v7, v1, 1, 2
    v_xor_b32 v7, v7, v2
    v_lshl_add_u32 v7, v7, 4, s7
    v_lshl_add_u32 v29, v1, 6, v7
    v_sub_u32 v6, 16, v1
    v_bfe_u32 v7, v6, 1, 2
    v_xor_b32 v7, v7, v2
    v_lshl_add_u32 v7, v7, 4, s7
    v_lshl_add_u32 v30, v6, 6, v7
    s_cmp_eq_u32 s58, 0
    s_cselect_b32 s6, 0, 2048
    v_add_u32 v4, s6, v5
    s_branch L_d2
L_ah:
    v_lshlrev_b32 v5, 4, v0
    v_mov_b32 v31, 0
    s_mov_b32 s64, 0x9E3779B1
    s_cmp_ge_u32 s7, 1
    s_waitcnt lgkmcnt(0)
    s_cbranch_scc1 L_nowpf
    global_load_dwordx4 v[32:35], v5, s[16:17]
    global_load_dword v30, v31, s[30:31]
    global_load_dwordx4 v[36:39], v5, s[24:25]
L_nowpf:
    v_lshlrev_b32 v14, 10, v0
    s_lshl_b32 s50, s2, 3
    s_add_u32 s50, s50, 65536
    s_mov_b32 s36, s30
    s_mov_b32 s37, s31
    s_mov_b32 s38, 0x1000000
    s_mov_b32 s39, 0x20000
    s_mov_b32 s65, 0
    v_lshlrev_b32 v6, 2, v2
    v_cvt_f32_u32 v7, v1
    v_cvt_f32_u32 v6, v6
    v_mul_f32 v7, 0x3d800000, v7
    v_mul_f32 v9, v6, v7
    v_cos_f32 v64, v9
    v_sin_f32 v68, v9
    v_add_f32 v9, v9, v7
    v_cos_f32 v65, v9
    v_sin_f32 v69, v9
    v_add_f32 v9, v9, v7
    v_cos_f32 v66, v9
    v_sin_f32 v70, v9
    v_add_f32 v9, v9, v7
    v_cos_f32 v67, v9
    v_sin_f32 v71, v9
    s_nop 0
    v_cvt_pk_bf16_f32 v40, v64, v68
    v_cvt_pk_bf16_f32 v48, -v68, v64
    v_cvt_pk_bf16_f32 v41, v65, v69
    v_cvt_pk_bf16_f32 v49, -v69, v65
    v_cvt_pk_bf16_f32 v42, v66, v70
    v_cvt_pk_bf16_f32 v50, -v70, v66
    v_cvt_pk_bf16_f32 v43, v67, v71
    v_cvt_pk_bf16_f32 v51, -v71, v67
    v_add_f32 v7, 0x3d800000, v7
    v_mul_f32 v9, v6, v7
    v_cos_f32 v64, v9
    v_sin_f32 v68, v9
    v_add_f32 v9, v9, v7
    v_cos_f32 v65, v9
    v_sin_f32 v69, v9
    v_add_f32 v9, v9, v7
    v_cos_f32 v66, v9
    v_sin_f32 v70, v9
    v_add_f32 v9, v9, v7
    v_cos_f32 v67, v9
    v_sin_f32 v71, v9
    s_nop 0
    v_cvt_pk_bf16_f32 v44, v64, -v68
    v_cvt_pk_bf16_f32 v52, -v68, -v64
    v_cvt_pk_bf16_f32 v45, v65, -v69
    v_cvt_pk_bf16_f32 v53, -v69, -v65
    v_cvt_pk_bf16_f32 v46, v66, -v70
    v_cvt_pk_bf16_f32 v54, -v70, -v66
    v_cvt_pk_bf16_f32 v47, v67, -v71
    v_cvt_pk_bf16_f32 v55, -v71, -v67
    ds_write_b128 v5, v[40:43] offset:42688
    ds_write_b128 v5, v[44:47] offset:43712
    ds_write_b128 v5, v[48:51] offset:44736
    ds_write_b128 v5, v[52:55] offset:45760
    global_load_dword v30, v31, s[30:31]
    v_mov_b32 v9, 33792
    s_waitcnt vmcnt(0)
    v_mul_lo_u32 v31, v30, s64
    v_add_u32 v31, 0x7F4A7C15, v31
    v_lshlrev_b32 v6, 1, v1
    v_lshrrev_b32 v6, v6, v31
    v_lshlrev_b32 v7, 15, v6
    v_and_b32 v6, 1, v6
    v_and_b32 v7, 0x10000, v7
    v_or_b32 v6, v6, v7
    v_lshlrev_b32 v7, 2, v1
    ds_write_b32 v7, v6 offset:33920
    s_waitcnt lgkmcnt(0)
    v_mov_b32 v9, 33792
    s_barrier
    ds_read_b128 v[40:43], v9 offset:0
    ds_read_b128 v[44:47], v9 offset:16
    ds_read_b128 v[48:51], v9 offset:32
    ds_read_b128 v[52:55], v9 offset:48
    s_mov_b64 exec, 0x3fffff
    s_waitcnt lgkmcnt(2)
    v_max3_u32 v6, v40, v41, v42
    v_max3_u32 v7, v43, v44, v45
    v_max3_u32 v6, v46, v47, v6
    s_waitcnt lgkmcnt(0)
    v_max3_u32 v7, v48, v49, v7
    v_max3_u32 v6, v50, v51, v6
    v_max3_u32 v7, v52, v53, v7
    v_max3_u32 v6, v54, v55, v6
    v_max_u32 v30, v6, v7
    buffer_store_dwordx2 v[30:31], v14, s[36:39], s50 offen sc1
    s_mov_b64 exec, -1
    s_and_b32 s61, s2, 0
    s_mul_i32 s61, s61, 3072
    s_add_u32 s61, s61, 84992
    s_add_u32 s62, s61, 2048
    s_waitcnt vmcnt(0)
    s_barrier
    s_sleep 10
    s_branch L_poll5_1
L_poll5:
    s_sleep 3
L_poll5_1:
    buffer_load_dwordx4 v[32:35], v5, s[36:39], s61 offen sc1
    s_add_u32 s61, s61, 1024
    s_min_u32 s61, s61, s62
    s_add_u32 s65, s65, 1
    s_lshr_b32 s34, s65, 17
    s_waitcnt vmcnt(0)
    s_cbranch_scc1 L_poll5_ok
    v_cmp_ne_u32 vcc, v31, v33
    v_cmp_ne_u32 s[12:13], v31, v35
    s_or_b64 vcc, vcc, s[12:13]
    s_cbranch_vccnz L_poll5
L_poll5_ok:
    v_max_u32 v32, v32, v34
    s_nop 1
    v_max_u32_dpp v32, v32, v32 row_ror:8 row_mask:0xf bank_mask:0xf
    s_nop 1
    v_max_u32_dpp v32, v32, v32 row_ror:4 row_mask:0xf bank_mask:0xf
    s_nop 1
    v_max_u32_dpp v32, v32, v32 row_ror:2 row_mask:0xf bank_mask:0xf
    s_nop 1
    v_max_u32_dpp v32, v32, v32 row_ror:1 row_mask:0xf bank_mask:0xf
    v_mov_b32 v33, v32
    s_nop 1
    v_permlane16_swap_b32 v32, v33
    v_max_u32 v32, v32, v33
    v_mov_b32 v33, v32
    s_nop 1
    v_permlane32_swap_b32 v32, v33
    v_max_u32 v32, v32, v33
    v_mov_b32 v9, 33856
    s_mov_b64 exec, 1
    ds_write_b32 v9, v32
    s_mov_b64 exec, -1
    s_waitcnt lgkmcnt(0)
    s_barrier
    s_endpgm
L_notA:
    s_lshl4_add_u32 s60, s6, s7
    s_sub_u32 s60, s60, 16
    s_cmp_ge_u32 s2, 256
    s_cbranch_scc1 L_end
    s_cmp_lt_u32 s6, 4
    s_cbranch_scc1 L_F
    s_mul_i32 s60, s6, 12
    s_add_u32 s60, s60, s7
    s_cmp_lt_u32 s7, 28
    s_cbranch_scc1 L_F
    s_mov_b32 s55, 1
    s_lshl2_add_u32 s47, s6, s7
    s_sub_u32 s47, s47, 44
    v_and_b32 v6, 1, v2
    v_lshlrev_b32 v6, 5, v6
    v_lshl_add_u32 v6, v1, 6, v6
    v_lshrrev_b32 v7, 1, v2
    v_lshl_add_u32 v3, v7, 4, v6
    v_lshlrev_b32 v5, 4, v0
    v_lshlrev_b32 v8, 31, v1
    v_lshrrev_b32 v9, 16, v8
    v_or_b32 v8, v8, v9
    s_waitcnt lgkmcnt(0)
    s_mov_b32 s36, s30
    s_mov_b32 s37, s31
    s_mov_b32 s38, 0x1000000
    s_mov_b32 s39, 0x20000
    s_mov_b32 s65, 0
    s_mov_b32 s40, s26
    s_mov_b32 s41, s27
    s_mov_b32 s42, 0x200000
    s_mov_b32 s43, 0x20000
    v_lshlrev_b32 v6, 4, v1
    v_lshl_add_u32 v10, v2, 13, v6
    v_mul_u32_u24 v6, 4352, v2
    v_bfe_u32 v7, v1, 1, 2
    v_xor_b32 v7, s3, v7
    v_lshl_add_u32 v7, v7, 4, v6
    v_lshl_add_u32 v11, v1, 6, v7
    s_lshl4_add_u32 s7, s3, 1024
    v_mov_b32 v9, 17600
    v_lshl_add_u32 v28, v0, 1, v9
    v_lshl_add_u32 v7, v1, 1, s7
    s_mov_b32 exec_lo, 0x00ff00ff
    s_mov_b32 exec_hi, 0x00ff00ff
    v_add_u32 v28, v7, v6
    s_mov_b64 exec, -1
    s_cmp_eq_u32 s3, 8
    s_cbranch_scc1 L_zh
    s_cmp_ge_u32 s3, 4
    s_cbranch_scc1 L_z0
    v_cvt_f32_u32 v6, v1
    s_lshl_b32 s6, s3, 2
    v_lshl_add_u32 v7, v2, 6, s6
    v_mul_f32 v6, 0x3b000000, v6
    v_cvt_f32_u32 v7, v7
    v_mul_f32 v15, 0x41800000, v6
    v_mul_f32 v7, v7, v6
    v_cos_f32 v64, v7
    v_sin_f32 v68, v7
    v_add_f32 v9, v7, v15
    v_cos_f32 v65, v9
    v_sin_f32 v69, v9
    v_add_f32 v9, v9, v15
    v_cos_f32 v66, v9
    v_sin_f32 v70, v9
    v_add_f32 v9, v9, v15
    v_cos_f32 v67, v9
    v_sin_f32 v71, v9
    v_mov_b32 v108, 0
    v_cvt_pk_bf16_f32 v100, v64, v65
    v_cvt_pk_bf16_f32 v104, -v68, -v69
    v_cvt_pk_bf16_f32 v101, v66, v67
    v_cvt_pk_bf16_f32 v105, -v70, -v71
    v_xor_b32 v102, v100, v8
    v_xor_b32 v106, v104, v8
    v_xor_b32 v103, v101, v8
    v_xor_b32 v107, v105, v8
    v_add_f32 v7, v7, v6
    v_cos_f32 v64, v7
    v_sin_f32 v68, v7
    v_add_f32 v9, v7, v15
    v_cos_f32 v65, v9
    v_sin_f32 v69, v9
    v_add_f32 v9, v9, v15
    v_cos_f32 v66, v9
    v_sin_f32 v70, v9
    v_add_f32 v9, v9, v15
    v_cos_f32 v67, v9
    v_sin_f32 v71, v9
    v_mov_b32 v120, 0
    v_cvt_pk_bf16_f32 v112, v64, v65
    v_cvt_pk_bf16_f32 v116, -v68, -v69
    v_cvt_pk_bf16_f32 v113, v66, v67
    v_cvt_pk_bf16_f32 v117, -v70, -v71
    v_xor_b32 v114, v112, v8
    v_xor_b32 v118, v116, v8
    v_xor_b32 v115, v113, v8
    v_xor_b32 v119, v117, v8
    v_add_f32 v7, v7, v6
    v_cos_f32 v64, v7
    v_sin_f32 v68, v7
    v_add_f32 v9, v7, v15
    v_cos_f32 v65, v9
    v_sin_f32 v69, v9
    v_add_f32 v9, v9, v15
    v_cos_f32 v66, v9
    v_sin_f32 v70, v9
    v_add_f32 v9, v9, v15
    v_cos_f32 v67, v9
    v_sin_f32 v71, v9
    v_mov_b32 v132, 0
    v_cvt_pk_bf16_f32 v124, v64, v65
    v_cvt_pk_bf16_f32 v128, -v68, -v69
    v_cvt_pk_bf16_f32 v125, v66, v67
    v_cvt_pk_bf16_f32 v129, -v70, -v71
    v_xor_b32 v126, v124, v8
    v_xor_b32 v130, v128, v8
    v_xor_b32 v127, v125, v8
    v_xor_b32 v131, v129, v8
    v_add_f32 v7, v7, v6
    v_cos_f32 v64, v7
    v_sin_f32 v68, v7
    v_add_f32 v9, v7, v15
    v_cos_f32 v65, v9
    v_sin_f32 v69, v9
    v_add_f32 v9, v9, v15
    v_cos_f32 v66, v9
    v_sin_f32 v70, v9
    v_add_f32 v9, v9, v15
    v_cos_f32 v67, v9
    v_sin_f32 v71, v9
    v_mov_b32 v144, 0
    v_cvt_pk_bf16_f32 v136, v64, v65
    v_cvt_pk_bf16_f32 v140, -v68, -v69
    v_cvt_pk_bf16_f32 v137, v66, v67
    v_cvt_pk_bf16_f32 v141, -v70, -v71
    v_xor_b32 v138, v136, v8
    v_xor_b32 v142, v140, v8
    v_xor_b32 v139, v137, v8
    v_xor_b32 v143, v141, v8
    v_lshrrev_b32 v6, 1, v1
    v_add_u32 v7, s6, v6
    v_and_b32 v9, 1, v1
    v_lshl_add_u32 v7, v9, 3, v7
    v_cvt_f32_u32 v7, v7
    v_mul_f32 v7, 0x3d000000, v7
    v_cos_f32 v7, v7
    s_mov_b32 exec_lo, 0x30003
    s_mov_b32 exec_hi, 0x30003
    v_cvt_pk_bf16_f32 v108, v7, -v7
    s_mov_b32 exec_lo, 0xc000c
    s_mov_b32 exec_hi, 0xc000c
    v_cvt_pk_bf16_f32 v120, v7, -v7
    s_mov_b32 exec_lo, 0x300030
    s_mov_b32 exec_hi, 0x300030
    v_cvt_pk_bf16_f32 v132, v7, -v7
    s_mov_b32 exec_lo, 0xc000c0
    s_mov_b32 exec_hi, 0xc000c0
    v_cvt_pk_bf16_f32 v144, v7, -v7
    s_mov_b64 exec, -1
    v_mov_b32 v109, v108
    v_mov_b32 v110, v108
    v_mov_b32 v111, v108
    v_mov_b32 v121, v120
    v_mov_b32 v122, v120
    v_mov_b32 v123, v120
    v_mov_b32 v133, v132
    v_mov_b32 v134, v132
    v_mov_b32 v135, v132
    v_mov_b32 v145, v144
    v_mov_b32 v146, v144
    v_mov_b32 v147, v144
    s_branch L_z1
L_z0:
    s_branch L_hi1
L_z0b:
    s_mov_b64 exec, 0
    s_sub_u32 s53, s3, 8
L_tzback:
    s_add_u32 s53, s53, 4
    s_cmp_eq_u32 s53, 0
    s_cbranch_scc1 L_tz0
    s_cmp_eq_u32 s53, 1
    s_cbranch_scc1 L_tz1
    s_cmp_eq_u32 s53, 2
    s_cbranch_scc1 L_tz2
    s_cmp_eq_u32 s53, 3
    s_cbranch_scc1 L_tz3
    s_cmp_eq_u32 s53, 4
    s_cbranch_scc1 L_tz4
    s_cmp_eq_u32 s53, 5
    s_cbranch_scc1 L_tz5
    s_cmp_eq_u32 s53, 6
    s_cbranch_scc1 L_tz6
    s_cmp_eq_u32 s53, 7
    s_cbranch_scc1 L_tz7
    s_mov_b64 exec, -1
L_z1:
    v_mov_b32 v9, 33792
    v_mov_b32 v12, 0
    v_mov_b32 v13, 0
    s_barrier
    ds_read_b64 v[30:31], v9
    ds_read_b128 v[24:27], v5 offset:47808
    s_waitcnt lgkmcnt(0)
    v_readfirstlane_b32 s44, v30
    s_andn2_b32 s54, 2047, s44
    s_and_b32 s6, s54, 127
    s_cmp_gt_u32 s6, 64
    s_cselect_b32 s46, 1, 0
    s_and_b32 s6, s54, 1087
    s_cmp_eq_u32 s6, 1024
    s_cselect_b32 s46, 1, s46
    s_sub_u32 s6, 2048, s54
    s_cmp_lg_u32 s46, 0
    s_cselect_b32 s6, s6, s54
    s_cmp_eq_u32 s6, 1024
    s_cselect_b32 s6, 0, s6
    s_and_b32 s56, s6, 127
    s_lshr_b32 s57, s6, 10
    s_bfe_u32 s45, s6, 0x30007
    s_lshl3_add_u32 s11, s57, s45
    s_lshl_b32 s11, s11, 7
    s_add_u32 s58, s11, s56
    s_sub_u32 s59, 2048, s58
    s_cmp_eq_u32 s58, 0
    s_cselect_b32 s59, 1024, s59
    s_lshl_b32 s10, s58, 10
    s_lshl_b32 s11, s59, 10
    v_add_u32 v6, s10, v5
    v_add_u32 v7, s11, v5
    s_cmp_ge_u32 s3, 4
    s_cbranch_scc1 L_z4
    v_lshrrev_b32 v6, 1, v1
    s_lshl_b32 s6, s57, 10
    s_add_u32 s6, s6, s56
    v_lshl_add_u32 v6, v6, 7, s6
    v_and_b32 v7, 1, v1
    v_lshlrev_b32 v9, 9, v7
    s_cmp_lg_u32 s56, 0
    s_cbranch_scc1 L_g06
    s_mov_b32 exec_lo, 0x00020002
    s_mov_b32 exec_hi, 0x00020002
    v_mov_b32 v6, 0x400
    v_mov_b32 v9, 0
    s_mov_b64 exec, -1
L_g06:
    v_lshlrev_b32 v7, 2, v2
    v_mad_u32_u24 v9, v7, v6, v9
    v_cvt_f32_u32 v6, v6
    v_cvt_f32_u32 v9, v9
    v_mul_f32 v6, 0x3a000000, v6
    v_mul_f32 v9, 0x3a000000, v9
    v_cos_f32 v64, v9
    v_sin_f32 v68, v9
    v_add_f32 v9, v9, v6
    v_cos_f32 v65, v9
    v_sin_f32 v69, v9
    v_add_f32 v9, v9, v6
    v_cos_f32 v66, v9
    v_sin_f32 v70, v9
    v_add_f32 v9, v9, v6
    v_cos_f32 v67, v9
    v_sin_f32 v71, v9
    s_and_b32 s7, s56, 63
    s_mul_i32 s32, s7, 33024
    v_cvt_pk_bf16_f32 v148, v64, v68
    v_cvt_pk_bf16_f32 v149, v65, v69
    v_cvt_pk_bf16_f32 v150, v66, v70
    v_cvt_pk_bf16_f32 v151, v67, v71
    s_cmp_lg_u32 s7, 0
    s_cbranch_scc1 L_gd7
    s_lshr_b32 s7, s56, 2
    v_and_b32 v148, 0xffff, v148
    v_lshlrev_b32 v148, s7, v148
    v_and_b32 v149, 0xffff, v149
    v_lshlrev_b32 v149, s7, v149
    v_and_b32 v150, 0xffff, v150
    v_lshlrev_b32 v150, s7, v150
    v_and_b32 v151, 0xffff, v151
    v_lshlrev_b32 v151, s7, v151
L_gd7:
    s_lshl_b32 s7, s3, 9
    s_add_u32 s32, s32, s7
    s_add_u32 s32, s32, 2097152
    s_add_u32 s33, s32, 4096
    v_and_b32 v6, 3, v1
    v_lshlrev_b32 v6, 4, v6
    ds_read_b128 v[96:99], v6 offset:33920
    s_waitcnt lgkmcnt(0)
    buffer_load_dwordx4 v[32:35], v10, s[36:39], s32 offen offset:0 sc1
    buffer_load_dwordx4 v[36:39], v10, s[36:39], s32 offen offset:2048 sc1
    buffer_load_dwordx4 v[40:43], v10, s[36:39], s33 offen offset:0 sc1
    buffer_load_dwordx4 v[44:47], v10, s[36:39], s33 offen offset:2048 sc1
    buffer_load_dwordx4 v[48:51], v10, s[36:39], s32 offen offset:256 sc1
    buffer_load_dwordx4 v[52:55], v10, s[36:39], s32 offen offset:2304 sc1
    buffer_load_dwordx4 v[56:59], v10, s[36:39], s33 offen offset:256 sc1
    buffer_load_dwordx4 v[60:63], v10, s[36:39], s33 offen offset:2304 sc1
    s_mul_i32 s7, s45, 2176
    v_bfe_u32 v7, v1, 1, 2
    v_xor_b32 v7, v7, v2
    v_lshl_add_u32 v7, v7, 4, s7
    v_lshl_add_u32 v29, v1, 6, v7
    v_sub_u32 v6, 16, v1
    v_bfe_u32 v7, v6, 1, 2
    v_xor_b32 v7, v7, v2
    v_lshl_add_u32 v7, v7, 4, s7
    v_lshl_add_u32 v30, v6, 6, v7
    s_cmp_eq_u32 s58, 0
    s_cselect_b32 s6, 0, 2048
    v_add_u32 v4, s6, v5
    v_lshlrev_b32 v6, 7, v1
    v_lshl_add_u32 v15, v2, 4, v6
    s_branch L_zjoin
L_z4:
    s_cmp_ge_u32 s3, 6
    s_cbranch_scc1 L_zend2
    global_load_dwordx4 v[16:19], v6, s[4:5]
    global_load_dwordx4 v[20:23], v7, s[4:5]
    s_sub_u32 s6, s3, 4
    s_lshl1_add_u32 s7, s47, s6
    s_lshl_b32 s7, s7, 5
    v_and_b32 v6, 7, v0
    v_lshl_add_u32 v10, v6, 2, s7
    s_lshl_b32 s8, s54, 10
    v_add_u32 v7, s8, v10
    global_load_dword v35, v7, s[4:5]
    v_lshlrev_b32 v10, 1, v10
    v_lshrrev_b32 v7, 3, v0
    v_lshlrev_b32 v7, 8, v7
    v_lshl_add_u32 v11, v6, 4, v7
    s_mul_i32 s48, s47, 14336
    s_lshl_b32 s6, s6, 7
    s_add_u32 s48, s48, s6
    s_add_u32 s48, s48, 720896
    s_add_u32 s49, s48, 229376
    s_and_b32 s6, s44, 0xffff0000
    s_xor_b32 s7, s6, 0x80000000
    s_xor_b32 s9, s6, 0xffff0000
    s_bitcmp1_b32 s6, 31
    s_cselect_b32 s6, s7, s9
    v_mov_b32 v15, s6
    v_mul_f32 v15, 0xbfb8aa3b, v15
    v_exp_f32 v15, v15
    s_nop 0
    v_add_f32 v15, 1.0, v15
    v_rcp_f32 v15, v15
    s_nop 0
    v_cvt_pk_bf16_f32 v15, v15, v15
    v_and_b32 v15, 0xffff0000, v15
    s_waitcnt vmcnt(0)
    v_dot2c_f32_bf16 v12, v16, v24
    v_dot2c_f32_bf16 v13, v20, v24
    v_dot2c_f32_bf16 v12, v17, v25
    v_dot2c_f32_bf16 v13, v21, v25
    v_dot2c_f32_bf16 v12, v18, v26
    v_dot2c_f32_bf16 v13, v22, v26
    v_dot2c_f32_bf16 v12, v19, v27
    v_dot2c_f32_bf16 v13, v23, v27
    s_nop 2
    v_permlane32_swap_b32 v12, v13
    v_add_f32 v12, v12, v13
    v_mov_b32 v13, v12
    s_nop 1
    v_permlane16_swap_b32 v12, v13
    v_add_f32 v12, v12, v13
    s_nop 1
    v_add_f32_dpp v12, v12, v12 row_ror:8 row_mask:0xf bank_mask:0xf
    s_nop 1
    v_add_f32_dpp v12, v12, v12 row_ror:4 row_mask:0xf bank_mask:0xf
    s_nop 1
    v_add_f32_dpp v12, v12, v12 row_ror:2 row_mask:0xf bank_mask:0xf
    s_nop 1
    v_add_f32_dpp v12, v12, v12 row_ror:1 row_mask:0xf bank_mask:0xf
    v_cvt_pk_bf16_f32 v12, v12, v12
    v_and_b32 v12, 0xffff0000, v12
    v_mul_f32 v13, 0xbfb8aa3b, v12
    v_exp_f32 v13, v13
    s_nop 0
    v_add_f32 v13, 1.0, v13
    v_rcp_f32 v13, v13
    s_nop 0
    v_cvt_pk_bf16_f32 v13, v13, v13
    v_and_b32 v13, 0xffff0000, v13
    v_sub_f32 v14, 1.0, v13
    v_cvt_pk_bf16_f32 v14, v14, v14
    v_and_b32 v14, 0xffff0000, v14
    v_readlane_b32 s6, v13, 0
    v_readlane_b32 s7, v13, 32
    v_readlane_b32 s8, v14, 0
    v_readlane_b32 s9, v14, 32
    s_xor_b32 s10, s6, 0x80000000
    s_cmp_eq_u32 s58, 0
    s_cselect_b32 s10, 0, s10
    s_cselect_b32 s11, 0, s7
    s_cmp_lg_u32 s46, 0
    s_cselect_b32 s8, s9, s8
    s_cselect_b32 s6, s11, s6
    s_cselect_b32 s10, s7, s10
    v_mov_b32 v36, s8
    v_mov_b32 v24, s6
    v_mov_b32 v25, s10
    v_lshlrev_b32 v34, 16, v35
    v_and_b32 v35, 0xffff0000, v35
    s_barrier
    s_sleep 10
    v_mov_b32 v9, 33864
L_tz_start:
L_zp:
    buffer_load_dwordx4 v[40:43], v11, s[36:39], s48 offen offset:0 sc1
    buffer_load_dwordx4 v[44:47], v11, s[36:39], s48 offen offset:2048 sc1
    s_add_u32 s6, s48, 4096
    buffer_load_dwordx4 v[48:51], v11, s[36:39], s6 offen offset:0 sc1
    buffer_load_dwordx4 v[52:55], v11, s[36:39], s6 offen offset:2048 sc1
    s_add_u32 s6, s48, 8192
    buffer_load_dwordx4 v[56:59], v11, s[36:39], s6 offen offset:0 sc1
    buffer_load_dwordx4 v[60:63], v11, s[36:39], s6 offen offset:2048 sc1
    s_add_u32 s6, s48, 12288
    buffer_load_dwordx4 v[64:67], v11, s[36:39], s6 offen offset:0 sc1
    s_add_u32 s48, s48, 229376
    s_min_u32 s48, s48, s49
    s_add_u32 s65, s65, 1
    s_lshr_b32 s34, s65, 17
L_tz0:
    s_cbranch_execz L_tzback
    s_cbranch_scc1 L_zp_ok
    s_waitcnt vmcnt(6)
    v_bitop3_b32 v37, v41, v43, v31 bitop3:0x7e
    s_waitcnt vmcnt(5)
    v_bitop3_b32 v39, v45, v47, v31 bitop3:0x7e
    v_add_f32 v40, v40, v44
    v_add_f32 v42, v42, v46
    s_waitcnt vmcnt(4)
    v_bitop3_b32 v38, v49, v51, v31 bitop3:0x7e
    v_add_f32 v40, v40, v48
    v_add_f32 v42, v42, v50
    v_or3_b32 v37, v37, v38, v39
    s_waitcnt vmcnt(3)
    v_bitop3_b32 v39, v53, v55, v31 bitop3:0x7e
    v_add_f32 v40, v40, v52
    v_add_f32 v42, v42, v54
    s_waitcnt vmcnt(2)
    v_bitop3_b32 v38, v57, v59, v31 bitop3:0x7e
    v_add_f32 v40, v40, v56
    v_add_f32 v42, v42, v58
    v_or3_b32 v37, v37, v38, v39
    s_waitcnt vmcnt(1)
    v_bitop3_b32 v39, v61, v63, v31 bitop3:0x7e
L_tz1:
    s_cbranch_execz L_tzback
    v_add_f32 v40, v40, v60
    v_add_f32 v42, v42, v62
    s_waitcnt vmcnt(0)
    v_bitop3_b32 v38, v65, v67, v31 bitop3:0x7e
    v_add_f32 v40, v40, v64
    v_add_f32 v42, v42, v66
    v_or3_b32 v37, v37, v38, v39
    v_cmp_ne_u32 vcc, 0, v37
    s_nop 0
    s_cbranch_vccnz L_zp
L_zp_ok:
    ds_read_b32 v12, v9
    ds_read_b64 v[32:33], v10 offset:38592
    ds_read_b64 v[16:17], v10 offset:40640
    v_lshrrev_b32 v11, 1, v10
    s_lshl_b32 s8, s54, 10
    s_waitcnt vmcnt(0)
    v_add_f32_dpp v40, v40, v40 row_ror:8 row_mask:0xf bank_mask:0xf
    v_add_f32_dpp v42, v42, v42 row_ror:8 row_mask:0xf bank_mask:0xf
    s_nop 0
    s_nop 0
    v_permlane16_swap_b32 v40, v42
    v_add_f32 v40, v40, v42
    v_mov_b32 v42, v40
    s_nop 1
L_tz2:
    s_cbranch_execz L_tzback
    v_permlane32_swap_b32 v40, v42
    v_add_f32 v40, v40, v42
    v_mov_b32 v42, v40
    s_nop 1
    v_permlane16_swap_b32 v40, v42
    v_cvt_pk_bf16_f32 v41, v40, v42
    v_lshlrev_b32 v40, 16, v41
    v_and_b32 v42, 0xffff0000, v41
    v_mul_f32 v40, v40, v15
    v_mul_f32 v42, v42, v15
    v_cvt_pk_bf16_f32 v41, v40, v42
    v_lshlrev_b32 v40, 16, v41
    v_and_b32 v42, 0xffff0000, v41
    v_add_f32 v40, v40, v34
    v_add_f32 v42, v42, v35
    v_cvt_pk_bf16_f32 v41, v40, v42
    v_lshlrev_b32 v40, 16, v41
    v_and_b32 v42, 0xffff0000, v41
L_zw:
    s_waitcnt lgkmcnt(0)
    v_cmp_eq_u32 vcc, 0, v12
    v_mul_f32 v32, v24, v32
    v_mul_f32 v33, v24, v33
    s_cbranch_vccz L_zw_ok
    s_add_u32 s65, s65, 1
    s_lshr_b32 s34, s65, 17
L_tz3:
    s_cbranch_execz L_tzback
    s_cbranch_scc1 L_zw_ok
    ds_read_b32 v12, v9
    ds_read_b64 v[32:33], v10 offset:38592
    ds_read_b64 v[16:17], v10 offset:40640
    s_branch L_zw
L_zw_ok:
    v_fmac_f32 v32, v25, v16
    v_fmac_f32 v33, v25, v17
    v_fmac_f32 v32, v40, v36
    v_fmac_f32 v33, v42, v36
    v_cvt_pk_bf16_f32 v32, v32, v33
    s_mov_b64 exec, 0xff
    buffer_store_dword v32, v11, s[40:43], s8 offen
    s_mov_b64 exec, -1
    s_barrier
    s_endpgm
L_zfin:
    s_cmp_lg_u32 s3, 0
    s_cbranch_scc1 L_zend
    s_waitcnt lgkmcnt(3)
    v_mfma_f32_16x16x32_bf16 v[48:51], v[32:35], v[64:67], 0
    s_waitcnt lgkmcnt(2)
    v_mfma_f32_16x16x32_bf16 v[52:55], v[36:39], v[68:71], 0
    s_waitcnt lgkmcnt(1)
    v_mfma_f32_16x16x32_bf16 v[56:59], v[40:43], v[72:75], 0
L_tz4:
    s_cbranch_execz L_tzback
    s_waitcnt lgkmcnt(0)
    v_mfma_f32_16x16x32_bf16 v[60:63], v[44:47], v[76:79], 0
    s_nop 2
    ds_write_b128 v15, v[48:51] offset:38592
    ds_write_b128 v15, v[52:55] offset:38656
    s_nop 1
    ds_write_b128 v15, v[56:59] offset:40640
    ds_write_b128 v15, v[60:63] offset:40704
    v_mov_b32 v9, 33864
    s_waitcnt lgkmcnt(0)
    ds_write_b32 v9, v9
    s_waitcnt lgkmcnt(0)
.set L_tz5, L_tzback
.set L_tz6, L_tzback
.set L_tz7, L_tzback
L_zend:
    s_endpgm
L_zend2:
    s_endpgm
L_zh:
    v_mov_b32 v9, 33864
    v_mov_b32 v6, 0
    ds_write_b32 v9, v6
    v_lshlrev_b32 v6, 2, v2
    v_cvt_f32_u32 v7, v1
    v_cvt_f32_u32 v6, v6
    v_mul_f32 v7, 0x3d800000, v7
    v_mul_f32 v9, v6, v7
    v_cos_f32 v64, v9
    v_sin_f32 v68, v9
    v_add_f32 v9, v9, v7
    v_cos_f32 v65, v9
    v_sin_f32 v69, v9
    v_add_f32 v9, v9, v7
    v_cos_f32 v66, v9
    v_sin_f32 v70, v9
    v_add_f32 v9, v9, v7
    v_cos_f32 v67, v9
    v_sin_f32 v71, v9
    s_nop 0
    v_cvt_pk_bf16_f32 v40, v64, v68
    v_cvt_pk_bf16_f32 v48, -v68, v64
    v_cvt_pk_bf16_f32 v41, v65, v69
    v_cvt_pk_bf16_f32 v49, -v69, v65
    v_cvt_pk_bf16_f32 v42, v66, v70
    v_cvt_pk_bf16_f32 v50, -v70, v66
    v_cvt_pk_bf16_f32 v43, v67, v71
    v_cvt_pk_bf16_f32 v51, -v71, v67
    v_add_f32 v7, 0x3d800000, v7
    v_mul_f32 v9, v6, v7
    v_cos_f32 v64, v9
    v_sin_f32 v68, v9
    v_add_f32 v9, v9, v7
    v_cos_f32 v65, v9
    v_sin_f32 v69, v9
    v_add_f32 v9, v9, v7
    v_cos_f32 v66, v9
    v_sin_f32 v70, v9
    v_add_f32 v9, v9, v7
    v_cos_f32 v67, v9
    v_sin_f32 v71, v9
    s_nop 0
    v_cvt_pk_bf16_f32 v44, v64, -v68
    v_cvt_pk_bf16_f32 v52, -v68, -v64
    v_cvt_pk_bf16_f32 v45, v65, -v69
    v_cvt_pk_bf16_f32 v53, -v69, -v65
    v_cvt_pk_bf16_f32 v46, v66, -v70
    v_cvt_pk_bf16_f32 v54, -v70, -v66
    v_cvt_pk_bf16_f32 v47, v67, -v71
    v_cvt_pk_bf16_f32 v55, -v71, -v67
    ds_write_b128 v5, v[40:43] offset:42688
    ds_write_b128 v5, v[44:47] offset:43712
    ds_write_b128 v5, v[48:51] offset:44736
    ds_write_b128 v5, v[52:55] offset:45760
    s_mov_b32 m0, 47808
    v_mov_b32 v31, 0
    global_load_dword v30, v31, s[30:31]
    s_mov_b32 s64, 0x9E3779B1
    global_load_lds_dwordx4 v5, s[24:25]
    s_waitcnt vmcnt(0)
    v_mul_lo_u32 v31, v30, s64
    v_add_u32 v31, 0x7F4A7C15, v31
    v_lshlrev_b32 v6, 1, v1
    v_lshrrev_b32 v6, v6, v31
    v_lshlrev_b32 v7, 15, v6
    v_and_b32 v6, 1, v6
    v_and_b32 v7, 0x10000, v7
    v_or_b32 v6, v6, v7
    v_lshlrev_b32 v7, 2, v1
    ds_write_b32 v7, v6 offset:33920
    s_waitcnt lgkmcnt(0)
    s_and_b32 s61, s2, 0
    s_mul_i32 s61, s61, 3072
    s_add_u32 s61, s61, 81920
    s_add_u32 s62, s61, 2048
    s_sleep 30
    s_branch L_poll8_1
L_poll8:
    s_sleep 8
L_poll8_1:
    buffer_load_dwordx4 v[32:35], v5, s[36:39], s61 offen sc1
    s_add_u32 s61, s61, 1024
    s_min_u32 s61, s61, s62
    s_add_u32 s65, s65, 1
    s_lshr_b32 s34, s65, 17
    s_waitcnt vmcnt(0)
    s_cbranch_scc1 L_poll8_ok
    v_cmp_ne_u32 vcc, v31, v33
    v_cmp_ne_u32 s[12:13], v31, v35
    s_or_b64 vcc, vcc, s[12:13]
    s_cbranch_vccnz L_poll8
L_poll8_ok:
    v_max_u32 v32, v32, v34
    s_nop 1
    v_max_u32_dpp v32, v32, v32 row_ror:8 row_mask:0xf bank_mask:0xf
    s_nop 1
    v_max_u32_dpp v32, v32, v32 row_ror:4 row_mask:0xf bank_mask:0xf
    s_nop 1
    v_max_u32_dpp v32, v32, v32 row_ror:2 row_mask:0xf bank_mask:0xf
    s_nop 1
    v_max_u32_dpp v32, v32, v32 row_ror:1 row_mask:0xf bank_mask:0xf
    v_mov_b32 v33, v32
    s_nop 1
    v_permlane16_swap_b32 v32, v33
    v_max_u32 v32, v32, v33
    v_mov_b32 v33, v32
    s_nop 1
    v_permlane32_swap_b32 v32, v33
    v_max_u32 v32, v32, v33
    v_mov_b32 v9, 33792
    s_mov_b64 exec, 1
    ds_write2_b32 v9, v32, v31 offset1:1
    s_mov_b64 exec, -1
    s_waitcnt lgkmcnt(0)
    s_barrier
    s_lshl_b32 s6, s47, 2
    s_add_u32 s6, s6, 4096
    s_mov_b64 exec, 1
    buffer_store_dword v31, v0, s[36:39], s6 offen sc1
    s_mov_b64 exec, -1
    s_cmp_lg_u32 s47, 0
    s_cbranch_scc1 L_zend
    s_mov_b64 exec, 0xffff
    v_lshlrev_b32 v6, 2, v0
    s_mov_b32 s6, 4096
    s_barrier
L_za:
    buffer_load_dword v7, v6, s[36:39], s6 offen sc1
    s_add_u32 s65, s65, 1
    s_lshr_b32 s34, s65, 17
    s_waitcnt vmcnt(0)
    s_cbranch_scc1 L_za_ok
    v_cmp_ne_u32 vcc, v31, v7
    s_nop 0
    s_cbranch_vccnz L_za
L_za_ok:
    s_mov_b64 exec, 1
    v_add_u32 v9, 1, v30
    s_barrier
    buffer_store_dword v9, v6, s[36:39], 0 offen sc1
    s_mov_b64 exec, -1
    s_branch L_zend
L_F:
    v_lshlrev_b32 v5, 4, v0
    s_cmp_eq_u32 s3, 8
    s_cbranch_scc1 L_fh
    s_and_b32 s6, s60, 3
    s_lshr_b32 s7, s3, 1
    s_lshl2_add_u32 s32, s6, s7
    s_mul_i32 s8, s32, 114688
    s_lshr_b32 s33, s60, 2
    s_lshl_b32 s9, s33, 7
    s_add_u32 s8, s8, s9
    v_lshrrev_b32 v6, 3, v0
    v_mul_u32_u24 v6, 3584, v6
    v_and_b32 v7, 7, v0
    v_bfe_u32 v8, v0, 4, 1
    v_lshlrev_b32 v8, 2, v8
    v_xor_b32 v4, v7, v8
    v_lshl_add_u32 v7, v4, 4, s8
    v_add_u32 v3, v6, v7
    s_lshl_b32 s10, s3, 12
    s_mov_b32 m0, s10
    s_bitcmp1_b32 s3, 0
    s_waitcnt lgkmcnt(0)
    s_cselect_b32 s18, s20, s18
    s_cselect_b32 s19, s21, s19
    global_load_lds_dwordx4 v3, s[18:19]
    s_add_u32 m0, s10, 1024
    v_add_u32 v3, 28672, v3
    global_load_lds_dwordx4 v3, s[18:19]
    s_add_u32 m0, s10, 2048
    v_add_u32 v3, 28672, v3
    global_load_lds_dwordx4 v3, s[18:19]
    s_add_u32 m0, s10, 3072
    v_add_u32 v3, 28672, v3
    global_load_lds_dwordx4 v3, s[18:19]
    s_mov_b32 s36, s30
    s_mov_b32 s37, s31
    s_mov_b32 s38, 0x1000000
    s_mov_b32 s39, 0x20000
    s_mov_b32 s65, 0
    v_bfe_u32 v6, v0, 2, 2
    v_and_b32 v7, 3, v0
    v_lshlrev_b32 v8, 3, v7
    v_lshl_add_u32 v8, v2, 5, v8
    v_and_b32 v9, 2, v6
    v_lshlrev_b32 v9, 5, v9
    v_xor_b32 v9, v9, v8
    v_lshl_add_u32 v9, v6, 7, v9
    v_add_u32 v9, s10, v9
    s_lshl_b32 s11, s3, 8
    v_lshlrev_b32 v11, 2, v0
    v_add_u32 v11, 49152, v11
    v_add_u32 v12, s11, v11
    s_lshl1_add_u32 s7, s33, s7
    s_lshl_b32 s8, s7, 15
    s_and_b32 s9, s3, 1
    s_lshl1_add_u32 s9, s6, s9
    s_lshl_b32 s11, s9, 7
    s_add_u32 s8, s8, s11
    v_lshrrev_b32 v6, 3, v0
    v_lshl_add_u32 v6, v6, 10, s8
    v_lshl_add_u32 v4, v4, 4, v6
    v_lshrrev_b32 v6, 5, v0
    v_mul_u32_u24 v13, 14336, v6
    v_and_b32 v6, 31, v0
    v_lshl_add_u32 v13, v6, 3, v13
    s_mul_i32 s8, s9, 28672
    s_lshl_b32 s7, s7, 8
    s_add_u32 s8, s8, s7
    s_add_u32 s8, s8, 720896
    s_lshl_b32 s32, s32, 6
    s_lshl_b32 s33, s33, 12
    s_add_u32 s61, s33, 196608
    s_add_u32 s62, s61, 114688
    s_lshl_b32 s7, s6, 10
    s_add_u32 s33, s61, s7
    v_mov_b32 v14, 51200
    s_lshr_b32 s7, s3, 1
    s_lshl_b32 s7, s7, 9
    v_lshl_add_u32 v15, v6, 4, s7
    v_lshrrev_b32 v6, 5, v0
    v_lshl_add_u32 v15, v6, 10, v15
    v_mov_b32 v16, 0
    v_mov_b32 v17, 0
    v_mov_b32 v24, 0
    v_mov_b32 v25, 0
    s_waitcnt vmcnt(0)
    s_cmp_ge_u32 s3, 4
    s_cbranch_scc1 L_nowd9
    s_add_u32 m0, s10, 32768
    s_nop 0
    global_load_lds_dwordx4 v4, s[22:23]
    s_add_u32 m0, s10, 33792
    v_add_u32 v4, 0x2000, v4
    global_load_lds_dwordx4 v4, s[22:23]
    s_add_u32 m0, s10, 34816
    v_add_u32 v4, 0x2000, v4
    global_load_lds_dwordx4 v4, s[22:23]
    s_add_u32 m0, s10, 35840
    v_add_u32 v4, 0x2000, v4
    global_load_lds_dwordx4 v4, s[22:23]
L_nowd9:
    ds_read_b64_tr_b16 v[32:33], v9 offset:0
    ds_read_b64_tr_b16 v[34:35], v9 offset:512
    ds_read_b64_tr_b16 v[36:37], v9 offset:1024
    ds_read_b64_tr_b16 v[38:39], v9 offset:1536
    ds_read_b64_tr_b16 v[40:41], v9 offset:2048
    ds_read_b64_tr_b16 v[42:43], v9 offset:2560
    ds_read_b64_tr_b16 v[44:45], v9 offset:3072
    ds_read_b64_tr_b16 v[46:47], v9 offset:3584
    s_mov_b64 exec, 0
    s_sub_u32 s53, s3, 8
L_tfback:
    s_add_u32 s53, s53, 8
    s_cmp_eq_u32 s53, 0
    s_cbranch_scc1 L_tf0
    s_cmp_eq_u32 s53, 1
    s_cbranch_scc1 L_tf1
    s_cmp_eq_u32 s53, 2
    s_cbranch_scc1 L_tf2
    s_cmp_eq_u32 s53, 3
    s_cbranch_scc1 L_tf3
    s_cmp_eq_u32 s53, 4
    s_cbranch_scc1 L_tf4
    s_cmp_eq_u32 s53, 5
    s_cbranch_scc1 L_tf5
    s_cmp_eq_u32 s53, 6
    s_cbranch_scc1 L_tf6
    s_cmp_eq_u32 s53, 7
    s_cbranch_scc1 L_tf7
    s_mov_b64 exec, -1
    s_waitcnt lgkmcnt(0)
    s_barrier
L_tf_start:
    ds_read_b64 v[30:31], v14
    s_waitcnt lgkmcnt(0)
    v_readfirstlane_b32 s6, v30
    s_andn2_b32 s6, 2047, s6
    s_lshl_b32 s6, s6, 10
    s_add_u32 s6, s6, s32
    s_load_dwordx16 s[44:59], s[4:5], s6
    v_mov_b32 v29, v31
    s_waitcnt vmcnt(0)
    ds_read_b64_tr_b16 v[48:49], v9 offset:32768
    ds_read_b64_tr_b16 v[50:51], v9 offset:33280
    ds_read_b64_tr_b16 v[52:53], v9 offset:33792
    ds_read_b64_tr_b16 v[54:55], v9 offset:34304
    ds_read_b64_tr_b16 v[56:57], v9 offset:34816
    ds_read_b64_tr_b16 v[58:59], v9 offset:35328
    ds_read_b64_tr_b16 v[60:61], v9 offset:35840
L_tf0:
    s_cbranch_execz L_tfback
    ds_read_b64_tr_b16 v[62:63], v9 offset:36352
    s_waitcnt lgkmcnt(0)
    v_dot2c_f32_bf16 v16, s44, v32
    v_dot2c_f32_bf16 v17, s45, v33
    v_dot2c_f32_bf16 v16, s46, v34
    v_dot2c_f32_bf16 v17, s47, v35
    v_dot2c_f32_bf16 v16, s48, v36
    v_dot2c_f32_bf16 v17, s49, v37
    v_dot2c_f32_bf16 v16, s50, v38
    v_dot2c_f32_bf16 v17, s51, v39
    v_dot2c_f32_bf16 v16, s52, v40
    v_dot2c_f32_bf16 v17, s53, v41
    v_dot2c_f32_bf16 v16, s54, v42
    v_dot2c_f32_bf16 v17, s55, v43
    v_dot2c_f32_bf16 v16, s56, v44
    v_dot2c_f32_bf16 v17, s57, v45
    v_dot2c_f32_bf16 v16, s58, v46
    v_dot2c_f32_bf16 v17, s59, v47
    s_nop 2
    v_add_f32 v16, v16, v17
    ds_write_b32 v12, v16
    s_waitcnt lgkmcnt(0)
    s_barrier
    s_lshl_b32 s6, s3, 4
    s_lshl_b64 s[12:13], 0xffff, s6
    ds_read2st64_b32 v[16:17], v11 offset0:0 offset1:2
    ds_read2st64_b32 v[18:19], v11 offset0:4 offset1:6
L_tf1:
    s_cbranch_execz L_tfback
    ds_read2st64_b32 v[20:21], v11 offset0:1 offset1:3
    ds_read2st64_b32 v[22:23], v11 offset0:5 offset1:7
    s_waitcnt lgkmcnt(2)
    v_add_f32 v16, v16, v17
    v_add_f32 v18, v18, v19
    s_waitcnt lgkmcnt(0)
    v_add_f32 v20, v20, v21
    v_add_f32 v22, v22, v23
    v_add_f32 v28, v16, v18
    s_mov_b64 exec, s[12:13]
    v_add_f32 v30, v20, v22
    s_cmp_ge_u32 s3, 4
    s_cbranch_scc1 L_f5
    buffer_store_dwordx4 v[28:31], v5, s[36:39], s33 offen
    s_mov_b64 exec, -1
    s_sleep 3
L_fx:
    buffer_load_dwordx4 v[64:67], v15, s[36:39], s61 offen offset:0 sc1
    buffer_load_dwordx4 v[68:71], v15, s[36:39], s61 offen offset:2048 sc1
    s_cmp_ge_u32 s65, 4
    s_cselect_b32 s6, 114688, 0
    s_add_u32 s61, s61, s6
    s_min_u32 s61, s61, s62
    s_add_u32 s65, s65, 1
    s_lshr_b32 s34, s65, 17
L_tf2:
    s_cbranch_execz L_tfback
    s_cbranch_scc1 L_fx_ok
    s_waitcnt vmcnt(1)
    v_bitop3_b32 v20, v65, v67, v31 bitop3:0x7e
    s_waitcnt vmcnt(0)
    v_add_f32 v16, v64, v68
    v_add_f32 v18, v66, v70
    v_bitop3_b32 v21, v69, v71, v31 bitop3:0x7e
    v_or_b32 v20, v20, v21
    v_cmp_ne_u32 vcc, 0, v20
    v_permlane32_swap_b32 v16, v18
    s_cbranch_vccnz L_fx
L_fx_ok:
    v_add_f32 v16, v16, v18
    v_cvt_pk_bf16_f32 v16, v16, v16
    v_and_b32 v16, 0xffff0000, v16
    v_mov_b32 v18, v16
    v_mul_f32 v17, 0xbfb8aa3b, v16
    v_exp_f32 v17, v17
    s_nop 0
    v_add_f32 v17, 1.0, v17
    v_rcp_f32 v17, v17
    s_nop 0
    v_permlane32_swap_b32 v16, v18
    v_mul_f32 v17, v17, v16
    v_cvt_pk_bf16_f32 v17, v17, v17
    v_and_b32 v17, 0xffff0000, v17
L_tf3:
    s_cbranch_execz L_tfback
    v_mul_f32 v17, v17, v18
    s_nop 1
    v_mov_b32_dpp v18, v17 quad_perm:[1,0,3,2] row_mask:0xf bank_mask:0xf
    v_cvt_pk_bf16_f32 v17, v17, v18
    s_nop 0
    v_readlane_b32 s44, v17, 0
    v_readlane_b32 s45, v17, 2
    v_readlane_b32 s46, v17, 4
    v_readlane_b32 s47, v17, 6
    v_readlane_b32 s48, v17, 8
    v_readlane_b32 s49, v17, 10
    v_readlane_b32 s50, v17, 12
    v_readlane_b32 s51, v17, 14
    v_readlane_b32 s52, v17, 16
    v_readlane_b32 s53, v17, 18
    v_readlane_b32 s54, v17, 20
    v_readlane_b32 s55, v17, 22
L_tf4:
    s_cbranch_execz L_tfback
    v_readlane_b32 s56, v17, 24
    v_readlane_b32 s57, v17, 26
    v_readlane_b32 s58, v17, 28
    v_readlane_b32 s59, v17, 30
    v_dot2c_f32_bf16 v24, s44, v48
    v_dot2c_f32_bf16 v25, s45, v49
    v_dot2c_f32_bf16 v24, s46, v50
    v_dot2c_f32_bf16 v25, s47, v51
    v_dot2c_f32_bf16 v24, s48, v52
    v_dot2c_f32_bf16 v25, s49, v53
    v_dot2c_f32_bf16 v24, s50, v54
    v_dot2c_f32_bf16 v25, s51, v55
    v_dot2c_f32_bf16 v24, s52, v56
    v_dot2c_f32_bf16 v25, s53, v57
    v_dot2c_f32_bf16 v24, s54, v58
    v_dot2c_f32_bf16 v25, s55, v59
    v_dot2c_f32_bf16 v24, s56, v60
    v_dot2c_f32_bf16 v25, s57, v61
    v_dot2c_f32_bf16 v24, s58, v62
    v_dot2c_f32_bf16 v25, s59, v63
    s_nop 2
    v_add_f32 v30, v24, v25
    buffer_store_dwordx2 v[30:31], v13, s[36:39], s8 offen sc1
    s_add_u32 s8, s8, 229376
L_tf5:
    s_cbranch_execz L_tfback
    buffer_store_dwordx2 v[30:31], v13, s[36:39], s8 offen sc1
.set L_tf6, L_tfback
.set L_tf7, L_tfback
L_fend:
    s_endpgm
L_f5:
    s_add_u32 s33, s33, 114688
    buffer_store_dwordx4 v[28:31], v5, s[36:39], s33 offen sc1
    s_mov_b64 exec, -1
    s_endpgm
L_fh:
    s_waitcnt lgkmcnt(0)
    v_mov_b32 v31, 0
    global_load_dword v30, v31, s[30:31]
    s_mov_b32 s64, 0x9E3779B1
    s_mov_b32 s36, s30
    s_mov_b32 s37, s31
    s_mov_b32 s38, 0x1000000
    s_mov_b32 s39, 0x20000
    s_mov_b32 s65, 0
    s_and_b32 s61, s2, 7
    s_mul_i32 s61, s61, 2048
    s_add_u32 s61, s61, 65536
    s_add_u32 s62, s61, 1024
    s_sleep 40
    s_waitcnt vmcnt(0)
    v_mul_lo_u32 v31, v30, s64
    v_add_u32 v31, 0x7F4A7C15, v31
    s_branch L_poll10_1
L_poll10:
    s_sleep 3
L_poll10_1:
    buffer_load_dwordx4 v[20:23], v5, s[36:39], s61 offen sc1
    s_add_u32 s61, s61, 1024
    s_min_u32 s61, s61, s62
    s_add_u32 s65, s65, 1
    s_lshr_b32 s34, s65, 17
    s_waitcnt vmcnt(0)
    s_cbranch_scc1 L_poll10_ok
    v_cmp_ne_u32 vcc, v31, v21
    v_cmp_ne_u32 s[12:13], v31, v23
    s_or_b64 vcc, vcc, s[12:13]
    s_cbranch_vccnz L_poll10
L_poll10_ok:
    v_max_u32 v20, v20, v22
    s_nop 1
    v_max_u32_dpp v20, v20, v20 row_ror:8 row_mask:0xf bank_mask:0xf
    s_nop 1
    v_max_u32_dpp v20, v20, v20 row_ror:4 row_mask:0xf bank_mask:0xf
    s_nop 1
    v_max_u32_dpp v20, v20, v20 row_ror:2 row_mask:0xf bank_mask:0xf
    s_nop 1
    v_max_u32_dpp v20, v20, v20 row_ror:1 row_mask:0xf bank_mask:0xf
    v_mov_b32 v21, v20
    s_nop 1
    v_permlane16_swap_b32 v20, v21
    v_max_u32 v20, v20, v21
    v_mov_b32 v21, v20
    s_nop 1
    v_permlane32_swap_b32 v20, v21
    v_max_u32 v20, v20, v21
    v_mov_b32 v9, 51200
    s_mov_b64 exec, 1
    ds_write2_b32 v9, v20, v31 offset1:1
    s_mov_b64 exec, -1
    s_waitcnt lgkmcnt(0)
    s_barrier
    s_endpgm
L_end:
    s_endpgm
.section .rodata,"a"
.p2align 6
.amdhsa_kernel gated_mix__spectral_fnet__moe_arch_mod__prompt_kernel
  .amdhsa_next_free_vgpr 168
  .amdhsa_next_free_sgpr 102
  .amdhsa_accum_offset 168
  .amdhsa_group_segment_fixed_size 0
  .amdhsa_kernarg_size 112
  .amdhsa_user_sgpr_count 2
  .amdhsa_user_sgpr_kernarg_segment_ptr 1
  .amdhsa_system_sgpr_workgroup_id_x 1
.end_amdhsa_kernel
```

```asm
; @launch grid=(256,1,1) block=(576,1,1) lds=86016
.amdgcn_target "amdgcn-amd-amdhsa--gfx950"
.text
.globl gated_mix__spectral_fnet__moe_arch_mod__prompt_kernel
.p2align 8
.type gated_mix__spectral_fnet__moe_arch_mod__prompt_kernel,@function
gated_mix__spectral_fnet__moe_arch_mod__prompt_kernel:
    s_load_dwordx2 s[4:5], s[0:1], 0
    s_load_dwordx16 s[16:31], s[0:1], 48
    v_lshrrev_b32 v1, 6, v0
    v_and_b32 v0, 63, v0
    v_readfirstlane_b32 s3, v1
    v_and_b32 v1, 15, v0
    v_lshrrev_b32 v2, 4, v0
    s_and_b32 s6, s2, 7
    s_sub_u32 s3, s3, 1
    s_min_u32 s3, s3, 8
    s_lshr_b32 s7, s2, 3
    s_cmp_ge_u32 s2, 128
    s_cbranch_scc1 L_notA
    s_add_u32 s8, s6, 1
    s_sub_u32 s9, 15, s6
    s_cmp_eq_u32 s3, 8
    s_cbranch_scc1 L_ah
    s_and_b32 s57, s7, 1
    s_bitcmp1_b32 s7, 1
    s_cselect_b32 s10, s9, s8
    s_lshr_b32 s11, s7, 2
    s_lshl4_add_u32 s56, s11, s10
    v_lshlrev_b32 v5, 4, v0
    v_mov_b32 v3, 0
    s_cmp_lg_u32 s6, 7
    s_cbranch_scc1 L_k7
    s_lshr_b32 s11, s7, 1
    s_lshl3_add_u32 s56, s11, 8
    s_mov_b32 s8, 0
    s_cmp_eq_u32 s2, 127
    s_cselect_b32 s56, 0, s56
    s_cselect_b32 s57, 0, s57
L_k7:
    s_lshl3_add_u32 s11, s57, s3
    s_lshl_b32 s11, s11, 7
    s_add_u32 s58, s11, s56
    s_sub_u32 s59, 2048, s58
    s_cmp_eq_u32 s58, 0
    s_cselect_b32 s59, 1024, s59
    s_lshl_b32 s10, s58, 10
    s_lshl_b32 s11, s59, 10
    v_add_u32 v6, s10, v5
    v_add_u32 v7, s11, v5
    s_waitcnt lgkmcnt(0)
    global_load_dwordx4 v[16:19], v6, s[4:5]
    global_load_dwordx4 v[20:23], v7, s[4:5]
    s_barrier
    s_bitcmp1_b32 s7, 3
    s_cselect_b32 s8, s9, s8
    s_and_b32 s9, s7, 7
    s_lshl3_add_u32 s51, s8, s9
    s_lshl_b32 s35, s8, 5
    s_add_u32 s35, s35, s9
    s_lshl_b32 s35, s35, 6
    s_lshr_b32 s6, s3, 2
    s_and_b32 s7, s3, 1
    s_bfe_u32 s8, s3, 0x10001
    v_lshl_add_u32 v6, s6, 4, v1
    s_lshl3_add_u32 s9, s8, s7
    s_lshl_b32 s9, s9, 2
    v_cvt_f32_u32 v6, v6
    v_lshl_add_u32 v7, v2, 3, s9
    v_mul_f32 v6, 0x3c000000, v6
    v_cvt_f32_u32 v7, v7
    v_mul_f32 v7, v7, v6
    v_cos_f32 v96, v7
    v_sin_f32 v100, v7
    v_add_f32 v7, v7, v6
    v_cos_f32 v97, v7
    v_sin_f32 v101, v7
    v_add_f32 v7, v7, v6
    v_cos_f32 v98, v7
    v_sin_f32 v102, v7
    v_add_f32 v7, v7, v6
    v_cos_f32 v99, v7
    v_sin_f32 v103, v7
    s_lshl_b32 s10, s6, 13
    s_lshl_b32 s11, s8, 10
    s_lshl3_add_u32 s11, s7, s11
    v_add_u32 v15, s10, v5
    v_add_u32 v9, s11, v15
    v_cvt_pk_bf16_f32 v104, v96, v97
    v_cvt_pk_bf16_f32 v105, v98, v99
    v_cvt_pk_bf16_f32 v106, -v100, -v101
    v_cvt_pk_bf16_f32 v107, -v102, -v103
    v_cmp_eq_f32 vcc, 0, v6
    v_cvt_pk_bf16_f32 v108, v96, -v101
    v_cvt_pk_bf16_f32 v109, -v98, v103
    v_cvt_pk_bf16_f32 v110, -v100, -v97
    v_cvt_pk_bf16_f32 v111, v102, v99
    ds_write_b64 v9, v[104:105] offset:16384
    ds_write_b64 v9, v[108:109] offset:20480
    ds_write_b64 v9, v[110:111] offset:22528
    s_mov_b64 exec, vcc
    v_mov_b32 v106, 0xbf803f80
    v_mov_b32 v107, 0xbf803f80
    s_mov_b64 exec, -1
    ds_write_b64 v9, v[106:107] offset:18432
    global_load_dwordx4 v[24:27], v5, s[16:17]
    s_lshl_b32 s10, s3, 11
    s_add_u32 s11, s10, s51
    s_lshl_b32 s11, s11, 7
    s_mov_b32 m0, s10
    v_and_b32 v9, 7, v0
    v_bfe_u32 v13, v0, 4, 1
    v_xor_b32 v9, v9, v13
    v_lshrrev_b32 v13, 3, v0
    v_lshl_add_u32 v9, v9, 4, s11
    v_lshl_add_u32 v13, v13, 14, v9
    global_load_lds_dwordx4 v13, s[4:5]
    s_add_u32 m0, s10, 1024
    v_add_u32 v13, 0x20000, v13
    global_load_lds_dwordx4 v13, s[4:5]
    v_mov_b32 v12, 0
    v_mov_b32 v13, 0
    s_waitcnt vmcnt(2)
    v_dot2c_f32_bf16 v12, v16, v24
    v_dot2c_f32_bf16 v13, v20, v24
    v_dot2c_f32_bf16 v12, v17, v25
    v_dot2c_f32_bf16 v13, v21, v25
    v_dot2c_f32_bf16 v12, v18, v26
    v_dot2c_f32_bf16 v13, v22, v26
    v_dot2c_f32_bf16 v12, v19, v27
    v_dot2c_f32_bf16 v13, v23, v27
    s_sub_u32 s10, 0xffff, s58
    s_sub_u32 s11, 0xffff, s59
    v_mov_b32 v4, s10
    v_permlane32_swap_b32 v12, v13
    v_add_f32 v12, v12, v13
    v_mov_b32 v13, v12
    v_writelane_b32 v4, s11, 32
    v_mov_b32 v9, 33792
    v_permlane16_swap_b32 v12, v13
    v_add_f32 v12, v12, v13
    v_lshlrev_b32 v8, 31, v1
    v_lshrrev_b32 v7, 16, v8
    v_add_f32_dpp v12, v12, v12 row_ror:8 row_mask:0xf bank_mask:0xf
    v_or_b32 v8, v8, v7
    v_bfe_u32 v6, v0, 2, 2
    v_add_f32_dpp v12, v12, v12 row_ror:4 row_mask:0xf bank_mask:0xf
    v_and_b32 v14, 3, v0
    v_lshl_add_u32 v14, v14, 1, s8
    v_add_f32_dpp v12, v12, v12 row_ror:2 row_mask:0xf bank_mask:0xf
    v_lshl_add_u32 v10, v2, 3, v6
    v_lshrrev_b32 v6, 1, v6
    v_add_f32_dpp v12, v12, v12 row_ror:1 row_mask:0xf bank_mask:0xf
    v_cvt_pk_bf16_f32 v12, v12, v12
    v_and_b32 v12, 0xffff0000, v12
    v_xor_b32 v14, v14, v6
    v_ashrrev_i32 v7, 31, v12
    v_or_b32 v7, 0x80000000, v7
    v_xor_b32 v7, v7, v12
    v_and_b32 v7, 0xffff0000, v7
    v_or_b32 v7, v7, v4
    s_mov_b32 exec_lo, 1
    s_mov_b32 exec_hi, 1
    ds_max_u32 v9, v7
    s_mov_b64 exec, -1
    s_waitcnt lgkmcnt(0)
    s_barrier
    ds_read_b128 v[32:35], v15 offset:16384
    ds_read_b128 v[48:51], v15 offset:18432
    ds_read_b128 v[64:67], v15 offset:20480
    ds_read_b128 v[80:83], v15 offset:22528
    ds_read_b128 v[36:39], v15 offset:17408
    ds_read_b128 v[52:55], v15 offset:19456
    ds_read_b128 v[68:71], v15 offset:21504
    ds_read_b128 v[84:87], v15 offset:23552
    s_lshl_b32 s7, s7, 3
    v_lshl_add_u32 v14, v14, 4, s7
    v_lshl_add_u32 v10, v10, 7, v14
    v_lshlrev_b32 v9, 4, v2
    s_waitcnt vmcnt(0)
    s_barrier
    s_waitcnt lgkmcnt(5)
    ds_read_b128 v[28:31], v9 offset:33920
    ds_read_b64_tr_b16 v[96:97], v10 offset:0
    ds_read_b64_tr_b16 v[98:99], v10 offset:512
    ds_read_b64_tr_b16 v[100:101], v10 offset:4096
    ds_read_b64_tr_b16 v[102:103], v10 offset:4608
    ds_read_b64_tr_b16 v[104:105], v10 offset:8192
    ds_read_b64_tr_b16 v[106:107], v10 offset:8704
    ds_read_b64_tr_b16 v[108:109], v10 offset:12288
    ds_read_b64_tr_b16 v[110:111], v10 offset:12800
    global_load_dwordx4 v[24:27], v5, s[24:25]
    s_waitcnt lgkmcnt(6)
    v_mfma_f32_16x16x32_bf16 v[112:115], v[96:99], v[32:35], 0
    v_xor_b32 v40, v32, v8
    v_xor_b32 v41, v33, v8
    v_xor_b32 v42, v34, v8
    v_xor_b32 v43, v35, v8
    v_mfma_f32_16x16x32_bf16 v[116:119], v[96:99], v[48:51], 0
    v_xor_b32 v56, v48, v8
    v_xor_b32 v57, v49, v8
    v_xor_b32 v58, v50, v8
    v_xor_b32 v59, v51, v8
    v_mfma_f32_16x16x32_bf16 v[120:123], v[96:99], v[64:67], 0
    v_xor_b32 v72, v64, v8
    v_xor_b32 v73, v65, v8
    v_xor_b32 v74, v66, v8
    v_xor_b32 v75, v67, v8
    v_mfma_f32_16x16x32_bf16 v[124:127], v[96:99], v[80:83], 0
    v_xor_b32 v88, v80, v8
    v_xor_b32 v89, v81, v8
    v_xor_b32 v90, v82, v8
    v_xor_b32 v91, v83, v8
    s_waitcnt lgkmcnt(4)
    v_mfma_f32_16x16x32_bf16 v[112:115], v[100:103], v[36:39], v[112:115]
    v_xor_b32 v44, v36, v8
    v_xor_b32 v45, v37, v8
    v_xor_b32 v46, v38, v8
    v_xor_b32 v47, v39, v8
    v_mfma_f32_16x16x32_bf16 v[116:119], v[100:103], v[52:55], v[116:119]
    v_xor_b32 v60, v52, v8
    v_xor_b32 v61, v53, v8
    v_xor_b32 v62, v54, v8
    v_xor_b32 v63, v55, v8
    v_mfma_f32_16x16x32_bf16 v[120:123], v[100:103], v[68:71], v[120:123]
    v_xor_b32 v76, v68, v8
    v_xor_b32 v77, v69, v8
    v_xor_b32 v78, v70, v8
    v_xor_b32 v79, v71, v8
    v_mfma_f32_16x16x32_bf16 v[124:127], v[100:103], v[84:87], v[124:127]
    v_xor_b32 v92, v84, v8
    v_xor_b32 v93, v85, v8
    v_xor_b32 v94, v86, v8
    v_xor_b32 v95, v87, v8
    s_waitcnt lgkmcnt(2)
    v_mfma_f32_16x16x32_bf16 v[112:115], v[104:107], v[40:43], v[112:115]
    s_mul_i32 s44, s6, 528384
    s_add_u32 s44, s44, s35
    v_mfma_f32_16x16x32_bf16 v[116:119], v[104:107], v[56:59], v[116:119]
    s_and_b32 s10, s3, 3
    s_lshl_b32 s10, s10, 9
    v_mfma_f32_16x16x32_bf16 v[120:123], v[104:107], v[72:75], v[120:123]
    s_add_u32 s44, s44, s10
    s_add_u32 s44, s44, 2097152
    v_mfma_f32_16x16x32_bf16 v[124:127], v[104:107], v[88:91], v[124:127]
    s_mov_b32 s36, s30
    s_mov_b32 s37, s31
    s_waitcnt lgkmcnt(0)
    v_mfma_f32_16x16x32_bf16 v[112:115], v[108:111], v[44:47], v[112:115]
    s_mov_b32 s38, 0x1000000
    s_mov_b32 s39, 0x20000
    v_mfma_f32_16x16x32_bf16 v[116:119], v[108:111], v[60:63], v[116:119]
    s_add_u32 s45, s44, 1056768
    s_mov_b32 s11, 0xfffefffe
    v_mfma_f32_16x16x32_bf16 v[120:123], v[108:111], v[76:79], v[120:123]
    s_mov_b32 s10, 0x07060302
    v_mul_u32_u24 v11, 33024, v1
    v_mfma_f32_16x16x32_bf16 v[124:127], v[108:111], v[92:95], v[124:127]
    v_lshl_add_u32 v11, v2, 4, v11
    v_mov_b32 v12, 0
    v_mov_b32 v13, 0
    v_add_u32 v112, 0x10000, v112
    v_add_u32 v113, 0x10000, v113
    v_add_u32 v114, 0x10000, v114
    v_add_u32 v115, 0x10000, v115
    v_add_u32 v116, 0x10000, v116
    v_add_u32 v117, 0x10000, v117
    v_add_u32 v118, 0x10000, v118
    v_add_u32 v119, 0x10000, v119
    v_perm_b32 v96, v116, v112, s10
    v_perm_b32 v97, v117, v113, s10
    v_perm_b32 v98, v118, v114, s10
    v_perm_b32 v99, v119, v115, s10
    v_and_or_b32 v96, v96, s11, v28
    v_and_or_b32 v97, v97, s11, v29
    v_and_or_b32 v98, v98, s11, v30
    v_and_or_b32 v99, v99, s11, v31
    buffer_store_dwordx4 v[96:99], v11, s[36:39], s44 offen sc1
    v_add_u32 v120, 0x10000, v120
    v_add_u32 v121, 0x10000, v121
    v_add_u32 v122, 0x10000, v122
    v_add_u32 v123, 0x10000, v123
    v_add_u32 v124, 0x10000, v124
    v_add_u32 v125, 0x10000, v125
    v_add_u32 v126, 0x10000, v126
    v_add_u32 v127, 0x10000, v127
    v_perm_b32 v100, v124, v120, s10
    v_perm_b32 v101, v125, v121, s10
    v_perm_b32 v102, v126, v122, s10
    v_perm_b32 v103, v127, v123, s10
    v_and_or_b32 v100, v100, s11, v28
    v_and_or_b32 v101, v101, s11, v29
    v_and_or_b32 v102, v102, s11, v30
    v_and_or_b32 v103, v103, s11, v31
    buffer_store_dwordx4 v[100:103], v11, s[36:39], s45 offen sc1
    s_mov_b32 s65, 0
    s_mov_b32 s55, 0
L_ta_end:
    s_mov_b32 s40, s26
    s_mov_b32 s41, s27
    s_mov_b32 s42, 0x200000
    s_mov_b32 s43, 0x20000
    s_cmp_ge_u32 s3, 4
    s_cbranch_scc1 L_hi0
    s_setprio 2
    v_lshlrev_b32 v6, 4, v1
    v_lshl_add_u32 v10, v2, 13, v6
    v_mul_u32_u24 v6, 4352, v2
    v_bfe_u32 v7, v1, 1, 2
    v_xor_b32 v7, s3, v7
    v_lshl_add_u32 v7, v7, 4, v6
    v_lshl_add_u32 v11, v1, 6, v7
    s_lshl4_add_u32 s7, s3, 1024
    v_mov_b32 v9, 17600
    v_lshl_add_u32 v28, v0, 1, v9
    v_lshl_add_u32 v7, v1, 1, s7
    s_mov_b32 exec_lo, 0x00ff00ff
    s_mov_b32 exec_hi, 0x00ff00ff
    v_add_u32 v28, v7, v6
    s_mov_b64 exec, -1
    s_and_b32 s7, s56, 63
    s_mul_i32 s32, s7, 33024
    s_lshl_b32 s7, s3, 9
    s_add_u32 s32, s32, s7
    s_add_u32 s32, s32, 2097152
    s_add_u32 s33, s32, 4096
    v_lshrrev_b32 v6, 1, v1
    s_lshl_b32 s6, s57, 10
    s_add_u32 s6, s6, s56
    v_lshl_add_u32 v6, v6, 7, s6
    v_and_b32 v7, 1, v1
    v_lshlrev_b32 v9, 9, v7
    s_cmp_lg_u32 s56, 0
    s_cbranch_scc1 L_g01
    s_mov_b32 exec_lo, 0x00020002
    s_mov_b32 exec_hi, 0x00020002
    v_mov_b32 v6, 0x400
    v_mov_b32 v9, 0
    s_mov_b64 exec, -1
L_g01:
    v_lshlrev_b32 v7, 2, v2
    v_mad_u32_u24 v9, v7, v6, v9
    v_cvt_f32_u32 v6, v6
    v_cvt_f32_u32 v9, v9
    v_mul_f32 v6, 0x3a000000, v6
    v_mul_f32 v9, 0x3a000000, v9
    v_cos_f32 v64, v9
    v_sin_f32 v68, v9
    v_add_f32 v9, v9, v6
    v_cos_f32 v65, v9
    v_sin_f32 v69, v9
    v_add_f32 v9, v9, v6
    v_cos_f32 v66, v9
    v_sin_f32 v70, v9
    v_add_f32 v9, v9, v6
    v_cos_f32 v67, v9
    v_sin_f32 v71, v9
    s_and_b32 s7, s56, 63
    s_nop 0
    v_cvt_pk_bf16_f32 v148, v64, v68
    v_cvt_pk_bf16_f32 v149, v65, v69
    v_cvt_pk_bf16_f32 v150, v66, v70
    v_cvt_pk_bf16_f32 v151, v67, v71
    s_cmp_lg_u32 s7, 0
    s_cbranch_scc1 L_gd2
    s_lshr_b32 s7, s56, 2
    v_and_b32 v148, 0xffff, v148
    v_lshlrev_b32 v148, s7, v148
    v_and_b32 v149, 0xffff, v149
    v_lshlrev_b32 v149, s7, v149
    v_and_b32 v150, 0xffff, v150
    v_lshlrev_b32 v150, s7, v150
    v_and_b32 v151, 0xffff, v151
    v_lshlrev_b32 v151, s7, v151
L_gd2:
    v_and_b32 v6, 3, v1
    v_lshlrev_b32 v6, 4, v6
    ds_read_b128 v[96:99], v6 offset:33920
    s_waitcnt lgkmcnt(0)
    v_cvt_f32_u32 v6, v1
    s_lshl_b32 s6, s3, 2
    v_lshl_add_u32 v7, v2, 6, s6
    v_mul_f32 v6, 0x3b000000, v6
    v_cvt_f32_u32 v7, v7
    v_mul_f32 v15, 0x41800000, v6
    v_mul_f32 v7, v7, v6
    v_cos_f32 v64, v7
    v_sin_f32 v68, v7
    v_add_f32 v9, v7, v15
    v_cos_f32 v65, v9
    v_sin_f32 v69, v9
    v_add_f32 v9, v9, v15
    v_cos_f32 v66, v9
    v_sin_f32 v70, v9
    v_add_f32 v9, v9, v15
    v_cos_f32 v67, v9
    v_sin_f32 v71, v9
    v_mov_b32 v108, 0
    v_cvt_pk_bf16_f32 v100, v64, v65
    v_cvt_pk_bf16_f32 v104, -v68, -v69
    v_cvt_pk_bf16_f32 v101, v66, v67
    v_cvt_pk_bf16_f32 v105, -v70, -v71
    v_xor_b32 v102, v100, v8
    v_xor_b32 v106, v104, v8
    v_xor_b32 v103, v101, v8
    v_xor_b32 v107, v105, v8
    v_add_f32 v7, v7, v6
    v_cos_f32 v64, v7
    v_sin_f32 v68, v7
    v_add_f32 v9, v7, v15
    v_cos_f32 v65, v9
    v_sin_f32 v69, v9
    v_add_f32 v9, v9, v15
    v_cos_f32 v66, v9
    v_sin_f32 v70, v9
    v_add_f32 v9, v9, v15
    v_cos_f32 v67, v9
    v_sin_f32 v71, v9
    v_mov_b32 v120, 0
    v_cvt_pk_bf16_f32 v112, v64, v65
    v_cvt_pk_bf16_f32 v116, -v68, -v69
    v_cvt_pk_bf16_f32 v113, v66, v67
    v_cvt_pk_bf16_f32 v117, -v70, -v71
    v_xor_b32 v114, v112, v8
    v_xor_b32 v118, v116, v8
    v_xor_b32 v115, v113, v8
    v_xor_b32 v119, v117, v8
    v_add_f32 v7, v7, v6
    v_cos_f32 v64, v7
    v_sin_f32 v68, v7
    v_add_f32 v9, v7, v15
    v_cos_f32 v65, v9
    v_sin_f32 v69, v9
    v_add_f32 v9, v9, v15
    v_cos_f32 v66, v9
    v_sin_f32 v70, v9
    v_add_f32 v9, v9, v15
    v_cos_f32 v67, v9
    v_sin_f32 v71, v9
    v_mov_b32 v132, 0
    v_cvt_pk_bf16_f32 v124, v64, v65
    v_cvt_pk_bf16_f32 v128, -v68, -v69
    v_cvt_pk_bf16_f32 v125, v66, v67
    v_cvt_pk_bf16_f32 v129, -v70, -v71
    v_xor_b32 v126, v124, v8
    v_xor_b32 v130, v128, v8
    v_xor_b32 v127, v125, v8
    v_xor_b32 v131, v129, v8
    v_add_f32 v7, v7, v6
    v_cos_f32 v64, v7
    v_sin_f32 v68, v7
    v_add_f32 v9, v7, v15
    v_cos_f32 v65, v9
    v_sin_f32 v69, v9
    v_add_f32 v9, v9, v15
    v_cos_f32 v66, v9
    v_sin_f32 v70, v9
    v_add_f32 v9, v9, v15
    v_cos_f32 v67, v9
    v_sin_f32 v71, v9
    v_mov_b32 v144, 0
    v_cvt_pk_bf16_f32 v136, v64, v65
    v_cvt_pk_bf16_f32 v140, -v68, -v69
    v_cvt_pk_bf16_f32 v137, v66, v67
    v_cvt_pk_bf16_f32 v141, -v70, -v71
    v_xor_b32 v138, v136, v8
    v_xor_b32 v142, v140, v8
    v_xor_b32 v139, v137, v8
    v_xor_b32 v143, v141, v8
    v_lshrrev_b32 v6, 1, v1
    v_add_u32 v7, s6, v6
    v_and_b32 v9, 1, v1
    v_lshl_add_u32 v7, v9, 3, v7
    v_cvt_f32_u32 v7, v7
    v_mul_f32 v7, 0x3d000000, v7
    v_cos_f32 v7, v7
    s_mov_b32 exec_lo, 0x30003
    s_mov_b32 exec_hi, 0x30003
    v_cvt_pk_bf16_f32 v108, v7, -v7
    s_mov_b32 exec_lo, 0xc000c
    s_mov_b32 exec_hi, 0xc000c
    v_cvt_pk_bf16_f32 v120, v7, -v7
    s_mov_b32 exec_lo, 0x300030
    s_mov_b32 exec_hi, 0x300030
    v_cvt_pk_bf16_f32 v132, v7, -v7
    s_mov_b32 exec_lo, 0xc000c0
    s_mov_b32 exec_hi, 0xc000c0
    v_cvt_pk_bf16_f32 v144, v7, -v7
    s_mov_b64 exec, -1
    v_mov_b32 v109, v108
    v_mov_b32 v110, v108
    v_mov_b32 v111, v108
    v_mov_b32 v121, v120
    v_mov_b32 v122, v120
    v_mov_b32 v123, v120
    v_mov_b32 v133, v132
    v_mov_b32 v134, v132
    v_mov_b32 v135, v132
    v_mov_b32 v145, v144
    v_mov_b32 v146, v144
    v_mov_b32 v147, v144
    s_waitcnt vmcnt(2)
    v_dot2c_f32_bf16 v12, v16, v24
    v_dot2c_f32_bf16 v13, v20, v24
    v_dot2c_f32_bf16 v12, v17, v25
    v_dot2c_f32_bf16 v13, v21, v25
    v_dot2c_f32_bf16 v12, v18, v26
    v_dot2c_f32_bf16 v13, v22, v26
    v_dot2c_f32_bf16 v12, v19, v27
    v_dot2c_f32_bf16 v13, v23, v27
    s_nop 2
    v_permlane32_swap_b32 v12, v13
    v_add_f32 v12, v12, v13
    v_mov_b32 v13, v12
    s_nop 1
    v_permlane16_swap_b32 v12, v13
    v_add_f32 v12, v12, v13
    s_nop 1
    v_add_f32_dpp v12, v12, v12 row_ror:8 row_mask:0xf bank_mask:0xf
    s_nop 1
    v_add_f32_dpp v12, v12, v12 row_ror:4 row_mask:0xf bank_mask:0xf
    s_nop 1
    v_add_f32_dpp v12, v12, v12 row_ror:2 row_mask:0xf bank_mask:0xf
    s_nop 1
    v_add_f32_dpp v12, v12, v12 row_ror:1 row_mask:0xf bank_mask:0xf
    v_cvt_pk_bf16_f32 v12, v12, v12
    v_and_b32 v12, 0xffff0000, v12
    s_lshl_b32 s6, s3, 11
    v_add_u32 v6, s6, v5
    ds_write_b128 v6, v[16:19] offset:48832
    ds_write_b128 v6, v[20:23] offset:49856
    v_lshl_add_u32 v7, v1, 6, s6
    v_lshl_add_u32 v7, v2, 3, v7
    s_waitcnt lgkmcnt(0)
    ds_read_b64 v[16:17], v7 offset:48832
    ds_read_b64 v[18:19], v7 offset:48864
    ds_read_b64 v[20:21], v7 offset:49856
    ds_read_b64 v[22:23], v7 offset:49888
    v_and_b32 v6, 1, v2
    v_lshlrev_b32 v6, 5, v6
    v_lshl_add_u32 v6, v1, 6, v6
    v_lshrrev_b32 v7, 1, v2
    v_lshl_add_u32 v3, v7, 4, v6
    v_mul_f32 v13, 0xbfb8aa3b, v12
    v_exp_f32 v13, v13
    s_nop 0
    v_add_f32 v13, 1.0, v13
    v_rcp_f32 v13, v13
    s_nop 0
    v_cvt_pk_bf16_f32 v13, v13, v13
    v_and_b32 v13, 0xffff0000, v13
    v_sub_f32 v14, 1.0, v13
    v_cvt_pk_bf16_f32 v14, v14, v14
    v_and_b32 v14, 0xffff0000, v14
    v_readlane_b32 s6, v13, 0
    v_readlane_b32 s7, v13, 32
    v_readlane_b32 s8, v14, 0
    v_readlane_b32 s9, v14, 32
    s_xor_b32 s10, s6, 0x80000000
    s_cmp_eq_u32 s58, 0
    s_cselect_b32 s10, 0, s10
    s_cselect_b32 s11, 0, s7
    v_mov_b32 v24, s6
    v_mov_b32 v25, s10
    v_mov_b32 v26, s11
    v_mov_b32 v27, s7
    v_mov_b32 v13, s8
    v_mov_b32 v14, s9
    s_waitcnt lgkmcnt(0)
    v_lshlrev_b32 v152, 16, v16
    v_and_b32 v153, 0xffff0000, v16
    v_lshlrev_b32 v154, 16, v17
    v_and_b32 v155, 0xffff0000, v17
    v_lshlrev_b32 v156, 16, v18
    v_and_b32 v157, 0xffff0000, v18
    v_lshlrev_b32 v158, 16, v19
    v_and_b32 v159, 0xffff0000, v19
    v_mul_f32 v152, v13, v152
    v_mul_f32 v153, v13, v153
    v_mul_f32 v154, v13, v154
    v_mul_f32 v155, v13, v155
    v_mul_f32 v156, v13, v156
    v_mul_f32 v157, v13, v157
    v_mul_f32 v158, v13, v158
    v_mul_f32 v159, v13, v159
    v_lshlrev_b32 v160, 16, v20
    v_and_b32 v161, 0xffff0000, v20
    v_lshlrev_b32 v162, 16, v21
    v_and_b32 v163, 0xffff0000, v21
    v_lshlrev_b32 v164, 16, v22
    v_and_b32 v165, 0xffff0000, v22
    v_lshlrev_b32 v166, 16, v23
    v_and_b32 v167, 0xffff0000, v23
    v_mul_f32 v160, v14, v160
    v_mul_f32 v161, v14, v161
    v_mul_f32 v162, v14, v162
    v_mul_f32 v163, v14, v163
    v_mul_f32 v164, v14, v164
    v_mul_f32 v165, v14, v165
    v_mul_f32 v166, v14, v166
    v_mul_f32 v167, v14, v167
    s_waitcnt vmcnt(0)
    s_barrier
    buffer_load_dwordx4 v[32:35], v10, s[36:39], s32 offen offset:0 sc1
    buffer_load_dwordx4 v[36:39], v10, s[36:39], s32 offen offset:2048 sc1
    buffer_load_dwordx4 v[40:43], v10, s[36:39], s33 offen offset:0 sc1
    buffer_load_dwordx4 v[44:47], v10, s[36:39], s33 offen offset:2048 sc1
    buffer_load_dwordx4 v[48:51], v10, s[36:39], s32 offen offset:256 sc1
    buffer_load_dwordx4 v[52:55], v10, s[36:39], s32 offen offset:2304 sc1
    buffer_load_dwordx4 v[56:59], v10, s[36:39], s33 offen offset:256 sc1
    buffer_load_dwordx4 v[60:63], v10, s[36:39], s33 offen offset:2304 sc1
    s_mul_i32 s7, s3, 2176
    v_bfe_u32 v7, v1, 1, 2
    v_xor_b32 v7, v7, v2
    v_lshl_add_u32 v7, v7, 4, s7
    v_lshl_add_u32 v29, v1, 6, v7
    v_sub_u32 v6, 16, v1
    v_bfe_u32 v7, v6, 1, 2
    v_xor_b32 v7, v7, v2
    v_lshl_add_u32 v7, v7, 4, s7
    v_lshl_add_u32 v30, v6, 6, v7
    s_cmp_eq_u32 s58, 0
    s_cselect_b32 s6, 0, 2048
    v_add_u32 v4, s6, v5
L_zjoin:
    s_waitcnt vmcnt(4)
L_got0:
    v_xor_b32 v80, v32, v96
    v_xor_b32 v81, v36, v96
    v_xor_b32 v82, v40, v96
    v_xor_b32 v83, v44, v96
    v_or3_b32 v6, v80, v81, v82
L_tb0:
    s_cbranch_execz L_tbback
    v_or_b32 v6, v6, v83
    v_mfma_f32_16x16x32_bf16 v[64:67], v[80:83], v[148:151], 0
    v_xor_b32 v84, v33, v97
    v_xor_b32 v85, v37, v97
    v_xor_b32 v86, v41, v97
    v_xor_b32 v87, v45, v97
    v_or3_b32 v6, v6, v84, v85
    v_or3_b32 v6, v6, v86, v87
    v_mfma_f32_16x16x32_bf16 v[68:71], v[84:87], v[148:151], 0
    v_xor_b32 v88, v34, v98
    v_xor_b32 v89, v38, v98
    v_xor_b32 v90, v42, v98
    v_xor_b32 v91, v46, v98
    v_or3_b32 v6, v6, v88, v89
    v_or3_b32 v6, v6, v90, v91
    v_mfma_f32_16x16x32_bf16 v[72:75], v[88:91], v[148:151], 0
    v_xor_b32 v92, v35, v99
    v_xor_b32 v93, v39, v99
    v_xor_b32 v94, v43, v99
    v_xor_b32 v95, v47, v99
    v_or3_b32 v6, v6, v92, v93
    v_or3_b32 v6, v6, v94, v95
L_tb1:
    s_cbranch_execz L_tbback
    v_and_b32 v6, 0x10001, v6
    v_cmp_ne_u32 vcc, 0, v6
    v_mfma_f32_16x16x32_bf16 v[76:79], v[92:95], v[148:151], 0
    s_cbranch_vccnz L_retry0
L_fail0:
    s_waitcnt vmcnt(0)
L_got1:
    v_xor_b32 v80, v48, v96
    v_xor_b32 v81, v52, v96
    v_xor_b32 v82, v56, v96
    v_xor_b32 v83, v60, v96
    v_or3_b32 v6, v80, v81, v82
    v_or_b32 v6, v6, v83
    v_mfma_f32_16x16x32_bf16 v[32:35], v[80:83], v[148:151], 0
    v_xor_b32 v84, v49, v97
    v_xor_b32 v85, v53, v97
    v_xor_b32 v86, v57, v97
    v_xor_b32 v87, v61, v97
    v_or3_b32 v6, v6, v84, v85
    v_or3_b32 v6, v6, v86, v87
    v_mfma_f32_16x16x32_bf16 v[36:39], v[84:87], v[148:151], 0
    v_xor_b32 v88, v50, v98
    v_xor_b32 v89, v54, v98
    v_xor_b32 v90, v58, v98
    v_xor_b32 v91, v62, v98
    v_or3_b32 v6, v6, v88, v89
L_tb2:
    s_cbranch_execz L_tbback
    v_or3_b32 v6, v6, v90, v91
    v_mfma_f32_16x16x32_bf16 v[40:43], v[88:91], v[148:151], 0
    v_xor_b32 v92, v51, v99
    v_xor_b32 v93, v55, v99
    v_xor_b32 v94, v59, v99
    v_xor_b32 v95, v63, v99
    v_or3_b32 v6, v6, v92, v93
    v_or3_b32 v6, v6, v94, v95
    v_and_b32 v6, 0x10001, v6
    v_cmp_ne_u32 vcc, 0, v6
    v_mfma_f32_16x16x32_bf16 v[44:47], v[92:95], v[148:151], 0
    s_cbranch_vccnz L_retry1
L_fail1:
    v_cvt_pk_bf16_f32 v80, v64, v65
    v_cvt_pk_bf16_f32 v81, v66, v67
    v_cvt_pk_bf16_f32 v82, v32, v33
    v_cvt_pk_bf16_f32 v83, v34, v35
    v_cvt_pk_bf16_f32 v84, v68, v69
    v_cvt_pk_bf16_f32 v85, v70, v71
L_tb3:
    s_cbranch_execz L_tbback
    v_cvt_pk_bf16_f32 v86, v36, v37
    v_cvt_pk_bf16_f32 v87, v38, v39
    v_mfma_f32_16x16x32_bf16 v[64:67], v[80:83], v[100:103], 0
    v_mfma_f32_16x16x32_bf16 v[32:35], v[80:83], v[104:107], 0
    v_mfma_f32_16x16x32_bf16 v[96:99], v[80:83], v[108:111], 0
    v_cvt_pk_bf16_f32 v88, v72, v73
    v_cvt_pk_bf16_f32 v89, v74, v75
    v_cvt_pk_bf16_f32 v90, v40, v41
    v_cvt_pk_bf16_f32 v91, v42, v43
    v_mfma_f32_16x16x32_bf16 v[68:71], v[84:87], v[112:115], 0
    v_mfma_f32_16x16x32_bf16 v[36:39], v[84:87], v[116:119], 0
    v_mfma_f32_16x16x32_bf16 v[96:99], v[84:87], v[120:123], v[96:99]
    v_cvt_pk_bf16_f32 v92, v76, v77
    v_cvt_pk_bf16_f32 v93, v78, v79
    v_cvt_pk_bf16_f32 v94, v44, v45
    v_cvt_pk_bf16_f32 v95, v46, v47
L_tb4:
    s_cbranch_execz L_tbback
    v_mfma_f32_16x16x32_bf16 v[72:75], v[88:91], v[124:127], 0
    v_mfma_f32_16x16x32_bf16 v[40:43], v[88:91], v[128:131], 0
    v_mfma_f32_16x16x32_bf16 v[96:99], v[88:91], v[132:135], v[96:99]
    v_mfma_f32_16x16x32_bf16 v[76:79], v[92:95], v[136:139], 0
    v_mfma_f32_16x16x32_bf16 v[44:47], v[92:95], v[140:143], 0
    v_mfma_f32_16x16x32_bf16 v[96:99], v[92:95], v[144:147], v[96:99]
    v_cvt_pk_bf16_f32 v48, v64, v32
    v_cvt_pk_bf16_f32 v52, v65, v33
    v_cvt_pk_bf16_f32 v56, v66, v34
    v_cvt_pk_bf16_f32 v60, v67, v35
    v_cvt_pk_bf16_f32 v49, v68, v36
    v_cvt_pk_bf16_f32 v53, v69, v37
    v_cvt_pk_bf16_f32 v57, v70, v38
    v_cvt_pk_bf16_f32 v61, v71, v39
    v_cvt_pk_bf16_f32 v50, v72, v40
L_tb5:
    s_cbranch_execz L_tbback
    v_cvt_pk_bf16_f32 v54, v73, v41
    v_cvt_pk_bf16_f32 v58, v74, v42
    v_cvt_pk_bf16_f32 v62, v75, v43
    v_cvt_pk_bf16_f32 v51, v76, v44
    ds_write_b128 v11, v[48:51] offset:16384
    v_cvt_pk_bf16_f32 v55, v77, v45
    ds_write_b128 v11, v[52:55] offset:17472
    v_cvt_pk_bf16_f32 v59, v78, v46
    ds_write_b128 v11, v[56:59] offset:18560
    v_cvt_pk_bf16_f32 v63, v79, v47
    ds_write_b128 v11, v[60:63] offset:19648
    v_cvt_pk_bf16_f32 v96, v96, v97
    v_cvt_pk_bf16_f32 v98, v98, v99
    ds_write_b16 v28, v96 offset:16384
    ds_write_b16_d16_hi v28, v96 offset:17472
    ds_write_b16 v28, v98 offset:18560
L_tb6:
    s_cbranch_execz L_tbback
    ds_write_b16_d16_hi v28, v98 offset:19648
L_d2:
    ds_read_b128 v[64:67], v5 offset:42688
    ds_read_b128 v[68:71], v5 offset:43712
    ds_read_b128 v[72:75], v4 offset:42688
    ds_read_b128 v[76:79], v4 offset:43712
    v_mov_b32 v9, 33856
    s_cmp_lg_u32 s55, 0
    s_waitcnt lgkmcnt(0)
    s_cbranch_scc1 L_zsync
    s_barrier
    ds_read_b32 v6, v9
    ds_read_b128 v[32:35], v29 offset:16384
    ds_read_b128 v[36:39], v30 offset:16384
    ds_read_b128 v[40:43], v29 offset:17472
    ds_read_b128 v[44:47], v30 offset:17472
    s_lshl_b32 s6, s58, 10
    s_lshl_b32 s7, s59, 10
    s_waitcnt lgkmcnt(3)
    v_mfma_f32_16x16x32_bf16 v[48:51], v[32:35], v[64:67], 0
L_tb7:
    s_cbranch_execz L_tbback
    s_waitcnt lgkmcnt(2)
    v_mfma_f32_16x16x32_bf16 v[52:55], v[36:39], v[68:71], 0
    s_waitcnt lgkmcnt(1)
    v_mfma_f32_16x16x32_bf16 v[56:59], v[40:43], v[72:75], 0
    s_waitcnt lgkmcnt(0)
    v_mfma_f32_16x16x32_bf16 v[60:63], v[44:47], v[76:79], 0
    v_readfirstlane_b32 s44, v6
    s_andn2_b32 s54, 0xffff, s44
    v_fmac_f32 v152, v24, v48
    v_fmac_f32 v153, v24, v49
    v_fmac_f32 v154, v24, v50
    v_fmac_f32 v155, v24, v51
    v_fmac_f32 v156, v24, v52
    v_fmac_f32 v157, v24, v53
    v_fmac_f32 v158, v24, v54
    v_fmac_f32 v159, v24, v55
    v_fmac_f32 v160, v26, v48
    v_fmac_f32 v161, v26, v49
    v_fmac_f32 v162, v26, v50
    v_fmac_f32 v163, v26, v51
    v_fmac_f32 v164, v26, v52
    v_fmac_f32 v165, v26, v53
    v_fmac_f32 v166, v26, v54
    v_fmac_f32 v167, v26, v55
    v_fmac_f32 v152, v25, v56
    v_fmac_f32 v153, v25, v57
L_tb8:
    s_cbranch_execz L_tbback
    v_fmac_f32 v154, v25, v58
    v_fmac_f32 v155, v25, v59
    v_fmac_f32 v156, v25, v60
    v_fmac_f32 v157, v25, v61
    v_fmac_f32 v158, v25, v62
    v_fmac_f32 v159, v25, v63
    v_cvt_pk_bf16_f32 v32, v152, v153
    v_cvt_pk_bf16_f32 v33, v154, v155
    v_cvt_pk_bf16_f32 v34, v156, v157
    v_cvt_pk_bf16_f32 v35, v158, v159
    s_cmp_eq_u32 s58, s54
    s_cbranch_scc1 L_skip3
    v_permlane16_swap_b32 v32, v34
    v_permlane16_swap_b32 v33, v35
    buffer_store_dwordx4 v[32:35], v3, s[40:43], s6 offen sc1
L_skip3:
    v_fmac_f32 v160, v27, v56
    v_fmac_f32 v161, v27, v57
    v_fmac_f32 v162, v27, v58
    v_fmac_f32 v163, v27, v59
    v_fmac_f32 v164, v27, v60
    v_fmac_f32 v165, v27, v61
    v_fmac_f32 v166, v27, v62
    v_fmac_f32 v167, v27, v63
    v_cvt_pk_bf16_f32 v36, v160, v161
    v_cvt_pk_bf16_f32 v37, v162, v163
L_tb9:
    s_cbranch_execz L_tbback
    v_cvt_pk_bf16_f32 v38, v164, v165
    v_cvt_pk_bf16_f32 v39, v166, v167
    s_cmp_eq_u32 s59, s54
    s_cbranch_scc1 L_skip4
    v_permlane16_swap_b32 v36, v38
    v_permlane16_swap_b32 v37, v39
    buffer_store_dwordx4 v[36:39], v3, s[40:43], s7 offen sc1
L_skip4:
L_tb_end:
    s_endpgm
L_retry0:
    s_sleep 3
    s_add_u32 s65, s65, 1
    s_lshr_b32 s34, s65, 17
    s_cbranch_scc1 L_fail0
    buffer_load_dwordx4 v[32:35], v10, s[36:39], s32 offen offset:0 sc1
    buffer_load_dwordx4 v[36:39], v10, s[36:39], s32 offen offset:2048 sc1
    buffer_load_dwordx4 v[40:43], v10, s[36:39], s33 offen offset:0 sc1
    buffer_load_dwordx4 v[44:47], v10, s[36:39], s33 offen offset:2048 sc1
    s_waitcnt vmcnt(0)
    s_branch L_got0
L_retry1:
    s_sleep 3
    s_add_u32 s65, s65, 1
    s_lshr_b32 s34, s65, 17
    s_cbranch_scc1 L_fail1
    buffer_load_dwordx4 v[48:51], v10, s[36:39], s32 offen offset:256 sc1
    buffer_load_dwordx4 v[52:55], v10, s[36:39], s32 offen offset:2304 sc1
    buffer_load_dwordx4 v[56:59], v10, s[36:39], s33 offen offset:256 sc1
    buffer_load_dwordx4 v[60:63], v10, s[36:39], s33 offen offset:2304 sc1
    s_waitcnt vmcnt(0)
    s_branch L_got1
L_hi0:
    s_waitcnt vmcnt(0)
    s_barrier
L_hi1:
    s_mov_b64 exec, 0
    s_sub_u32 s53, s3, 8
L_tbback:
    s_add_u32 s53, s53, 4
    s_cmp_eq_u32 s53, 0
    s_cbranch_scc1 L_tb0
    s_cmp_eq_u32 s53, 1
    s_cbranch_scc1 L_tb1
    s_cmp_eq_u32 s53, 2
    s_cbranch_scc1 L_tb2
    s_cmp_eq_u32 s53, 3
    s_cbranch_scc1 L_tb3
    s_cmp_eq_u32 s53, 4
    s_cbranch_scc1 L_tb4
    s_cmp_eq_u32 s53, 5
    s_cbranch_scc1 L_tb5
    s_cmp_eq_u32 s53, 6
    s_cbranch_scc1 L_tb6
    s_cmp_eq_u32 s53, 7
    s_cbranch_scc1 L_tb7
    s_cmp_eq_u32 s53, 8
    s_cbranch_scc1 L_tb8
    s_cmp_eq_u32 s53, 9
    s_cbranch_scc1 L_tb9
    s_mov_b64 exec, -1
    s_cmp_lg_u32 s55, 0
    s_cbranch_scc1 L_z0b
    s_waitcnt vmcnt(2)
    v_dot2c_f32_bf16 v12, v16, v24
    v_dot2c_f32_bf16 v13, v20, v24
    v_dot2c_f32_bf16 v12, v17, v25
    v_dot2c_f32_bf16 v13, v21, v25
    v_dot2c_f32_bf16 v12, v18, v26
    v_dot2c_f32_bf16 v13, v22, v26
    v_dot2c_f32_bf16 v12, v19, v27
    v_dot2c_f32_bf16 v13, v23, v27
    s_nop 2
    v_permlane32_swap_b32 v12, v13
    v_add_f32 v12, v12, v13
    v_mov_b32 v13, v12
    s_nop 1
    v_permlane16_swap_b32 v12, v13
    v_add_f32 v12, v12, v13
    s_nop 1
    v_add_f32_dpp v12, v12, v12 row_ror:8 row_mask:0xf bank_mask:0xf
    s_nop 1
    v_add_f32_dpp v12, v12, v12 row_ror:4 row_mask:0xf bank_mask:0xf
    s_nop 1
    v_add_f32_dpp v12, v12, v12 row_ror:2 row_mask:0xf bank_mask:0xf
    s_nop 1
    v_add_f32_dpp v12, v12, v12 row_ror:1 row_mask:0xf bank_mask:0xf
    v_cvt_pk_bf16_f32 v12, v12, v12
    v_and_b32 v12, 0xffff0000, v12
    s_lshl_b32 s6, s3, 11
    v_add_u32 v6, s6, v5
    ds_write_b128 v6, v[16:19] offset:48832
    ds_write_b128 v6, v[20:23] offset:49856
    v_lshl_add_u32 v7, v1, 6, s6
    v_lshl_add_u32 v7, v2, 3, v7
    s_waitcnt lgkmcnt(0)
    ds_read_b64 v[16:17], v7 offset:48832
    ds_read_b64 v[18:19], v7 offset:48864
    ds_read_b64 v[20:21], v7 offset:49856
    ds_read_b64 v[22:23], v7 offset:49888
    v_and_b32 v6, 1, v2
    v_lshlrev_b32 v6, 5, v6
    v_lshl_add_u32 v6, v1, 6, v6
    v_lshrrev_b32 v7, 1, v2
    v_lshl_add_u32 v3, v7, 4, v6
    v_mul_f32 v13, 0xbfb8aa3b, v12
    v_exp_f32 v13, v13
    s_nop 0
    v_add_f32 v13, 1.0, v13
    v_rcp_f32 v13, v13
    s_nop 0
    v_cvt_pk_bf16_f32 v13, v13, v13
    v_and_b32 v13, 0xffff0000, v13
    v_sub_f32 v14, 1.0, v13
    v_cvt_pk_bf16_f32 v14, v14, v14
    v_and_b32 v14, 0xffff0000, v14
    v_readlane_b32 s6, v13, 0
    v_readlane_b32 s7, v13, 32
    v_readlane_b32 s8, v14, 0
    v_readlane_b32 s9, v14, 32
    s_xor_b32 s10, s6, 0x80000000
    s_cmp_eq_u32 s58, 0
    s_cselect_b32 s10, 0, s10
    s_cselect_b32 s11, 0, s7
    v_mov_b32 v24, s6
    v_mov_b32 v25, s10
    v_mov_b32 v26, s11
    v_mov_b32 v27, s7
    v_mov_b32 v13, s8
    v_mov_b32 v14, s9
    s_waitcnt lgkmcnt(0)
    v_lshlrev_b32 v152, 16, v16
    v_and_b32 v153, 0xffff0000, v16
    v_lshlrev_b32 v154, 16, v17
    v_and_b32 v155, 0xffff0000, v17
    v_lshlrev_b32 v156, 16, v18
    v_and_b32 v157, 0xffff0000, v18
    v_lshlrev_b32 v158, 16, v19
    v_and_b32 v159, 0xffff0000, v19
    v_mul_f32 v152, v13, v152
    v_mul_f32 v153, v13, v153
    v_mul_f32 v154, v13, v154
    v_mul_f32 v155, v13, v155
    v_mul_f32 v156, v13, v156
    v_mul_f32 v157, v13, v157
    v_mul_f32 v158, v13, v158
    v_mul_f32 v159, v13, v159
    v_lshlrev_b32 v160, 16, v20
    v_and_b32 v161, 0xffff0000, v20
    v_lshlrev_b32 v162, 16, v21
    v_and_b32 v163, 0xffff0000, v21
    v_lshlrev_b32 v164, 16, v22
    v_and_b32 v165, 0xffff0000, v22
    v_lshlrev_b32 v166, 16, v23
    v_and_b32 v167, 0xffff0000, v23
    v_mul_f32 v160, v14, v160
    v_mul_f32 v161, v14, v161
    v_mul_f32 v162, v14, v162
    v_mul_f32 v163, v14, v163
    v_mul_f32 v164, v14, v164
    v_mul_f32 v165, v14, v165
    v_mul_f32 v166, v14, v166
    v_mul_f32 v167, v14, v167
    s_mul_i32 s7, s3, 2176
    v_bfe_u32 v7, v1, 1, 2
    v_xor_b32 v7, v7, v2
    v_lshl_add_u32 v7, v7, 4, s7
    v_lshl_add_u32 v29, v1, 6, v7
    v_sub_u32 v6, 16, v1
    v_bfe_u32 v7, v6, 1, 2
    v_xor_b32 v7, v7, v2
    v_lshl_add_u32 v7, v7, 4, s7
    v_lshl_add_u32 v30, v6, 6, v7
    s_cmp_eq_u32 s58, 0
    s_cselect_b32 s6, 0, 2048
    v_add_u32 v4, s6, v5
    s_branch L_d2
L_ah:
    s_cmp_ge_u32 s7, 2
    s_cbranch_scc1 L_nocpf
    s_getpc_b64 s[12:13]
L_pc:
    s_sub_u32 s12, s12, L_pc - gated_mix__spectral_fnet__moe_arch_mod__prompt_kernel
    s_subb_u32 s13, s13, 0
    v_lshlrev_b32 v6, 7, v0
    v_add_u32 v7, 0x2000, v6
    v_min_u32 v7, L_end - gated_mix__spectral_fnet__moe_arch_mod__prompt_kernel, v7
    v_mov_b32 v13, s13
    v_mov_b32 v15, s13
    v_add_co_u32 v12, vcc, s12, v6
    s_nop 1
    v_addc_co_u32 v13, vcc, 0, v13, vcc
    v_add_co_u32 v14, vcc, s12, v7
    s_nop 1
    v_addc_co_u32 v15, vcc, 0, v15, vcc
    global_load_dword v10, v[12:13], off
    global_load_dword v11, v[14:15], off
L_nocpf:
    v_lshlrev_b32 v5, 4, v0
    v_mov_b32 v31, 0
    v_mov_b32 v9, 33792
    ds_write_b32 v9, v31
    s_mov_b32 s64, 0x9E3779B1
    s_cmp_ge_u32 s7, 2
    s_waitcnt lgkmcnt(0)
    s_cbranch_scc1 L_nowpf
    global_load_dwordx4 v[32:35], v5, s[16:17]
    global_load_dword v30, v31, s[30:31]
    global_load_dwordx4 v[36:39], v5, s[24:25]
L_nowpf:
    v_lshlrev_b32 v14, 10, v0
    s_lshl_b32 s50, s2, 3
    s_add_u32 s50, s50, 65536
    s_mov_b32 s36, s30
    s_mov_b32 s37, s31
    s_mov_b32 s38, 0x1000000
    s_mov_b32 s39, 0x20000
    s_mov_b32 s65, 0
    s_barrier
    v_lshlrev_b32 v6, 2, v2
    v_cvt_f32_u32 v7, v1
    v_cvt_f32_u32 v6, v6
    v_mul_f32 v7, 0x3d800000, v7
    v_mul_f32 v9, v6, v7
    v_cos_f32 v64, v9
    v_sin_f32 v68, v9
    v_add_f32 v9, v9, v7
    v_cos_f32 v65, v9
    v_sin_f32 v69, v9
    v_add_f32 v9, v9, v7
    v_cos_f32 v66, v9
    v_sin_f32 v70, v9
    v_add_f32 v9, v9, v7
    v_cos_f32 v67, v9
    v_sin_f32 v71, v9
    s_nop 0
    v_cvt_pk_bf16_f32 v40, v64, v68
    v_cvt_pk_bf16_f32 v48, -v68, v64
    v_cvt_pk_bf16_f32 v41, v65, v69
    v_cvt_pk_bf16_f32 v49, -v69, v65
    v_cvt_pk_bf16_f32 v42, v66, v70
    v_cvt_pk_bf16_f32 v50, -v70, v66
    v_cvt_pk_bf16_f32 v43, v67, v71
    v_cvt_pk_bf16_f32 v51, -v71, v67
    v_add_f32 v7, 0x3d800000, v7
    v_mul_f32 v9, v6, v7
    v_cos_f32 v64, v9
    v_sin_f32 v68, v9
    v_add_f32 v9, v9, v7
    v_cos_f32 v65, v9
    v_sin_f32 v69, v9
    v_add_f32 v9, v9, v7
    v_cos_f32 v66, v9
    v_sin_f32 v70, v9
    v_add_f32 v9, v9, v7
    v_cos_f32 v67, v9
    v_sin_f32 v71, v9
    s_nop 0
    v_cvt_pk_bf16_f32 v44, v64, -v68
    v_cvt_pk_bf16_f32 v52, -v68, -v64
    v_cvt_pk_bf16_f32 v45, v65, -v69
    v_cvt_pk_bf16_f32 v53, -v69, -v65
    v_cvt_pk_bf16_f32 v46, v66, -v70
    v_cvt_pk_bf16_f32 v54, -v70, -v66
    v_cvt_pk_bf16_f32 v47, v67, -v71
    v_cvt_pk_bf16_f32 v55, -v71, -v67
    ds_write_b128 v5, v[40:43] offset:42688
    ds_write_b128 v5, v[44:47] offset:43712
    ds_write_b128 v5, v[48:51] offset:44736
    ds_write_b128 v5, v[52:55] offset:45760
    global_load_dword v30, v31, s[30:31]
    s_waitcnt lgkmcnt(0)
    v_mov_b32 v9, 33792
    s_waitcnt vmcnt(0)
    v_mul_lo_u32 v31, v30, s64
    v_add_u32 v31, 0x7F4A7C15, v31
    v_lshlrev_b32 v6, 1, v1
    v_lshrrev_b32 v6, v6, v31
    v_lshlrev_b32 v7, 15, v6
    v_and_b32 v6, 1, v6
    v_and_b32 v7, 0x10000, v7
    v_or_b32 v6, v6, v7
    v_lshlrev_b32 v7, 2, v1
    ds_write_b32 v7, v6 offset:33920
    s_waitcnt lgkmcnt(0)
    v_mov_b32 v9, 33792
    s_barrier
    ds_read_b32 v30, v9
    s_mov_b32 exec_lo, -1
    s_mov_b32 exec_hi, 0x7
    s_waitcnt lgkmcnt(0)
    buffer_store_dwordx2 v[30:31], v14, s[36:39], s50 offen sc1
    s_mov_b64 exec, -1
    s_barrier
    s_and_b32 s61, s2, 7
    s_mul_i32 s61, s61, 2048
    s_add_u32 s61, s61, 84992
    s_add_u32 s62, s61, 1024
    s_waitcnt vmcnt(0)
    s_sleep 6
    s_branch L_poll5_1
L_poll5:
    s_sleep 5
L_poll5_1:
    buffer_load_dwordx4 v[32:35], v5, s[36:39], s61 offen sc1
    s_add_u32 s61, s61, 1024
    s_min_u32 s61, s61, s62
    s_add_u32 s65, s65, 1
    s_lshr_b32 s34, s65, 17
    s_waitcnt vmcnt(0)
    s_cbranch_scc1 L_poll5_ok
    v_cmp_ne_u32 vcc, v31, v33
    v_cmp_ne_u32 s[12:13], v31, v35
    s_or_b64 vcc, vcc, s[12:13]
    s_cbranch_vccnz L_poll5
L_poll5_ok:
    v_max_u32 v32, v32, v34
    s_nop 1
    v_max_u32_dpp v32, v32, v32 row_ror:8 row_mask:0xf bank_mask:0xf
    s_nop 1
    v_max_u32_dpp v32, v32, v32 row_ror:4 row_mask:0xf bank_mask:0xf
    s_nop 1
    v_max_u32_dpp v32, v32, v32 row_ror:2 row_mask:0xf bank_mask:0xf
    s_nop 1
    v_max_u32_dpp v32, v32, v32 row_ror:1 row_mask:0xf bank_mask:0xf
    s_nop 1
    v_max_u32_dpp v32, v32, v32 row_bcast:15 row_mask:0xa bank_mask:0xf
    s_nop 1
    v_max_u32_dpp v32, v32, v32 row_bcast:31 row_mask:0xc bank_mask:0xf
    v_mov_b32 v9, 33856
    s_mov_b32 exec_lo, 0
    s_brev_b32 exec_hi, 1
    ds_write_b32 v9, v32
    s_mov_b64 exec, -1
    s_waitcnt lgkmcnt(0)
    s_sleep 1
    s_barrier
    s_endpgm
    s_barrier
    s_endpgm
L_notA:
    s_lshl4_add_u32 s60, s6, s7
    s_sub_u32 s60, s60, 16
    s_cmp_ge_u32 s2, 256
    s_cbranch_scc1 L_end
    s_cmp_lt_u32 s6, 4
    s_cbranch_scc1 L_F
    s_mul_i32 s60, s6, 12
    s_add_u32 s60, s60, s7
    s_cmp_lt_u32 s7, 28
    s_cbranch_scc1 L_F
    s_mov_b32 s55, 1
    s_lshl2_add_u32 s47, s6, s7
    s_sub_u32 s47, s47, 44
    v_and_b32 v6, 1, v2
    v_lshlrev_b32 v6, 5, v6
    v_lshl_add_u32 v6, v1, 6, v6
    v_lshrrev_b32 v7, 1, v2
    v_lshl_add_u32 v3, v7, 4, v6
    v_lshlrev_b32 v5, 4, v0
    v_lshlrev_b32 v8, 31, v1
    v_lshrrev_b32 v9, 16, v8
    v_or_b32 v8, v8, v9
    s_waitcnt lgkmcnt(0)
    s_mov_b32 s36, s30
    s_mov_b32 s37, s31
    s_mov_b32 s38, 0x1000000
    s_mov_b32 s39, 0x20000
    s_mov_b32 s65, 0
    s_mov_b32 s40, s26
    s_mov_b32 s41, s27
    s_mov_b32 s42, 0x200000
    s_mov_b32 s43, 0x20000
    v_lshlrev_b32 v6, 4, v1
    v_lshl_add_u32 v10, v2, 13, v6
    v_mul_u32_u24 v6, 4352, v2
    v_bfe_u32 v7, v1, 1, 2
    v_xor_b32 v7, s3, v7
    v_lshl_add_u32 v7, v7, 4, v6
    v_lshl_add_u32 v11, v1, 6, v7
    s_lshl4_add_u32 s7, s3, 1024
    v_mov_b32 v9, 17600
    v_lshl_add_u32 v28, v0, 1, v9
    v_lshl_add_u32 v7, v1, 1, s7
    s_mov_b32 exec_lo, 0x00ff00ff
    s_mov_b32 exec_hi, 0x00ff00ff
    v_add_u32 v28, v7, v6
    s_mov_b64 exec, -1
    s_cmp_eq_u32 s3, 8
    s_cbranch_scc1 L_zh
    s_cmp_ge_u32 s3, 4
    s_cbranch_scc1 L_z0
    v_cvt_f32_u32 v6, v1
    s_lshl_b32 s6, s3, 2
    v_lshl_add_u32 v7, v2, 6, s6
    v_mul_f32 v6, 0x3b000000, v6
    v_cvt_f32_u32 v7, v7
    v_mul_f32 v15, 0x41800000, v6
    v_mul_f32 v7, v7, v6
    v_cos_f32 v64, v7
    v_sin_f32 v68, v7
    v_add_f32 v9, v7, v15
    v_cos_f32 v65, v9
    v_sin_f32 v69, v9
    v_add_f32 v9, v9, v15
    v_cos_f32 v66, v9
    v_sin_f32 v70, v9
    v_add_f32 v9, v9, v15
    v_cos_f32 v67, v9
    v_sin_f32 v71, v9
    v_mov_b32 v108, 0
    v_cvt_pk_bf16_f32 v100, v64, v65
    v_cvt_pk_bf16_f32 v104, -v68, -v69
    v_cvt_pk_bf16_f32 v101, v66, v67
    v_cvt_pk_bf16_f32 v105, -v70, -v71
    v_xor_b32 v102, v100, v8
    v_xor_b32 v106, v104, v8
    v_xor_b32 v103, v101, v8
    v_xor_b32 v107, v105, v8
    v_add_f32 v7, v7, v6
    v_cos_f32 v64, v7
    v_sin_f32 v68, v7
    v_add_f32 v9, v7, v15
    v_cos_f32 v65, v9
    v_sin_f32 v69, v9
    v_add_f32 v9, v9, v15
    v_cos_f32 v66, v9
    v_sin_f32 v70, v9
    v_add_f32 v9, v9, v15
    v_cos_f32 v67, v9
    v_sin_f32 v71, v9
    v_mov_b32 v120, 0
    v_cvt_pk_bf16_f32 v112, v64, v65
    v_cvt_pk_bf16_f32 v116, -v68, -v69
    v_cvt_pk_bf16_f32 v113, v66, v67
    v_cvt_pk_bf16_f32 v117, -v70, -v71
    v_xor_b32 v114, v112, v8
    v_xor_b32 v118, v116, v8
    v_xor_b32 v115, v113, v8
    v_xor_b32 v119, v117, v8
    v_add_f32 v7, v7, v6
    v_cos_f32 v64, v7
    v_sin_f32 v68, v7
    v_add_f32 v9, v7, v15
    v_cos_f32 v65, v9
    v_sin_f32 v69, v9
    v_add_f32 v9, v9, v15
    v_cos_f32 v66, v9
    v_sin_f32 v70, v9
    v_add_f32 v9, v9, v15
    v_cos_f32 v67, v9
    v_sin_f32 v71, v9
    v_mov_b32 v132, 0
    v_cvt_pk_bf16_f32 v124, v64, v65
    v_cvt_pk_bf16_f32 v128, -v68, -v69
    v_cvt_pk_bf16_f32 v125, v66, v67
    v_cvt_pk_bf16_f32 v129, -v70, -v71
    v_xor_b32 v126, v124, v8
    v_xor_b32 v130, v128, v8
    v_xor_b32 v127, v125, v8
    v_xor_b32 v131, v129, v8
    v_add_f32 v7, v7, v6
    v_cos_f32 v64, v7
    v_sin_f32 v68, v7
    v_add_f32 v9, v7, v15
    v_cos_f32 v65, v9
    v_sin_f32 v69, v9
    v_add_f32 v9, v9, v15
    v_cos_f32 v66, v9
    v_sin_f32 v70, v9
    v_add_f32 v9, v9, v15
    v_cos_f32 v67, v9
    v_sin_f32 v71, v9
    v_mov_b32 v144, 0
    v_cvt_pk_bf16_f32 v136, v64, v65
    v_cvt_pk_bf16_f32 v140, -v68, -v69
    v_cvt_pk_bf16_f32 v137, v66, v67
    v_cvt_pk_bf16_f32 v141, -v70, -v71
    v_xor_b32 v138, v136, v8
    v_xor_b32 v142, v140, v8
    v_xor_b32 v139, v137, v8
    v_xor_b32 v143, v141, v8
    v_lshrrev_b32 v6, 1, v1
    v_add_u32 v7, s6, v6
    v_and_b32 v9, 1, v1
    v_lshl_add_u32 v7, v9, 3, v7
    v_cvt_f32_u32 v7, v7
    v_mul_f32 v7, 0x3d000000, v7
    v_cos_f32 v7, v7
    s_mov_b32 exec_lo, 0x30003
    s_mov_b32 exec_hi, 0x30003
    v_cvt_pk_bf16_f32 v108, v7, -v7
    s_mov_b32 exec_lo, 0xc000c
    s_mov_b32 exec_hi, 0xc000c
    v_cvt_pk_bf16_f32 v120, v7, -v7
    s_mov_b32 exec_lo, 0x300030
    s_mov_b32 exec_hi, 0x300030
    v_cvt_pk_bf16_f32 v132, v7, -v7
    s_mov_b32 exec_lo, 0xc000c0
    s_mov_b32 exec_hi, 0xc000c0
    v_cvt_pk_bf16_f32 v144, v7, -v7
    s_mov_b64 exec, -1
    v_mov_b32 v109, v108
    v_mov_b32 v110, v108
    v_mov_b32 v111, v108
    v_mov_b32 v121, v120
    v_mov_b32 v122, v120
    v_mov_b32 v123, v120
    v_mov_b32 v133, v132
    v_mov_b32 v134, v132
    v_mov_b32 v135, v132
    v_mov_b32 v145, v144
    v_mov_b32 v146, v144
    v_mov_b32 v147, v144
    s_branch L_z1
L_z0:
    s_branch L_hi1
L_z0b:
    s_mov_b64 exec, 0
    s_sub_u32 s53, s3, 8
L_tzback:
    s_add_u32 s53, s53, 4
    s_cmp_eq_u32 s53, 0
    s_cbranch_scc1 L_tz0
    s_cmp_eq_u32 s53, 1
    s_cbranch_scc1 L_tz1
    s_cmp_eq_u32 s53, 2
    s_cbranch_scc1 L_tz2
    s_cmp_eq_u32 s53, 3
    s_cbranch_scc1 L_tz3
    s_cmp_eq_u32 s53, 4
    s_cbranch_scc1 L_tz4
    s_cmp_eq_u32 s53, 5
    s_cbranch_scc1 L_tz5
    s_cmp_eq_u32 s53, 6
    s_cbranch_scc1 L_tz6
    s_cmp_eq_u32 s53, 7
    s_cbranch_scc1 L_tz7
    s_mov_b64 exec, -1
L_z1:
    v_mov_b32 v9, 33792
    v_mov_b32 v12, 0
    v_mov_b32 v13, 0
    s_barrier
    ds_read_b64 v[30:31], v9
    ds_read_b128 v[24:27], v5 offset:47808
    s_waitcnt lgkmcnt(0)
    v_readfirstlane_b32 s44, v30
    s_andn2_b32 s54, 2047, s44
    s_and_b32 s6, s54, 127
    s_cmp_gt_u32 s6, 64
    s_cselect_b32 s46, 1, 0
    s_and_b32 s6, s54, 1087
    s_cmp_eq_u32 s6, 1024
    s_cselect_b32 s46, 1, s46
    s_sub_u32 s6, 2048, s54
    s_cmp_lg_u32 s46, 0
    s_cselect_b32 s6, s6, s54
    s_cmp_eq_u32 s6, 1024
    s_cselect_b32 s6, 0, s6
    s_and_b32 s56, s6, 127
    s_lshr_b32 s57, s6, 10
    s_bfe_u32 s45, s6, 0x30007
    s_lshl3_add_u32 s11, s57, s45
    s_lshl_b32 s11, s11, 7
    s_add_u32 s58, s11, s56
    s_sub_u32 s59, 2048, s58
    s_cmp_eq_u32 s58, 0
    s_cselect_b32 s59, 1024, s59
    s_lshl_b32 s10, s58, 10
    s_lshl_b32 s11, s59, 10
    v_add_u32 v6, s10, v5
    v_add_u32 v7, s11, v5
    s_cmp_ge_u32 s3, 4
    s_cbranch_scc1 L_z4
    s_and_b32 s7, s56, 63
    s_mul_i32 s32, s7, 33024
    s_lshl_b32 s7, s3, 9
    s_add_u32 s32, s32, s7
    s_add_u32 s32, s32, 2097152
    s_add_u32 s33, s32, 4096
    s_sleep 5
    buffer_load_dwordx4 v[32:35], v10, s[36:39], s32 offen offset:0 sc1
    buffer_load_dwordx4 v[36:39], v10, s[36:39], s32 offen offset:2048 sc1
    buffer_load_dwordx4 v[40:43], v10, s[36:39], s33 offen offset:0 sc1
    buffer_load_dwordx4 v[44:47], v10, s[36:39], s33 offen offset:2048 sc1
    buffer_load_dwordx4 v[48:51], v10, s[36:39], s32 offen offset:256 sc1
    buffer_load_dwordx4 v[52:55], v10, s[36:39], s32 offen offset:2304 sc1
    buffer_load_dwordx4 v[56:59], v10, s[36:39], s33 offen offset:256 sc1
    buffer_load_dwordx4 v[60:63], v10, s[36:39], s33 offen offset:2304 sc1
    v_lshrrev_b32 v6, 1, v1
    s_lshl_b32 s6, s57, 10
    s_add_u32 s6, s6, s56
    v_lshl_add_u32 v6, v6, 7, s6
    v_and_b32 v7, 1, v1
    v_lshlrev_b32 v9, 9, v7
    s_cmp_lg_u32 s56, 0
    s_cbranch_scc1 L_g06
    s_mov_b32 exec_lo, 0x00020002
    s_mov_b32 exec_hi, 0x00020002
    v_mov_b32 v6, 0x400
    v_mov_b32 v9, 0
    s_mov_b64 exec, -1
L_g06:
    v_lshlrev_b32 v7, 2, v2
    v_mad_u32_u24 v9, v7, v6, v9
    v_cvt_f32_u32 v6, v6
    v_cvt_f32_u32 v9, v9
    v_mul_f32 v6, 0x3a000000, v6
    v_mul_f32 v9, 0x3a000000, v9
    v_cos_f32 v64, v9
    v_sin_f32 v68, v9
    v_add_f32 v9, v9, v6
    v_cos_f32 v65, v9
    v_sin_f32 v69, v9
    v_add_f32 v9, v9, v6
    v_cos_f32 v66, v9
    v_sin_f32 v70, v9
    v_add_f32 v9, v9, v6
    v_cos_f32 v67, v9
    v_sin_f32 v71, v9
    s_and_b32 s7, s56, 63
    s_nop 0
    v_cvt_pk_bf16_f32 v148, v64, v68
    v_cvt_pk_bf16_f32 v149, v65, v69
    v_cvt_pk_bf16_f32 v150, v66, v70
    v_cvt_pk_bf16_f32 v151, v67, v71
    s_cmp_lg_u32 s7, 0
    s_cbranch_scc1 L_gd7
    s_lshr_b32 s7, s56, 2
    v_and_b32 v148, 0xffff, v148
    v_lshlrev_b32 v148, s7, v148
    v_and_b32 v149, 0xffff, v149
    v_lshlrev_b32 v149, s7, v149
    v_and_b32 v150, 0xffff, v150
    v_lshlrev_b32 v150, s7, v150
    v_and_b32 v151, 0xffff, v151
    v_lshlrev_b32 v151, s7, v151
L_gd7:
    v_and_b32 v6, 3, v1
    v_lshlrev_b32 v6, 4, v6
    ds_read_b128 v[96:99], v6 offset:33920
    s_waitcnt lgkmcnt(0)
    s_mul_i32 s7, s45, 2176
    v_bfe_u32 v7, v1, 1, 2
    v_xor_b32 v7, v7, v2
    v_lshl_add_u32 v7, v7, 4, s7
    v_lshl_add_u32 v29, v1, 6, v7
    v_sub_u32 v6, 16, v1
    v_bfe_u32 v7, v6, 1, 2
    v_xor_b32 v7, v7, v2
    v_lshl_add_u32 v7, v7, 4, s7
    v_lshl_add_u32 v30, v6, 6, v7
    s_cmp_eq_u32 s58, 0
    s_cselect_b32 s6, 0, 2048
    v_add_u32 v4, s6, v5
    v_lshlrev_b32 v6, 7, v1
    v_lshl_add_u32 v15, v2, 4, v6
    s_branch L_zjoin
L_z4:
    s_cmp_ge_u32 s3, 6
    s_cbranch_scc1 L_zend2
    global_load_dwordx4 v[16:19], v6, s[4:5]
    global_load_dwordx4 v[20:23], v7, s[4:5]
    s_sub_u32 s6, s3, 4
    s_lshl1_add_u32 s7, s47, s6
    s_lshl_b32 s7, s7, 5
    v_and_b32 v6, 7, v0
    v_lshl_add_u32 v10, v6, 2, s7
    s_lshl_b32 s8, s54, 10
    v_add_u32 v7, s8, v10
    global_load_dword v35, v7, s[4:5]
    v_lshlrev_b32 v10, 1, v10
    v_lshrrev_b32 v7, 3, v0
    v_lshlrev_b32 v7, 8, v7
    v_lshl_add_u32 v11, v6, 4, v7
    s_mul_i32 s48, s47, 14336
    s_lshl_b32 s6, s6, 7
    s_add_u32 s48, s48, s6
    s_add_u32 s48, s48, 720896
    s_add_u32 s49, s48, 0
    s_and_b32 s6, s44, 0xffff0000
    s_xor_b32 s7, s6, 0x80000000
    s_xor_b32 s9, s6, 0xffff0000
    s_bitcmp1_b32 s6, 31
    s_cselect_b32 s6, s7, s9
    v_mov_b32 v15, s6
    v_mul_f32 v15, 0xbfb8aa3b, v15
    v_exp_f32 v15, v15
    s_nop 0
    v_add_f32 v15, 1.0, v15
    v_rcp_f32 v15, v15
    s_nop 0
    v_cvt_pk_bf16_f32 v15, v15, v15
    v_and_b32 v15, 0xffff0000, v15
    s_waitcnt vmcnt(0)
    v_dot2c_f32_bf16 v12, v16, v24
    v_dot2c_f32_bf16 v13, v20, v24
    v_dot2c_f32_bf16 v12, v17, v25
    v_dot2c_f32_bf16 v13, v21, v25
    v_dot2c_f32_bf16 v12, v18, v26
    v_dot2c_f32_bf16 v13, v22, v26
    v_dot2c_f32_bf16 v12, v19, v27
    v_dot2c_f32_bf16 v13, v23, v27
    s_nop 2
    v_permlane32_swap_b32 v12, v13
    v_add_f32 v12, v12, v13
    v_mov_b32 v13, v12
    s_nop 1
    v_permlane16_swap_b32 v12, v13
    v_add_f32 v12, v12, v13
    s_nop 1
    v_add_f32_dpp v12, v12, v12 row_ror:8 row_mask:0xf bank_mask:0xf
    s_nop 1
    v_add_f32_dpp v12, v12, v12 row_ror:4 row_mask:0xf bank_mask:0xf
    s_nop 1
    v_add_f32_dpp v12, v12, v12 row_ror:2 row_mask:0xf bank_mask:0xf
    s_nop 1
    v_add_f32_dpp v12, v12, v12 row_ror:1 row_mask:0xf bank_mask:0xf
    v_cvt_pk_bf16_f32 v12, v12, v12
    v_and_b32 v12, 0xffff0000, v12
    v_mul_f32 v13, 0xbfb8aa3b, v12
    v_exp_f32 v13, v13
    s_nop 0
    v_add_f32 v13, 1.0, v13
    v_rcp_f32 v13, v13
    s_nop 0
    v_cvt_pk_bf16_f32 v13, v13, v13
    v_and_b32 v13, 0xffff0000, v13
    v_sub_f32 v14, 1.0, v13
    v_cvt_pk_bf16_f32 v14, v14, v14
    v_and_b32 v14, 0xffff0000, v14
    v_readlane_b32 s6, v13, 0
    v_readlane_b32 s7, v13, 32
    v_readlane_b32 s8, v14, 0
    v_readlane_b32 s9, v14, 32
    s_xor_b32 s10, s6, 0x80000000
    s_cmp_eq_u32 s58, 0
    s_cselect_b32 s10, 0, s10
    s_cselect_b32 s11, 0, s7
    s_cmp_lg_u32 s46, 0
    s_cselect_b32 s8, s9, s8
    s_cselect_b32 s6, s11, s6
    s_cselect_b32 s10, s7, s10
    v_xor_b32 v31, s54, v31
    v_mov_b32 v36, s8
    v_mov_b32 v24, s6
    v_mov_b32 v25, s10
    v_lshlrev_b32 v34, 16, v35
    v_and_b32 v35, 0xffff0000, v35
    s_sleep 22
    v_mov_b32 v9, 33864
L_tz_start:
L_zp:
    buffer_load_dwordx4 v[40:43], v11, s[36:39], s48 offen offset:0 sc1
    buffer_load_dwordx4 v[44:47], v11, s[36:39], s48 offen offset:2048 sc1
    s_add_u32 s6, s48, 4096
    buffer_load_dwordx4 v[48:51], v11, s[36:39], s6 offen offset:0 sc1
    buffer_load_dwordx4 v[52:55], v11, s[36:39], s6 offen offset:2048 sc1
    s_add_u32 s6, s48, 8192
    buffer_load_dwordx4 v[56:59], v11, s[36:39], s6 offen offset:0 sc1
    buffer_load_dwordx4 v[60:63], v11, s[36:39], s6 offen offset:2048 sc1
    s_add_u32 s6, s48, 12288
L_tz0:
    s_cbranch_execz L_tzback
    buffer_load_dwordx4 v[64:67], v11, s[36:39], s6 offen offset:0 sc1
    s_add_u32 s48, s48, 229376
    s_min_u32 s48, s48, s49
    s_add_u32 s65, s65, 1
    s_lshr_b32 s34, s65, 17
    s_cbranch_scc1 L_zp_ok
    s_waitcnt vmcnt(6)
    v_bitop3_b32 v37, v41, v43, v31 bitop3:0x7e
    s_waitcnt vmcnt(5)
    v_bitop3_b32 v39, v45, v47, v31 bitop3:0x7e
    v_add_f32 v40, v40, v44
    v_add_f32 v42, v42, v46
    s_waitcnt vmcnt(4)
    v_bitop3_b32 v38, v49, v51, v31 bitop3:0x7e
    v_add_f32 v40, v40, v48
    v_add_f32 v42, v42, v50
    v_or3_b32 v37, v37, v38, v39
    s_waitcnt vmcnt(3)
    v_bitop3_b32 v39, v53, v55, v31 bitop3:0x7e
    v_add_f32 v40, v40, v52
    v_add_f32 v42, v42, v54
    s_waitcnt vmcnt(2)
    v_bitop3_b32 v38, v57, v59, v31 bitop3:0x7e
L_tz1:
    s_cbranch_execz L_tzback
    v_add_f32 v40, v40, v56
    v_add_f32 v42, v42, v58
    v_or3_b32 v37, v37, v38, v39
    s_waitcnt vmcnt(1)
    v_bitop3_b32 v39, v61, v63, v31 bitop3:0x7e
    v_add_f32 v40, v40, v60
    v_add_f32 v42, v42, v62
    s_waitcnt vmcnt(0)
    v_bitop3_b32 v38, v65, v67, v31 bitop3:0x7e
    v_add_f32 v40, v40, v64
    v_add_f32 v42, v42, v66
    v_or3_b32 v37, v37, v38, v39
    v_cmp_ne_u32 vcc, 0, v37
    s_nop 0
    s_cbranch_vccnz L_zp
L_zp_ok:
    ds_read_b32 v12, v9
    ds_read_b64 v[32:33], v10 offset:38592
    ds_read_b64 v[16:17], v10 offset:40640
    v_lshrrev_b32 v11, 1, v10
    s_lshl_b32 s8, s54, 10
    s_waitcnt vmcnt(0)
    v_add_f32_dpp v40, v40, v40 row_ror:8 row_mask:0xf bank_mask:0xf
L_tz2:
    s_cbranch_execz L_tzback
    v_add_f32_dpp v42, v42, v42 row_ror:8 row_mask:0xf bank_mask:0xf
    s_nop 0
    s_nop 0
    v_permlane16_swap_b32 v40, v42
    v_add_f32 v40, v40, v42
    v_mov_b32 v42, v40
    s_nop 1
    v_permlane32_swap_b32 v40, v42
    v_add_f32 v40, v40, v42
    v_mov_b32 v42, v40
    s_nop 1
    v_permlane16_swap_b32 v40, v42
    v_cvt_pk_bf16_f32 v41, v40, v42
    v_lshlrev_b32 v40, 16, v41
    v_and_b32 v42, 0xffff0000, v41
    v_mul_f32 v40, v40, v15
    v_mul_f32 v42, v42, v15
    v_cvt_pk_bf16_f32 v41, v40, v42
    v_lshlrev_b32 v40, 16, v41
    v_and_b32 v42, 0xffff0000, v41
    v_add_f32 v40, v40, v34
    v_add_f32 v42, v42, v35
    v_cvt_pk_bf16_f32 v41, v40, v42
    v_lshlrev_b32 v40, 16, v41
    v_and_b32 v42, 0xffff0000, v41
L_zw:
L_tz3:
    s_cbranch_execz L_tzback
    s_waitcnt lgkmcnt(0)
    v_cmp_eq_u32 vcc, 0, v12
    v_mul_f32 v32, v24, v32
    v_mul_f32 v33, v24, v33
    s_cbranch_vccz L_zw_ok
    s_add_u32 s65, s65, 1
    s_lshr_b32 s34, s65, 17
    s_cbranch_scc1 L_zw_ok
    ds_read_b32 v12, v9
    ds_read_b64 v[32:33], v10 offset:38592
    ds_read_b64 v[16:17], v10 offset:40640
    s_branch L_zw
L_zw_ok:
    v_fmac_f32 v32, v25, v16
    v_fmac_f32 v33, v25, v17
    v_fmac_f32 v32, v40, v36
    v_fmac_f32 v33, v42, v36
    v_cvt_pk_bf16_f32 v32, v32, v33
    s_mov_b64 exec, 0xff
    buffer_store_dword v32, v11, s[40:43], s8 offen
    s_mov_b64 exec, -1
    s_barrier
    s_endpgm
L_zsync:
    v_mov_b32 v9, 33868
L_tz4:
    s_cbranch_execz L_tzback
    v_mov_b32 v6, 1
    s_mov_b64 exec, 1
    ds_add_u32 v9, v6
    s_mov_b64 exec, -1
    s_cmp_lg_u32 s3, 0
    s_cbranch_scc1 L_zend
L_zs:
    ds_read_b32 v6, v9
    s_add_u32 s65, s65, 1
    s_lshr_b32 s34, s65, 17
    s_waitcnt lgkmcnt(0)
    s_cbranch_scc1 L_zs_ok
    v_cmp_ne_u32 vcc, 4, v6
    s_nop 0
    s_cbranch_vccnz L_zs
L_zs_ok:
    ds_read_b128 v[32:35], v29 offset:16384
    ds_read_b128 v[36:39], v30 offset:16384
    ds_read_b128 v[40:43], v29 offset:17472
    ds_read_b128 v[44:47], v30 offset:17472
    s_waitcnt lgkmcnt(3)
    v_mfma_f32_16x16x32_bf16 v[48:51], v[32:35], v[64:67], 0
    s_waitcnt lgkmcnt(2)
    v_mfma_f32_16x16x32_bf16 v[52:55], v[36:39], v[68:71], 0
    s_waitcnt lgkmcnt(1)
L_tz5:
    s_cbranch_execz L_tzback
    v_mfma_f32_16x16x32_bf16 v[56:59], v[40:43], v[72:75], 0
    s_waitcnt lgkmcnt(0)
    v_mfma_f32_16x16x32_bf16 v[60:63], v[44:47], v[76:79], 0
    s_nop 2
    ds_write_b128 v15, v[48:51] offset:38592
    ds_write_b128 v15, v[52:55] offset:38656
    s_nop 1
    ds_write_b128 v15, v[56:59] offset:40640
    ds_write_b128 v15, v[60:63] offset:40704
    v_mov_b32 v9, 33864
    s_waitcnt lgkmcnt(0)
    ds_write_b32 v9, v9
    s_waitcnt lgkmcnt(0)
.set L_tz6, L_tzback
.set L_tz7, L_tzback
L_zend:
    s_endpgm
L_zend2:
    s_endpgm
L_zh:
    v_mov_b32 v9, 33864
    v_mov_b32 v6, 0
    ds_write2_b32 v9, v6, v6 offset1:1
    v_lshlrev_b32 v6, 2, v2
    v_cvt_f32_u32 v7, v1
    v_cvt_f32_u32 v6, v6
    v_mul_f32 v7, 0x3d800000, v7
    v_mul_f32 v9, v6, v7
    v_cos_f32 v64, v9
    v_sin_f32 v68, v9
    v_add_f32 v9, v9, v7
    v_cos_f32 v65, v9
    v_sin_f32 v69, v9
    v_add_f32 v9, v9, v7
    v_cos_f32 v66, v9
    v_sin_f32 v70, v9
    v_add_f32 v9, v9, v7
    v_cos_f32 v67, v9
    v_sin_f32 v71, v9
    s_nop 0
    v_cvt_pk_bf16_f32 v40, v64, v68
    v_cvt_pk_bf16_f32 v48, -v68, v64
    v_cvt_pk_bf16_f32 v41, v65, v69
    v_cvt_pk_bf16_f32 v49, -v69, v65
    v_cvt_pk_bf16_f32 v42, v66, v70
    v_cvt_pk_bf16_f32 v50, -v70, v66
    v_cvt_pk_bf16_f32 v43, v67, v71
    v_cvt_pk_bf16_f32 v51, -v71, v67
    v_add_f32 v7, 0x3d800000, v7
    v_mul_f32 v9, v6, v7
    v_cos_f32 v64, v9
    v_sin_f32 v68, v9
    v_add_f32 v9, v9, v7
    v_cos_f32 v65, v9
    v_sin_f32 v69, v9
    v_add_f32 v9, v9, v7
    v_cos_f32 v66, v9
    v_sin_f32 v70, v9
    v_add_f32 v9, v9, v7
    v_cos_f32 v67, v9
    v_sin_f32 v71, v9
    s_nop 0
    v_cvt_pk_bf16_f32 v44, v64, -v68
    v_cvt_pk_bf16_f32 v52, -v68, -v64
    v_cvt_pk_bf16_f32 v45, v65, -v69
    v_cvt_pk_bf16_f32 v53, -v69, -v65
    v_cvt_pk_bf16_f32 v46, v66, -v70
    v_cvt_pk_bf16_f32 v54, -v70, -v66
    v_cvt_pk_bf16_f32 v47, v67, -v71
    v_cvt_pk_bf16_f32 v55, -v71, -v67
    ds_write_b128 v5, v[40:43] offset:42688
    ds_write_b128 v5, v[44:47] offset:43712
    ds_write_b128 v5, v[48:51] offset:44736
    ds_write_b128 v5, v[52:55] offset:45760
    s_mov_b32 m0, 47808
    v_mov_b32 v31, 0
    global_load_dword v30, v31, s[30:31]
    s_mov_b32 s64, 0x9E3779B1
    global_load_lds_dwordx4 v5, s[24:25]
    s_waitcnt vmcnt(0)
    v_mul_lo_u32 v31, v30, s64
    v_add_u32 v31, 0x7F4A7C15, v31
    v_lshlrev_b32 v6, 1, v1
    v_lshrrev_b32 v6, v6, v31
    v_lshlrev_b32 v7, 15, v6
    v_and_b32 v6, 1, v6
    v_and_b32 v7, 0x10000, v7
    v_or_b32 v6, v6, v7
    v_lshlrev_b32 v7, 2, v1
    ds_write_b32 v7, v6 offset:33920
    s_waitcnt lgkmcnt(0)
    s_and_b32 s61, s2, 0
    s_mul_i32 s61, s61, 3072
    s_add_u32 s61, s61, 81920
    s_add_u32 s62, s61, 2048
    s_sleep 24
    s_branch L_poll8_1
L_poll8:
    s_sleep 8
L_poll8_1:
    buffer_load_dwordx4 v[32:35], v5, s[36:39], s61 offen sc1
    s_add_u32 s61, s61, 1024
    s_min_u32 s61, s61, s62
    s_add_u32 s65, s65, 1
    s_lshr_b32 s34, s65, 17
    s_waitcnt vmcnt(0)
    s_cbranch_scc1 L_poll8_ok
    v_cmp_ne_u32 vcc, v31, v33
    v_cmp_ne_u32 s[12:13], v31, v35
    s_or_b64 vcc, vcc, s[12:13]
    s_cbranch_vccnz L_poll8
L_poll8_ok:
    v_max_u32 v32, v32, v34
    s_nop 1
    v_max_u32_dpp v32, v32, v32 row_ror:8 row_mask:0xf bank_mask:0xf
    s_nop 1
    v_max_u32_dpp v32, v32, v32 row_ror:4 row_mask:0xf bank_mask:0xf
    s_nop 1
    v_max_u32_dpp v32, v32, v32 row_ror:2 row_mask:0xf bank_mask:0xf
    s_nop 1
    v_max_u32_dpp v32, v32, v32 row_ror:1 row_mask:0xf bank_mask:0xf
    s_nop 1
    v_max_u32_dpp v32, v32, v32 row_bcast:15 row_mask:0xa bank_mask:0xf
    s_nop 1
    v_max_u32_dpp v32, v32, v32 row_bcast:31 row_mask:0xc bank_mask:0xf
    v_mov_b32 v9, 33792
    s_mov_b32 exec_lo, 0
    s_brev_b32 exec_hi, 1
    ds_write2_b32 v9, v32, v31 offset1:1
    s_mov_b64 exec, -1
    s_waitcnt lgkmcnt(0)
    s_barrier
    s_lshl_b32 s6, s47, 2
    s_add_u32 s6, s6, 4096
    s_mov_b64 exec, 1
    buffer_store_dword v31, v0, s[36:39], s6 offen sc1
    s_mov_b64 exec, -1
    s_cmp_lg_u32 s47, 0
    s_cbranch_scc1 L_zend
    s_mov_b64 exec, 0xffff
    v_lshlrev_b32 v6, 2, v0
    s_mov_b32 s6, 4096
    s_waitcnt vmcnt(0)
    s_sleep 24
L_za:
    buffer_load_dword v7, v6, s[36:39], s6 offen sc1
    s_add_u32 s65, s65, 1
    s_lshr_b32 s34, s65, 17
    s_waitcnt vmcnt(0)
    s_cbranch_scc1 L_za_ok
    v_cmp_ne_u32 vcc, v31, v7
    s_nop 0
    s_cbranch_vccnz L_za
L_za_ok:
    s_mov_b64 exec, 1
    v_add_u32 v9, 1, v30
    s_barrier
    buffer_store_dword v9, v6, s[36:39], 0 offen sc1
    s_mov_b64 exec, -1
    s_branch L_zend
L_F:
    v_lshlrev_b32 v5, 4, v0
    s_cmp_eq_u32 s3, 8
    s_cbranch_scc1 L_fh
    s_and_b32 s6, s60, 3
    s_lshr_b32 s7, s3, 1
    s_lshl2_add_u32 s32, s6, s7
    s_mul_i32 s8, s32, 114688
    s_lshr_b32 s33, s60, 2
    s_lshl_b32 s9, s33, 7
    s_add_u32 s8, s8, s9
    v_lshrrev_b32 v6, 3, v0
    v_mul_u32_u24 v6, 3584, v6
    v_and_b32 v7, 7, v0
    v_bfe_u32 v8, v0, 4, 1
    v_lshlrev_b32 v8, 2, v8
    v_xor_b32 v4, v7, v8
    v_lshl_add_u32 v7, v4, 4, s8
    v_add_u32 v3, v6, v7
    s_lshl_b32 s10, s3, 12
    s_mov_b32 m0, s10
    v_bfe_u32 v6, v0, 2, 2
    v_and_b32 v7, 3, v0
    v_lshlrev_b32 v8, 3, v7
    v_lshl_add_u32 v8, v2, 5, v8
    v_and_b32 v9, 2, v6
    v_lshlrev_b32 v9, 5, v9
    v_xor_b32 v9, v9, v8
    v_lshl_add_u32 v9, v6, 7, v9
    v_add_u32 v9, s10, v9
    s_lshl_b32 s11, s3, 8
    v_lshlrev_b32 v11, 2, v0
    v_add_u32 v11, 49152, v11
    v_add_u32 v12, s11, v11
    s_lshl1_add_u32 s7, s33, s7
    s_lshl_b32 s8, s7, 15
    s_and_b32 s9, s3, 1
    s_lshl1_add_u32 s9, s6, s9
    s_lshl_b32 s11, s9, 7
    s_add_u32 s8, s8, s11
    v_lshrrev_b32 v6, 3, v0
    v_lshl_add_u32 v6, v6, 10, s8
    v_lshl_add_u32 v4, v4, 4, v6
    v_lshrrev_b32 v6, 5, v0
    v_mul_u32_u24 v13, 14336, v6
    v_and_b32 v6, 31, v0
    v_lshl_add_u32 v13, v6, 3, v13
    s_mul_i32 s8, s9, 28672
    s_lshl_b32 s7, s7, 8
    s_add_u32 s8, s8, s7
    s_add_u32 s8, s8, 720896
    s_lshl_b32 s32, s32, 6
    s_lshl_b32 s33, s33, 12
    s_add_u32 s61, s33, 196608
    s_add_u32 s62, s61, 114688
    s_lshl_b32 s7, s6, 10
    s_add_u32 s33, s61, s7
    v_mov_b32 v14, 51200
    s_lshr_b32 s7, s3, 1
    s_lshl_b32 s7, s7, 9
    v_lshl_add_u32 v15, v6, 4, s7
    v_lshrrev_b32 v6, 5, v0
    v_lshl_add_u32 v15, v6, 10, v15
    s_mov_b32 s40, s61
    s_mov_b32 s41, s33
    s_mov_b32 s42, s8
    s_mov_b32 s35, 0
    s_bitcmp1_b32 s3, 0
    s_waitcnt lgkmcnt(0)
    s_cselect_b32 s18, s20, s18
    s_cselect_b32 s19, s21, s19
    global_load_lds_dwordx4 v3, s[18:19]
    s_add_u32 m0, s10, 1024
    v_add_u32 v3, 28672, v3
    global_load_lds_dwordx4 v3, s[18:19]
    s_add_u32 m0, s10, 2048
    v_add_u32 v3, 28672, v3
    global_load_lds_dwordx4 v3, s[18:19]
    s_add_u32 m0, s10, 3072
    v_add_u32 v3, 28672, v3
    global_load_lds_dwordx4 v3, s[18:19]
    s_mov_b32 s36, s30
    s_mov_b32 s37, s31
    s_mov_b32 s38, 0x1000000
    s_mov_b32 s39, 0x20000
    s_mov_b32 s65, 0
    s_waitcnt vmcnt(0)
    s_cmp_ge_u32 s3, 4
    s_cbranch_scc1 L_nowd9
    s_add_u32 m0, s10, 32768
    s_nop 0
    global_load_lds_dwordx4 v4, s[22:23]
    s_add_u32 m0, s10, 33792
    v_add_u32 v4, 0x2000, v4
    global_load_lds_dwordx4 v4, s[22:23]
    s_add_u32 m0, s10, 34816
    v_add_u32 v4, 0x2000, v4
    global_load_lds_dwordx4 v4, s[22:23]
    s_add_u32 m0, s10, 35840
    v_add_u32 v4, 0x2000, v4
    global_load_lds_dwordx4 v4, s[22:23]
L_nowd9:
    ds_read_b64_tr_b16 v[32:33], v9 offset:0
    ds_read_b64_tr_b16 v[34:35], v9 offset:512
    ds_read_b64_tr_b16 v[36:37], v9 offset:1024
    ds_read_b64_tr_b16 v[38:39], v9 offset:1536
    ds_read_b64_tr_b16 v[40:41], v9 offset:2048
    ds_read_b64_tr_b16 v[42:43], v9 offset:2560
    ds_read_b64_tr_b16 v[44:45], v9 offset:3072
    ds_read_b64_tr_b16 v[46:47], v9 offset:3584
    s_mov_b64 exec, 0
    s_sub_u32 s53, s3, 8
L_tfback:
    s_add_u32 s53, s53, 8
    s_cmp_eq_u32 s53, 0
    s_cbranch_scc1 L_tf0
    s_cmp_eq_u32 s53, 1
    s_cbranch_scc1 L_tf1
    s_cmp_eq_u32 s53, 2
    s_cbranch_scc1 L_tf2
    s_cmp_eq_u32 s53, 3
    s_cbranch_scc1 L_tf3
    s_cmp_eq_u32 s53, 4
    s_cbranch_scc1 L_tf4
    s_cmp_eq_u32 s53, 5
    s_cbranch_scc1 L_tf5
    s_cmp_eq_u32 s53, 6
    s_cbranch_scc1 L_tf6
    s_cmp_eq_u32 s53, 7
    s_cbranch_scc1 L_tf7
    s_mov_b64 exec, -1
    s_waitcnt lgkmcnt(0)
    s_barrier
L_tf_start:
    ds_read_b64 v[26:27], v14
    s_waitcnt lgkmcnt(0)
    v_readfirstlane_b32 s43, v26
L_redo:
    s_andn2_b32 s6, 2047, s43
    s_lshl_b32 s7, s6, 10
    s_add_u32 s7, s7, s32
    s_load_dwordx16 s[44:59], s[4:5], s7
    v_xor_b32 v31, s6, v27
    v_xor_b32 v29, s6, v27
    v_mov_b32 v16, 0
    v_mov_b32 v17, 0
    v_mov_b32 v24, 0
    v_mov_b32 v25, 0
    s_mov_b32 s61, s40
    s_mov_b32 s33, s41
    s_mov_b32 s8, s42
    s_mov_b32 s64, 0
    s_waitcnt lgkmcnt(0)
    v_dot2c_f32_bf16 v16, s44, v32
    v_dot2c_f32_bf16 v17, s45, v33
    v_dot2c_f32_bf16 v16, s46, v34
    v_dot2c_f32_bf16 v17, s47, v35
L_tf0:
    s_cbranch_execz L_tfback
    v_dot2c_f32_bf16 v16, s48, v36
    v_dot2c_f32_bf16 v17, s49, v37
    v_dot2c_f32_bf16 v16, s50, v38
    v_dot2c_f32_bf16 v17, s51, v39
    v_dot2c_f32_bf16 v16, s52, v40
    v_dot2c_f32_bf16 v17, s53, v41
    v_dot2c_f32_bf16 v16, s54, v42
    v_dot2c_f32_bf16 v17, s55, v43
    v_dot2c_f32_bf16 v16, s56, v44
    v_dot2c_f32_bf16 v17, s57, v45
    v_dot2c_f32_bf16 v16, s58, v46
    v_dot2c_f32_bf16 v17, s59, v47
    s_nop 2
    v_add_f32 v16, v16, v17
    ds_write_b32 v12, v16
    s_waitcnt lgkmcnt(0)
    s_barrier
    s_lshl_b32 s6, s3, 4
    s_lshl_b64 s[12:13], 0xffff, s6
    ds_read2st64_b32 v[16:17], v11 offset0:0 offset1:2
    ds_read2st64_b32 v[18:19], v11 offset0:4 offset1:6
    ds_read2st64_b32 v[20:21], v11 offset0:1 offset1:3
    ds_read2st64_b32 v[22:23], v11 offset0:5 offset1:7
    s_waitcnt lgkmcnt(2)
    v_add_f32 v16, v16, v17
L_tf1:
    s_cbranch_execz L_tfback
    v_add_f32 v18, v18, v19
    s_waitcnt lgkmcnt(0)
    v_add_f32 v20, v20, v21
    v_add_f32 v22, v22, v23
    v_add_f32 v28, v16, v18
    s_mov_b64 exec, s[12:13]
    v_add_f32 v30, v20, v22
    s_cmp_ge_u32 s3, 4
    s_cbranch_scc1 L_f5
    buffer_store_dwordx4 v[28:31], v5, s[36:39], s33 offen
    s_mov_b64 exec, -1
    s_waitcnt vmcnt(1)
    ds_read_b64_tr_b16 v[48:49], v9 offset:32768
    ds_read_b64_tr_b16 v[50:51], v9 offset:33280
    ds_read_b64_tr_b16 v[52:53], v9 offset:33792
    ds_read_b64_tr_b16 v[54:55], v9 offset:34304
    ds_read_b64_tr_b16 v[56:57], v9 offset:34816
    ds_read_b64_tr_b16 v[58:59], v9 offset:35328
    ds_read_b64_tr_b16 v[60:61], v9 offset:35840
    ds_read_b64_tr_b16 v[62:63], v9 offset:36352
    s_sleep 3
L_fx:
    buffer_load_dwordx4 v[64:67], v15, s[36:39], s61 offen offset:0 sc1
L_tf2:
    s_cbranch_execz L_tfback
    buffer_load_dwordx4 v[68:71], v15, s[36:39], s61 offen offset:2048 sc1
    s_add_u32 s64, s64, 1
    s_cmp_ge_u32 s64, 5
    s_cselect_b32 s6, 114688, 0
    s_add_u32 s61, s61, s6
    s_min_u32 s61, s61, s62
    s_add_u32 s65, s65, 1
    s_lshr_b32 s34, s65, 17
    s_cbranch_scc1 L_fx_ok
    s_waitcnt vmcnt(1)
    v_bitop3_b32 v20, v65, v67, v31 bitop3:0x7e
    s_waitcnt vmcnt(0)
    v_add_f32 v16, v64, v68
    v_add_f32 v18, v66, v70
    v_bitop3_b32 v21, v69, v71, v31 bitop3:0x7e
    v_or_b32 v20, v20, v21
    v_cmp_ne_u32 vcc, 0, v20
    v_permlane32_swap_b32 v16, v18
    s_cbranch_vccnz L_fxr
L_fx_ok:
    v_add_f32 v16, v16, v18
    v_cvt_pk_bf16_f32 v16, v16, v16
    v_and_b32 v16, 0xffff0000, v16
    v_mov_b32 v18, v16
    v_mul_f32 v17, 0xbfb8aa3b, v16
L_tf3:
    s_cbranch_execz L_tfback
    v_exp_f32 v17, v17
    s_nop 0
    v_add_f32 v17, 1.0, v17
    v_rcp_f32 v17, v17
    s_nop 0
    v_permlane32_swap_b32 v16, v18
    v_mul_f32 v17, v17, v16
    v_cvt_pk_bf16_f32 v17, v17, v17
    v_and_b32 v17, 0xffff0000, v17
    v_mul_f32 v17, v17, v18
    s_nop 1
    v_mov_b32_dpp v18, v17 quad_perm:[1,0,3,2] row_mask:0xf bank_mask:0xf
    v_cvt_pk_bf16_f32 v17, v17, v18
    s_nop 0
    v_readlane_b32 s44, v17, 0
    v_readlane_b32 s45, v17, 2
    v_readlane_b32 s46, v17, 4
    v_readlane_b32 s47, v17, 6
    v_readlane_b32 s48, v17, 8
    v_readlane_b32 s49, v17, 10
L_tf4:
    s_cbranch_execz L_tfback
    v_readlane_b32 s50, v17, 12
    v_readlane_b32 s51, v17, 14
    v_readlane_b32 s52, v17, 16
    v_readlane_b32 s53, v17, 18
    v_readlane_b32 s54, v17, 20
    v_readlane_b32 s55, v17, 22
    v_readlane_b32 s56, v17, 24
    v_readlane_b32 s57, v17, 26
    v_readlane_b32 s58, v17, 28
    v_readlane_b32 s59, v17, 30
    s_waitcnt lgkmcnt(0)
    v_dot2c_f32_bf16 v24, s44, v48
    v_dot2c_f32_bf16 v25, s45, v49
    v_dot2c_f32_bf16 v24, s46, v50
    v_dot2c_f32_bf16 v25, s47, v51
    v_dot2c_f32_bf16 v24, s48, v52
    v_dot2c_f32_bf16 v25, s49, v53
    v_dot2c_f32_bf16 v24, s50, v54
    v_dot2c_f32_bf16 v25, s51, v55
    v_dot2c_f32_bf16 v24, s52, v56
    v_dot2c_f32_bf16 v25, s53, v57
L_tf5:
    s_cbranch_execz L_tfback
    v_dot2c_f32_bf16 v24, s54, v58
    v_dot2c_f32_bf16 v25, s55, v59
    v_dot2c_f32_bf16 v24, s56, v60
    v_dot2c_f32_bf16 v25, s57, v61
    v_dot2c_f32_bf16 v24, s58, v62
    v_dot2c_f32_bf16 v25, s59, v63
    s_nop 2
    v_add_f32 v30, v24, v25
    buffer_store_dwordx2 v[30:31], v13, s[36:39], s8 offen sc1
.set L_tf6, L_tfback
.set L_tf7, L_tfback
L_fend:
    s_cmp_lg_u32 s35, 0
    s_cbranch_scc1 L_fexit
    s_barrier
    ds_read_b32 v26, v14 offset:8
    s_mov_b32 s35, 1
    s_waitcnt lgkmcnt(0)
    v_readfirstlane_b32 s6, v26
    s_cmp_eq_u32 s6, s43
    s_mov_b32 s43, s6
    s_cbranch_scc0 L_redo
L_fexit:
    s_endpgm
L_f5:
    s_add_u32 s33, s33, 114688
    buffer_store_dwordx4 v[28:31], v5, s[36:39], s33 offen sc1
    s_mov_b64 exec, -1
    s_branch L_fend
L_fxr:
    ds_read_b32 v26, v14 offset:8
    s_waitcnt lgkmcnt(0)
    v_readfirstlane_b32 s6, v26
    s_cmp_eq_u32 s6, 0
    s_cbranch_scc1 L_fx
    s_cmp_eq_u32 s6, s43
    s_cbranch_scc1 L_fx
    s_branch L_fend
L_fh:
    s_waitcnt lgkmcnt(0)
    v_mov_b32 v31, 0
    global_load_dword v30, v31, s[30:31]
    s_mov_b32 s64, 0x9E3779B1
    s_mov_b32 s36, s30
    s_mov_b32 s37, s31
    s_mov_b32 s38, 0x1000000
    s_mov_b32 s39, 0x20000
    s_mov_b32 s65, 0
    v_mov_b32 v14, 51200
    v_mov_b32 v6, 0
    ds_write_b32 v14, v6 offset:8
    s_and_b32 s61, s2, 7
    s_mul_i32 s61, s61, 2048
    s_add_u32 s61, s61, 65536
    s_add_u32 s62, s61, 1024
    s_sleep 37
    s_waitcnt vmcnt(0)
    v_mul_lo_u32 v31, v30, s64
    v_add_u32 v31, 0x7F4A7C15, v31
    s_branch L_poll10_1
L_poll10:
    s_sleep 4
L_poll10_1:
    buffer_load_dwordx4 v[20:23], v5, s[36:39], s61 offen sc1
    s_add_u32 s61, s61, 1024
    s_min_u32 s61, s61, s62
    s_add_u32 s65, s65, 1
    s_lshr_b32 s34, s65, 17
    s_waitcnt vmcnt(0)
    s_cbranch_scc1 L_poll10_ok
    v_cmp_ne_u32 vcc, v31, v21
    v_cmp_ne_u32 s[12:13], v31, v23
    s_or_b64 vcc, vcc, s[12:13]
    s_cbranch_vccnz L_poll10
L_poll10_ok:
    v_max_u32 v20, v20, v22
    s_nop 1
    v_max_u32_dpp v20, v20, v20 row_ror:8 row_mask:0xf bank_mask:0xf
    s_nop 1
    v_max_u32_dpp v20, v20, v20 row_ror:4 row_mask:0xf bank_mask:0xf
    s_nop 1
    v_max_u32_dpp v20, v20, v20 row_ror:2 row_mask:0xf bank_mask:0xf
    s_nop 1
    v_max_u32_dpp v20, v20, v20 row_ror:1 row_mask:0xf bank_mask:0xf
    s_nop 1
    v_max_u32_dpp v20, v20, v20 row_bcast:15 row_mask:0xa bank_mask:0xf
    s_nop 1
    v_max_u32_dpp v20, v20, v20 row_bcast:31 row_mask:0xc bank_mask:0xf
    v_mov_b32 v9, 51200
    s_mov_b32 exec_lo, 0
    s_brev_b32 exec_hi, 1
    ds_write2_b32 v9, v20, v31 offset1:1
    s_mov_b64 exec, -1
    s_waitcnt lgkmcnt(0)
    s_barrier
    v_mov_b32 v9, 51208
    s_mov_b32 exec_lo, 0
    s_brev_b32 exec_hi, 1
    ds_write_b32 v9, v20
    s_mov_b64 exec, -1
    s_waitcnt lgkmcnt(0)
    s_barrier
    s_endpgm
L_end:
    s_endpgm
.section .rodata,"a"
.p2align 6
.amdhsa_kernel gated_mix__spectral_fnet__moe_arch_mod__prompt_kernel
  .amdhsa_next_free_vgpr 168
  .amdhsa_next_free_sgpr 72
  .amdhsa_accum_offset 168
  .amdhsa_group_segment_fixed_size 0
  .amdhsa_kernarg_size 112
  .amdhsa_user_sgpr_count 2
  .amdhsa_user_sgpr_kernarg_segment_ptr 1
  .amdhsa_system_sgpr_workgroup_id_x 1
.end_amdhsa_kernel
```

```asm
; @launch grid=(256,1,1) block=(576,1,1) lds=86016
.amdgcn_target "amdgcn-amd-amdhsa--gfx950"
.text
.globl gated_mix__spectral_fnet__moe_arch_mod__prompt_kernel
.p2align 8
.type gated_mix__spectral_fnet__moe_arch_mod__prompt_kernel,@function
gated_mix__spectral_fnet__moe_arch_mod__prompt_kernel:
    s_load_dwordx2 s[4:5], s[0:1], 0
    s_load_dwordx16 s[16:31], s[0:1], 48
    v_lshrrev_b32 v1, 6, v0
    v_and_b32 v0, 63, v0
    v_readfirstlane_b32 s3, v1
    v_and_b32 v1, 15, v0
    v_lshrrev_b32 v2, 4, v0
    s_and_b32 s6, s2, 7
    s_sub_u32 s3, s3, 1
    s_min_u32 s3, s3, 8
    s_lshr_b32 s7, s2, 3
    s_cmp_ge_u32 s2, 128
    s_cbranch_scc1 L_notA
    s_add_u32 s8, s6, 1
    s_sub_u32 s9, 15, s6
    s_cmp_eq_u32 s3, 8
    s_cbranch_scc1 L_ah
    s_and_b32 s57, s7, 1
    s_bitcmp1_b32 s7, 1
    s_cselect_b32 s10, s9, s8
    s_lshr_b32 s11, s7, 2
    s_lshl4_add_u32 s56, s11, s10
    v_lshlrev_b32 v5, 4, v0
    v_mov_b32 v3, 0
    s_cmp_lg_u32 s6, 7
    s_cbranch_scc1 L_k7
    s_lshr_b32 s11, s7, 1
    s_lshl3_add_u32 s56, s11, 8
    s_mov_b32 s8, 0
    s_cmp_eq_u32 s2, 127
    s_cselect_b32 s56, 0, s56
    s_cselect_b32 s57, 0, s57
L_k7:
    s_lshl3_add_u32 s11, s57, s3
    s_lshl_b32 s11, s11, 7
    s_add_u32 s58, s11, s56
    s_sub_u32 s59, 2048, s58
    s_cmp_eq_u32 s58, 0
    s_cselect_b32 s59, 1024, s59
    s_lshl_b32 s10, s58, 10
    s_lshl_b32 s11, s59, 10
    v_add_u32 v6, s10, v5
    v_add_u32 v7, s11, v5
    s_waitcnt lgkmcnt(0)
    global_load_dwordx4 v[16:19], v6, s[4:5]
    global_load_dwordx4 v[20:23], v7, s[4:5]
    s_barrier
    s_bitcmp1_b32 s7, 3
    s_cselect_b32 s8, s9, s8
    s_and_b32 s9, s7, 7
    s_lshl3_add_u32 s51, s8, s9
    s_lshl_b32 s35, s8, 5
    s_add_u32 s35, s35, s9
    s_lshl_b32 s35, s35, 6
    s_lshr_b32 s6, s3, 2
    s_and_b32 s7, s3, 1
    s_bfe_u32 s8, s3, 0x10001
    v_lshl_add_u32 v6, s6, 4, v1
    s_lshl3_add_u32 s9, s8, s7
    s_lshl_b32 s9, s9, 2
    v_cvt_f32_u32 v6, v6
    v_lshl_add_u32 v7, v2, 3, s9
    v_mul_f32 v6, 0x3c000000, v6
    v_cvt_f32_u32 v7, v7
    v_mul_f32 v7, v7, v6
    v_cos_f32 v96, v7
    v_sin_f32 v100, v7
    v_add_f32 v7, v7, v6
    v_cos_f32 v97, v7
    v_sin_f32 v101, v7
    v_add_f32 v7, v7, v6
    v_cos_f32 v98, v7
    v_sin_f32 v102, v7
    v_add_f32 v7, v7, v6
    v_cos_f32 v99, v7
    v_sin_f32 v103, v7
    s_lshl_b32 s10, s6, 13
    s_lshl_b32 s11, s8, 10
    s_lshl3_add_u32 s11, s7, s11
    v_add_u32 v15, s10, v5
    v_add_u32 v9, s11, v15
    v_cvt_pk_bf16_f32 v104, v96, v97
    v_cvt_pk_bf16_f32 v105, v98, v99
    v_cvt_pk_bf16_f32 v106, -v100, -v101
    v_cvt_pk_bf16_f32 v107, -v102, -v103
    v_cmp_eq_f32 vcc, 0, v6
    v_cvt_pk_bf16_f32 v108, v96, -v101
    v_cvt_pk_bf16_f32 v109, -v98, v103
    v_cvt_pk_bf16_f32 v110, -v100, -v97
    v_cvt_pk_bf16_f32 v111, v102, v99
    ds_write_b64 v9, v[104:105] offset:16384
    ds_write_b64 v9, v[108:109] offset:20480
    ds_write_b64 v9, v[110:111] offset:22528
    s_mov_b64 exec, vcc
    v_mov_b32 v106, 0xbf803f80
    v_mov_b32 v107, 0xbf803f80
    s_mov_b64 exec, -1
    ds_write_b64 v9, v[106:107] offset:18432
    global_load_dwordx4 v[24:27], v5, s[16:17]
    s_lshl_b32 s10, s3, 11
    s_add_u32 s11, s10, s51
    s_lshl_b32 s11, s11, 7
    s_mov_b32 m0, s10
    v_and_b32 v9, 7, v0
    v_bfe_u32 v13, v0, 4, 1
    v_xor_b32 v9, v9, v13
    v_lshrrev_b32 v13, 3, v0
    v_lshl_add_u32 v9, v9, 4, s11
    v_lshl_add_u32 v13, v13, 14, v9
    global_load_lds_dwordx4 v13, s[4:5]
    s_add_u32 m0, s10, 1024
    v_add_u32 v13, 0x20000, v13
    global_load_lds_dwordx4 v13, s[4:5]
    v_mov_b32 v12, 0
    v_mov_b32 v13, 0
    s_waitcnt vmcnt(2)
    v_dot2c_f32_bf16 v12, v16, v24
    v_dot2c_f32_bf16 v13, v20, v24
    v_dot2c_f32_bf16 v12, v17, v25
    v_dot2c_f32_bf16 v13, v21, v25
    v_dot2c_f32_bf16 v12, v18, v26
    v_dot2c_f32_bf16 v13, v22, v26
    v_dot2c_f32_bf16 v12, v19, v27
    v_dot2c_f32_bf16 v13, v23, v27
    s_sub_u32 s10, 0xffff, s58
    s_sub_u32 s11, 0xffff, s59
    v_mov_b32 v4, s10
    v_permlane32_swap_b32 v12, v13
    v_add_f32 v12, v12, v13
    v_mov_b32 v13, v12
    v_writelane_b32 v4, s11, 32
    v_mov_b32 v9, 33792
    v_permlane16_swap_b32 v12, v13
    v_add_f32 v12, v12, v13
    v_lshlrev_b32 v8, 31, v1
    v_lshrrev_b32 v7, 16, v8
    v_add_f32_dpp v12, v12, v12 row_ror:8 row_mask:0xf bank_mask:0xf
    v_or_b32 v8, v8, v7
    v_bfe_u32 v6, v0, 2, 2
    v_add_f32_dpp v12, v12, v12 row_ror:4 row_mask:0xf bank_mask:0xf
    v_and_b32 v14, 3, v0
    v_lshl_add_u32 v14, v14, 1, s8
    v_add_f32_dpp v12, v12, v12 row_ror:2 row_mask:0xf bank_mask:0xf
    v_lshl_add_u32 v10, v2, 3, v6
    v_lshrrev_b32 v6, 1, v6
    v_add_f32_dpp v12, v12, v12 row_ror:1 row_mask:0xf bank_mask:0xf
    v_cvt_pk_bf16_f32 v12, v12, v12
    v_and_b32 v12, 0xffff0000, v12
    v_xor_b32 v14, v14, v6
    v_ashrrev_i32 v7, 31, v12
    v_or_b32 v7, 0x80000000, v7
    v_xor_b32 v7, v7, v12
    v_and_b32 v7, 0xffff0000, v7
    v_or_b32 v7, v7, v4
    s_mov_b32 exec_lo, 1
    s_mov_b32 exec_hi, 1
    ds_max_u32 v9, v7
    s_mov_b64 exec, -1
    s_waitcnt lgkmcnt(0)
    s_barrier
    ds_read_b128 v[32:35], v15 offset:16384
    ds_read_b128 v[48:51], v15 offset:18432
    ds_read_b128 v[64:67], v15 offset:20480
    ds_read_b128 v[80:83], v15 offset:22528
    ds_read_b128 v[36:39], v15 offset:17408
    ds_read_b128 v[52:55], v15 offset:19456
    ds_read_b128 v[68:71], v15 offset:21504
    ds_read_b128 v[84:87], v15 offset:23552
    s_lshl_b32 s7, s7, 3
    v_lshl_add_u32 v14, v14, 4, s7
    v_lshl_add_u32 v10, v10, 7, v14
    v_lshlrev_b32 v9, 4, v2
    s_waitcnt vmcnt(0)
    s_barrier
    s_waitcnt lgkmcnt(5)
    ds_read_b128 v[28:31], v9 offset:33920
    ds_read_b64_tr_b16 v[96:97], v10 offset:0
    ds_read_b64_tr_b16 v[98:99], v10 offset:512
    ds_read_b64_tr_b16 v[100:101], v10 offset:4096
    ds_read_b64_tr_b16 v[102:103], v10 offset:4608
    ds_read_b64_tr_b16 v[104:105], v10 offset:8192
    ds_read_b64_tr_b16 v[106:107], v10 offset:8704
    ds_read_b64_tr_b16 v[108:109], v10 offset:12288
    ds_read_b64_tr_b16 v[110:111], v10 offset:12800
    global_load_dwordx4 v[24:27], v5, s[24:25]
    s_waitcnt lgkmcnt(6)
    v_mfma_f32_16x16x32_bf16 v[112:115], v[96:99], v[32:35], 0
    v_xor_b32 v40, v32, v8
    v_xor_b32 v41, v33, v8
    v_xor_b32 v42, v34, v8
    v_xor_b32 v43, v35, v8
    v_mfma_f32_16x16x32_bf16 v[116:119], v[96:99], v[48:51], 0
    v_xor_b32 v56, v48, v8
    v_xor_b32 v57, v49, v8
    v_xor_b32 v58, v50, v8
    v_xor_b32 v59, v51, v8
    v_mfma_f32_16x16x32_bf16 v[120:123], v[96:99], v[64:67], 0
    v_xor_b32 v72, v64, v8
    v_xor_b32 v73, v65, v8
    v_xor_b32 v74, v66, v8
    v_xor_b32 v75, v67, v8
    v_mfma_f32_16x16x32_bf16 v[124:127], v[96:99], v[80:83], 0
    v_xor_b32 v88, v80, v8
    v_xor_b32 v89, v81, v8
    v_xor_b32 v90, v82, v8
    v_xor_b32 v91, v83, v8
    s_waitcnt lgkmcnt(4)
    v_mfma_f32_16x16x32_bf16 v[112:115], v[100:103], v[36:39], v[112:115]
    v_xor_b32 v44, v36, v8
    v_xor_b32 v45, v37, v8
    v_xor_b32 v46, v38, v8
    v_xor_b32 v47, v39, v8
    v_mfma_f32_16x16x32_bf16 v[116:119], v[100:103], v[52:55], v[116:119]
    v_xor_b32 v60, v52, v8
    v_xor_b32 v61, v53, v8
    v_xor_b32 v62, v54, v8
    v_xor_b32 v63, v55, v8
    v_mfma_f32_16x16x32_bf16 v[120:123], v[100:103], v[68:71], v[120:123]
    v_xor_b32 v76, v68, v8
    v_xor_b32 v77, v69, v8
    v_xor_b32 v78, v70, v8
    v_xor_b32 v79, v71, v8
    v_mfma_f32_16x16x32_bf16 v[124:127], v[100:103], v[84:87], v[124:127]
    v_xor_b32 v92, v84, v8
    v_xor_b32 v93, v85, v8
    v_xor_b32 v94, v86, v8
    v_xor_b32 v95, v87, v8
    s_waitcnt lgkmcnt(2)
    v_mfma_f32_16x16x32_bf16 v[112:115], v[104:107], v[40:43], v[112:115]
    s_mul_i32 s44, s6, 528384
    s_add_u32 s44, s44, s35
    v_mfma_f32_16x16x32_bf16 v[116:119], v[104:107], v[56:59], v[116:119]
    s_and_b32 s10, s3, 3
    s_lshl_b32 s10, s10, 9
    v_mfma_f32_16x16x32_bf16 v[120:123], v[104:107], v[72:75], v[120:123]
    s_add_u32 s44, s44, s10
    s_add_u32 s44, s44, 2097152
    v_mfma_f32_16x16x32_bf16 v[124:127], v[104:107], v[88:91], v[124:127]
    s_mov_b32 s36, s30
    s_mov_b32 s37, s31
    s_waitcnt lgkmcnt(0)
    v_mfma_f32_16x16x32_bf16 v[112:115], v[108:111], v[44:47], v[112:115]
    s_mov_b32 s38, 0x1000000
    s_mov_b32 s39, 0x20000
    v_mfma_f32_16x16x32_bf16 v[116:119], v[108:111], v[60:63], v[116:119]
    s_add_u32 s45, s44, 1056768
    s_mov_b32 s11, 0xfffefffe
    v_mfma_f32_16x16x32_bf16 v[120:123], v[108:111], v[76:79], v[120:123]
    s_mov_b32 s10, 0x07060302
    v_mul_u32_u24 v11, 33024, v1
    v_mfma_f32_16x16x32_bf16 v[124:127], v[108:111], v[92:95], v[124:127]
    v_lshl_add_u32 v11, v2, 4, v11
    v_mov_b32 v12, 0
    v_mov_b32 v13, 0
    v_add_u32 v112, 0x10000, v112
    v_add_u32 v113, 0x10000, v113
    v_add_u32 v114, 0x10000, v114
    v_add_u32 v115, 0x10000, v115
    v_add_u32 v116, 0x10000, v116
    v_add_u32 v117, 0x10000, v117
    v_add_u32 v118, 0x10000, v118
    v_add_u32 v119, 0x10000, v119
    v_perm_b32 v96, v116, v112, s10
    v_perm_b32 v97, v117, v113, s10
    v_perm_b32 v98, v118, v114, s10
    v_perm_b32 v99, v119, v115, s10
    v_and_or_b32 v96, v96, s11, v28
    v_and_or_b32 v97, v97, s11, v29
    v_and_or_b32 v98, v98, s11, v30
    v_and_or_b32 v99, v99, s11, v31
    buffer_store_dwordx4 v[96:99], v11, s[36:39], s44 offen sc1
    v_add_u32 v120, 0x10000, v120
    v_add_u32 v121, 0x10000, v121
    v_add_u32 v122, 0x10000, v122
    v_add_u32 v123, 0x10000, v123
    v_add_u32 v124, 0x10000, v124
    v_add_u32 v125, 0x10000, v125
    v_add_u32 v126, 0x10000, v126
    v_add_u32 v127, 0x10000, v127
    v_perm_b32 v100, v124, v120, s10
    v_perm_b32 v101, v125, v121, s10
    v_perm_b32 v102, v126, v122, s10
    v_perm_b32 v103, v127, v123, s10
    v_and_or_b32 v100, v100, s11, v28
    v_and_or_b32 v101, v101, s11, v29
    v_and_or_b32 v102, v102, s11, v30
    v_and_or_b32 v103, v103, s11, v31
    buffer_store_dwordx4 v[100:103], v11, s[36:39], s45 offen sc1
    s_mov_b32 s65, 0
    s_mov_b32 s55, 0
L_ta_end:
    s_mov_b32 s40, s26
    s_mov_b32 s41, s27
    s_mov_b32 s42, 0x200000
    s_mov_b32 s43, 0x20000
    s_cmp_ge_u32 s3, 4
    s_cbranch_scc1 L_hi0
    s_setprio 2
    v_lshlrev_b32 v6, 4, v1
    v_lshl_add_u32 v10, v2, 13, v6
    v_mul_u32_u24 v6, 4352, v2
    v_bfe_u32 v7, v1, 1, 2
    v_xor_b32 v7, s3, v7
    v_lshl_add_u32 v7, v7, 4, v6
    v_lshl_add_u32 v11, v1, 6, v7
    s_lshl4_add_u32 s7, s3, 1024
    v_mov_b32 v9, 17600
    v_lshl_add_u32 v28, v0, 1, v9
    v_lshl_add_u32 v7, v1, 1, s7
    s_mov_b32 exec_lo, 0x00ff00ff
    s_mov_b32 exec_hi, 0x00ff00ff
    v_add_u32 v28, v7, v6
    s_mov_b64 exec, -1
    s_and_b32 s7, s56, 63
    s_mul_i32 s32, s7, 33024
    s_lshl_b32 s7, s3, 9
    s_add_u32 s32, s32, s7
    s_add_u32 s32, s32, 2097152
    s_add_u32 s33, s32, 4096
    v_lshrrev_b32 v6, 1, v1
    s_lshl_b32 s6, s57, 10
    s_add_u32 s6, s6, s56
    v_lshl_add_u32 v6, v6, 7, s6
    v_and_b32 v7, 1, v1
    v_lshlrev_b32 v9, 9, v7
    s_cmp_lg_u32 s56, 0
    s_cbranch_scc1 L_g01
    s_mov_b32 exec_lo, 0x00020002
    s_mov_b32 exec_hi, 0x00020002
    v_mov_b32 v6, 0x400
    v_mov_b32 v9, 0
    s_mov_b64 exec, -1
L_g01:
    v_lshlrev_b32 v7, 2, v2
    v_mad_u32_u24 v9, v7, v6, v9
    v_cvt_f32_u32 v6, v6
    v_cvt_f32_u32 v9, v9
    v_mul_f32 v6, 0x3a000000, v6
    v_mul_f32 v9, 0x3a000000, v9
    v_cos_f32 v64, v9
    v_sin_f32 v68, v9
    v_add_f32 v9, v9, v6
    v_cos_f32 v65, v9
    v_sin_f32 v69, v9
    v_add_f32 v9, v9, v6
    v_cos_f32 v66, v9
    v_sin_f32 v70, v9
    v_add_f32 v9, v9, v6
    v_cos_f32 v67, v9
    v_sin_f32 v71, v9
    s_and_b32 s7, s56, 63
    s_nop 0
    v_cvt_pk_bf16_f32 v148, v64, v68
    v_cvt_pk_bf16_f32 v149, v65, v69
    v_cvt_pk_bf16_f32 v150, v66, v70
    v_cvt_pk_bf16_f32 v151, v67, v71
    s_cmp_lg_u32 s7, 0
    s_cbranch_scc1 L_gd2
    s_lshr_b32 s7, s56, 2
    v_and_b32 v148, 0xffff, v148
    v_lshlrev_b32 v148, s7, v148
    v_and_b32 v149, 0xffff, v149
    v_lshlrev_b32 v149, s7, v149
    v_and_b32 v150, 0xffff, v150
    v_lshlrev_b32 v150, s7, v150
    v_and_b32 v151, 0xffff, v151
    v_lshlrev_b32 v151, s7, v151
L_gd2:
    v_and_b32 v6, 3, v1
    v_lshlrev_b32 v6, 4, v6
    ds_read_b128 v[96:99], v6 offset:33920
    s_waitcnt lgkmcnt(0)
    v_cvt_f32_u32 v6, v1
    s_lshl_b32 s6, s3, 2
    v_lshl_add_u32 v7, v2, 6, s6
    v_mul_f32 v6, 0x3b000000, v6
    v_cvt_f32_u32 v7, v7
    v_mul_f32 v15, 0x41800000, v6
    v_mul_f32 v7, v7, v6
    v_cos_f32 v64, v7
    v_sin_f32 v68, v7
    v_add_f32 v9, v7, v15
    v_cos_f32 v65, v9
    v_sin_f32 v69, v9
    v_add_f32 v9, v9, v15
    v_cos_f32 v66, v9
    v_sin_f32 v70, v9
    v_add_f32 v9, v9, v15
    v_cos_f32 v67, v9
    v_sin_f32 v71, v9
    v_mov_b32 v108, 0
    v_cvt_pk_bf16_f32 v100, v64, v65
    v_cvt_pk_bf16_f32 v104, -v68, -v69
    v_cvt_pk_bf16_f32 v101, v66, v67
    v_cvt_pk_bf16_f32 v105, -v70, -v71
    v_xor_b32 v102, v100, v8
    v_xor_b32 v106, v104, v8
    v_xor_b32 v103, v101, v8
    v_xor_b32 v107, v105, v8
    v_add_f32 v7, v7, v6
    v_cos_f32 v64, v7
    v_sin_f32 v68, v7
    v_add_f32 v9, v7, v15
    v_cos_f32 v65, v9
    v_sin_f32 v69, v9
    v_add_f32 v9, v9, v15
    v_cos_f32 v66, v9
    v_sin_f32 v70, v9
    v_add_f32 v9, v9, v15
    v_cos_f32 v67, v9
    v_sin_f32 v71, v9
    v_mov_b32 v120, 0
    v_cvt_pk_bf16_f32 v112, v64, v65
    v_cvt_pk_bf16_f32 v116, -v68, -v69
    v_cvt_pk_bf16_f32 v113, v66, v67
    v_cvt_pk_bf16_f32 v117, -v70, -v71
    v_xor_b32 v114, v112, v8
    v_xor_b32 v118, v116, v8
    v_xor_b32 v115, v113, v8
    v_xor_b32 v119, v117, v8
    v_add_f32 v7, v7, v6
    v_cos_f32 v64, v7
    v_sin_f32 v68, v7
    v_add_f32 v9, v7, v15
    v_cos_f32 v65, v9
    v_sin_f32 v69, v9
    v_add_f32 v9, v9, v15
    v_cos_f32 v66, v9
    v_sin_f32 v70, v9
    v_add_f32 v9, v9, v15
    v_cos_f32 v67, v9
    v_sin_f32 v71, v9
    v_mov_b32 v132, 0
    v_cvt_pk_bf16_f32 v124, v64, v65
    v_cvt_pk_bf16_f32 v128, -v68, -v69
    v_cvt_pk_bf16_f32 v125, v66, v67
    v_cvt_pk_bf16_f32 v129, -v70, -v71
    v_xor_b32 v126, v124, v8
    v_xor_b32 v130, v128, v8
    v_xor_b32 v127, v125, v8
    v_xor_b32 v131, v129, v8
    v_add_f32 v7, v7, v6
    v_cos_f32 v64, v7
    v_sin_f32 v68, v7
    v_add_f32 v9, v7, v15
    v_cos_f32 v65, v9
    v_sin_f32 v69, v9
    v_add_f32 v9, v9, v15
    v_cos_f32 v66, v9
    v_sin_f32 v70, v9
    v_add_f32 v9, v9, v15
    v_cos_f32 v67, v9
    v_sin_f32 v71, v9
    v_mov_b32 v144, 0
    v_cvt_pk_bf16_f32 v136, v64, v65
    v_cvt_pk_bf16_f32 v140, -v68, -v69
    v_cvt_pk_bf16_f32 v137, v66, v67
    v_cvt_pk_bf16_f32 v141, -v70, -v71
    v_xor_b32 v138, v136, v8
    v_xor_b32 v142, v140, v8
    v_xor_b32 v139, v137, v8
    v_xor_b32 v143, v141, v8
    v_lshrrev_b32 v6, 1, v1
    v_add_u32 v7, s6, v6
    v_and_b32 v9, 1, v1
    v_lshl_add_u32 v7, v9, 3, v7
    v_cvt_f32_u32 v7, v7
    v_mul_f32 v7, 0x3d000000, v7
    v_cos_f32 v7, v7
    s_mov_b32 exec_lo, 0x30003
    s_mov_b32 exec_hi, 0x30003
    v_cvt_pk_bf16_f32 v108, v7, -v7
    s_mov_b32 exec_lo, 0xc000c
    s_mov_b32 exec_hi, 0xc000c
    v_cvt_pk_bf16_f32 v120, v7, -v7
    s_mov_b32 exec_lo, 0x300030
    s_mov_b32 exec_hi, 0x300030
    v_cvt_pk_bf16_f32 v132, v7, -v7
    s_mov_b32 exec_lo, 0xc000c0
    s_mov_b32 exec_hi, 0xc000c0
    v_cvt_pk_bf16_f32 v144, v7, -v7
    s_mov_b64 exec, -1
    v_mov_b32 v109, v108
    v_mov_b32 v110, v108
    v_mov_b32 v111, v108
    v_mov_b32 v121, v120
    v_mov_b32 v122, v120
    v_mov_b32 v123, v120
    v_mov_b32 v133, v132
    v_mov_b32 v134, v132
    v_mov_b32 v135, v132
    v_mov_b32 v145, v144
    v_mov_b32 v146, v144
    v_mov_b32 v147, v144
    s_waitcnt vmcnt(2)
    v_dot2c_f32_bf16 v12, v16, v24
    v_dot2c_f32_bf16 v13, v20, v24
    v_dot2c_f32_bf16 v12, v17, v25
    v_dot2c_f32_bf16 v13, v21, v25
    v_dot2c_f32_bf16 v12, v18, v26
    v_dot2c_f32_bf16 v13, v22, v26
    v_dot2c_f32_bf16 v12, v19, v27
    v_dot2c_f32_bf16 v13, v23, v27
    s_nop 2
    v_permlane32_swap_b32 v12, v13
    v_add_f32 v12, v12, v13
    v_mov_b32 v13, v12
    s_nop 1
    v_permlane16_swap_b32 v12, v13
    v_add_f32 v12, v12, v13
    s_nop 1
    v_add_f32_dpp v12, v12, v12 row_ror:8 row_mask:0xf bank_mask:0xf
    s_nop 1
    v_add_f32_dpp v12, v12, v12 row_ror:4 row_mask:0xf bank_mask:0xf
    s_nop 1
    v_add_f32_dpp v12, v12, v12 row_ror:2 row_mask:0xf bank_mask:0xf
    s_nop 1
    v_add_f32_dpp v12, v12, v12 row_ror:1 row_mask:0xf bank_mask:0xf
    v_cvt_pk_bf16_f32 v12, v12, v12
    v_and_b32 v12, 0xffff0000, v12
    s_lshl_b32 s6, s3, 11
    v_add_u32 v6, s6, v5
    ds_write_b128 v6, v[16:19] offset:48832
    ds_write_b128 v6, v[20:23] offset:49856
    v_lshl_add_u32 v7, v1, 6, s6
    v_lshl_add_u32 v7, v2, 3, v7
    s_waitcnt lgkmcnt(0)
    ds_read_b64 v[16:17], v7 offset:48832
    ds_read_b64 v[18:19], v7 offset:48864
    ds_read_b64 v[20:21], v7 offset:49856
    ds_read_b64 v[22:23], v7 offset:49888
    v_and_b32 v6, 1, v2
    v_lshlrev_b32 v6, 5, v6
    v_lshl_add_u32 v6, v1, 6, v6
    v_lshrrev_b32 v7, 1, v2
    v_lshl_add_u32 v3, v7, 4, v6
    v_mul_f32 v13, 0xbfb8aa3b, v12
    v_exp_f32 v13, v13
    s_nop 0
    v_add_f32 v13, 1.0, v13
    v_rcp_f32 v13, v13
    s_nop 0
    v_cvt_pk_bf16_f32 v13, v13, v13
    v_and_b32 v13, 0xffff0000, v13
    v_sub_f32 v14, 1.0, v13
    v_cvt_pk_bf16_f32 v14, v14, v14
    v_and_b32 v14, 0xffff0000, v14
    v_readlane_b32 s6, v13, 0
    v_readlane_b32 s7, v13, 32
    v_readlane_b32 s8, v14, 0
    v_readlane_b32 s9, v14, 32
    s_xor_b32 s10, s6, 0x80000000
    s_cmp_eq_u32 s58, 0
    s_cselect_b32 s10, 0, s10
    s_cselect_b32 s11, 0, s7
    v_mov_b32 v24, s6
    v_mov_b32 v25, s10
    v_mov_b32 v26, s11
    v_mov_b32 v27, s7
    v_mov_b32 v13, s8
    v_mov_b32 v14, s9
    s_waitcnt lgkmcnt(0)
    v_lshlrev_b32 v152, 16, v16
    v_and_b32 v153, 0xffff0000, v16
    v_lshlrev_b32 v154, 16, v17
    v_and_b32 v155, 0xffff0000, v17
    v_lshlrev_b32 v156, 16, v18
    v_and_b32 v157, 0xffff0000, v18
    v_lshlrev_b32 v158, 16, v19
    v_and_b32 v159, 0xffff0000, v19
    v_mul_f32 v152, v13, v152
    v_mul_f32 v153, v13, v153
    v_mul_f32 v154, v13, v154
    v_mul_f32 v155, v13, v155
    v_mul_f32 v156, v13, v156
    v_mul_f32 v157, v13, v157
    v_mul_f32 v158, v13, v158
    v_mul_f32 v159, v13, v159
    v_lshlrev_b32 v160, 16, v20
    v_and_b32 v161, 0xffff0000, v20
    v_lshlrev_b32 v162, 16, v21
    v_and_b32 v163, 0xffff0000, v21
    v_lshlrev_b32 v164, 16, v22
    v_and_b32 v165, 0xffff0000, v22
    v_lshlrev_b32 v166, 16, v23
    v_and_b32 v167, 0xffff0000, v23
    v_mul_f32 v160, v14, v160
    v_mul_f32 v161, v14, v161
    v_mul_f32 v162, v14, v162
    v_mul_f32 v163, v14, v163
    v_mul_f32 v164, v14, v164
    v_mul_f32 v165, v14, v165
    v_mul_f32 v166, v14, v166
    v_mul_f32 v167, v14, v167
    s_waitcnt vmcnt(2)
    s_barrier
    s_cmp_lg_u32 s57, 0
    s_cbranch_scc1 L_stg1
    buffer_load_dwordx4 v[32:35], v10, s[36:39], s32 offen offset:0 sc1
    buffer_load_dwordx4 v[36:39], v10, s[36:39], s32 offen offset:2048 sc1
    buffer_load_dwordx4 v[40:43], v10, s[36:39], s33 offen offset:0 sc1
    buffer_load_dwordx4 v[44:47], v10, s[36:39], s33 offen offset:2048 sc1
    s_waitcnt vmcnt(2)
    buffer_load_dwordx4 v[48:51], v10, s[36:39], s32 offen offset:256 sc1
    buffer_load_dwordx4 v[52:55], v10, s[36:39], s32 offen offset:2304 sc1
    buffer_load_dwordx4 v[56:59], v10, s[36:39], s33 offen offset:256 sc1
    buffer_load_dwordx4 v[60:63], v10, s[36:39], s33 offen offset:2304 sc1
    s_branch L_stg2
L_stg1:
    buffer_load_dwordx4 v[48:51], v10, s[36:39], s32 offen offset:256 sc1
    buffer_load_dwordx4 v[52:55], v10, s[36:39], s32 offen offset:2304 sc1
    buffer_load_dwordx4 v[56:59], v10, s[36:39], s33 offen offset:256 sc1
    buffer_load_dwordx4 v[60:63], v10, s[36:39], s33 offen offset:2304 sc1
    s_waitcnt vmcnt(2)
    buffer_load_dwordx4 v[32:35], v10, s[36:39], s32 offen offset:0 sc1
    buffer_load_dwordx4 v[36:39], v10, s[36:39], s32 offen offset:2048 sc1
    buffer_load_dwordx4 v[40:43], v10, s[36:39], s33 offen offset:0 sc1
    buffer_load_dwordx4 v[44:47], v10, s[36:39], s33 offen offset:2048 sc1
    s_waitcnt vmcnt(0)
L_stg2:
    s_mul_i32 s7, s3, 2176
    v_bfe_u32 v7, v1, 1, 2
    v_xor_b32 v7, v7, v2
    v_lshl_add_u32 v7, v7, 4, s7
    v_lshl_add_u32 v29, v1, 6, v7
    v_sub_u32 v6, 16, v1
    v_bfe_u32 v7, v6, 1, 2
    v_xor_b32 v7, v7, v2
    v_lshl_add_u32 v7, v7, 4, s7
    v_lshl_add_u32 v30, v6, 6, v7
    s_cmp_eq_u32 s58, 0
    s_cselect_b32 s6, 0, 2048
    v_add_u32 v4, s6, v5
L_zjoin:
    s_waitcnt vmcnt(4)
L_got0:
    v_xor_b32 v80, v32, v96
    v_xor_b32 v81, v36, v96
    v_xor_b32 v82, v40, v96
    v_xor_b32 v83, v44, v96
    v_or3_b32 v6, v80, v81, v82
    v_or_b32 v6, v6, v83
    v_mfma_f32_16x16x32_bf16 v[64:67], v[80:83], v[148:151], 0
    v_xor_b32 v84, v33, v97
    v_xor_b32 v85, v37, v97
    v_xor_b32 v86, v41, v97
    v_xor_b32 v87, v45, v97
    v_or3_b32 v6, v6, v84, v85
    v_or3_b32 v6, v6, v86, v87
L_tb0:
    s_cbranch_execz L_tbback
    v_mfma_f32_16x16x32_bf16 v[68:71], v[84:87], v[148:151], 0
    v_xor_b32 v88, v34, v98
    v_xor_b32 v89, v38, v98
    v_xor_b32 v90, v42, v98
    v_xor_b32 v91, v46, v98
    v_or3_b32 v6, v6, v88, v89
    v_or3_b32 v6, v6, v90, v91
    v_mfma_f32_16x16x32_bf16 v[72:75], v[88:91], v[148:151], 0
    v_xor_b32 v92, v35, v99
    v_xor_b32 v93, v39, v99
    v_xor_b32 v94, v43, v99
    v_xor_b32 v95, v47, v99
    v_or3_b32 v6, v6, v92, v93
    v_or3_b32 v6, v6, v94, v95
    v_and_b32 v6, 0x10001, v6
    v_cmp_ne_u32 vcc, 0, v6
    v_mfma_f32_16x16x32_bf16 v[76:79], v[92:95], v[148:151], 0
    s_cbranch_vccnz L_retry0
L_fail0:
    s_waitcnt vmcnt(0)
L_got1:
    v_xor_b32 v80, v48, v96
    v_xor_b32 v81, v52, v96
    v_xor_b32 v82, v56, v96
L_tb1:
    s_cbranch_execz L_tbback
    v_xor_b32 v83, v60, v96
    v_or3_b32 v6, v80, v81, v82
    v_or_b32 v6, v6, v83
    v_mfma_f32_16x16x32_bf16 v[32:35], v[80:83], v[148:151], 0
    v_xor_b32 v84, v49, v97
    v_xor_b32 v85, v53, v97
    v_xor_b32 v86, v57, v97
    v_xor_b32 v87, v61, v97
    v_or3_b32 v6, v6, v84, v85
    v_or3_b32 v6, v6, v86, v87
    v_mfma_f32_16x16x32_bf16 v[36:39], v[84:87], v[148:151], 0
    v_xor_b32 v88, v50, v98
    v_xor_b32 v89, v54, v98
    v_xor_b32 v90, v58, v98
    v_xor_b32 v91, v62, v98
    v_or3_b32 v6, v6, v88, v89
    v_or3_b32 v6, v6, v90, v91
    v_mfma_f32_16x16x32_bf16 v[40:43], v[88:91], v[148:151], 0
    v_xor_b32 v92, v51, v99
    v_xor_b32 v93, v55, v99
    v_xor_b32 v94, v59, v99
    v_xor_b32 v95, v63, v99
    v_or3_b32 v6, v6, v92, v93
L_tb2:
    s_cbranch_execz L_tbback
    v_or3_b32 v6, v6, v94, v95
    v_and_b32 v6, 0x10001, v6
    v_cmp_ne_u32 vcc, 0, v6
    v_mfma_f32_16x16x32_bf16 v[44:47], v[92:95], v[148:151], 0
    s_cbranch_vccnz L_retry1
L_fail1:
    v_cvt_pk_bf16_f32 v80, v64, v65
    v_cvt_pk_bf16_f32 v81, v66, v67
    v_cvt_pk_bf16_f32 v82, v32, v33
    v_cvt_pk_bf16_f32 v83, v34, v35
    v_cvt_pk_bf16_f32 v84, v68, v69
    v_cvt_pk_bf16_f32 v85, v70, v71
    v_cvt_pk_bf16_f32 v86, v36, v37
    v_cvt_pk_bf16_f32 v87, v38, v39
    v_mfma_f32_16x16x32_bf16 v[64:67], v[80:83], v[100:103], 0
    v_mfma_f32_16x16x32_bf16 v[32:35], v[80:83], v[104:107], 0
    v_mfma_f32_16x16x32_bf16 v[96:99], v[80:83], v[108:111], 0
L_tb3:
    s_cbranch_execz L_tbback
    v_cvt_pk_bf16_f32 v88, v72, v73
    v_cvt_pk_bf16_f32 v89, v74, v75
    v_cvt_pk_bf16_f32 v90, v40, v41
    v_cvt_pk_bf16_f32 v91, v42, v43
    v_mfma_f32_16x16x32_bf16 v[68:71], v[84:87], v[112:115], 0
    v_mfma_f32_16x16x32_bf16 v[36:39], v[84:87], v[116:119], 0
    v_mfma_f32_16x16x32_bf16 v[96:99], v[84:87], v[120:123], v[96:99]
    v_cvt_pk_bf16_f32 v92, v76, v77
    v_cvt_pk_bf16_f32 v93, v78, v79
    v_cvt_pk_bf16_f32 v94, v44, v45
    v_cvt_pk_bf16_f32 v95, v46, v47
    v_mfma_f32_16x16x32_bf16 v[72:75], v[88:91], v[124:127], 0
    v_mfma_f32_16x16x32_bf16 v[40:43], v[88:91], v[128:131], 0
    v_mfma_f32_16x16x32_bf16 v[96:99], v[88:91], v[132:135], v[96:99]
    v_mfma_f32_16x16x32_bf16 v[76:79], v[92:95], v[136:139], 0
    v_mfma_f32_16x16x32_bf16 v[44:47], v[92:95], v[140:143], 0
L_tb4:
    s_cbranch_execz L_tbback
    v_mfma_f32_16x16x32_bf16 v[96:99], v[92:95], v[144:147], v[96:99]
    v_cvt_pk_bf16_f32 v48, v64, v32
    v_cvt_pk_bf16_f32 v52, v65, v33
    v_cvt_pk_bf16_f32 v56, v66, v34
    v_cvt_pk_bf16_f32 v60, v67, v35
    v_cvt_pk_bf16_f32 v49, v68, v36
    v_cvt_pk_bf16_f32 v53, v69, v37
    v_cvt_pk_bf16_f32 v57, v70, v38
    v_cvt_pk_bf16_f32 v61, v71, v39
    v_cvt_pk_bf16_f32 v50, v72, v40
    v_cvt_pk_bf16_f32 v54, v73, v41
    v_cvt_pk_bf16_f32 v58, v74, v42
    v_cvt_pk_bf16_f32 v62, v75, v43
    v_cvt_pk_bf16_f32 v51, v76, v44
    ds_write_b128 v11, v[48:51] offset:16384
L_tb5:
    s_cbranch_execz L_tbback
    v_cvt_pk_bf16_f32 v55, v77, v45
    ds_write_b128 v11, v[52:55] offset:17472
    v_cvt_pk_bf16_f32 v59, v78, v46
    ds_write_b128 v11, v[56:59] offset:18560
    v_cvt_pk_bf16_f32 v63, v79, v47
    ds_write_b128 v11, v[60:63] offset:19648
    v_cvt_pk_bf16_f32 v96, v96, v97
    v_cvt_pk_bf16_f32 v98, v98, v99
    ds_write_b16 v28, v96 offset:16384
    ds_write_b16_d16_hi v28, v96 offset:17472
    ds_write_b16 v28, v98 offset:18560
    ds_write_b16_d16_hi v28, v98 offset:19648
L_d2:
    ds_read_b128 v[64:67], v5 offset:42688
    ds_read_b128 v[68:71], v5 offset:43712
    ds_read_b128 v[72:75], v4 offset:42688
    ds_read_b128 v[76:79], v4 offset:43712
L_tb6:
    s_cbranch_execz L_tbback
    v_mov_b32 v9, 33856
    s_cmp_lg_u32 s55, 0
    s_waitcnt lgkmcnt(0)
    s_cbranch_scc1 L_zsync
    s_barrier
    ds_read_b32 v6, v9
    ds_read_b128 v[32:35], v29 offset:16384
    ds_read_b128 v[36:39], v30 offset:16384
    ds_read_b128 v[40:43], v29 offset:17472
    ds_read_b128 v[44:47], v30 offset:17472
    s_lshl_b32 s6, s58, 10
    s_lshl_b32 s7, s59, 10
    s_waitcnt lgkmcnt(3)
    v_mfma_f32_16x16x32_bf16 v[48:51], v[32:35], v[64:67], 0
    s_waitcnt lgkmcnt(2)
    v_mfma_f32_16x16x32_bf16 v[52:55], v[36:39], v[68:71], 0
    s_waitcnt lgkmcnt(1)
    v_mfma_f32_16x16x32_bf16 v[56:59], v[40:43], v[72:75], 0
    s_waitcnt lgkmcnt(0)
    v_mfma_f32_16x16x32_bf16 v[60:63], v[44:47], v[76:79], 0
L_tb7:
    s_cbranch_execz L_tbback
    v_readfirstlane_b32 s44, v6
    s_andn2_b32 s54, 0xffff, s44
    v_fmac_f32 v152, v24, v48
    v_fmac_f32 v153, v24, v49
    v_fmac_f32 v154, v24, v50
    v_fmac_f32 v155, v24, v51
    v_fmac_f32 v156, v24, v52
    v_fmac_f32 v157, v24, v53
    v_fmac_f32 v158, v24, v54
    v_fmac_f32 v159, v24, v55
    v_fmac_f32 v160, v26, v48
    v_fmac_f32 v161, v26, v49
    v_fmac_f32 v162, v26, v50
    v_fmac_f32 v163, v26, v51
    v_fmac_f32 v164, v26, v52
    v_fmac_f32 v165, v26, v53
    v_fmac_f32 v166, v26, v54
    v_fmac_f32 v167, v26, v55
    v_fmac_f32 v152, v25, v56
    v_fmac_f32 v153, v25, v57
    v_fmac_f32 v154, v25, v58
    v_fmac_f32 v155, v25, v59
    v_fmac_f32 v156, v25, v60
    v_fmac_f32 v157, v25, v61
    v_fmac_f32 v158, v25, v62
    v_fmac_f32 v159, v25, v63
    v_cvt_pk_bf16_f32 v32, v152, v153
    v_cvt_pk_bf16_f32 v33, v154, v155
L_tb8:
    s_cbranch_execz L_tbback
    v_cvt_pk_bf16_f32 v34, v156, v157
    v_cvt_pk_bf16_f32 v35, v158, v159
    s_cmp_eq_u32 s58, s54
    s_cbranch_scc1 L_skip3
    v_permlane16_swap_b32 v32, v34
    v_permlane16_swap_b32 v33, v35
    buffer_store_dwordx4 v[32:35], v3, s[40:43], s6 offen nt
L_skip3:
    v_fmac_f32 v160, v27, v56
    v_fmac_f32 v161, v27, v57
    v_fmac_f32 v162, v27, v58
    v_fmac_f32 v163, v27, v59
    v_fmac_f32 v164, v27, v60
    v_fmac_f32 v165, v27, v61
    v_fmac_f32 v166, v27, v62
    v_fmac_f32 v167, v27, v63
    v_cvt_pk_bf16_f32 v36, v160, v161
    v_cvt_pk_bf16_f32 v37, v162, v163
    v_cvt_pk_bf16_f32 v38, v164, v165
    v_cvt_pk_bf16_f32 v39, v166, v167
    s_cmp_eq_u32 s59, s54
    s_cbranch_scc1 L_skip4
    v_permlane16_swap_b32 v36, v38
    v_permlane16_swap_b32 v37, v39
    buffer_store_dwordx4 v[36:39], v3, s[40:43], s7 offen nt
L_skip4:
.set L_tb9, L_tbback
L_tb_end:
    s_endpgm
L_retry0:
    s_sleep 3
    s_add_u32 s65, s65, 1
    s_lshr_b32 s34, s65, 17
    s_cbranch_scc1 L_fail0
    buffer_load_dwordx4 v[32:35], v10, s[36:39], s32 offen offset:0 sc1
    buffer_load_dwordx4 v[36:39], v10, s[36:39], s32 offen offset:2048 sc1
    buffer_load_dwordx4 v[40:43], v10, s[36:39], s33 offen offset:0 sc1
    buffer_load_dwordx4 v[44:47], v10, s[36:39], s33 offen offset:2048 sc1
    s_waitcnt vmcnt(0)
    s_branch L_got0
L_retry1:
    s_sleep 3
    s_add_u32 s65, s65, 1
    s_lshr_b32 s34, s65, 17
    s_cbranch_scc1 L_fail1
    buffer_load_dwordx4 v[48:51], v10, s[36:39], s32 offen offset:256 sc1
    buffer_load_dwordx4 v[52:55], v10, s[36:39], s32 offen offset:2304 sc1
    buffer_load_dwordx4 v[56:59], v10, s[36:39], s33 offen offset:256 sc1
    buffer_load_dwordx4 v[60:63], v10, s[36:39], s33 offen offset:2304 sc1
    s_waitcnt vmcnt(0)
    s_branch L_got1
L_hi0:
    s_barrier
L_hi1:
    s_mov_b64 exec, 0
    s_sub_u32 s53, s3, 8
L_tbback:
    s_add_u32 s53, s53, 4
    s_cmp_eq_u32 s53, 0
    s_cbranch_scc1 L_tb0
    s_cmp_eq_u32 s53, 1
    s_cbranch_scc1 L_tb1
    s_cmp_eq_u32 s53, 2
    s_cbranch_scc1 L_tb2
    s_cmp_eq_u32 s53, 3
    s_cbranch_scc1 L_tb3
    s_cmp_eq_u32 s53, 4
    s_cbranch_scc1 L_tb4
    s_cmp_eq_u32 s53, 5
    s_cbranch_scc1 L_tb5
    s_cmp_eq_u32 s53, 6
    s_cbranch_scc1 L_tb6
    s_cmp_eq_u32 s53, 7
    s_cbranch_scc1 L_tb7
    s_cmp_eq_u32 s53, 8
    s_cbranch_scc1 L_tb8
    s_cmp_eq_u32 s53, 9
    s_cbranch_scc1 L_tb9
    s_mov_b64 exec, -1
    s_cmp_lg_u32 s55, 0
    s_cbranch_scc1 L_z0b
    s_waitcnt vmcnt(2)
    v_dot2c_f32_bf16 v12, v16, v24
    v_dot2c_f32_bf16 v13, v20, v24
    v_dot2c_f32_bf16 v12, v17, v25
    v_dot2c_f32_bf16 v13, v21, v25
    v_dot2c_f32_bf16 v12, v18, v26
    v_dot2c_f32_bf16 v13, v22, v26
    v_dot2c_f32_bf16 v12, v19, v27
    v_dot2c_f32_bf16 v13, v23, v27
    s_nop 2
    v_permlane32_swap_b32 v12, v13
    v_add_f32 v12, v12, v13
    v_mov_b32 v13, v12
    s_nop 1
    v_permlane16_swap_b32 v12, v13
    v_add_f32 v12, v12, v13
    s_nop 1
    v_add_f32_dpp v12, v12, v12 row_ror:8 row_mask:0xf bank_mask:0xf
    s_nop 1
    v_add_f32_dpp v12, v12, v12 row_ror:4 row_mask:0xf bank_mask:0xf
    s_nop 1
    v_add_f32_dpp v12, v12, v12 row_ror:2 row_mask:0xf bank_mask:0xf
    s_nop 1
    v_add_f32_dpp v12, v12, v12 row_ror:1 row_mask:0xf bank_mask:0xf
    v_cvt_pk_bf16_f32 v12, v12, v12
    v_and_b32 v12, 0xffff0000, v12
    s_lshl_b32 s6, s3, 11
    v_add_u32 v6, s6, v5
    ds_write_b128 v6, v[16:19] offset:48832
    ds_write_b128 v6, v[20:23] offset:49856
    v_lshl_add_u32 v7, v1, 6, s6
    v_lshl_add_u32 v7, v2, 3, v7
    s_waitcnt lgkmcnt(0)
    ds_read_b64 v[16:17], v7 offset:48832
    ds_read_b64 v[18:19], v7 offset:48864
    ds_read_b64 v[20:21], v7 offset:49856
    ds_read_b64 v[22:23], v7 offset:49888
    v_and_b32 v6, 1, v2
    v_lshlrev_b32 v6, 5, v6
    v_lshl_add_u32 v6, v1, 6, v6
    v_lshrrev_b32 v7, 1, v2
    v_lshl_add_u32 v3, v7, 4, v6
    v_mul_f32 v13, 0xbfb8aa3b, v12
    v_exp_f32 v13, v13
    s_nop 0
    v_add_f32 v13, 1.0, v13
    v_rcp_f32 v13, v13
    s_nop 0
    v_cvt_pk_bf16_f32 v13, v13, v13
    v_and_b32 v13, 0xffff0000, v13
    v_sub_f32 v14, 1.0, v13
    v_cvt_pk_bf16_f32 v14, v14, v14
    v_and_b32 v14, 0xffff0000, v14
    v_readlane_b32 s6, v13, 0
    v_readlane_b32 s7, v13, 32
    v_readlane_b32 s8, v14, 0
    v_readlane_b32 s9, v14, 32
    s_xor_b32 s10, s6, 0x80000000
    s_cmp_eq_u32 s58, 0
    s_cselect_b32 s10, 0, s10
    s_cselect_b32 s11, 0, s7
    v_mov_b32 v24, s6
    v_mov_b32 v25, s10
    v_mov_b32 v26, s11
    v_mov_b32 v27, s7
    v_mov_b32 v13, s8
    v_mov_b32 v14, s9
    s_waitcnt lgkmcnt(0)
    v_lshlrev_b32 v152, 16, v16
    v_and_b32 v153, 0xffff0000, v16
    v_lshlrev_b32 v154, 16, v17
    v_and_b32 v155, 0xffff0000, v17
    v_lshlrev_b32 v156, 16, v18
    v_and_b32 v157, 0xffff0000, v18
    v_lshlrev_b32 v158, 16, v19
    v_and_b32 v159, 0xffff0000, v19
    v_mul_f32 v152, v13, v152
    v_mul_f32 v153, v13, v153
    v_mul_f32 v154, v13, v154
    v_mul_f32 v155, v13, v155
    v_mul_f32 v156, v13, v156
    v_mul_f32 v157, v13, v157
    v_mul_f32 v158, v13, v158
    v_mul_f32 v159, v13, v159
    v_lshlrev_b32 v160, 16, v20
    v_and_b32 v161, 0xffff0000, v20
    v_lshlrev_b32 v162, 16, v21
    v_and_b32 v163, 0xffff0000, v21
    v_lshlrev_b32 v164, 16, v22
    v_and_b32 v165, 0xffff0000, v22
    v_lshlrev_b32 v166, 16, v23
    v_and_b32 v167, 0xffff0000, v23
    v_mul_f32 v160, v14, v160
    v_mul_f32 v161, v14, v161
    v_mul_f32 v162, v14, v162
    v_mul_f32 v163, v14, v163
    v_mul_f32 v164, v14, v164
    v_mul_f32 v165, v14, v165
    v_mul_f32 v166, v14, v166
    v_mul_f32 v167, v14, v167
    s_mul_i32 s7, s3, 2176
    v_bfe_u32 v7, v1, 1, 2
    v_xor_b32 v7, v7, v2
    v_lshl_add_u32 v7, v7, 4, s7
    v_lshl_add_u32 v29, v1, 6, v7
    v_sub_u32 v6, 16, v1
    v_bfe_u32 v7, v6, 1, 2
    v_xor_b32 v7, v7, v2
    v_lshl_add_u32 v7, v7, 4, s7
    v_lshl_add_u32 v30, v6, 6, v7
    s_cmp_eq_u32 s58, 0
    s_cselect_b32 s6, 0, 2048
    v_add_u32 v4, s6, v5
    s_branch L_d2
L_ah:
    s_cmp_ge_u32 s7, 2
    s_cbranch_scc1 L_nocpf
    s_getpc_b64 s[12:13]
L_pc:
    s_sub_u32 s12, s12, L_pc - gated_mix__spectral_fnet__moe_arch_mod__prompt_kernel
    s_subb_u32 s13, s13, 0
    v_lshlrev_b32 v6, 7, v0
    v_add_u32 v7, 0x2000, v6
    v_min_u32 v7, L_end - gated_mix__spectral_fnet__moe_arch_mod__prompt_kernel, v7
    v_mov_b32 v13, s13
    v_mov_b32 v15, s13
    v_add_co_u32 v12, vcc, s12, v6
    s_nop 1
    v_addc_co_u32 v13, vcc, 0, v13, vcc
    v_add_co_u32 v14, vcc, s12, v7
    s_nop 1
    v_addc_co_u32 v15, vcc, 0, v15, vcc
    global_load_dword v10, v[12:13], off
    global_load_dword v11, v[14:15], off
L_nocpf:
    v_lshlrev_b32 v5, 4, v0
    v_mov_b32 v31, 0
    v_mov_b32 v9, 33792
    ds_write_b32 v9, v31
    s_mov_b32 s64, 0x9E3779B1
    s_cmp_ge_u32 s7, 2
    s_waitcnt lgkmcnt(0)
    s_cbranch_scc1 L_nowpf
    global_load_dwordx4 v[32:35], v5, s[16:17]
    global_load_dword v30, v31, s[30:31]
    global_load_dwordx4 v[36:39], v5, s[24:25]
L_nowpf:
    v_lshlrev_b32 v14, 10, v0
    s_lshl_b32 s50, s2, 3
    s_add_u32 s50, s50, 65536
    s_mov_b32 s36, s30
    s_mov_b32 s37, s31
    s_mov_b32 s38, 0x1000000
    s_mov_b32 s39, 0x20000
    s_mov_b32 s65, 0
    s_barrier
    v_lshlrev_b32 v6, 2, v2
    v_cvt_f32_u32 v7, v1
    v_cvt_f32_u32 v6, v6
    v_mul_f32 v7, 0x3d800000, v7
    v_mul_f32 v9, v6, v7
    v_cos_f32 v64, v9
    v_sin_f32 v68, v9
    v_add_f32 v9, v9, v7
    v_cos_f32 v65, v9
    v_sin_f32 v69, v9
    v_add_f32 v9, v9, v7
    v_cos_f32 v66, v9
    v_sin_f32 v70, v9
    v_add_f32 v9, v9, v7
    v_cos_f32 v67, v9
    v_sin_f32 v71, v9
    s_nop 0
    v_cvt_pk_bf16_f32 v40, v64, v68
    v_cvt_pk_bf16_f32 v48, -v68, v64
    v_cvt_pk_bf16_f32 v41, v65, v69
    v_cvt_pk_bf16_f32 v49, -v69, v65
    v_cvt_pk_bf16_f32 v42, v66, v70
    v_cvt_pk_bf16_f32 v50, -v70, v66
    v_cvt_pk_bf16_f32 v43, v67, v71
    v_cvt_pk_bf16_f32 v51, -v71, v67
    v_add_f32 v7, 0x3d800000, v7
    v_mul_f32 v9, v6, v7
    v_cos_f32 v64, v9
    v_sin_f32 v68, v9
    v_add_f32 v9, v9, v7
    v_cos_f32 v65, v9
    v_sin_f32 v69, v9
    v_add_f32 v9, v9, v7
    v_cos_f32 v66, v9
    v_sin_f32 v70, v9
    v_add_f32 v9, v9, v7
    v_cos_f32 v67, v9
    v_sin_f32 v71, v9
    s_nop 0
    v_cvt_pk_bf16_f32 v44, v64, -v68
    v_cvt_pk_bf16_f32 v52, -v68, -v64
    v_cvt_pk_bf16_f32 v45, v65, -v69
    v_cvt_pk_bf16_f32 v53, -v69, -v65
    v_cvt_pk_bf16_f32 v46, v66, -v70
    v_cvt_pk_bf16_f32 v54, -v70, -v66
    v_cvt_pk_bf16_f32 v47, v67, -v71
    v_cvt_pk_bf16_f32 v55, -v71, -v67
    ds_write_b128 v5, v[40:43] offset:42688
    ds_write_b128 v5, v[44:47] offset:43712
    ds_write_b128 v5, v[48:51] offset:44736
    ds_write_b128 v5, v[52:55] offset:45760
    global_load_dword v30, v31, s[30:31]
    s_waitcnt lgkmcnt(0)
    v_mov_b32 v9, 33792
    s_waitcnt vmcnt(0)
    v_mul_lo_u32 v31, v30, s64
    v_add_u32 v31, 0x7F4A7C15, v31
    v_lshlrev_b32 v6, 1, v1
    v_lshrrev_b32 v6, v6, v31
    v_lshlrev_b32 v7, 15, v6
    v_and_b32 v6, 1, v6
    v_and_b32 v7, 0x10000, v7
    v_or_b32 v6, v6, v7
    v_lshlrev_b32 v7, 2, v1
    ds_write_b32 v7, v6 offset:33920
    s_waitcnt lgkmcnt(0)
    v_mov_b32 v9, 33792
    s_barrier
    ds_read_b32 v30, v9
    s_mov_b32 exec_lo, -1
    s_mov_b32 exec_hi, 0x7
    s_waitcnt lgkmcnt(0)
    buffer_store_dwordx2 v[30:31], v14, s[36:39], s50 offen sc1
    s_mov_b64 exec, -1
    s_barrier
    s_and_b32 s61, s2, 7
    s_mul_i32 s61, s61, 2048
    s_add_u32 s61, s61, 84992
    s_add_u32 s62, s61, 1024
    s_waitcnt vmcnt(0)
    s_sleep 6
    s_branch L_poll5_1
L_poll5:
    s_sleep 5
L_poll5_1:
    buffer_load_dwordx4 v[32:35], v5, s[36:39], s61 offen sc1
    s_add_u32 s61, s61, 1024
    s_min_u32 s61, s61, s62
    s_add_u32 s65, s65, 1
    s_lshr_b32 s34, s65, 17
    s_waitcnt vmcnt(0)
    s_cbranch_scc1 L_poll5_ok
    v_cmp_ne_u32 vcc, v31, v33
    v_cmp_ne_u32 s[12:13], v31, v35
    s_or_b64 vcc, vcc, s[12:13]
    s_cbranch_vccnz L_poll5
L_poll5_ok:
    v_max_u32 v32, v32, v34
    s_nop 1
    v_max_u32_dpp v32, v32, v32 row_ror:8 row_mask:0xf bank_mask:0xf
    s_nop 1
    v_max_u32_dpp v32, v32, v32 row_ror:4 row_mask:0xf bank_mask:0xf
    s_nop 1
    v_max_u32_dpp v32, v32, v32 row_ror:2 row_mask:0xf bank_mask:0xf
    s_nop 1
    v_max_u32_dpp v32, v32, v32 row_ror:1 row_mask:0xf bank_mask:0xf
    s_nop 1
    v_max_u32_dpp v32, v32, v32 row_bcast:15 row_mask:0xa bank_mask:0xf
    s_nop 1
    v_max_u32_dpp v32, v32, v32 row_bcast:31 row_mask:0xc bank_mask:0xf
    v_mov_b32 v9, 33856
    s_mov_b32 exec_lo, 0
    s_brev_b32 exec_hi, 1
    ds_write_b32 v9, v32
    s_mov_b64 exec, -1
    s_waitcnt lgkmcnt(0)
    s_sleep 12
    s_barrier
    s_endpgm
    s_barrier
    s_endpgm
L_notA:
    s_lshl4_add_u32 s60, s6, s7
    s_sub_u32 s60, s60, 16
    s_cmp_ge_u32 s2, 256
    s_cbranch_scc1 L_end
    s_cmp_lt_u32 s6, 4
    s_cbranch_scc1 L_F
    s_mul_i32 s60, s6, 12
    s_add_u32 s60, s60, s7
    s_cmp_lt_u32 s7, 28
    s_cbranch_scc1 L_F
    s_mov_b32 s55, 1
    s_lshl2_add_u32 s47, s6, s7
    s_sub_u32 s47, s47, 44
    v_and_b32 v6, 1, v2
    v_lshlrev_b32 v6, 5, v6
    v_lshl_add_u32 v6, v1, 6, v6
    v_lshrrev_b32 v7, 1, v2
    v_lshl_add_u32 v3, v7, 4, v6
    v_lshlrev_b32 v5, 4, v0
    v_lshlrev_b32 v8, 31, v1
    v_lshrrev_b32 v9, 16, v8
    v_or_b32 v8, v8, v9
    s_waitcnt lgkmcnt(0)
    s_mov_b32 s36, s30
    s_mov_b32 s37, s31
    s_mov_b32 s38, 0x1000000
    s_mov_b32 s39, 0x20000
    s_mov_b32 s65, 0
    s_mov_b32 s40, s26
    s_mov_b32 s41, s27
    s_mov_b32 s42, 0x200000
    s_mov_b32 s43, 0x20000
    v_lshlrev_b32 v6, 4, v1
    v_lshl_add_u32 v10, v2, 13, v6
    v_mul_u32_u24 v6, 4352, v2
    v_bfe_u32 v7, v1, 1, 2
    v_xor_b32 v7, s3, v7
    v_lshl_add_u32 v7, v7, 4, v6
    v_lshl_add_u32 v11, v1, 6, v7
    s_lshl4_add_u32 s7, s3, 1024
    v_mov_b32 v9, 17600
    v_lshl_add_u32 v28, v0, 1, v9
    v_lshl_add_u32 v7, v1, 1, s7
    s_mov_b32 exec_lo, 0x00ff00ff
    s_mov_b32 exec_hi, 0x00ff00ff
    v_add_u32 v28, v7, v6
    s_mov_b64 exec, -1
    s_cmp_eq_u32 s3, 8
    s_cbranch_scc1 L_zh
    s_cmp_ge_u32 s3, 4
    s_cbranch_scc1 L_z0
    v_cvt_f32_u32 v6, v1
    s_lshl_b32 s6, s3, 2
    v_lshl_add_u32 v7, v2, 6, s6
    v_mul_f32 v6, 0x3b000000, v6
    v_cvt_f32_u32 v7, v7
    v_mul_f32 v15, 0x41800000, v6
    v_mul_f32 v7, v7, v6
    v_cos_f32 v64, v7
    v_sin_f32 v68, v7
    v_add_f32 v9, v7, v15
    v_cos_f32 v65, v9
    v_sin_f32 v69, v9
    v_add_f32 v9, v9, v15
    v_cos_f32 v66, v9
    v_sin_f32 v70, v9
    v_add_f32 v9, v9, v15
    v_cos_f32 v67, v9
    v_sin_f32 v71, v9
    v_mov_b32 v108, 0
    v_cvt_pk_bf16_f32 v100, v64, v65
    v_cvt_pk_bf16_f32 v104, -v68, -v69
    v_cvt_pk_bf16_f32 v101, v66, v67
    v_cvt_pk_bf16_f32 v105, -v70, -v71
    v_xor_b32 v102, v100, v8
    v_xor_b32 v106, v104, v8
    v_xor_b32 v103, v101, v8
    v_xor_b32 v107, v105, v8
    v_add_f32 v7, v7, v6
    v_cos_f32 v64, v7
    v_sin_f32 v68, v7
    v_add_f32 v9, v7, v15
    v_cos_f32 v65, v9
    v_sin_f32 v69, v9
    v_add_f32 v9, v9, v15
    v_cos_f32 v66, v9
    v_sin_f32 v70, v9
    v_add_f32 v9, v9, v15
    v_cos_f32 v67, v9
    v_sin_f32 v71, v9
    v_mov_b32 v120, 0
    v_cvt_pk_bf16_f32 v112, v64, v65
    v_cvt_pk_bf16_f32 v116, -v68, -v69
    v_cvt_pk_bf16_f32 v113, v66, v67
    v_cvt_pk_bf16_f32 v117, -v70, -v71
    v_xor_b32 v114, v112, v8
    v_xor_b32 v118, v116, v8
    v_xor_b32 v115, v113, v8
    v_xor_b32 v119, v117, v8
    v_add_f32 v7, v7, v6
    v_cos_f32 v64, v7
    v_sin_f32 v68, v7
    v_add_f32 v9, v7, v15
    v_cos_f32 v65, v9
    v_sin_f32 v69, v9
    v_add_f32 v9, v9, v15
    v_cos_f32 v66, v9
    v_sin_f32 v70, v9
    v_add_f32 v9, v9, v15
    v_cos_f32 v67, v9
    v_sin_f32 v71, v9
    v_mov_b32 v132, 0
    v_cvt_pk_bf16_f32 v124, v64, v65
    v_cvt_pk_bf16_f32 v128, -v68, -v69
    v_cvt_pk_bf16_f32 v125, v66, v67
    v_cvt_pk_bf16_f32 v129, -v70, -v71
    v_xor_b32 v126, v124, v8
    v_xor_b32 v130, v128, v8
    v_xor_b32 v127, v125, v8
    v_xor_b32 v131, v129, v8
    v_add_f32 v7, v7, v6
    v_cos_f32 v64, v7
    v_sin_f32 v68, v7
    v_add_f32 v9, v7, v15
    v_cos_f32 v65, v9
    v_sin_f32 v69, v9
    v_add_f32 v9, v9, v15
    v_cos_f32 v66, v9
    v_sin_f32 v70, v9
    v_add_f32 v9, v9, v15
    v_cos_f32 v67, v9
    v_sin_f32 v71, v9
    v_mov_b32 v144, 0
    v_cvt_pk_bf16_f32 v136, v64, v65
    v_cvt_pk_bf16_f32 v140, -v68, -v69
    v_cvt_pk_bf16_f32 v137, v66, v67
    v_cvt_pk_bf16_f32 v141, -v70, -v71
    v_xor_b32 v138, v136, v8
    v_xor_b32 v142, v140, v8
    v_xor_b32 v139, v137, v8
    v_xor_b32 v143, v141, v8
    v_lshrrev_b32 v6, 1, v1
    v_add_u32 v7, s6, v6
    v_and_b32 v9, 1, v1
    v_lshl_add_u32 v7, v9, 3, v7
    v_cvt_f32_u32 v7, v7
    v_mul_f32 v7, 0x3d000000, v7
    v_cos_f32 v7, v7
    s_mov_b32 exec_lo, 0x30003
    s_mov_b32 exec_hi, 0x30003
    v_cvt_pk_bf16_f32 v108, v7, -v7
    s_mov_b32 exec_lo, 0xc000c
    s_mov_b32 exec_hi, 0xc000c
    v_cvt_pk_bf16_f32 v120, v7, -v7
    s_mov_b32 exec_lo, 0x300030
    s_mov_b32 exec_hi, 0x300030
    v_cvt_pk_bf16_f32 v132, v7, -v7
    s_mov_b32 exec_lo, 0xc000c0
    s_mov_b32 exec_hi, 0xc000c0
    v_cvt_pk_bf16_f32 v144, v7, -v7
    s_mov_b64 exec, -1
    v_mov_b32 v109, v108
    v_mov_b32 v110, v108
    v_mov_b32 v111, v108
    v_mov_b32 v121, v120
    v_mov_b32 v122, v120
    v_mov_b32 v123, v120
    v_mov_b32 v133, v132
    v_mov_b32 v134, v132
    v_mov_b32 v135, v132
    v_mov_b32 v145, v144
    v_mov_b32 v146, v144
    v_mov_b32 v147, v144
    s_branch L_z1
L_z0:
    s_branch L_hi1
L_z0b:
    s_mov_b64 exec, 0
    s_sub_u32 s53, s3, 8
L_tzback:
    s_add_u32 s53, s53, 4
    s_cmp_eq_u32 s53, 0
    s_cbranch_scc1 L_tz0
    s_cmp_eq_u32 s53, 1
    s_cbranch_scc1 L_tz1
    s_cmp_eq_u32 s53, 2
    s_cbranch_scc1 L_tz2
    s_cmp_eq_u32 s53, 3
    s_cbranch_scc1 L_tz3
    s_cmp_eq_u32 s53, 4
    s_cbranch_scc1 L_tz4
    s_cmp_eq_u32 s53, 5
    s_cbranch_scc1 L_tz5
    s_cmp_eq_u32 s53, 6
    s_cbranch_scc1 L_tz6
    s_cmp_eq_u32 s53, 7
    s_cbranch_scc1 L_tz7
    s_mov_b64 exec, -1
L_z1:
    v_mov_b32 v9, 33792
    v_mov_b32 v12, 0
    v_mov_b32 v13, 0
    s_barrier
    ds_read_b64 v[30:31], v9
    ds_read_b128 v[24:27], v5 offset:47808
    s_waitcnt lgkmcnt(0)
    v_readfirstlane_b32 s44, v30
    s_andn2_b32 s54, 2047, s44
    s_and_b32 s6, s54, 127
    s_cmp_gt_u32 s6, 64
    s_cselect_b32 s46, 1, 0
    s_and_b32 s6, s54, 1087
    s_cmp_eq_u32 s6, 1024
    s_cselect_b32 s46, 1, s46
    s_sub_u32 s6, 2048, s54
    s_cmp_lg_u32 s46, 0
    s_cselect_b32 s6, s6, s54
    s_cmp_eq_u32 s6, 1024
    s_cselect_b32 s6, 0, s6
    s_and_b32 s56, s6, 127
    s_lshr_b32 s57, s6, 10
    s_bfe_u32 s45, s6, 0x30007
    s_lshl3_add_u32 s11, s57, s45
    s_lshl_b32 s11, s11, 7
    s_add_u32 s58, s11, s56
    s_sub_u32 s59, 2048, s58
    s_cmp_eq_u32 s58, 0
    s_cselect_b32 s59, 1024, s59
    s_lshl_b32 s10, s58, 10
    s_lshl_b32 s11, s59, 10
    v_add_u32 v6, s10, v5
    v_add_u32 v7, s11, v5
    s_cmp_ge_u32 s3, 4
    s_cbranch_scc1 L_z4
    s_and_b32 s7, s56, 63
    s_mul_i32 s32, s7, 33024
    s_lshl_b32 s7, s3, 9
    s_add_u32 s32, s32, s7
    s_add_u32 s32, s32, 2097152
    s_add_u32 s33, s32, 4096
    s_sleep 5
    buffer_load_dwordx4 v[32:35], v10, s[36:39], s32 offen offset:0 sc1
    buffer_load_dwordx4 v[36:39], v10, s[36:39], s32 offen offset:2048 sc1
    buffer_load_dwordx4 v[40:43], v10, s[36:39], s33 offen offset:0 sc1
    buffer_load_dwordx4 v[44:47], v10, s[36:39], s33 offen offset:2048 sc1
    buffer_load_dwordx4 v[48:51], v10, s[36:39], s32 offen offset:256 sc1
    buffer_load_dwordx4 v[52:55], v10, s[36:39], s32 offen offset:2304 sc1
    buffer_load_dwordx4 v[56:59], v10, s[36:39], s33 offen offset:256 sc1
    buffer_load_dwordx4 v[60:63], v10, s[36:39], s33 offen offset:2304 sc1
    v_lshrrev_b32 v6, 1, v1
    s_lshl_b32 s6, s57, 10
    s_add_u32 s6, s6, s56
    v_lshl_add_u32 v6, v6, 7, s6
    v_and_b32 v7, 1, v1
    v_lshlrev_b32 v9, 9, v7
    s_cmp_lg_u32 s56, 0
    s_cbranch_scc1 L_g06
    s_mov_b32 exec_lo, 0x00020002
    s_mov_b32 exec_hi, 0x00020002
    v_mov_b32 v6, 0x400
    v_mov_b32 v9, 0
    s_mov_b64 exec, -1
L_g06:
    v_lshlrev_b32 v7, 2, v2
    v_mad_u32_u24 v9, v7, v6, v9
    v_cvt_f32_u32 v6, v6
    v_cvt_f32_u32 v9, v9
    v_mul_f32 v6, 0x3a000000, v6
    v_mul_f32 v9, 0x3a000000, v9
    v_cos_f32 v64, v9
    v_sin_f32 v68, v9
    v_add_f32 v9, v9, v6
    v_cos_f32 v65, v9
    v_sin_f32 v69, v9
    v_add_f32 v9, v9, v6
    v_cos_f32 v66, v9
    v_sin_f32 v70, v9
    v_add_f32 v9, v9, v6
    v_cos_f32 v67, v9
    v_sin_f32 v71, v9
    s_and_b32 s7, s56, 63
    s_nop 0
    v_cvt_pk_bf16_f32 v148, v64, v68
    v_cvt_pk_bf16_f32 v149, v65, v69
    v_cvt_pk_bf16_f32 v150, v66, v70
    v_cvt_pk_bf16_f32 v151, v67, v71
    s_cmp_lg_u32 s7, 0
    s_cbranch_scc1 L_gd7
    s_lshr_b32 s7, s56, 2
    v_and_b32 v148, 0xffff, v148
    v_lshlrev_b32 v148, s7, v148
    v_and_b32 v149, 0xffff, v149
    v_lshlrev_b32 v149, s7, v149
    v_and_b32 v150, 0xffff, v150
    v_lshlrev_b32 v150, s7, v150
    v_and_b32 v151, 0xffff, v151
    v_lshlrev_b32 v151, s7, v151
L_gd7:
    v_and_b32 v6, 3, v1
    v_lshlrev_b32 v6, 4, v6
    ds_read_b128 v[96:99], v6 offset:33920
    s_waitcnt lgkmcnt(0)
    s_mul_i32 s7, s45, 2176
    v_bfe_u32 v7, v1, 1, 2
    v_xor_b32 v7, v7, v2
    v_lshl_add_u32 v7, v7, 4, s7
    v_lshl_add_u32 v29, v1, 6, v7
    v_sub_u32 v6, 16, v1
    v_bfe_u32 v7, v6, 1, 2
    v_xor_b32 v7, v7, v2
    v_lshl_add_u32 v7, v7, 4, s7
    v_lshl_add_u32 v30, v6, 6, v7
    s_cmp_eq_u32 s58, 0
    s_cselect_b32 s6, 0, 2048
    v_add_u32 v4, s6, v5
    v_lshlrev_b32 v6, 7, v1
    v_lshl_add_u32 v15, v2, 4, v6
    s_branch L_zjoin
L_z4:
    s_cmp_ge_u32 s3, 6
    s_cbranch_scc1 L_zend2
    global_load_dwordx4 v[16:19], v6, s[4:5]
    global_load_dwordx4 v[20:23], v7, s[4:5]
    s_sub_u32 s6, s3, 4
    s_lshl1_add_u32 s7, s47, s6
    s_lshl_b32 s7, s7, 5
    v_and_b32 v6, 7, v0
    v_lshl_add_u32 v10, v6, 2, s7
    s_lshl_b32 s8, s54, 10
    v_add_u32 v7, s8, v10
    global_load_dword v35, v7, s[4:5]
    v_lshlrev_b32 v10, 1, v10
    v_lshrrev_b32 v7, 3, v0
    v_lshlrev_b32 v7, 8, v7
    v_lshl_add_u32 v11, v6, 4, v7
    s_mul_i32 s48, s47, 14336
    s_lshl_b32 s6, s6, 7
    s_add_u32 s48, s48, s6
    s_add_u32 s48, s48, 720896
    s_add_u32 s49, s48, 0
    s_and_b32 s6, s44, 0xffff0000
    s_xor_b32 s7, s6, 0x80000000
    s_xor_b32 s9, s6, 0xffff0000
    s_bitcmp1_b32 s6, 31
    s_cselect_b32 s6, s7, s9
    v_mov_b32 v15, s6
    v_mul_f32 v15, 0xbfb8aa3b, v15
    v_exp_f32 v15, v15
    s_nop 0
    v_add_f32 v15, 1.0, v15
    v_rcp_f32 v15, v15
    s_nop 0
    v_cvt_pk_bf16_f32 v15, v15, v15
    v_and_b32 v15, 0xffff0000, v15
    s_waitcnt vmcnt(0)
    v_dot2c_f32_bf16 v12, v16, v24
    v_dot2c_f32_bf16 v13, v20, v24
    v_dot2c_f32_bf16 v12, v17, v25
    v_dot2c_f32_bf16 v13, v21, v25
    v_dot2c_f32_bf16 v12, v18, v26
    v_dot2c_f32_bf16 v13, v22, v26
    v_dot2c_f32_bf16 v12, v19, v27
    v_dot2c_f32_bf16 v13, v23, v27
    s_nop 2
    v_permlane32_swap_b32 v12, v13
    v_add_f32 v12, v12, v13
    v_mov_b32 v13, v12
    s_nop 1
    v_permlane16_swap_b32 v12, v13
    v_add_f32 v12, v12, v13
    s_nop 1
    v_add_f32_dpp v12, v12, v12 row_ror:8 row_mask:0xf bank_mask:0xf
    s_nop 1
    v_add_f32_dpp v12, v12, v12 row_ror:4 row_mask:0xf bank_mask:0xf
    s_nop 1
    v_add_f32_dpp v12, v12, v12 row_ror:2 row_mask:0xf bank_mask:0xf
    s_nop 1
    v_add_f32_dpp v12, v12, v12 row_ror:1 row_mask:0xf bank_mask:0xf
    v_cvt_pk_bf16_f32 v12, v12, v12
    v_and_b32 v12, 0xffff0000, v12
    v_mul_f32 v13, 0xbfb8aa3b, v12
    v_exp_f32 v13, v13
    s_nop 0
    v_add_f32 v13, 1.0, v13
    v_rcp_f32 v13, v13
    s_nop 0
    v_cvt_pk_bf16_f32 v13, v13, v13
    v_and_b32 v13, 0xffff0000, v13
    v_sub_f32 v14, 1.0, v13
    v_cvt_pk_bf16_f32 v14, v14, v14
    v_and_b32 v14, 0xffff0000, v14
    v_readlane_b32 s6, v13, 0
    v_readlane_b32 s7, v13, 32
    v_readlane_b32 s8, v14, 0
    v_readlane_b32 s9, v14, 32
    s_xor_b32 s10, s6, 0x80000000
    s_cmp_eq_u32 s58, 0
    s_cselect_b32 s10, 0, s10
    s_cselect_b32 s11, 0, s7
    s_cmp_lg_u32 s46, 0
    s_cselect_b32 s8, s9, s8
    s_cselect_b32 s6, s11, s6
    s_cselect_b32 s10, s7, s10
    v_xor_b32 v31, s54, v31
    v_mov_b32 v36, s8
    v_mov_b32 v24, s6
    v_mov_b32 v25, s10
    v_lshlrev_b32 v34, 16, v35
    v_and_b32 v35, 0xffff0000, v35
    s_sleep 24
    v_mov_b32 v9, 33864
L_tz_start:
L_zp:
    buffer_load_dwordx4 v[40:43], v11, s[36:39], s48 offen offset:0 sc1
    buffer_load_dwordx4 v[44:47], v11, s[36:39], s48 offen offset:2048 sc1
    s_add_u32 s6, s48, 4096
    buffer_load_dwordx4 v[48:51], v11, s[36:39], s6 offen offset:0 sc1
    buffer_load_dwordx4 v[52:55], v11, s[36:39], s6 offen offset:2048 sc1
    s_add_u32 s6, s48, 8192
    buffer_load_dwordx4 v[56:59], v11, s[36:39], s6 offen offset:0 sc1
    buffer_load_dwordx4 v[60:63], v11, s[36:39], s6 offen offset:2048 sc1
    s_add_u32 s6, s48, 12288
    buffer_load_dwordx4 v[64:67], v11, s[36:39], s6 offen offset:0 sc1
    s_add_u32 s48, s48, 229376
    s_min_u32 s48, s48, s49
    s_add_u32 s65, s65, 1
    s_lshr_b32 s34, s65, 17
    s_cbranch_scc1 L_zp_ok
    s_waitcnt vmcnt(6)
    v_bitop3_b32 v37, v41, v43, v31 bitop3:0x7e
L_tz0:
    s_cbranch_execz L_tzback
    s_waitcnt vmcnt(5)
    v_bitop3_b32 v39, v45, v47, v31 bitop3:0x7e
    v_add_f32 v40, v40, v44
    v_add_f32 v42, v42, v46
    s_waitcnt vmcnt(4)
    v_bitop3_b32 v38, v49, v51, v31 bitop3:0x7e
    v_add_f32 v40, v40, v48
    v_add_f32 v42, v42, v50
    v_or3_b32 v37, v37, v38, v39
    s_waitcnt vmcnt(3)
    v_bitop3_b32 v39, v53, v55, v31 bitop3:0x7e
    v_add_f32 v40, v40, v52
    v_add_f32 v42, v42, v54
    s_waitcnt vmcnt(2)
    v_bitop3_b32 v38, v57, v59, v31 bitop3:0x7e
    v_add_f32 v40, v40, v56
    v_add_f32 v42, v42, v58
    v_or3_b32 v37, v37, v38, v39
    s_waitcnt vmcnt(1)
    v_bitop3_b32 v39, v61, v63, v31 bitop3:0x7e
    v_add_f32 v40, v40, v60
    v_add_f32 v42, v42, v62
    s_waitcnt vmcnt(0)
    v_bitop3_b32 v38, v65, v67, v31 bitop3:0x7e
L_tz1:
    s_cbranch_execz L_tzback
    v_add_f32 v40, v40, v64
    v_add_f32 v42, v42, v66
    v_or3_b32 v37, v37, v38, v39
    v_cmp_ne_u32 vcc, 0, v37
    s_nop 0
    s_cbranch_vccnz L_zp
L_zp_ok:
    ds_read_b32 v12, v9
    ds_read_b64 v[32:33], v10 offset:38592
    ds_read_b64 v[16:17], v10 offset:40640
    v_lshrrev_b32 v11, 1, v10
    s_lshl_b32 s8, s54, 10
    s_waitcnt vmcnt(0)
    v_add_f32_dpp v40, v40, v40 row_ror:8 row_mask:0xf bank_mask:0xf
    v_add_f32_dpp v42, v42, v42 row_ror:8 row_mask:0xf bank_mask:0xf
    s_nop 0
    s_nop 0
    v_permlane16_swap_b32 v40, v42
    v_add_f32 v40, v40, v42
    v_mov_b32 v42, v40
    s_nop 1
    v_permlane32_swap_b32 v40, v42
    v_add_f32 v40, v40, v42
    v_mov_b32 v42, v40
    s_nop 1
L_tz2:
    s_cbranch_execz L_tzback
    v_permlane16_swap_b32 v40, v42
    v_cvt_pk_bf16_f32 v41, v40, v42
    v_lshlrev_b32 v40, 16, v41
    v_and_b32 v42, 0xffff0000, v41
    v_mul_f32 v40, v40, v15
    v_mul_f32 v42, v42, v15
    v_cvt_pk_bf16_f32 v41, v40, v42
    v_lshlrev_b32 v40, 16, v41
    v_and_b32 v42, 0xffff0000, v41
    v_add_f32 v40, v40, v34
    v_add_f32 v42, v42, v35
    v_cvt_pk_bf16_f32 v41, v40, v42
    v_lshlrev_b32 v40, 16, v41
    v_and_b32 v42, 0xffff0000, v41
L_zw:
    s_waitcnt lgkmcnt(0)
    v_cmp_eq_u32 vcc, 0, v12
    v_mul_f32 v32, v24, v32
    v_mul_f32 v33, v24, v33
    s_cbranch_vccz L_zw_ok
    s_add_u32 s65, s65, 1
    s_lshr_b32 s34, s65, 17
    s_cbranch_scc1 L_zw_ok
    ds_read_b32 v12, v9
    ds_read_b64 v[32:33], v10 offset:38592
L_tz3:
    s_cbranch_execz L_tzback
    ds_read_b64 v[16:17], v10 offset:40640
    s_branch L_zw
L_zw_ok:
    v_fmac_f32 v32, v25, v16
    v_fmac_f32 v33, v25, v17
    v_fmac_f32 v32, v40, v36
    v_fmac_f32 v33, v42, v36
    v_cvt_pk_bf16_f32 v32, v32, v33
    s_mov_b64 exec, 0xff
    buffer_store_dword v32, v11, s[40:43], s8 offen
    s_mov_b64 exec, -1
    s_barrier
    s_endpgm
L_zsync:
    v_mov_b32 v9, 33868
    v_mov_b32 v6, 1
    s_mov_b64 exec, 1
    ds_add_u32 v9, v6
    s_mov_b64 exec, -1
    s_cmp_lg_u32 s3, 0
    s_cbranch_scc1 L_zend
L_zs:
    ds_read_b32 v6, v9
    s_add_u32 s65, s65, 1
    s_lshr_b32 s34, s65, 17
    s_waitcnt lgkmcnt(0)
L_tz4:
    s_cbranch_execz L_tzback
    s_cbranch_scc1 L_zs_ok
    v_cmp_ne_u32 vcc, 4, v6
    s_nop 0
    s_cbranch_vccnz L_zs
L_zs_ok:
    ds_read_b128 v[32:35], v29 offset:16384
    ds_read_b128 v[36:39], v30 offset:16384
    ds_read_b128 v[40:43], v29 offset:17472
    ds_read_b128 v[44:47], v30 offset:17472
    s_waitcnt lgkmcnt(3)
    v_mfma_f32_16x16x32_bf16 v[48:51], v[32:35], v[64:67], 0
    s_waitcnt lgkmcnt(2)
    v_mfma_f32_16x16x32_bf16 v[52:55], v[36:39], v[68:71], 0
    s_waitcnt lgkmcnt(1)
    v_mfma_f32_16x16x32_bf16 v[56:59], v[40:43], v[72:75], 0
    s_waitcnt lgkmcnt(0)
    v_mfma_f32_16x16x32_bf16 v[60:63], v[44:47], v[76:79], 0
    s_nop 2
    ds_write_b128 v15, v[48:51] offset:38592
    ds_write_b128 v15, v[52:55] offset:38656
    s_nop 1
    ds_write_b128 v15, v[56:59] offset:40640
L_tz5:
    s_cbranch_execz L_tzback
    ds_write_b128 v15, v[60:63] offset:40704
    v_mov_b32 v9, 33864
    s_waitcnt lgkmcnt(0)
    ds_write_b32 v9, v9
    s_waitcnt lgkmcnt(0)
.set L_tz6, L_tzback
.set L_tz7, L_tzback
L_zend:
    s_endpgm
L_zend2:
    s_endpgm
L_zh:
    v_mov_b32 v9, 33864
    v_mov_b32 v6, 0
    ds_write2_b32 v9, v6, v6 offset1:1
    v_lshlrev_b32 v6, 2, v2
    v_cvt_f32_u32 v7, v1
    v_cvt_f32_u32 v6, v6
    v_mul_f32 v7, 0x3d800000, v7
    v_mul_f32 v9, v6, v7
    v_cos_f32 v64, v9
    v_sin_f32 v68, v9
    v_add_f32 v9, v9, v7
    v_cos_f32 v65, v9
    v_sin_f32 v69, v9
    v_add_f32 v9, v9, v7
    v_cos_f32 v66, v9
    v_sin_f32 v70, v9
    v_add_f32 v9, v9, v7
    v_cos_f32 v67, v9
    v_sin_f32 v71, v9
    s_nop 0
    v_cvt_pk_bf16_f32 v40, v64, v68
    v_cvt_pk_bf16_f32 v48, -v68, v64
    v_cvt_pk_bf16_f32 v41, v65, v69
    v_cvt_pk_bf16_f32 v49, -v69, v65
    v_cvt_pk_bf16_f32 v42, v66, v70
    v_cvt_pk_bf16_f32 v50, -v70, v66
    v_cvt_pk_bf16_f32 v43, v67, v71
    v_cvt_pk_bf16_f32 v51, -v71, v67
    v_add_f32 v7, 0x3d800000, v7
    v_mul_f32 v9, v6, v7
    v_cos_f32 v64, v9
    v_sin_f32 v68, v9
    v_add_f32 v9, v9, v7
    v_cos_f32 v65, v9
    v_sin_f32 v69, v9
    v_add_f32 v9, v9, v7
    v_cos_f32 v66, v9
    v_sin_f32 v70, v9
    v_add_f32 v9, v9, v7
    v_cos_f32 v67, v9
    v_sin_f32 v71, v9
    s_nop 0
    v_cvt_pk_bf16_f32 v44, v64, -v68
    v_cvt_pk_bf16_f32 v52, -v68, -v64
    v_cvt_pk_bf16_f32 v45, v65, -v69
    v_cvt_pk_bf16_f32 v53, -v69, -v65
    v_cvt_pk_bf16_f32 v46, v66, -v70
    v_cvt_pk_bf16_f32 v54, -v70, -v66
    v_cvt_pk_bf16_f32 v47, v67, -v71
    v_cvt_pk_bf16_f32 v55, -v71, -v67
    ds_write_b128 v5, v[40:43] offset:42688
    ds_write_b128 v5, v[44:47] offset:43712
    ds_write_b128 v5, v[48:51] offset:44736
    ds_write_b128 v5, v[52:55] offset:45760
    s_mov_b32 m0, 47808
    v_mov_b32 v31, 0
    global_load_dword v30, v31, s[30:31]
    s_mov_b32 s64, 0x9E3779B1
    global_load_lds_dwordx4 v5, s[24:25]
    s_waitcnt vmcnt(0)
    v_mul_lo_u32 v31, v30, s64
    v_add_u32 v31, 0x7F4A7C15, v31
    v_lshlrev_b32 v6, 1, v1
    v_lshrrev_b32 v6, v6, v31
    v_lshlrev_b32 v7, 15, v6
    v_and_b32 v6, 1, v6
    v_and_b32 v7, 0x10000, v7
    v_or_b32 v6, v6, v7
    v_lshlrev_b32 v7, 2, v1
    ds_write_b32 v7, v6 offset:33920
    s_waitcnt lgkmcnt(0)
    s_and_b32 s61, s2, 0
    s_mul_i32 s61, s61, 3072
    s_add_u32 s61, s61, 81920
    s_add_u32 s62, s61, 2048
    s_sleep 24
    s_branch L_poll8_1
L_poll8:
    s_sleep 8
L_poll8_1:
    buffer_load_dwordx4 v[32:35], v5, s[36:39], s61 offen sc1
    s_add_u32 s61, s61, 1024
    s_min_u32 s61, s61, s62
    s_add_u32 s65, s65, 1
    s_lshr_b32 s34, s65, 17
    s_waitcnt vmcnt(0)
    s_cbranch_scc1 L_poll8_ok
    v_cmp_ne_u32 vcc, v31, v33
    v_cmp_ne_u32 s[12:13], v31, v35
    s_or_b64 vcc, vcc, s[12:13]
    s_cbranch_vccnz L_poll8
L_poll8_ok:
    v_max_u32 v32, v32, v34
    s_nop 1
    v_max_u32_dpp v32, v32, v32 row_ror:8 row_mask:0xf bank_mask:0xf
    s_nop 1
    v_max_u32_dpp v32, v32, v32 row_ror:4 row_mask:0xf bank_mask:0xf
    s_nop 1
    v_max_u32_dpp v32, v32, v32 row_ror:2 row_mask:0xf bank_mask:0xf
    s_nop 1
    v_max_u32_dpp v32, v32, v32 row_ror:1 row_mask:0xf bank_mask:0xf
    s_nop 1
    v_max_u32_dpp v32, v32, v32 row_bcast:15 row_mask:0xa bank_mask:0xf
    s_nop 1
    v_max_u32_dpp v32, v32, v32 row_bcast:31 row_mask:0xc bank_mask:0xf
    v_mov_b32 v9, 33792
    s_mov_b32 exec_lo, 0
    s_brev_b32 exec_hi, 1
    ds_write2_b32 v9, v32, v31 offset1:1
    s_mov_b64 exec, -1
    s_waitcnt lgkmcnt(0)
    s_barrier
    s_lshl_b32 s6, s47, 2
    s_add_u32 s6, s6, 4096
    s_mov_b64 exec, 1
    buffer_store_dword v31, v0, s[36:39], s6 offen sc1
    s_mov_b64 exec, -1
    s_cmp_lg_u32 s47, 0
    s_cbranch_scc1 L_zend
    s_mov_b64 exec, 0xffff
    v_lshlrev_b32 v6, 2, v0
    s_mov_b32 s6, 4096
    s_waitcnt vmcnt(0)
    s_sleep 24
L_za:
    buffer_load_dword v7, v6, s[36:39], s6 offen sc1
    s_add_u32 s65, s65, 1
    s_lshr_b32 s34, s65, 17
    s_waitcnt vmcnt(0)
    s_cbranch_scc1 L_za_ok
    v_cmp_ne_u32 vcc, v31, v7
    s_nop 0
    s_cbranch_vccnz L_za
L_za_ok:
    s_mov_b64 exec, 1
    v_add_u32 v9, 1, v30
    s_barrier
    buffer_store_dword v9, v6, s[36:39], 0 offen sc1
    s_mov_b64 exec, -1
    s_branch L_zend
L_F:
    v_lshlrev_b32 v5, 4, v0
    s_cmp_eq_u32 s3, 8
    s_cbranch_scc1 L_fh
    s_and_b32 s6, s60, 3
    s_lshr_b32 s7, s3, 1
    s_lshl2_add_u32 s32, s6, s7
    s_mul_i32 s8, s32, 114688
    s_lshr_b32 s33, s60, 2
    s_lshl_b32 s9, s33, 7
    s_add_u32 s8, s8, s9
    v_lshrrev_b32 v6, 3, v0
    v_mul_u32_u24 v6, 3584, v6
    v_and_b32 v7, 7, v0
    v_bfe_u32 v8, v0, 4, 1
    v_lshlrev_b32 v8, 2, v8
    v_xor_b32 v4, v7, v8
    v_lshl_add_u32 v7, v4, 4, s8
    v_add_u32 v3, v6, v7
    s_lshl_b32 s10, s3, 12
    s_mov_b32 m0, s10
    v_bfe_u32 v6, v0, 2, 2
    v_and_b32 v7, 3, v0
    v_lshlrev_b32 v8, 3, v7
    v_lshl_add_u32 v8, v2, 5, v8
    v_and_b32 v9, 2, v6
    v_lshlrev_b32 v9, 5, v9
    v_xor_b32 v9, v9, v8
    v_lshl_add_u32 v9, v6, 7, v9
    v_add_u32 v9, s10, v9
    s_lshl_b32 s11, s3, 8
    v_lshlrev_b32 v11, 2, v0
    v_add_u32 v11, 49152, v11
    v_add_u32 v12, s11, v11
    s_lshl1_add_u32 s7, s33, s7
    s_lshl_b32 s8, s7, 15
    s_and_b32 s9, s3, 1
    s_lshl1_add_u32 s9, s6, s9
    s_lshl_b32 s11, s9, 7
    s_add_u32 s8, s8, s11
    v_lshrrev_b32 v6, 3, v0
    v_lshl_add_u32 v6, v6, 10, s8
    v_lshl_add_u32 v4, v4, 4, v6
    v_lshrrev_b32 v6, 5, v0
    v_mul_u32_u24 v13, 14336, v6
    v_and_b32 v6, 31, v0
    v_lshl_add_u32 v13, v6, 3, v13
    s_mul_i32 s8, s9, 28672
    s_lshl_b32 s7, s7, 8
    s_add_u32 s8, s8, s7
    s_add_u32 s8, s8, 720896
    s_lshl_b32 s32, s32, 6
    s_lshl_b32 s33, s33, 12
    s_add_u32 s61, s33, 196608
    s_add_u32 s62, s61, 114688
    s_lshl_b32 s7, s6, 10
    s_add_u32 s33, s61, s7
    v_mov_b32 v14, 51200
    s_lshr_b32 s7, s3, 1
    s_lshl_b32 s7, s7, 9
    v_lshl_add_u32 v15, v6, 4, s7
    v_lshrrev_b32 v6, 5, v0
    v_lshl_add_u32 v15, v6, 10, v15
    s_mov_b32 s40, s61
    s_mov_b32 s41, s33
    s_mov_b32 s42, s8
    s_mov_b32 s35, 0
    s_bitcmp1_b32 s3, 0
    s_waitcnt lgkmcnt(0)
    s_cselect_b32 s18, s20, s18
    s_cselect_b32 s19, s21, s19
    global_load_lds_dwordx4 v3, s[18:19]
    s_add_u32 m0, s10, 1024
    v_add_u32 v3, 28672, v3
    global_load_lds_dwordx4 v3, s[18:19]
    s_add_u32 m0, s10, 2048
    v_add_u32 v3, 28672, v3
    global_load_lds_dwordx4 v3, s[18:19]
    s_add_u32 m0, s10, 3072
    v_add_u32 v3, 28672, v3
    global_load_lds_dwordx4 v3, s[18:19]
    s_mov_b32 s36, s30
    s_mov_b32 s37, s31
    s_mov_b32 s38, 0x1000000
    s_mov_b32 s39, 0x20000
    s_mov_b32 s65, 0
    s_cmp_ge_u32 s3, 4
    s_cbranch_scc1 L_nowd9
    s_add_u32 m0, s10, 32768
    s_nop 0
    global_load_lds_dwordx4 v4, s[22:23]
    s_add_u32 m0, s10, 33792
    v_add_u32 v4, 0x2000, v4
    global_load_lds_dwordx4 v4, s[22:23]
    s_add_u32 m0, s10, 34816
    v_add_u32 v4, 0x2000, v4
    global_load_lds_dwordx4 v4, s[22:23]
    s_add_u32 m0, s10, 35840
    v_add_u32 v4, 0x2000, v4
    global_load_lds_dwordx4 v4, s[22:23]
L_nowd9:
    s_waitcnt vmcnt(0)
    ds_read_b64_tr_b16 v[32:33], v9 offset:0
    ds_read_b64_tr_b16 v[34:35], v9 offset:512
    ds_read_b64_tr_b16 v[36:37], v9 offset:1024
    ds_read_b64_tr_b16 v[38:39], v9 offset:1536
    ds_read_b64_tr_b16 v[40:41], v9 offset:2048
    ds_read_b64_tr_b16 v[42:43], v9 offset:2560
    ds_read_b64_tr_b16 v[44:45], v9 offset:3072
    ds_read_b64_tr_b16 v[46:47], v9 offset:3584
    s_mov_b64 exec, 0
    s_sub_u32 s53, s3, 8
L_tfback:
    s_add_u32 s53, s53, 8
    s_cmp_eq_u32 s53, 0
    s_cbranch_scc1 L_tf0
    s_cmp_eq_u32 s53, 1
    s_cbranch_scc1 L_tf1
    s_cmp_eq_u32 s53, 2
    s_cbranch_scc1 L_tf2
    s_cmp_eq_u32 s53, 3
    s_cbranch_scc1 L_tf3
    s_cmp_eq_u32 s53, 4
    s_cbranch_scc1 L_tf4
    s_cmp_eq_u32 s53, 5
    s_cbranch_scc1 L_tf5
    s_cmp_eq_u32 s53, 6
    s_cbranch_scc1 L_tf6
    s_cmp_eq_u32 s53, 7
    s_cbranch_scc1 L_tf7
    s_mov_b64 exec, -1
    s_waitcnt lgkmcnt(0)
    s_barrier
L_tf_start:
    ds_read_b64 v[26:27], v14
    s_waitcnt lgkmcnt(0)
    v_readfirstlane_b32 s43, v26
L_redo:
    s_andn2_b32 s6, 2047, s43
L_tf0:
    s_cbranch_execz L_tfback
    s_lshl_b32 s7, s6, 10
    s_add_u32 s7, s7, s32
    s_load_dwordx16 s[44:59], s[4:5], s7
    v_xor_b32 v31, s6, v27
    v_xor_b32 v29, s6, v27
    v_mov_b32 v16, 0
    v_mov_b32 v17, 0
    v_mov_b32 v24, 0
    v_mov_b32 v25, 0
    s_mov_b32 s61, s40
    s_mov_b32 s33, s41
    s_mov_b32 s8, s42
    s_mov_b32 s64, 0
    s_waitcnt lgkmcnt(0)
    v_dot2c_f32_bf16 v16, s44, v32
    v_dot2c_f32_bf16 v17, s45, v33
    v_dot2c_f32_bf16 v16, s46, v34
    v_dot2c_f32_bf16 v17, s47, v35
    v_dot2c_f32_bf16 v16, s48, v36
    v_dot2c_f32_bf16 v17, s49, v37
    v_dot2c_f32_bf16 v16, s50, v38
    v_dot2c_f32_bf16 v17, s51, v39
    v_dot2c_f32_bf16 v16, s52, v40
    v_dot2c_f32_bf16 v17, s53, v41
    v_dot2c_f32_bf16 v16, s54, v42
    v_dot2c_f32_bf16 v17, s55, v43
    v_dot2c_f32_bf16 v16, s56, v44
    v_dot2c_f32_bf16 v17, s57, v45
    v_dot2c_f32_bf16 v16, s58, v46
L_tf1:
    s_cbranch_execz L_tfback
    v_dot2c_f32_bf16 v17, s59, v47
    s_nop 2
    v_add_f32 v16, v16, v17
    ds_write_b32 v12, v16
    s_waitcnt lgkmcnt(0)
    s_barrier
    s_lshl_b32 s6, s3, 4
    s_lshl_b64 s[12:13], 0xffff, s6
    ds_read2st64_b32 v[16:17], v11 offset0:0 offset1:2
    ds_read2st64_b32 v[18:19], v11 offset0:4 offset1:6
    ds_read2st64_b32 v[20:21], v11 offset0:1 offset1:3
    ds_read2st64_b32 v[22:23], v11 offset0:5 offset1:7
    s_waitcnt lgkmcnt(2)
    v_add_f32 v16, v16, v17
    v_add_f32 v18, v18, v19
    s_waitcnt lgkmcnt(0)
    v_add_f32 v20, v20, v21
    v_add_f32 v22, v22, v23
    v_add_f32 v28, v16, v18
    s_mov_b64 exec, s[12:13]
    v_add_f32 v30, v20, v22
    s_cmp_ge_u32 s3, 4
    s_cbranch_scc1 L_f5
    buffer_store_dwordx4 v[28:31], v5, s[36:39], s33 offen
    s_mov_b64 exec, -1
L_tf2:
    s_cbranch_execz L_tfback
    s_waitcnt vmcnt(1)
    ds_read_b64_tr_b16 v[48:49], v9 offset:32768
    ds_read_b64_tr_b16 v[50:51], v9 offset:33280
    ds_read_b64_tr_b16 v[52:53], v9 offset:33792
    ds_read_b64_tr_b16 v[54:55], v9 offset:34304
    ds_read_b64_tr_b16 v[56:57], v9 offset:34816
    ds_read_b64_tr_b16 v[58:59], v9 offset:35328
    ds_read_b64_tr_b16 v[60:61], v9 offset:35840
    ds_read_b64_tr_b16 v[62:63], v9 offset:36352
    s_sleep 3
L_fx:
    buffer_load_dwordx4 v[64:67], v15, s[36:39], s61 offen offset:0 sc1
    buffer_load_dwordx4 v[68:71], v15, s[36:39], s61 offen offset:2048 sc1
    s_add_u32 s64, s64, 1
    s_cmp_ge_u32 s64, 8
    s_cselect_b32 s6, 114688, 0
    s_add_u32 s61, s61, s6
    s_min_u32 s61, s61, s62
    s_add_u32 s65, s65, 1
    s_lshr_b32 s34, s65, 17
L_tf3:
    s_cbranch_execz L_tfback
    s_cbranch_scc1 L_fx_ok
    s_waitcnt vmcnt(1)
    v_bitop3_b32 v20, v65, v67, v31 bitop3:0x7e
    s_waitcnt vmcnt(0)
    v_add_f32 v16, v64, v68
    v_add_f32 v18, v66, v70
    v_bitop3_b32 v21, v69, v71, v31 bitop3:0x7e
    v_or_b32 v20, v20, v21
    v_cmp_ne_u32 vcc, 0, v20
    v_permlane32_swap_b32 v16, v18
    s_cbranch_vccnz L_fxr
L_fx_ok:
    v_add_f32 v16, v16, v18
    v_cvt_pk_bf16_f32 v16, v16, v16
    v_and_b32 v16, 0xffff0000, v16
    v_mov_b32 v18, v16
    v_mul_f32 v17, 0xbfb8aa3b, v16
    v_exp_f32 v17, v17
    s_nop 0
    v_add_f32 v17, 1.0, v17
    v_rcp_f32 v17, v17
    s_nop 0
    v_permlane32_swap_b32 v16, v18
    v_mul_f32 v17, v17, v16
    v_cvt_pk_bf16_f32 v17, v17, v17
    v_and_b32 v17, 0xffff0000, v17
L_tf4:
    s_cbranch_execz L_tfback
    v_mul_f32 v17, v17, v18
    s_nop 1
    v_mov_b32_dpp v18, v17 quad_perm:[1,0,3,2] row_mask:0xf bank_mask:0xf
    v_cvt_pk_bf16_f32 v17, v17, v18
    s_nop 0
    v_readlane_b32 s44, v17, 0
    v_readlane_b32 s45, v17, 2
    v_readlane_b32 s46, v17, 4
    v_readlane_b32 s47, v17, 6
    v_readlane_b32 s48, v17, 8
    v_readlane_b32 s49, v17, 10
    v_readlane_b32 s50, v17, 12
    v_readlane_b32 s51, v17, 14
    v_readlane_b32 s52, v17, 16
    v_readlane_b32 s53, v17, 18
    v_readlane_b32 s54, v17, 20
    v_readlane_b32 s55, v17, 22
L_tf5:
    s_cbranch_execz L_tfback
    v_readlane_b32 s56, v17, 24
    v_readlane_b32 s57, v17, 26
    v_readlane_b32 s58, v17, 28
    v_readlane_b32 s59, v17, 30
    s_waitcnt lgkmcnt(0)
    v_dot2c_f32_bf16 v24, s44, v48
    v_dot2c_f32_bf16 v25, s45, v49
    v_dot2c_f32_bf16 v24, s46, v50
    v_dot2c_f32_bf16 v25, s47, v51
    v_dot2c_f32_bf16 v24, s48, v52
    v_dot2c_f32_bf16 v25, s49, v53
    v_dot2c_f32_bf16 v24, s50, v54
    v_dot2c_f32_bf16 v25, s51, v55
    v_dot2c_f32_bf16 v24, s52, v56
    v_dot2c_f32_bf16 v25, s53, v57
    v_dot2c_f32_bf16 v24, s54, v58
    v_dot2c_f32_bf16 v25, s55, v59
    v_dot2c_f32_bf16 v24, s56, v60
    v_dot2c_f32_bf16 v25, s57, v61
    v_dot2c_f32_bf16 v24, s58, v62
    v_dot2c_f32_bf16 v25, s59, v63
    s_nop 2
    v_add_f32 v30, v24, v25
    buffer_store_dwordx2 v[30:31], v13, s[36:39], s8 offen sc1
.set L_tf6, L_tfback
.set L_tf7, L_tfback
L_fend:
    s_cmp_lg_u32 s35, 0
    s_cbranch_scc1 L_fexit
    s_barrier
    ds_read_b32 v26, v14 offset:8
    s_mov_b32 s35, 1
    s_waitcnt lgkmcnt(0)
    v_readfirstlane_b32 s6, v26
    s_cmp_eq_u32 s6, s43
    s_mov_b32 s43, s6
    s_cbranch_scc0 L_redo
L_fexit:
    s_endpgm
L_f5:
    s_add_u32 s33, s33, 114688
    buffer_store_dwordx4 v[28:31], v5, s[36:39], s33 offen sc1
    s_mov_b64 exec, -1
    s_branch L_fend
L_fxr:
    ds_read_b32 v26, v14 offset:8
    s_waitcnt lgkmcnt(0)
    v_readfirstlane_b32 s6, v26
    s_cmp_eq_u32 s6, 0
    s_cbranch_scc1 L_fx
    s_cmp_eq_u32 s6, s43
    s_cbranch_scc1 L_fx
    s_branch L_fend
L_fh:
    s_waitcnt lgkmcnt(0)
    v_mov_b32 v31, 0
    global_load_dword v30, v31, s[30:31]
    s_mov_b32 s64, 0x9E3779B1
    s_mov_b32 s36, s30
    s_mov_b32 s37, s31
    s_mov_b32 s38, 0x1000000
    s_mov_b32 s39, 0x20000
    s_mov_b32 s65, 0
    v_mov_b32 v14, 51200
    v_mov_b32 v6, 0
    ds_write_b32 v14, v6 offset:8
    s_and_b32 s61, s2, 7
    s_mul_i32 s61, s61, 2048
    s_add_u32 s61, s61, 65536
    s_add_u32 s62, s61, 1024
    s_sleep 37
    s_waitcnt vmcnt(0)
    v_mul_lo_u32 v31, v30, s64
    v_add_u32 v31, 0x7F4A7C15, v31
    s_branch L_poll10_1
L_poll10:
    s_sleep 4
L_poll10_1:
    buffer_load_dwordx4 v[20:23], v5, s[36:39], s61 offen sc1
    s_add_u32 s61, s61, 1024
    s_min_u32 s61, s61, s62
    s_add_u32 s65, s65, 1
    s_lshr_b32 s34, s65, 17
    s_waitcnt vmcnt(0)
    s_cbranch_scc1 L_poll10_ok
    v_cmp_ne_u32 vcc, v31, v21
    v_cmp_ne_u32 s[12:13], v31, v23
    s_or_b64 vcc, vcc, s[12:13]
    s_cbranch_vccnz L_poll10
L_poll10_ok:
    v_max_u32 v20, v20, v22
    s_nop 1
    v_max_u32_dpp v20, v20, v20 row_ror:8 row_mask:0xf bank_mask:0xf
    s_nop 1
    v_max_u32_dpp v20, v20, v20 row_ror:4 row_mask:0xf bank_mask:0xf
    s_nop 1
    v_max_u32_dpp v20, v20, v20 row_ror:2 row_mask:0xf bank_mask:0xf
    s_nop 1
    v_max_u32_dpp v20, v20, v20 row_ror:1 row_mask:0xf bank_mask:0xf
    s_nop 1
    v_max_u32_dpp v20, v20, v20 row_bcast:15 row_mask:0xa bank_mask:0xf
    s_nop 1
    v_max_u32_dpp v20, v20, v20 row_bcast:31 row_mask:0xc bank_mask:0xf
    v_mov_b32 v9, 51200
    s_mov_b32 exec_lo, 0
    s_brev_b32 exec_hi, 1
    ds_write2_b32 v9, v20, v31 offset1:1
    s_mov_b64 exec, -1
    s_waitcnt lgkmcnt(0)
    s_barrier
    v_mov_b32 v9, 51208
    s_mov_b32 exec_lo, 0
    s_brev_b32 exec_hi, 1
    ds_write_b32 v9, v20
    s_mov_b64 exec, -1
    s_waitcnt lgkmcnt(0)
    s_barrier
    s_endpgm
L_end:
    s_endpgm
.section .rodata,"a"
.p2align 6
.amdhsa_kernel gated_mix__spectral_fnet__moe_arch_mod__prompt_kernel
  .amdhsa_next_free_vgpr 168
  .amdhsa_next_free_sgpr 72
  .amdhsa_accum_offset 168
  .amdhsa_group_segment_fixed_size 0
  .amdhsa_kernarg_size 112
  .amdhsa_user_sgpr_count 2
  .amdhsa_user_sgpr_kernarg_segment_ptr 1
  .amdhsa_system_sgpr_workgroup_id_x 1
.end_amdhsa_kernel
```

```asm
; @launch grid=(256,1,1) block=(576,1,1) lds=86016
.amdgcn_target "amdgcn-amd-amdhsa--gfx950"
.text
.globl gated_mix__spectral_fnet__moe_arch_mod__prompt_kernel
.p2align 8
.type gated_mix__spectral_fnet__moe_arch_mod__prompt_kernel,@function
gated_mix__spectral_fnet__moe_arch_mod__prompt_kernel:
    s_load_dwordx2 s[4:5], s[0:1], 0
    s_load_dwordx16 s[16:31], s[0:1], 48
    s_cmp_ge_u32 s2, 8
    s_cbranch_scc1 L_nocpf0
    s_getpc_b64 s[12:13]
L_pc0:
    v_lshlrev_b32 v6, 7, v0
    v_min_u32 v6, L_end - L_pc0, v6
    v_mov_b32 v13, s13
    v_add_co_u32 v12, vcc, s12, v6
    s_nop 1
    v_addc_co_u32 v13, vcc, 0, v13, vcc
    global_load_dword v164, v[12:13], off
L_nocpf0:
    v_lshrrev_b32 v1, 6, v0
    v_and_b32 v0, 63, v0
    v_readfirstlane_b32 s3, v1
    v_and_b32 v1, 15, v0
    v_lshrrev_b32 v2, 4, v0
    s_and_b32 s6, s2, 7
    s_sub_u32 s3, s3, 1
    s_min_u32 s3, s3, 8
    s_lshr_b32 s7, s2, 3
    s_cmp_ge_u32 s2, 128
    s_cbranch_scc1 L_notA
    s_add_u32 s8, s6, 1
    s_sub_u32 s9, 15, s6
    s_cmp_eq_u32 s3, 8
    s_cbranch_scc1 L_ah
    s_and_b32 s57, s7, 1
    s_bitcmp1_b32 s7, 1
    s_cselect_b32 s10, s9, s8
    s_lshr_b32 s11, s7, 2
    s_lshl4_add_u32 s56, s11, s10
    v_lshlrev_b32 v5, 4, v0
    v_mov_b32 v3, 0
    s_cmp_lg_u32 s6, 7
    s_cbranch_scc1 L_k7
    s_lshr_b32 s11, s7, 1
    s_lshl3_add_u32 s56, s11, 8
    s_mov_b32 s8, 0
    s_cmp_eq_u32 s2, 127
    s_cselect_b32 s56, 0, s56
    s_cselect_b32 s57, 0, s57
L_k7:
    s_lshl3_add_u32 s11, s57, s3
    s_lshl_b32 s11, s11, 7
    s_add_u32 s58, s11, s56
    s_sub_u32 s59, 2048, s58
    s_cmp_eq_u32 s58, 0
    s_cselect_b32 s59, 1024, s59
    s_lshl_b32 s10, s58, 10
    s_lshl_b32 s11, s59, 10
    v_add_u32 v6, s10, v5
    v_add_u32 v7, s11, v5
    s_waitcnt lgkmcnt(0)
    global_load_dwordx4 v[16:19], v6, s[4:5]
    global_load_dwordx4 v[20:23], v7, s[4:5]
L_ta_start:
    s_barrier
    s_bitcmp1_b32 s7, 3
    s_cselect_b32 s8, s9, s8
    s_and_b32 s9, s7, 7
    s_lshl3_add_u32 s51, s8, s9
    s_lshl_b32 s35, s8, 5
    s_add_u32 s35, s35, s9
    s_lshl_b32 s35, s35, 6
    s_lshr_b32 s6, s3, 2
    s_and_b32 s7, s3, 1
    s_bfe_u32 s8, s3, 0x10001
    v_lshl_add_u32 v6, s6, 4, v1
    s_lshl3_add_u32 s9, s8, s7
    s_lshl_b32 s9, s9, 2
    v_cvt_f32_u32 v6, v6
    v_lshl_add_u32 v7, v2, 3, s9
    v_mul_f32 v6, 0x3c000000, v6
    v_cvt_f32_u32 v7, v7
    v_mul_f32 v7, v7, v6
    v_cos_f32 v96, v7
    v_sin_f32 v100, v7
    v_add_f32 v7, v7, v6
    v_cos_f32 v97, v7
    v_sin_f32 v101, v7
    v_add_f32 v7, v7, v6
    v_cos_f32 v98, v7
    v_sin_f32 v102, v7
    v_add_f32 v7, v7, v6
    v_cos_f32 v99, v7
    v_sin_f32 v103, v7
    s_lshl_b32 s10, s6, 13
    s_lshl_b32 s11, s8, 10
    s_lshl3_add_u32 s11, s7, s11
    v_add_u32 v15, s10, v5
    v_add_u32 v9, s11, v15
    v_cvt_pk_bf16_f32 v104, v96, v97
    v_cvt_pk_bf16_f32 v105, v98, v99
    v_cvt_pk_bf16_f32 v106, -v100, -v101
    v_cvt_pk_bf16_f32 v107, -v102, -v103
    v_cmp_eq_f32 vcc, 0, v6
    v_cvt_pk_bf16_f32 v108, v96, -v101
    v_cvt_pk_bf16_f32 v109, -v98, v103
    v_cvt_pk_bf16_f32 v110, -v100, -v97
    v_cvt_pk_bf16_f32 v111, v102, v99
    ds_write_b64 v9, v[104:105] offset:16384
    ds_write_b64 v9, v[108:109] offset:20480
    ds_write_b64 v9, v[110:111] offset:22528
    s_mov_b64 exec, vcc
    v_mov_b32 v106, 0xbf803f80
    v_mov_b32 v107, 0xbf803f80
    s_mov_b64 exec, -1
    ds_write_b64 v9, v[106:107] offset:18432
    global_load_dwordx4 v[24:27], v5, s[16:17]
    s_lshl_b32 s10, s3, 11
    s_add_u32 s11, s10, s51
    s_lshl_b32 s11, s11, 7
    s_mov_b32 m0, s10
    v_and_b32 v9, 7, v0
    v_bfe_u32 v13, v0, 4, 1
    v_xor_b32 v9, v9, v13
    v_lshrrev_b32 v13, 3, v0
    v_lshl_add_u32 v9, v9, 4, s11
    v_lshl_add_u32 v13, v13, 14, v9
    global_load_lds_dwordx4 v13, s[4:5]
    s_add_u32 m0, s10, 1024
    v_add_u32 v13, 0x20000, v13
    global_load_lds_dwordx4 v13, s[4:5]
    v_mov_b32 v12, 0
    v_mov_b32 v13, 0
    s_waitcnt vmcnt(2)
    v_dot2c_f32_bf16 v12, v16, v24
    v_dot2c_f32_bf16 v13, v20, v24
    v_dot2c_f32_bf16 v12, v17, v25
    v_dot2c_f32_bf16 v13, v21, v25
    v_dot2c_f32_bf16 v12, v18, v26
    v_dot2c_f32_bf16 v13, v22, v26
    v_dot2c_f32_bf16 v12, v19, v27
    v_dot2c_f32_bf16 v13, v23, v27
    s_sub_u32 s10, 0xffff, s58
    s_sub_u32 s11, 0xffff, s59
    v_mov_b32 v4, s10
    v_permlane32_swap_b32 v12, v13
    v_add_f32 v12, v12, v13
    v_mov_b32 v13, v12
    v_writelane_b32 v4, s11, 32
    v_mov_b32 v9, 33792
    v_permlane16_swap_b32 v12, v13
    v_add_f32 v12, v12, v13
    v_lshlrev_b32 v8, 31, v1
    v_lshrrev_b32 v7, 16, v8
    v_add_f32_dpp v12, v12, v12 row_ror:8 row_mask:0xf bank_mask:0xf
    v_or_b32 v8, v8, v7
    v_bfe_u32 v6, v0, 2, 2
    v_add_f32_dpp v12, v12, v12 row_ror:4 row_mask:0xf bank_mask:0xf
    v_and_b32 v14, 3, v0
    v_lshl_add_u32 v14, v14, 1, s8
    v_add_f32_dpp v12, v12, v12 row_ror:2 row_mask:0xf bank_mask:0xf
    v_lshl_add_u32 v10, v2, 3, v6
    v_lshrrev_b32 v6, 1, v6
    v_add_f32_dpp v12, v12, v12 row_ror:1 row_mask:0xf bank_mask:0xf
    v_cvt_pk_bf16_f32 v12, v12, v12
    v_and_b32 v12, 0xffff0000, v12
    v_xor_b32 v14, v14, v6
    v_ashrrev_i32 v7, 31, v12
    v_or_b32 v7, 0x80000000, v7
    v_xor_b32 v7, v7, v12
    v_and_b32 v7, 0xffff0000, v7
    v_or_b32 v7, v7, v4
    s_mov_b32 exec_lo, 1
    s_mov_b32 exec_hi, 1
    ds_max_u32 v9, v7
    s_mov_b64 exec, -1
    s_waitcnt lgkmcnt(0)
    s_barrier
    ds_read_b128 v[32:35], v15 offset:16384
    ds_read_b128 v[48:51], v15 offset:18432
    ds_read_b128 v[64:67], v15 offset:20480
    ds_read_b128 v[80:83], v15 offset:22528
    ds_read_b128 v[36:39], v15 offset:17408
    ds_read_b128 v[52:55], v15 offset:19456
    ds_read_b128 v[68:71], v15 offset:21504
    ds_read_b128 v[84:87], v15 offset:23552
    s_lshl_b32 s7, s7, 3
    v_lshl_add_u32 v14, v14, 4, s7
    v_lshl_add_u32 v10, v10, 7, v14
    v_lshlrev_b32 v9, 4, v2
    s_waitcnt vmcnt(0)
    s_barrier
    s_waitcnt lgkmcnt(5)
    ds_read_b128 v[28:31], v9 offset:33920
    ds_read_b64_tr_b16 v[96:97], v10 offset:0
    ds_read_b64_tr_b16 v[98:99], v10 offset:512
    ds_read_b64_tr_b16 v[100:101], v10 offset:4096
    ds_read_b64_tr_b16 v[102:103], v10 offset:4608
    ds_read_b64_tr_b16 v[104:105], v10 offset:8192
    ds_read_b64_tr_b16 v[106:107], v10 offset:8704
    ds_read_b64_tr_b16 v[108:109], v10 offset:12288
    ds_read_b64_tr_b16 v[110:111], v10 offset:12800
    global_load_dwordx4 v[24:27], v5, s[24:25]
    s_waitcnt lgkmcnt(6)
    v_mfma_f32_16x16x32_bf16 v[112:115], v[96:99], v[32:35], 0
    v_xor_b32 v40, v32, v8
    v_xor_b32 v41, v33, v8
    v_xor_b32 v42, v34, v8
    v_xor_b32 v43, v35, v8
    v_mfma_f32_16x16x32_bf16 v[116:119], v[96:99], v[48:51], 0
    v_xor_b32 v56, v48, v8
    v_xor_b32 v57, v49, v8
    v_xor_b32 v58, v50, v8
    v_xor_b32 v59, v51, v8
    v_mfma_f32_16x16x32_bf16 v[120:123], v[96:99], v[64:67], 0
    v_xor_b32 v72, v64, v8
    v_xor_b32 v73, v65, v8
    v_xor_b32 v74, v66, v8
    v_xor_b32 v75, v67, v8
    v_mfma_f32_16x16x32_bf16 v[124:127], v[96:99], v[80:83], 0
    v_xor_b32 v88, v80, v8
    v_xor_b32 v89, v81, v8
    v_xor_b32 v90, v82, v8
    v_xor_b32 v91, v83, v8
    s_waitcnt lgkmcnt(4)
    v_mfma_f32_16x16x32_bf16 v[112:115], v[100:103], v[36:39], v[112:115]
    v_xor_b32 v44, v36, v8
    v_xor_b32 v45, v37, v8
    v_xor_b32 v46, v38, v8
    v_xor_b32 v47, v39, v8
    v_mfma_f32_16x16x32_bf16 v[116:119], v[100:103], v[52:55], v[116:119]
    v_xor_b32 v60, v52, v8
    v_xor_b32 v61, v53, v8
    v_xor_b32 v62, v54, v8
    v_xor_b32 v63, v55, v8
    v_mfma_f32_16x16x32_bf16 v[120:123], v[100:103], v[68:71], v[120:123]
    v_xor_b32 v76, v68, v8
    v_xor_b32 v77, v69, v8
    v_xor_b32 v78, v70, v8
    v_xor_b32 v79, v71, v8
    v_mfma_f32_16x16x32_bf16 v[124:127], v[100:103], v[84:87], v[124:127]
    v_xor_b32 v92, v84, v8
    v_xor_b32 v93, v85, v8
    v_xor_b32 v94, v86, v8
    v_xor_b32 v95, v87, v8
    s_waitcnt lgkmcnt(2)
    v_mfma_f32_16x16x32_bf16 v[112:115], v[104:107], v[40:43], v[112:115]
    s_mul_i32 s44, s6, 528384
    s_add_u32 s44, s44, s35
    v_mfma_f32_16x16x32_bf16 v[116:119], v[104:107], v[56:59], v[116:119]
    s_and_b32 s10, s3, 3
    s_lshl_b32 s10, s10, 9
    v_mfma_f32_16x16x32_bf16 v[120:123], v[104:107], v[72:75], v[120:123]
    s_add_u32 s44, s44, s10
    s_add_u32 s44, s44, 2097152
    v_mfma_f32_16x16x32_bf16 v[124:127], v[104:107], v[88:91], v[124:127]
    s_mov_b32 s36, s30
    s_mov_b32 s37, s31
    s_waitcnt lgkmcnt(0)
    v_mfma_f32_16x16x32_bf16 v[112:115], v[108:111], v[44:47], v[112:115]
    s_mov_b32 s38, 0x1000000
    s_mov_b32 s39, 0x20000
    v_mfma_f32_16x16x32_bf16 v[116:119], v[108:111], v[60:63], v[116:119]
    s_add_u32 s45, s44, 1056768
    s_mov_b32 s11, 0xfffefffe
    v_mfma_f32_16x16x32_bf16 v[120:123], v[108:111], v[76:79], v[120:123]
    s_mov_b32 s10, 0x07060302
    v_mul_u32_u24 v11, 33024, v1
    v_mfma_f32_16x16x32_bf16 v[124:127], v[108:111], v[92:95], v[124:127]
    v_lshl_add_u32 v11, v2, 4, v11
    v_mov_b32 v12, 0
    v_mov_b32 v13, 0
    v_add_u32 v112, 0x10000, v112
    v_add_u32 v113, 0x10000, v113
    v_add_u32 v114, 0x10000, v114
    v_add_u32 v115, 0x10000, v115
    v_add_u32 v116, 0x10000, v116
    v_add_u32 v117, 0x10000, v117
    v_add_u32 v118, 0x10000, v118
    v_add_u32 v119, 0x10000, v119
    v_perm_b32 v96, v116, v112, s10
    v_perm_b32 v97, v117, v113, s10
    v_perm_b32 v98, v118, v114, s10
    v_perm_b32 v99, v119, v115, s10
    v_and_or_b32 v96, v96, s11, v28
    v_and_or_b32 v97, v97, s11, v29
    v_and_or_b32 v98, v98, s11, v30
    v_and_or_b32 v99, v99, s11, v31
    buffer_store_dwordx4 v[96:99], v11, s[36:39], s44 offen sc1
    v_add_u32 v120, 0x10000, v120
    v_add_u32 v121, 0x10000, v121
    v_add_u32 v122, 0x10000, v122
    v_add_u32 v123, 0x10000, v123
    v_add_u32 v124, 0x10000, v124
    v_add_u32 v125, 0x10000, v125
    v_add_u32 v126, 0x10000, v126
    v_add_u32 v127, 0x10000, v127
    v_perm_b32 v100, v124, v120, s10
    v_perm_b32 v101, v125, v121, s10
    v_perm_b32 v102, v126, v122, s10
    v_perm_b32 v103, v127, v123, s10
    v_and_or_b32 v100, v100, s11, v28
    v_and_or_b32 v101, v101, s11, v29
    v_and_or_b32 v102, v102, s11, v30
    v_and_or_b32 v103, v103, s11, v31
    buffer_store_dwordx4 v[100:103], v11, s[36:39], s45 offen sc1
    s_mov_b32 s65, 0
    s_mov_b32 s55, 0
L_ta_end:
    s_mov_b32 s40, s26
    s_mov_b32 s41, s27
    s_mov_b32 s42, 0x200000
    s_mov_b32 s43, 0x20000
    s_cmp_ge_u32 s3, 4
    s_cbranch_scc1 L_hi0
    s_setprio 2
    v_lshlrev_b32 v6, 4, v1
    v_lshl_add_u32 v10, v2, 13, v6
    v_mul_u32_u24 v6, 4352, v2
    v_bfe_u32 v7, v1, 1, 2
    v_xor_b32 v7, s3, v7
    v_lshl_add_u32 v7, v7, 4, v6
    v_lshl_add_u32 v11, v1, 6, v7
    s_lshl4_add_u32 s7, s3, 1024
    v_mov_b32 v9, 17600
    v_lshl_add_u32 v28, v0, 1, v9
    v_lshl_add_u32 v7, v1, 1, s7
    s_mov_b32 exec_lo, 0x00ff00ff
    s_mov_b32 exec_hi, 0x00ff00ff
    v_add_u32 v28, v7, v6
    s_mov_b64 exec, -1
    s_and_b32 s7, s56, 63
    s_mul_i32 s32, s7, 33024
    s_lshl_b32 s7, s3, 9
    s_add_u32 s32, s32, s7
    s_add_u32 s32, s32, 2097152
    s_add_u32 s33, s32, 4096
    v_lshrrev_b32 v6, 1, v1
    s_lshl_b32 s6, s57, 10
    s_add_u32 s6, s6, s56
    v_lshl_add_u32 v6, v6, 7, s6
    v_and_b32 v7, 1, v1
    v_lshlrev_b32 v9, 9, v7
    s_cmp_lg_u32 s56, 0
    s_cbranch_scc1 L_g01
    s_mov_b32 exec_lo, 0x00020002
    s_mov_b32 exec_hi, 0x00020002
    v_mov_b32 v6, 0x400
    v_mov_b32 v9, 0
    s_mov_b64 exec, -1
L_g01:
    v_lshlrev_b32 v7, 2, v2
    v_mad_u32_u24 v9, v7, v6, v9
    v_cvt_f32_u32 v6, v6
    v_cvt_f32_u32 v9, v9
    v_mul_f32 v6, 0x3a000000, v6
    v_mul_f32 v9, 0x3a000000, v9
    v_cos_f32 v64, v9
    v_sin_f32 v68, v9
    v_add_f32 v9, v9, v6
    v_cos_f32 v65, v9
    v_sin_f32 v69, v9
    v_add_f32 v9, v9, v6
    v_cos_f32 v66, v9
    v_sin_f32 v70, v9
    v_add_f32 v9, v9, v6
    v_cos_f32 v67, v9
    v_sin_f32 v71, v9
    s_and_b32 s7, s56, 63
    s_nop 0
    v_cvt_pk_bf16_f32 v148, v64, v68
    v_cvt_pk_bf16_f32 v149, v65, v69
    v_cvt_pk_bf16_f32 v150, v66, v70
    v_cvt_pk_bf16_f32 v151, v67, v71
    s_cmp_lg_u32 s7, 0
    s_cbranch_scc1 L_gd2
    s_lshr_b32 s7, s56, 2
    v_and_b32 v148, 0xffff, v148
    v_lshlrev_b32 v148, s7, v148
    v_and_b32 v149, 0xffff, v149
    v_lshlrev_b32 v149, s7, v149
    v_and_b32 v150, 0xffff, v150
    v_lshlrev_b32 v150, s7, v150
    v_and_b32 v151, 0xffff, v151
    v_lshlrev_b32 v151, s7, v151
L_gd2:
    v_and_b32 v6, 3, v1
    v_lshlrev_b32 v6, 4, v6
    ds_read_b128 v[96:99], v6 offset:33920
    s_waitcnt lgkmcnt(0)
    v_cvt_f32_u32 v6, v1
    s_lshl_b32 s6, s3, 2
    v_lshl_add_u32 v7, v2, 6, s6
    v_mul_f32 v6, 0x3b000000, v6
    v_cvt_f32_u32 v7, v7
    v_mul_f32 v15, 0x41800000, v6
    v_mul_f32 v7, v7, v6
    v_cos_f32 v64, v7
    v_sin_f32 v68, v7
    v_add_f32 v9, v7, v15
    v_cos_f32 v65, v9
    v_sin_f32 v69, v9
    v_add_f32 v9, v9, v15
    v_cos_f32 v66, v9
    v_sin_f32 v70, v9
    v_add_f32 v9, v9, v15
    v_cos_f32 v67, v9
    v_sin_f32 v71, v9
    v_mov_b32 v108, 0
    v_cvt_pk_bf16_f32 v100, v64, v65
    v_cvt_pk_bf16_f32 v104, -v68, -v69
    v_cvt_pk_bf16_f32 v101, v66, v67
    v_cvt_pk_bf16_f32 v105, -v70, -v71
    v_xor_b32 v102, v100, v8
    v_xor_b32 v106, v104, v8
    v_xor_b32 v103, v101, v8
    v_xor_b32 v107, v105, v8
    v_add_f32 v7, v7, v6
    v_cos_f32 v64, v7
    v_sin_f32 v68, v7
    v_add_f32 v9, v7, v15
    v_cos_f32 v65, v9
    v_sin_f32 v69, v9
    v_add_f32 v9, v9, v15
    v_cos_f32 v66, v9
    v_sin_f32 v70, v9
    v_add_f32 v9, v9, v15
    v_cos_f32 v67, v9
    v_sin_f32 v71, v9
    v_mov_b32 v120, 0
    v_cvt_pk_bf16_f32 v112, v64, v65
    v_cvt_pk_bf16_f32 v116, -v68, -v69
    v_cvt_pk_bf16_f32 v113, v66, v67
    v_cvt_pk_bf16_f32 v117, -v70, -v71
    v_xor_b32 v114, v112, v8
    v_xor_b32 v118, v116, v8
    v_xor_b32 v115, v113, v8
    v_xor_b32 v119, v117, v8
    v_add_f32 v7, v7, v6
    v_cos_f32 v64, v7
    v_sin_f32 v68, v7
    v_add_f32 v9, v7, v15
    v_cos_f32 v65, v9
    v_sin_f32 v69, v9
    v_add_f32 v9, v9, v15
    v_cos_f32 v66, v9
    v_sin_f32 v70, v9
    v_add_f32 v9, v9, v15
    v_cos_f32 v67, v9
    v_sin_f32 v71, v9
    v_mov_b32 v132, 0
    v_cvt_pk_bf16_f32 v124, v64, v65
    v_cvt_pk_bf16_f32 v128, -v68, -v69
    v_cvt_pk_bf16_f32 v125, v66, v67
    v_cvt_pk_bf16_f32 v129, -v70, -v71
    v_xor_b32 v126, v124, v8
    v_xor_b32 v130, v128, v8
    v_xor_b32 v127, v125, v8
    v_xor_b32 v131, v129, v8
    v_add_f32 v7, v7, v6
    v_cos_f32 v64, v7
    v_sin_f32 v68, v7
    v_add_f32 v9, v7, v15
    v_cos_f32 v65, v9
    v_sin_f32 v69, v9
    v_add_f32 v9, v9, v15
    v_cos_f32 v66, v9
    v_sin_f32 v70, v9
    v_add_f32 v9, v9, v15
    v_cos_f32 v67, v9
    v_sin_f32 v71, v9
    v_mov_b32 v144, 0
    v_cvt_pk_bf16_f32 v136, v64, v65
    v_cvt_pk_bf16_f32 v140, -v68, -v69
    v_cvt_pk_bf16_f32 v137, v66, v67
    v_cvt_pk_bf16_f32 v141, -v70, -v71
    v_xor_b32 v138, v136, v8
    v_xor_b32 v142, v140, v8
    v_xor_b32 v139, v137, v8
    v_xor_b32 v143, v141, v8
    v_lshrrev_b32 v6, 1, v1
    v_add_u32 v7, s6, v6
    v_and_b32 v9, 1, v1
    v_lshl_add_u32 v7, v9, 3, v7
    v_cvt_f32_u32 v7, v7
    v_mul_f32 v7, 0x3d000000, v7
    v_cos_f32 v7, v7
    s_mov_b32 exec_lo, 0x30003
    s_mov_b32 exec_hi, 0x30003
    v_cvt_pk_bf16_f32 v108, v7, -v7
    s_mov_b32 exec_lo, 0xc000c
    s_mov_b32 exec_hi, 0xc000c
    v_cvt_pk_bf16_f32 v120, v7, -v7
    s_mov_b32 exec_lo, 0x300030
    s_mov_b32 exec_hi, 0x300030
    v_cvt_pk_bf16_f32 v132, v7, -v7
    s_mov_b32 exec_lo, 0xc000c0
    s_mov_b32 exec_hi, 0xc000c0
    v_cvt_pk_bf16_f32 v144, v7, -v7
    s_mov_b64 exec, -1
    v_mov_b32 v109, v108
    v_mov_b32 v110, v108
    v_mov_b32 v111, v108
    v_mov_b32 v121, v120
    v_mov_b32 v122, v120
    v_mov_b32 v123, v120
    v_mov_b32 v133, v132
    v_mov_b32 v134, v132
    v_mov_b32 v135, v132
    v_mov_b32 v145, v144
    v_mov_b32 v146, v144
    v_mov_b32 v147, v144
    s_waitcnt vmcnt(2)
    v_dot2c_f32_bf16 v12, v16, v24
    v_dot2c_f32_bf16 v13, v20, v24
    v_dot2c_f32_bf16 v12, v17, v25
    v_dot2c_f32_bf16 v13, v21, v25
    v_dot2c_f32_bf16 v12, v18, v26
    v_dot2c_f32_bf16 v13, v22, v26
    v_dot2c_f32_bf16 v12, v19, v27
    v_dot2c_f32_bf16 v13, v23, v27
    s_nop 2
    v_permlane32_swap_b32 v12, v13
    v_add_f32 v12, v12, v13
    v_mov_b32 v13, v12
    s_nop 1
    v_permlane16_swap_b32 v12, v13
    v_add_f32 v12, v12, v13
    s_nop 1
    v_add_f32_dpp v12, v12, v12 row_ror:8 row_mask:0xf bank_mask:0xf
    s_nop 1
    v_add_f32_dpp v12, v12, v12 row_ror:4 row_mask:0xf bank_mask:0xf
    s_nop 1
    v_add_f32_dpp v12, v12, v12 row_ror:2 row_mask:0xf bank_mask:0xf
    s_nop 1
    v_add_f32_dpp v12, v12, v12 row_ror:1 row_mask:0xf bank_mask:0xf
    v_cvt_pk_bf16_f32 v12, v12, v12
    v_and_b32 v12, 0xffff0000, v12
    s_lshl_b32 s6, s3, 11
    v_add_u32 v6, s6, v5
    ds_write_b128 v6, v[16:19] offset:48832
    ds_write_b128 v6, v[20:23] offset:49856
    v_lshl_add_u32 v7, v1, 6, s6
    v_lshl_add_u32 v7, v2, 3, v7
    s_waitcnt lgkmcnt(0)
    ds_read_b64 v[16:17], v7 offset:48832
    ds_read_b64 v[18:19], v7 offset:48864
    ds_read_b64 v[20:21], v7 offset:49856
    ds_read_b64 v[22:23], v7 offset:49888
    v_and_b32 v6, 1, v2
    v_lshlrev_b32 v6, 5, v6
    v_lshl_add_u32 v6, v1, 6, v6
    v_lshrrev_b32 v7, 1, v2
    v_lshl_add_u32 v3, v7, 4, v6
    v_mul_f32 v13, 0xbfb8aa3b, v12
    v_exp_f32 v13, v13
    s_nop 0
    v_add_f32 v13, 1.0, v13
    v_rcp_f32 v13, v13
    s_nop 0
    v_cvt_pk_bf16_f32 v13, v13, v13
    v_and_b32 v13, 0xffff0000, v13
    v_sub_f32 v14, 1.0, v13
    v_cvt_pk_bf16_f32 v14, v14, v14
    v_and_b32 v14, 0xffff0000, v14
    v_readlane_b32 s6, v13, 0
    v_readlane_b32 s7, v13, 32
    v_readlane_b32 s8, v14, 0
    v_readlane_b32 s9, v14, 32
    s_xor_b32 s10, s6, 0x80000000
    s_cmp_eq_u32 s58, 0
    s_cselect_b32 s10, 0, s10
    s_cselect_b32 s11, 0, s7
    v_mov_b32 v24, s6
    v_mov_b32 v25, s10
    v_mov_b32 v26, s11
    v_mov_b32 v27, s7
    v_mov_b32 v13, s8
    v_mov_b32 v14, s9
    s_waitcnt lgkmcnt(0)
    v_lshlrev_b32 v152, 16, v16
    v_and_b32 v153, 0xffff0000, v16
    v_lshlrev_b32 v154, 16, v17
    v_and_b32 v155, 0xffff0000, v17
    v_lshlrev_b32 v156, 16, v18
    v_and_b32 v157, 0xffff0000, v18
    v_lshlrev_b32 v158, 16, v19
    v_and_b32 v159, 0xffff0000, v19
    v_mul_f32 v152, v13, v152
    v_mul_f32 v153, v13, v153
    v_mul_f32 v154, v13, v154
    v_mul_f32 v155, v13, v155
    v_mul_f32 v156, v13, v156
    v_mul_f32 v157, v13, v157
    v_mul_f32 v158, v13, v158
    v_mul_f32 v159, v13, v159
    v_lshlrev_b32 v160, 16, v20
    v_and_b32 v161, 0xffff0000, v20
    v_lshlrev_b32 v162, 16, v21
    v_and_b32 v163, 0xffff0000, v21
    v_lshlrev_b32 v164, 16, v22
    v_and_b32 v165, 0xffff0000, v22
    v_lshlrev_b32 v166, 16, v23
    v_and_b32 v167, 0xffff0000, v23
    v_mul_f32 v160, v14, v160
    v_mul_f32 v161, v14, v161
    v_mul_f32 v162, v14, v162
    v_mul_f32 v163, v14, v163
    v_mul_f32 v164, v14, v164
    v_mul_f32 v165, v14, v165
    v_mul_f32 v166, v14, v166
    v_mul_f32 v167, v14, v167
    s_waitcnt vmcnt(2)
    s_barrier
    s_cmp_lg_u32 s57, 0
    s_cbranch_scc1 L_stg1
    buffer_load_dwordx4 v[32:35], v10, s[36:39], s32 offen offset:0 sc1
    buffer_load_dwordx4 v[36:39], v10, s[36:39], s32 offen offset:2048 sc1
    buffer_load_dwordx4 v[40:43], v10, s[36:39], s33 offen offset:0 sc1
    buffer_load_dwordx4 v[44:47], v10, s[36:39], s33 offen offset:2048 sc1
    s_waitcnt vmcnt(2)
    buffer_load_dwordx4 v[48:51], v10, s[36:39], s32 offen offset:256 sc1
    buffer_load_dwordx4 v[52:55], v10, s[36:39], s32 offen offset:2304 sc1
    buffer_load_dwordx4 v[56:59], v10, s[36:39], s33 offen offset:256 sc1
    buffer_load_dwordx4 v[60:63], v10, s[36:39], s33 offen offset:2304 sc1
    s_branch L_stg2
L_stg1:
    buffer_load_dwordx4 v[48:51], v10, s[36:39], s32 offen offset:256 sc1
    buffer_load_dwordx4 v[52:55], v10, s[36:39], s32 offen offset:2304 sc1
    buffer_load_dwordx4 v[56:59], v10, s[36:39], s33 offen offset:256 sc1
    buffer_load_dwordx4 v[60:63], v10, s[36:39], s33 offen offset:2304 sc1
    s_waitcnt vmcnt(2)
    buffer_load_dwordx4 v[32:35], v10, s[36:39], s32 offen offset:0 sc1
    buffer_load_dwordx4 v[36:39], v10, s[36:39], s32 offen offset:2048 sc1
    buffer_load_dwordx4 v[40:43], v10, s[36:39], s33 offen offset:0 sc1
    buffer_load_dwordx4 v[44:47], v10, s[36:39], s33 offen offset:2048 sc1
    s_waitcnt vmcnt(0)
L_stg2:
    s_mul_i32 s7, s3, 2176
    v_bfe_u32 v7, v1, 1, 2
    v_xor_b32 v7, v7, v2
    v_lshl_add_u32 v7, v7, 4, s7
    v_lshl_add_u32 v29, v1, 6, v7
    v_sub_u32 v6, 16, v1
    v_bfe_u32 v7, v6, 1, 2
    v_xor_b32 v7, v7, v2
    v_lshl_add_u32 v7, v7, 4, s7
    v_lshl_add_u32 v30, v6, 6, v7
    s_cmp_eq_u32 s58, 0
    s_cselect_b32 s6, 0, 2048
    v_add_u32 v4, s6, v5
L_zjoin:
    s_waitcnt vmcnt(4)
L_got0:
    v_xor_b32 v80, v32, v96
    v_xor_b32 v81, v36, v96
    v_xor_b32 v82, v40, v96
    v_xor_b32 v83, v44, v96
L_tb0:
    s_cbranch_execz L_tbback
    v_or3_b32 v6, v80, v81, v82
    v_or_b32 v6, v6, v83
    v_mfma_f32_16x16x32_bf16 v[64:67], v[80:83], v[148:151], 0
    v_xor_b32 v84, v33, v97
    v_xor_b32 v85, v37, v97
    v_xor_b32 v86, v41, v97
    v_xor_b32 v87, v45, v97
    v_or3_b32 v6, v6, v84, v85
    v_or3_b32 v6, v6, v86, v87
    v_mfma_f32_16x16x32_bf16 v[68:71], v[84:87], v[148:151], 0
    v_xor_b32 v88, v34, v98
    v_xor_b32 v89, v38, v98
    v_xor_b32 v90, v42, v98
    v_xor_b32 v91, v46, v98
    v_or3_b32 v6, v6, v88, v89
    v_or3_b32 v6, v6, v90, v91
    v_mfma_f32_16x16x32_bf16 v[72:75], v[88:91], v[148:151], 0
    v_xor_b32 v92, v35, v99
    v_xor_b32 v93, v39, v99
    v_xor_b32 v94, v43, v99
    v_xor_b32 v95, v47, v99
    v_or3_b32 v6, v6, v92, v93
L_tb1:
    s_cbranch_execz L_tbback
    v_or3_b32 v6, v6, v94, v95
    v_and_b32 v6, 0x10001, v6
    v_cmp_ne_u32 vcc, 0, v6
    v_mfma_f32_16x16x32_bf16 v[76:79], v[92:95], v[148:151], 0
    s_cbranch_vccnz L_retry0
L_fail0:
    s_waitcnt vmcnt(0)
L_got1:
    v_xor_b32 v80, v48, v96
    v_xor_b32 v81, v52, v96
    v_xor_b32 v82, v56, v96
    v_xor_b32 v83, v60, v96
    v_or3_b32 v6, v80, v81, v82
    v_or_b32 v6, v6, v83
    v_mfma_f32_16x16x32_bf16 v[32:35], v[80:83], v[148:151], 0
    v_xor_b32 v84, v49, v97
    v_xor_b32 v85, v53, v97
    v_xor_b32 v86, v57, v97
    v_xor_b32 v87, v61, v97
    v_or3_b32 v6, v6, v84, v85
    v_or3_b32 v6, v6, v86, v87
    v_mfma_f32_16x16x32_bf16 v[36:39], v[84:87], v[148:151], 0
    v_xor_b32 v88, v50, v98
    v_xor_b32 v89, v54, v98
    v_xor_b32 v90, v58, v98
L_tb2:
    s_cbranch_execz L_tbback
    v_xor_b32 v91, v62, v98
    v_or3_b32 v6, v6, v88, v89
    v_or3_b32 v6, v6, v90, v91
    v_mfma_f32_16x16x32_bf16 v[40:43], v[88:91], v[148:151], 0
    v_xor_b32 v92, v51, v99
    v_xor_b32 v93, v55, v99
    v_xor_b32 v94, v59, v99
    v_xor_b32 v95, v63, v99
    v_or3_b32 v6, v6, v92, v93
    v_or3_b32 v6, v6, v94, v95
    v_and_b32 v6, 0x10001, v6
    v_cmp_ne_u32 vcc, 0, v6
    v_mfma_f32_16x16x32_bf16 v[44:47], v[92:95], v[148:151], 0
    s_cbranch_vccnz L_retry1
L_fail1:
    v_cvt_pk_bf16_f32 v80, v64, v65
    v_cvt_pk_bf16_f32 v81, v66, v67
    v_cvt_pk_bf16_f32 v82, v32, v33
    v_cvt_pk_bf16_f32 v83, v34, v35
    v_cvt_pk_bf16_f32 v84, v68, v69
L_tb3:
    s_cbranch_execz L_tbback
    v_cvt_pk_bf16_f32 v85, v70, v71
    v_cvt_pk_bf16_f32 v86, v36, v37
    v_cvt_pk_bf16_f32 v87, v38, v39
    v_mfma_f32_16x16x32_bf16 v[64:67], v[80:83], v[100:103], 0
    v_mfma_f32_16x16x32_bf16 v[32:35], v[80:83], v[104:107], 0
    v_mfma_f32_16x16x32_bf16 v[96:99], v[80:83], v[108:111], 0
    v_cvt_pk_bf16_f32 v88, v72, v73
    v_cvt_pk_bf16_f32 v89, v74, v75
    v_cvt_pk_bf16_f32 v90, v40, v41
    v_cvt_pk_bf16_f32 v91, v42, v43
    v_mfma_f32_16x16x32_bf16 v[68:71], v[84:87], v[112:115], 0
    v_mfma_f32_16x16x32_bf16 v[36:39], v[84:87], v[116:119], 0
    v_mfma_f32_16x16x32_bf16 v[96:99], v[84:87], v[120:123], v[96:99]
    v_cvt_pk_bf16_f32 v92, v76, v77
    v_cvt_pk_bf16_f32 v93, v78, v79
    v_cvt_pk_bf16_f32 v94, v44, v45
L_tb4:
    s_cbranch_execz L_tbback
    v_cvt_pk_bf16_f32 v95, v46, v47
    v_mfma_f32_16x16x32_bf16 v[72:75], v[88:91], v[124:127], 0
    v_mfma_f32_16x16x32_bf16 v[40:43], v[88:91], v[128:131], 0
    v_mfma_f32_16x16x32_bf16 v[96:99], v[88:91], v[132:135], v[96:99]
    v_mfma_f32_16x16x32_bf16 v[76:79], v[92:95], v[136:139], 0
    v_mfma_f32_16x16x32_bf16 v[44:47], v[92:95], v[140:143], 0
    v_mfma_f32_16x16x32_bf16 v[96:99], v[92:95], v[144:147], v[96:99]
    v_cvt_pk_bf16_f32 v48, v64, v32
    v_cvt_pk_bf16_f32 v52, v65, v33
    v_cvt_pk_bf16_f32 v56, v66, v34
    v_cvt_pk_bf16_f32 v60, v67, v35
    v_cvt_pk_bf16_f32 v49, v68, v36
    v_cvt_pk_bf16_f32 v53, v69, v37
    v_cvt_pk_bf16_f32 v57, v70, v38
    v_cvt_pk_bf16_f32 v61, v71, v39
L_tb5:
    s_cbranch_execz L_tbback
    v_cvt_pk_bf16_f32 v50, v72, v40
    v_cvt_pk_bf16_f32 v54, v73, v41
    v_cvt_pk_bf16_f32 v58, v74, v42
    v_cvt_pk_bf16_f32 v62, v75, v43
    v_cvt_pk_bf16_f32 v51, v76, v44
    ds_write_b128 v11, v[48:51] offset:16384
    v_cvt_pk_bf16_f32 v55, v77, v45
    ds_write_b128 v11, v[52:55] offset:17472
    v_cvt_pk_bf16_f32 v59, v78, v46
    ds_write_b128 v11, v[56:59] offset:18560
    v_cvt_pk_bf16_f32 v63, v79, v47
    ds_write_b128 v11, v[60:63] offset:19648
    v_cvt_pk_bf16_f32 v96, v96, v97
    v_cvt_pk_bf16_f32 v98, v98, v99
    ds_write_b16 v28, v96 offset:16384
    ds_write_b16_d16_hi v28, v96 offset:17472
L_tb6:
    s_cbranch_execz L_tbback
    ds_write_b16 v28, v98 offset:18560
    ds_write_b16_d16_hi v28, v98 offset:19648
L_d2:
    ds_read_b128 v[64:67], v5 offset:42688
    ds_read_b128 v[68:71], v5 offset:43712
    ds_read_b128 v[72:75], v4 offset:42688
    ds_read_b128 v[76:79], v4 offset:43712
    v_mov_b32 v9, 33856
    s_cmp_lg_u32 s55, 0
    s_waitcnt lgkmcnt(0)
    s_cbranch_scc1 L_zsync
    s_barrier
    ds_read_b32 v6, v9
    ds_read_b128 v[32:35], v29 offset:16384
    ds_read_b128 v[36:39], v30 offset:16384
    ds_read_b128 v[40:43], v29 offset:17472
    ds_read_b128 v[44:47], v30 offset:17472
    s_lshl_b32 s6, s58, 10
    s_lshl_b32 s7, s59, 10
L_tb7:
    s_cbranch_execz L_tbback
    s_waitcnt lgkmcnt(3)
    v_mfma_f32_16x16x32_bf16 v[48:51], v[32:35], v[64:67], 0
    s_waitcnt lgkmcnt(2)
    v_mfma_f32_16x16x32_bf16 v[52:55], v[36:39], v[68:71], 0
    s_waitcnt lgkmcnt(1)
    v_mfma_f32_16x16x32_bf16 v[56:59], v[40:43], v[72:75], 0
    s_waitcnt lgkmcnt(0)
    v_mfma_f32_16x16x32_bf16 v[60:63], v[44:47], v[76:79], 0
    v_readfirstlane_b32 s44, v6
    s_andn2_b32 s54, 0xffff, s44
    v_fmac_f32 v152, v24, v48
    v_fmac_f32 v153, v24, v49
    v_fmac_f32 v154, v24, v50
    v_fmac_f32 v155, v24, v51
    v_fmac_f32 v156, v24, v52
    v_fmac_f32 v157, v24, v53
    v_fmac_f32 v158, v24, v54
    v_fmac_f32 v159, v24, v55
    v_fmac_f32 v160, v26, v48
    v_fmac_f32 v161, v26, v49
    v_fmac_f32 v162, v26, v50
    v_fmac_f32 v163, v26, v51
    v_fmac_f32 v164, v26, v52
    v_fmac_f32 v165, v26, v53
    v_fmac_f32 v166, v26, v54
    v_fmac_f32 v167, v26, v55
L_tb8:
    s_cbranch_execz L_tbback
    v_fmac_f32 v152, v25, v56
    v_fmac_f32 v153, v25, v57
    v_fmac_f32 v154, v25, v58
    v_fmac_f32 v155, v25, v59
    v_fmac_f32 v156, v25, v60
    v_fmac_f32 v157, v25, v61
    v_fmac_f32 v158, v25, v62
    v_fmac_f32 v159, v25, v63
    v_cvt_pk_bf16_f32 v32, v152, v153
    v_cvt_pk_bf16_f32 v33, v154, v155
    v_cvt_pk_bf16_f32 v34, v156, v157
    v_cvt_pk_bf16_f32 v35, v158, v159
    s_cmp_eq_u32 s58, s54
    s_cbranch_scc1 L_skip3
    v_permlane16_swap_b32 v32, v34
    v_permlane16_swap_b32 v33, v35
    buffer_store_dwordx4 v[32:35], v3, s[40:43], s6 offen nt
L_skip3:
    v_fmac_f32 v160, v27, v56
    v_fmac_f32 v161, v27, v57
    v_fmac_f32 v162, v27, v58
    v_fmac_f32 v163, v27, v59
    v_fmac_f32 v164, v27, v60
    v_fmac_f32 v165, v27, v61
    v_fmac_f32 v166, v27, v62
    v_fmac_f32 v167, v27, v63
    v_cvt_pk_bf16_f32 v36, v160, v161
L_tb9:
    s_cbranch_execz L_tbback
    v_cvt_pk_bf16_f32 v37, v162, v163
    v_cvt_pk_bf16_f32 v38, v164, v165
    v_cvt_pk_bf16_f32 v39, v166, v167
    s_cmp_eq_u32 s59, s54
    s_cbranch_scc1 L_skip4
    v_permlane16_swap_b32 v36, v38
    v_permlane16_swap_b32 v37, v39
    buffer_store_dwordx4 v[36:39], v3, s[40:43], s7 offen nt
L_skip4:
L_tb_end:
    s_endpgm
L_retry0:
    s_sleep 3
    s_add_u32 s65, s65, 1
    s_lshr_b32 s34, s65, 17
    s_cbranch_scc1 L_fail0
    buffer_load_dwordx4 v[32:35], v10, s[36:39], s32 offen offset:0 sc1
    buffer_load_dwordx4 v[36:39], v10, s[36:39], s32 offen offset:2048 sc1
    buffer_load_dwordx4 v[40:43], v10, s[36:39], s33 offen offset:0 sc1
    buffer_load_dwordx4 v[44:47], v10, s[36:39], s33 offen offset:2048 sc1
    s_waitcnt vmcnt(0)
    s_branch L_got0
L_retry1:
    s_sleep 3
    s_add_u32 s65, s65, 1
    s_lshr_b32 s34, s65, 17
    s_cbranch_scc1 L_fail1
    buffer_load_dwordx4 v[48:51], v10, s[36:39], s32 offen offset:256 sc1
    buffer_load_dwordx4 v[52:55], v10, s[36:39], s32 offen offset:2304 sc1
    buffer_load_dwordx4 v[56:59], v10, s[36:39], s33 offen offset:256 sc1
    buffer_load_dwordx4 v[60:63], v10, s[36:39], s33 offen offset:2304 sc1
    s_waitcnt vmcnt(0)
    s_branch L_got1
L_hi0:
    s_barrier
L_hi1:
    s_mov_b64 exec, 0
    s_sub_u32 s53, s3, 8
L_tbback:
    s_add_u32 s53, s53, 4
    s_cmp_eq_u32 s53, 0
    s_cbranch_scc1 L_tb0
    s_cmp_eq_u32 s53, 1
    s_cbranch_scc1 L_tb1
    s_cmp_eq_u32 s53, 2
    s_cbranch_scc1 L_tb2
    s_cmp_eq_u32 s53, 3
    s_cbranch_scc1 L_tb3
    s_cmp_eq_u32 s53, 4
    s_cbranch_scc1 L_tb4
    s_cmp_eq_u32 s53, 5
    s_cbranch_scc1 L_tb5
    s_cmp_eq_u32 s53, 6
    s_cbranch_scc1 L_tb6
    s_cmp_eq_u32 s53, 7
    s_cbranch_scc1 L_tb7
    s_cmp_eq_u32 s53, 8
    s_cbranch_scc1 L_tb8
    s_cmp_eq_u32 s53, 9
    s_cbranch_scc1 L_tb9
    s_mov_b64 exec, -1
    s_cmp_lg_u32 s55, 0
    s_cbranch_scc1 L_z0b
    s_waitcnt vmcnt(2)
    v_dot2c_f32_bf16 v12, v16, v24
    v_dot2c_f32_bf16 v13, v20, v24
    v_dot2c_f32_bf16 v12, v17, v25
    v_dot2c_f32_bf16 v13, v21, v25
    v_dot2c_f32_bf16 v12, v18, v26
    v_dot2c_f32_bf16 v13, v22, v26
    v_dot2c_f32_bf16 v12, v19, v27
    v_dot2c_f32_bf16 v13, v23, v27
    s_nop 2
    v_permlane32_swap_b32 v12, v13
    v_add_f32 v12, v12, v13
    v_mov_b32 v13, v12
    s_nop 1
    v_permlane16_swap_b32 v12, v13
    v_add_f32 v12, v12, v13
    s_nop 1
    v_add_f32_dpp v12, v12, v12 row_ror:8 row_mask:0xf bank_mask:0xf
    s_nop 1
    v_add_f32_dpp v12, v12, v12 row_ror:4 row_mask:0xf bank_mask:0xf
    s_nop 1
    v_add_f32_dpp v12, v12, v12 row_ror:2 row_mask:0xf bank_mask:0xf
    s_nop 1
    v_add_f32_dpp v12, v12, v12 row_ror:1 row_mask:0xf bank_mask:0xf
    v_cvt_pk_bf16_f32 v12, v12, v12
    v_and_b32 v12, 0xffff0000, v12
    s_lshl_b32 s6, s3, 11
    v_add_u32 v6, s6, v5
    ds_write_b128 v6, v[16:19] offset:48832
    ds_write_b128 v6, v[20:23] offset:49856
    v_lshl_add_u32 v7, v1, 6, s6
    v_lshl_add_u32 v7, v2, 3, v7
    s_waitcnt lgkmcnt(0)
    ds_read_b64 v[16:17], v7 offset:48832
    ds_read_b64 v[18:19], v7 offset:48864
    ds_read_b64 v[20:21], v7 offset:49856
    ds_read_b64 v[22:23], v7 offset:49888
    v_and_b32 v6, 1, v2
    v_lshlrev_b32 v6, 5, v6
    v_lshl_add_u32 v6, v1, 6, v6
    v_lshrrev_b32 v7, 1, v2
    v_lshl_add_u32 v3, v7, 4, v6
    v_mul_f32 v13, 0xbfb8aa3b, v12
    v_exp_f32 v13, v13
    s_nop 0
    v_add_f32 v13, 1.0, v13
    v_rcp_f32 v13, v13
    s_nop 0
    v_cvt_pk_bf16_f32 v13, v13, v13
    v_and_b32 v13, 0xffff0000, v13
    v_sub_f32 v14, 1.0, v13
    v_cvt_pk_bf16_f32 v14, v14, v14
    v_and_b32 v14, 0xffff0000, v14
    v_readlane_b32 s6, v13, 0
    v_readlane_b32 s7, v13, 32
    v_readlane_b32 s8, v14, 0
    v_readlane_b32 s9, v14, 32
    s_xor_b32 s10, s6, 0x80000000
    s_cmp_eq_u32 s58, 0
    s_cselect_b32 s10, 0, s10
    s_cselect_b32 s11, 0, s7
    v_mov_b32 v24, s6
    v_mov_b32 v25, s10
    v_mov_b32 v26, s11
    v_mov_b32 v27, s7
    v_mov_b32 v13, s8
    v_mov_b32 v14, s9
    s_waitcnt lgkmcnt(0)
    v_lshlrev_b32 v152, 16, v16
    v_and_b32 v153, 0xffff0000, v16
    v_lshlrev_b32 v154, 16, v17
    v_and_b32 v155, 0xffff0000, v17
    v_lshlrev_b32 v156, 16, v18
    v_and_b32 v157, 0xffff0000, v18
    v_lshlrev_b32 v158, 16, v19
    v_and_b32 v159, 0xffff0000, v19
    v_mul_f32 v152, v13, v152
    v_mul_f32 v153, v13, v153
    v_mul_f32 v154, v13, v154
    v_mul_f32 v155, v13, v155
    v_mul_f32 v156, v13, v156
    v_mul_f32 v157, v13, v157
    v_mul_f32 v158, v13, v158
    v_mul_f32 v159, v13, v159
    v_lshlrev_b32 v160, 16, v20
    v_and_b32 v161, 0xffff0000, v20
    v_lshlrev_b32 v162, 16, v21
    v_and_b32 v163, 0xffff0000, v21
    v_lshlrev_b32 v164, 16, v22
    v_and_b32 v165, 0xffff0000, v22
    v_lshlrev_b32 v166, 16, v23
    v_and_b32 v167, 0xffff0000, v23
    v_mul_f32 v160, v14, v160
    v_mul_f32 v161, v14, v161
    v_mul_f32 v162, v14, v162
    v_mul_f32 v163, v14, v163
    v_mul_f32 v164, v14, v164
    v_mul_f32 v165, v14, v165
    v_mul_f32 v166, v14, v166
    v_mul_f32 v167, v14, v167
    s_mul_i32 s7, s3, 2176
    v_bfe_u32 v7, v1, 1, 2
    v_xor_b32 v7, v7, v2
    v_lshl_add_u32 v7, v7, 4, s7
    v_lshl_add_u32 v29, v1, 6, v7
    v_sub_u32 v6, 16, v1
    v_bfe_u32 v7, v6, 1, 2
    v_xor_b32 v7, v7, v2
    v_lshl_add_u32 v7, v7, 4, s7
    v_lshl_add_u32 v30, v6, 6, v7
    s_cmp_eq_u32 s58, 0
    s_cselect_b32 s6, 0, 2048
    v_add_u32 v4, s6, v5
    s_branch L_d2
L_ah:
    v_lshlrev_b32 v5, 4, v0
    v_mov_b32 v31, 0
    v_mov_b32 v9, 33792
    ds_write_b32 v9, v31
    s_mov_b32 s64, 0x9E3779B1
    s_cmp_ge_u32 s7, 2
    s_waitcnt lgkmcnt(0)
    s_cbranch_scc1 L_nowpf
    global_load_dwordx4 v[32:35], v5, s[16:17]
    global_load_dword v30, v31, s[30:31]
    global_load_dwordx4 v[36:39], v5, s[24:25]
L_nowpf:
    v_lshlrev_b32 v14, 10, v0
    s_lshl_b32 s50, s2, 3
    s_add_u32 s50, s50, 65536
    s_mov_b32 s36, s30
    s_mov_b32 s37, s31
    s_mov_b32 s38, 0x1000000
    s_mov_b32 s39, 0x20000
    s_mov_b32 s65, 0
    s_barrier
    v_lshlrev_b32 v6, 2, v2
    v_cvt_f32_u32 v7, v1
    v_cvt_f32_u32 v6, v6
    v_mul_f32 v7, 0x3d800000, v7
    v_mul_f32 v9, v6, v7
    v_cos_f32 v64, v9
    v_sin_f32 v68, v9
    v_add_f32 v9, v9, v7
    v_cos_f32 v65, v9
    v_sin_f32 v69, v9
    v_add_f32 v9, v9, v7
    v_cos_f32 v66, v9
    v_sin_f32 v70, v9
    v_add_f32 v9, v9, v7
    v_cos_f32 v67, v9
    v_sin_f32 v71, v9
    s_nop 0
    v_cvt_pk_bf16_f32 v40, v64, v68
    v_cvt_pk_bf16_f32 v48, -v68, v64
    v_cvt_pk_bf16_f32 v41, v65, v69
    v_cvt_pk_bf16_f32 v49, -v69, v65
    v_cvt_pk_bf16_f32 v42, v66, v70
    v_cvt_pk_bf16_f32 v50, -v70, v66
    v_cvt_pk_bf16_f32 v43, v67, v71
    v_cvt_pk_bf16_f32 v51, -v71, v67
    v_add_f32 v7, 0x3d800000, v7
    v_mul_f32 v9, v6, v7
    v_cos_f32 v64, v9
    v_sin_f32 v68, v9
    v_add_f32 v9, v9, v7
    v_cos_f32 v65, v9
    v_sin_f32 v69, v9
    v_add_f32 v9, v9, v7
    v_cos_f32 v66, v9
    v_sin_f32 v70, v9
    v_add_f32 v9, v9, v7
    v_cos_f32 v67, v9
    v_sin_f32 v71, v9
    s_nop 0
    v_cvt_pk_bf16_f32 v44, v64, -v68
    v_cvt_pk_bf16_f32 v52, -v68, -v64
    v_cvt_pk_bf16_f32 v45, v65, -v69
    v_cvt_pk_bf16_f32 v53, -v69, -v65
    v_cvt_pk_bf16_f32 v46, v66, -v70
    v_cvt_pk_bf16_f32 v54, -v70, -v66
    v_cvt_pk_bf16_f32 v47, v67, -v71
    v_cvt_pk_bf16_f32 v55, -v71, -v67
    ds_write_b128 v5, v[40:43] offset:42688
    ds_write_b128 v5, v[44:47] offset:43712
    ds_write_b128 v5, v[48:51] offset:44736
    ds_write_b128 v5, v[52:55] offset:45760
    global_load_dword v30, v31, s[30:31]
    s_waitcnt lgkmcnt(0)
    v_mov_b32 v9, 33792
    s_waitcnt vmcnt(0)
    v_mul_lo_u32 v31, v30, s64
    v_add_u32 v31, 0x7F4A7C15, v31
    v_lshlrev_b32 v6, 1, v1
    v_lshrrev_b32 v6, v6, v31
    v_lshlrev_b32 v7, 15, v6
    v_and_b32 v6, 1, v6
    v_and_b32 v7, 0x10000, v7
    v_or_b32 v6, v6, v7
    v_lshlrev_b32 v7, 2, v1
    ds_write_b32 v7, v6 offset:33920
    s_waitcnt lgkmcnt(0)
    v_mov_b32 v9, 33792
    s_barrier
    ds_read_b32 v30, v9
    s_mov_b32 exec_lo, -1
    s_mov_b32 exec_hi, 0x7
    s_waitcnt lgkmcnt(0)
    buffer_store_dwordx2 v[30:31], v14, s[36:39], s50 offen sc1
    s_mov_b64 exec, -1
    s_barrier
    s_and_b32 s61, s2, 7
    s_mul_i32 s61, s61, 2048
    s_add_u32 s61, s61, 84992
    s_add_u32 s62, s61, 1024
    s_waitcnt vmcnt(0)
    s_sleep 6
    s_branch L_poll5_1
L_poll5:
    s_sleep 5
L_poll5_1:
    buffer_load_dwordx4 v[32:35], v5, s[36:39], s61 offen sc1
    s_add_u32 s61, s61, 1024
    s_min_u32 s61, s61, s62
    s_add_u32 s65, s65, 1
    s_lshr_b32 s34, s65, 17
    s_waitcnt vmcnt(0)
    s_cbranch_scc1 L_poll5_ok
    v_cmp_ne_u32 vcc, v31, v33
    v_cmp_ne_u32 s[12:13], v31, v35
    s_or_b64 vcc, vcc, s[12:13]
    s_cbranch_vccnz L_poll5
L_poll5_ok:
    v_max_u32 v32, v32, v34
    s_nop 1
    v_max_u32_dpp v32, v32, v32 row_ror:8 row_mask:0xf bank_mask:0xf
    s_nop 1
    v_max_u32_dpp v32, v32, v32 row_ror:4 row_mask:0xf bank_mask:0xf
    s_nop 1
    v_max_u32_dpp v32, v32, v32 row_ror:2 row_mask:0xf bank_mask:0xf
    s_nop 1
    v_max_u32_dpp v32, v32, v32 row_ror:1 row_mask:0xf bank_mask:0xf
    s_nop 1
    v_max_u32_dpp v32, v32, v32 row_bcast:15 row_mask:0xa bank_mask:0xf
    s_nop 1
    v_max_u32_dpp v32, v32, v32 row_bcast:31 row_mask:0xc bank_mask:0xf
    v_mov_b32 v9, 33856
    s_mov_b32 exec_lo, 0
    s_brev_b32 exec_hi, 1
    ds_write_b32 v9, v32
    s_mov_b64 exec, -1
    s_waitcnt lgkmcnt(0)
    s_sleep 8
    s_barrier
    s_endpgm
    s_barrier
    s_endpgm
L_notA:
    s_lshl4_add_u32 s60, s6, s7
    s_sub_u32 s60, s60, 16
    s_cmp_ge_u32 s2, 256
    s_cbranch_scc1 L_end
    s_cmp_lt_u32 s6, 4
    s_cbranch_scc1 L_F
    s_mul_i32 s60, s6, 12
    s_add_u32 s60, s60, s7
    s_cmp_lt_u32 s7, 28
    s_cbranch_scc1 L_F
    s_mov_b32 s55, 1
    s_lshl2_add_u32 s47, s6, s7
    s_sub_u32 s47, s47, 44
    v_and_b32 v6, 1, v2
    v_lshlrev_b32 v6, 5, v6
    v_lshl_add_u32 v6, v1, 6, v6
    v_lshrrev_b32 v7, 1, v2
    v_lshl_add_u32 v3, v7, 4, v6
    v_lshlrev_b32 v5, 4, v0
    v_lshlrev_b32 v8, 31, v1
    v_lshrrev_b32 v9, 16, v8
    v_or_b32 v8, v8, v9
    s_waitcnt lgkmcnt(0)
    s_mov_b32 s36, s30
    s_mov_b32 s37, s31
    s_mov_b32 s38, 0x1000000
    s_mov_b32 s39, 0x20000
    s_mov_b32 s65, 0
    s_mov_b32 s40, s26
    s_mov_b32 s41, s27
    s_mov_b32 s42, 0x200000
    s_mov_b32 s43, 0x20000
    v_lshlrev_b32 v6, 4, v1
    v_lshl_add_u32 v10, v2, 13, v6
    v_mul_u32_u24 v6, 4352, v2
    v_bfe_u32 v7, v1, 1, 2
    v_xor_b32 v7, s3, v7
    v_lshl_add_u32 v7, v7, 4, v6
    v_lshl_add_u32 v11, v1, 6, v7
    s_lshl4_add_u32 s7, s3, 1024
    v_mov_b32 v9, 17600
    v_lshl_add_u32 v28, v0, 1, v9
    v_lshl_add_u32 v7, v1, 1, s7
    s_mov_b32 exec_lo, 0x00ff00ff
    s_mov_b32 exec_hi, 0x00ff00ff
    v_add_u32 v28, v7, v6
    s_mov_b64 exec, -1
    s_cmp_eq_u32 s3, 8
    s_cbranch_scc1 L_zh
    s_cmp_ge_u32 s3, 4
    s_cbranch_scc1 L_z0
    v_cvt_f32_u32 v6, v1
    s_lshl_b32 s6, s3, 2
    v_lshl_add_u32 v7, v2, 6, s6
    v_mul_f32 v6, 0x3b000000, v6
    v_cvt_f32_u32 v7, v7
    v_mul_f32 v15, 0x41800000, v6
    v_mul_f32 v7, v7, v6
    v_cos_f32 v64, v7
    v_sin_f32 v68, v7
    v_add_f32 v9, v7, v15
    v_cos_f32 v65, v9
    v_sin_f32 v69, v9
    v_add_f32 v9, v9, v15
    v_cos_f32 v66, v9
    v_sin_f32 v70, v9
    v_add_f32 v9, v9, v15
    v_cos_f32 v67, v9
    v_sin_f32 v71, v9
    v_mov_b32 v108, 0
    v_cvt_pk_bf16_f32 v100, v64, v65
    v_cvt_pk_bf16_f32 v104, -v68, -v69
    v_cvt_pk_bf16_f32 v101, v66, v67
    v_cvt_pk_bf16_f32 v105, -v70, -v71
    v_xor_b32 v102, v100, v8
    v_xor_b32 v106, v104, v8
    v_xor_b32 v103, v101, v8
    v_xor_b32 v107, v105, v8
    v_add_f32 v7, v7, v6
    v_cos_f32 v64, v7
    v_sin_f32 v68, v7
    v_add_f32 v9, v7, v15
    v_cos_f32 v65, v9
    v_sin_f32 v69, v9
    v_add_f32 v9, v9, v15
    v_cos_f32 v66, v9
    v_sin_f32 v70, v9
    v_add_f32 v9, v9, v15
    v_cos_f32 v67, v9
    v_sin_f32 v71, v9
    v_mov_b32 v120, 0
    v_cvt_pk_bf16_f32 v112, v64, v65
    v_cvt_pk_bf16_f32 v116, -v68, -v69
    v_cvt_pk_bf16_f32 v113, v66, v67
    v_cvt_pk_bf16_f32 v117, -v70, -v71
    v_xor_b32 v114, v112, v8
    v_xor_b32 v118, v116, v8
    v_xor_b32 v115, v113, v8
    v_xor_b32 v119, v117, v8
    v_add_f32 v7, v7, v6
    v_cos_f32 v64, v7
    v_sin_f32 v68, v7
    v_add_f32 v9, v7, v15
    v_cos_f32 v65, v9
    v_sin_f32 v69, v9
    v_add_f32 v9, v9, v15
    v_cos_f32 v66, v9
    v_sin_f32 v70, v9
    v_add_f32 v9, v9, v15
    v_cos_f32 v67, v9
    v_sin_f32 v71, v9
    v_mov_b32 v132, 0
    v_cvt_pk_bf16_f32 v124, v64, v65
    v_cvt_pk_bf16_f32 v128, -v68, -v69
    v_cvt_pk_bf16_f32 v125, v66, v67
    v_cvt_pk_bf16_f32 v129, -v70, -v71
    v_xor_b32 v126, v124, v8
    v_xor_b32 v130, v128, v8
    v_xor_b32 v127, v125, v8
    v_xor_b32 v131, v129, v8
    v_add_f32 v7, v7, v6
    v_cos_f32 v64, v7
    v_sin_f32 v68, v7
    v_add_f32 v9, v7, v15
    v_cos_f32 v65, v9
    v_sin_f32 v69, v9
    v_add_f32 v9, v9, v15
    v_cos_f32 v66, v9
    v_sin_f32 v70, v9
    v_add_f32 v9, v9, v15
    v_cos_f32 v67, v9
    v_sin_f32 v71, v9
    v_mov_b32 v144, 0
    v_cvt_pk_bf16_f32 v136, v64, v65
    v_cvt_pk_bf16_f32 v140, -v68, -v69
    v_cvt_pk_bf16_f32 v137, v66, v67
    v_cvt_pk_bf16_f32 v141, -v70, -v71
    v_xor_b32 v138, v136, v8
    v_xor_b32 v142, v140, v8
    v_xor_b32 v139, v137, v8
    v_xor_b32 v143, v141, v8
    v_lshrrev_b32 v6, 1, v1
    v_add_u32 v7, s6, v6
    v_and_b32 v9, 1, v1
    v_lshl_add_u32 v7, v9, 3, v7
    v_cvt_f32_u32 v7, v7
    v_mul_f32 v7, 0x3d000000, v7
    v_cos_f32 v7, v7
    s_mov_b32 exec_lo, 0x30003
    s_mov_b32 exec_hi, 0x30003
    v_cvt_pk_bf16_f32 v108, v7, -v7
    s_mov_b32 exec_lo, 0xc000c
    s_mov_b32 exec_hi, 0xc000c
    v_cvt_pk_bf16_f32 v120, v7, -v7
    s_mov_b32 exec_lo, 0x300030
    s_mov_b32 exec_hi, 0x300030
    v_cvt_pk_bf16_f32 v132, v7, -v7
    s_mov_b32 exec_lo, 0xc000c0
    s_mov_b32 exec_hi, 0xc000c0
    v_cvt_pk_bf16_f32 v144, v7, -v7
    s_mov_b64 exec, -1
    v_mov_b32 v109, v108
    v_mov_b32 v110, v108
    v_mov_b32 v111, v108
    v_mov_b32 v121, v120
    v_mov_b32 v122, v120
    v_mov_b32 v123, v120
    v_mov_b32 v133, v132
    v_mov_b32 v134, v132
    v_mov_b32 v135, v132
    v_mov_b32 v145, v144
    v_mov_b32 v146, v144
    v_mov_b32 v147, v144
    s_branch L_z1
L_z0:
    s_branch L_hi1
L_z0b:
    s_mov_b64 exec, 0
    s_sub_u32 s53, s3, 8
L_tzback:
    s_add_u32 s53, s53, 4
    s_cmp_eq_u32 s53, 0
    s_cbranch_scc1 L_tz0
    s_cmp_eq_u32 s53, 1
    s_cbranch_scc1 L_tz1
    s_cmp_eq_u32 s53, 2
    s_cbranch_scc1 L_tz2
    s_cmp_eq_u32 s53, 3
    s_cbranch_scc1 L_tz3
    s_cmp_eq_u32 s53, 4
    s_cbranch_scc1 L_tz4
    s_cmp_eq_u32 s53, 5
    s_cbranch_scc1 L_tz5
    s_cmp_eq_u32 s53, 6
    s_cbranch_scc1 L_tz6
    s_cmp_eq_u32 s53, 7
    s_cbranch_scc1 L_tz7
    s_mov_b64 exec, -1
L_z1:
    v_mov_b32 v9, 33792
    v_mov_b32 v12, 0
    v_mov_b32 v13, 0
    s_barrier
    ds_read_b64 v[30:31], v9
    ds_read_b128 v[24:27], v5 offset:47808
    s_waitcnt lgkmcnt(0)
    v_readfirstlane_b32 s44, v30
    s_andn2_b32 s54, 2047, s44
    s_and_b32 s6, s54, 127
    s_cmp_gt_u32 s6, 64
    s_cselect_b32 s46, 1, 0
    s_and_b32 s6, s54, 1087
    s_cmp_eq_u32 s6, 1024
    s_cselect_b32 s46, 1, s46
    s_sub_u32 s6, 2048, s54
    s_cmp_lg_u32 s46, 0
    s_cselect_b32 s6, s6, s54
    s_cmp_eq_u32 s6, 1024
    s_cselect_b32 s6, 0, s6
    s_and_b32 s56, s6, 127
    s_lshr_b32 s57, s6, 10
    s_bfe_u32 s45, s6, 0x30007
    s_lshl3_add_u32 s11, s57, s45
    s_lshl_b32 s11, s11, 7
    s_add_u32 s58, s11, s56
    s_sub_u32 s59, 2048, s58
    s_cmp_eq_u32 s58, 0
    s_cselect_b32 s59, 1024, s59
    s_lshl_b32 s10, s58, 10
    s_lshl_b32 s11, s59, 10
    v_add_u32 v6, s10, v5
    v_add_u32 v7, s11, v5
    s_cmp_ge_u32 s3, 4
    s_cbranch_scc1 L_z4
    s_and_b32 s7, s56, 63
    s_mul_i32 s32, s7, 33024
    s_lshl_b32 s7, s3, 9
    s_add_u32 s32, s32, s7
    s_add_u32 s32, s32, 2097152
    s_add_u32 s33, s32, 4096
    s_sleep 5
    buffer_load_dwordx4 v[32:35], v10, s[36:39], s32 offen offset:0 sc1
    buffer_load_dwordx4 v[36:39], v10, s[36:39], s32 offen offset:2048 sc1
    buffer_load_dwordx4 v[40:43], v10, s[36:39], s33 offen offset:0 sc1
    buffer_load_dwordx4 v[44:47], v10, s[36:39], s33 offen offset:2048 sc1
    buffer_load_dwordx4 v[48:51], v10, s[36:39], s32 offen offset:256 sc1
    buffer_load_dwordx4 v[52:55], v10, s[36:39], s32 offen offset:2304 sc1
    buffer_load_dwordx4 v[56:59], v10, s[36:39], s33 offen offset:256 sc1
    buffer_load_dwordx4 v[60:63], v10, s[36:39], s33 offen offset:2304 sc1
    v_lshrrev_b32 v6, 1, v1
    s_lshl_b32 s6, s57, 10
    s_add_u32 s6, s6, s56
    v_lshl_add_u32 v6, v6, 7, s6
    v_and_b32 v7, 1, v1
    v_lshlrev_b32 v9, 9, v7
    s_cmp_lg_u32 s56, 0
    s_cbranch_scc1 L_g06
    s_mov_b32 exec_lo, 0x00020002
    s_mov_b32 exec_hi, 0x00020002
    v_mov_b32 v6, 0x400
    v_mov_b32 v9, 0
    s_mov_b64 exec, -1
L_g06:
    v_lshlrev_b32 v7, 2, v2
    v_mad_u32_u24 v9, v7, v6, v9
    v_cvt_f32_u32 v6, v6
    v_cvt_f32_u32 v9, v9
    v_mul_f32 v6, 0x3a000000, v6
    v_mul_f32 v9, 0x3a000000, v9
    v_cos_f32 v64, v9
    v_sin_f32 v68, v9
    v_add_f32 v9, v9, v6
    v_cos_f32 v65, v9
    v_sin_f32 v69, v9
    v_add_f32 v9, v9, v6
    v_cos_f32 v66, v9
    v_sin_f32 v70, v9
    v_add_f32 v9, v9, v6
    v_cos_f32 v67, v9
    v_sin_f32 v71, v9
    s_and_b32 s7, s56, 63
    s_nop 0
    v_cvt_pk_bf16_f32 v148, v64, v68
    v_cvt_pk_bf16_f32 v149, v65, v69
    v_cvt_pk_bf16_f32 v150, v66, v70
    v_cvt_pk_bf16_f32 v151, v67, v71
    s_cmp_lg_u32 s7, 0
    s_cbranch_scc1 L_gd7
    s_lshr_b32 s7, s56, 2
    v_and_b32 v148, 0xffff, v148
    v_lshlrev_b32 v148, s7, v148
    v_and_b32 v149, 0xffff, v149
    v_lshlrev_b32 v149, s7, v149
    v_and_b32 v150, 0xffff, v150
    v_lshlrev_b32 v150, s7, v150
    v_and_b32 v151, 0xffff, v151
    v_lshlrev_b32 v151, s7, v151
L_gd7:
    v_and_b32 v6, 3, v1
    v_lshlrev_b32 v6, 4, v6
    ds_read_b128 v[96:99], v6 offset:33920
    s_waitcnt lgkmcnt(0)
    s_mul_i32 s7, s45, 2176
    v_bfe_u32 v7, v1, 1, 2
    v_xor_b32 v7, v7, v2
    v_lshl_add_u32 v7, v7, 4, s7
    v_lshl_add_u32 v29, v1, 6, v7
    v_sub_u32 v6, 16, v1
    v_bfe_u32 v7, v6, 1, 2
    v_xor_b32 v7, v7, v2
    v_lshl_add_u32 v7, v7, 4, s7
    v_lshl_add_u32 v30, v6, 6, v7
    s_cmp_eq_u32 s58, 0
    s_cselect_b32 s6, 0, 2048
    v_add_u32 v4, s6, v5
    v_lshlrev_b32 v6, 7, v1
    v_lshl_add_u32 v15, v2, 4, v6
    s_branch L_zjoin
L_z4:
    s_cmp_ge_u32 s3, 6
    s_cbranch_scc1 L_zend2
    global_load_dwordx4 v[16:19], v6, s[4:5]
    global_load_dwordx4 v[20:23], v7, s[4:5]
    s_sub_u32 s6, s3, 4
    s_lshl1_add_u32 s7, s47, s6
    s_lshl_b32 s7, s7, 5
    v_and_b32 v6, 7, v0
    v_lshl_add_u32 v10, v6, 2, s7
    s_lshl_b32 s8, s54, 10
    v_add_u32 v7, s8, v10
    global_load_dword v35, v7, s[4:5]
    v_lshlrev_b32 v10, 1, v10
    v_lshrrev_b32 v7, 3, v0
    v_lshlrev_b32 v7, 8, v7
    v_lshl_add_u32 v11, v6, 4, v7
    s_mul_i32 s48, s47, 14336
    s_lshl_b32 s6, s6, 7
    s_add_u32 s48, s48, s6
    s_add_u32 s48, s48, 720896
    s_add_u32 s49, s48, 0
    s_and_b32 s6, s44, 0xffff0000
    s_xor_b32 s7, s6, 0x80000000
    s_xor_b32 s9, s6, 0xffff0000
    s_bitcmp1_b32 s6, 31
    s_cselect_b32 s6, s7, s9
    v_mov_b32 v15, s6
    v_mul_f32 v15, 0xbfb8aa3b, v15
    v_exp_f32 v15, v15
    s_nop 0
    v_add_f32 v15, 1.0, v15
    v_rcp_f32 v15, v15
    s_nop 0
    v_cvt_pk_bf16_f32 v15, v15, v15
    v_and_b32 v15, 0xffff0000, v15
    s_waitcnt vmcnt(0)
    v_dot2c_f32_bf16 v12, v16, v24
    v_dot2c_f32_bf16 v13, v20, v24
    v_dot2c_f32_bf16 v12, v17, v25
    v_dot2c_f32_bf16 v13, v21, v25
    v_dot2c_f32_bf16 v12, v18, v26
    v_dot2c_f32_bf16 v13, v22, v26
    v_dot2c_f32_bf16 v12, v19, v27
    v_dot2c_f32_bf16 v13, v23, v27
    s_nop 2
    v_permlane32_swap_b32 v12, v13
    v_add_f32 v12, v12, v13
    v_mov_b32 v13, v12
    s_nop 1
    v_permlane16_swap_b32 v12, v13
    v_add_f32 v12, v12, v13
    s_nop 1
    v_add_f32_dpp v12, v12, v12 row_ror:8 row_mask:0xf bank_mask:0xf
    s_nop 1
    v_add_f32_dpp v12, v12, v12 row_ror:4 row_mask:0xf bank_mask:0xf
    s_nop 1
    v_add_f32_dpp v12, v12, v12 row_ror:2 row_mask:0xf bank_mask:0xf
    s_nop 1
    v_add_f32_dpp v12, v12, v12 row_ror:1 row_mask:0xf bank_mask:0xf
    v_cvt_pk_bf16_f32 v12, v12, v12
    v_and_b32 v12, 0xffff0000, v12
    v_mul_f32 v13, 0xbfb8aa3b, v12
    v_exp_f32 v13, v13
    s_nop 0
    v_add_f32 v13, 1.0, v13
    v_rcp_f32 v13, v13
    s_nop 0
    v_cvt_pk_bf16_f32 v13, v13, v13
    v_and_b32 v13, 0xffff0000, v13
    v_sub_f32 v14, 1.0, v13
    v_cvt_pk_bf16_f32 v14, v14, v14
    v_and_b32 v14, 0xffff0000, v14
    v_readlane_b32 s6, v13, 0
    v_readlane_b32 s7, v13, 32
    v_readlane_b32 s8, v14, 0
    v_readlane_b32 s9, v14, 32
    s_xor_b32 s10, s6, 0x80000000
    s_cmp_eq_u32 s58, 0
    s_cselect_b32 s10, 0, s10
    s_cselect_b32 s11, 0, s7
    s_cmp_lg_u32 s46, 0
    s_cselect_b32 s8, s9, s8
    s_cselect_b32 s6, s11, s6
    s_cselect_b32 s10, s7, s10
    v_xor_b32 v31, s54, v31
    v_mov_b32 v36, s8
    v_mov_b32 v24, s6
    v_mov_b32 v25, s10
    v_lshlrev_b32 v34, 16, v35
    v_and_b32 v35, 0xffff0000, v35
    s_sleep 20
    v_mov_b32 v9, 33864
L_tz_start:
L_zp:
    buffer_load_dwordx4 v[40:43], v11, s[36:39], s48 offen offset:0 sc1
    buffer_load_dwordx4 v[44:47], v11, s[36:39], s48 offen offset:2048 sc1
    s_add_u32 s6, s48, 4096
    buffer_load_dwordx4 v[48:51], v11, s[36:39], s6 offen offset:0 sc1
L_tz0:
    s_cbranch_execz L_tzback
    buffer_load_dwordx4 v[52:55], v11, s[36:39], s6 offen offset:2048 sc1
    s_add_u32 s6, s48, 8192
    buffer_load_dwordx4 v[56:59], v11, s[36:39], s6 offen offset:0 sc1
    buffer_load_dwordx4 v[60:63], v11, s[36:39], s6 offen offset:2048 sc1
    s_add_u32 s6, s48, 12288
    buffer_load_dwordx4 v[64:67], v11, s[36:39], s6 offen offset:0 sc1
    s_add_u32 s48, s48, 229376
    s_min_u32 s48, s48, s49
    s_add_u32 s65, s65, 1
    s_lshr_b32 s34, s65, 17
    s_cbranch_scc1 L_zp_ok
    s_waitcnt vmcnt(6)
    v_bitop3_b32 v37, v41, v43, v31 bitop3:0x7e
    s_waitcnt vmcnt(5)
    v_bitop3_b32 v39, v45, v47, v31 bitop3:0x7e
    v_add_f32 v40, v40, v44
    v_add_f32 v42, v42, v46
    s_waitcnt vmcnt(4)
    v_bitop3_b32 v38, v49, v51, v31 bitop3:0x7e
    v_add_f32 v40, v40, v48
L_tz1:
    s_cbranch_execz L_tzback
    v_add_f32 v42, v42, v50
    v_or3_b32 v37, v37, v38, v39
    s_waitcnt vmcnt(3)
    v_bitop3_b32 v39, v53, v55, v31 bitop3:0x7e
    v_add_f32 v40, v40, v52
    v_add_f32 v42, v42, v54
    s_waitcnt vmcnt(2)
    v_bitop3_b32 v38, v57, v59, v31 bitop3:0x7e
    v_add_f32 v40, v40, v56
    v_add_f32 v42, v42, v58
    v_or3_b32 v37, v37, v38, v39
    s_waitcnt vmcnt(1)
    v_bitop3_b32 v39, v61, v63, v31 bitop3:0x7e
    v_add_f32 v40, v40, v60
    v_add_f32 v42, v42, v62
    s_waitcnt vmcnt(0)
    v_bitop3_b32 v38, v65, v67, v31 bitop3:0x7e
    v_add_f32 v40, v40, v64
    v_add_f32 v42, v42, v66
    v_or3_b32 v37, v37, v38, v39
    v_cmp_ne_u32 vcc, 0, v37
    s_nop 0
    s_cbranch_vccnz L_zp
L_zp_ok:
    ds_read_b32 v12, v9
L_tz2:
    s_cbranch_execz L_tzback
    ds_read_b64 v[32:33], v10 offset:38592
    ds_read_b64 v[16:17], v10 offset:40640
    v_lshrrev_b32 v11, 1, v10
    s_lshl_b32 s8, s54, 10
    s_waitcnt vmcnt(0)
    v_add_f32_dpp v40, v40, v40 row_ror:8 row_mask:0xf bank_mask:0xf
    v_add_f32_dpp v42, v42, v42 row_ror:8 row_mask:0xf bank_mask:0xf
    s_nop 0
    s_nop 0
    v_permlane16_swap_b32 v40, v42
    v_add_f32 v40, v40, v42
    v_mov_b32 v42, v40
    s_nop 1
    v_permlane32_swap_b32 v40, v42
    v_add_f32 v40, v40, v42
    v_mov_b32 v42, v40
    s_nop 1
    v_permlane16_swap_b32 v40, v42
    v_cvt_pk_bf16_f32 v41, v40, v42
    v_lshlrev_b32 v40, 16, v41
    v_and_b32 v42, 0xffff0000, v41
    v_mul_f32 v40, v40, v15
    v_mul_f32 v42, v42, v15
    v_cvt_pk_bf16_f32 v41, v40, v42
L_tz3:
    s_cbranch_execz L_tzback
    v_lshlrev_b32 v40, 16, v41
    v_and_b32 v42, 0xffff0000, v41
    v_add_f32 v40, v40, v34
    v_add_f32 v42, v42, v35
    v_cvt_pk_bf16_f32 v41, v40, v42
    v_lshlrev_b32 v40, 16, v41
    v_and_b32 v42, 0xffff0000, v41
L_zw:
    s_waitcnt lgkmcnt(0)
    v_cmp_eq_u32 vcc, 0, v12
    v_mul_f32 v32, v24, v32
    v_mul_f32 v33, v24, v33
    s_cbranch_vccz L_zw_ok
    s_add_u32 s65, s65, 1
    s_lshr_b32 s34, s65, 17
    s_cbranch_scc1 L_zw_ok
    ds_read_b32 v12, v9
    ds_read_b64 v[32:33], v10 offset:38592
    ds_read_b64 v[16:17], v10 offset:40640
    s_branch L_zw
L_zw_ok:
    v_fmac_f32 v32, v25, v16
    v_fmac_f32 v33, v25, v17
    v_fmac_f32 v32, v40, v36
    v_fmac_f32 v33, v42, v36
    v_cvt_pk_bf16_f32 v32, v32, v33
L_tz4:
    s_cbranch_execz L_tzback
    s_mov_b64 exec, 0xff
    buffer_store_dword v32, v11, s[40:43], s8 offen
    s_mov_b64 exec, -1
    s_barrier
    s_endpgm
L_zsync:
    v_mov_b32 v9, 33868
    v_mov_b32 v6, 1
    s_mov_b64 exec, 1
    ds_add_u32 v9, v6
    s_mov_b64 exec, -1
    s_cmp_lg_u32 s3, 0
    s_cbranch_scc1 L_zend
L_zs:
    ds_read_b32 v6, v9
    s_add_u32 s65, s65, 1
    s_lshr_b32 s34, s65, 17
    s_waitcnt lgkmcnt(0)
    s_cbranch_scc1 L_zs_ok
    v_cmp_ne_u32 vcc, 4, v6
    s_nop 0
    s_cbranch_vccnz L_zs
L_zs_ok:
    ds_read_b128 v[32:35], v29 offset:16384
    ds_read_b128 v[36:39], v30 offset:16384
    ds_read_b128 v[40:43], v29 offset:17472
L_tz5:
    s_cbranch_execz L_tzback
    ds_read_b128 v[44:47], v30 offset:17472
    s_waitcnt lgkmcnt(3)
    v_mfma_f32_16x16x32_bf16 v[48:51], v[32:35], v[64:67], 0
    s_waitcnt lgkmcnt(2)
    v_mfma_f32_16x16x32_bf16 v[52:55], v[36:39], v[68:71], 0
    s_waitcnt lgkmcnt(1)
    v_mfma_f32_16x16x32_bf16 v[56:59], v[40:43], v[72:75], 0
    s_waitcnt lgkmcnt(0)
    v_mfma_f32_16x16x32_bf16 v[60:63], v[44:47], v[76:79], 0
    s_nop 2
    ds_write_b128 v15, v[48:51] offset:38592
    ds_write_b128 v15, v[52:55] offset:38656
    s_nop 1
    ds_write_b128 v15, v[56:59] offset:40640
    ds_write_b128 v15, v[60:63] offset:40704
    v_mov_b32 v9, 33864
    s_waitcnt lgkmcnt(0)
    ds_write_b32 v9, v9
    s_waitcnt lgkmcnt(0)
.set L_tz6, L_tzback
.set L_tz7, L_tzback
L_zend:
    s_endpgm
L_zend2:
    s_endpgm
L_zh:
    v_mov_b32 v9, 33864
    v_mov_b32 v6, 0
    ds_write2_b32 v9, v6, v6 offset1:1
    v_lshlrev_b32 v6, 2, v2
    v_cvt_f32_u32 v7, v1
    v_cvt_f32_u32 v6, v6
    v_mul_f32 v7, 0x3d800000, v7
    v_mul_f32 v9, v6, v7
    v_cos_f32 v64, v9
    v_sin_f32 v68, v9
    v_add_f32 v9, v9, v7
    v_cos_f32 v65, v9
    v_sin_f32 v69, v9
    v_add_f32 v9, v9, v7
    v_cos_f32 v66, v9
    v_sin_f32 v70, v9
    v_add_f32 v9, v9, v7
    v_cos_f32 v67, v9
    v_sin_f32 v71, v9
    s_nop 0
    v_cvt_pk_bf16_f32 v40, v64, v68
    v_cvt_pk_bf16_f32 v48, -v68, v64
    v_cvt_pk_bf16_f32 v41, v65, v69
    v_cvt_pk_bf16_f32 v49, -v69, v65
    v_cvt_pk_bf16_f32 v42, v66, v70
    v_cvt_pk_bf16_f32 v50, -v70, v66
    v_cvt_pk_bf16_f32 v43, v67, v71
    v_cvt_pk_bf16_f32 v51, -v71, v67
    v_add_f32 v7, 0x3d800000, v7
    v_mul_f32 v9, v6, v7
    v_cos_f32 v64, v9
    v_sin_f32 v68, v9
    v_add_f32 v9, v9, v7
    v_cos_f32 v65, v9
    v_sin_f32 v69, v9
    v_add_f32 v9, v9, v7
    v_cos_f32 v66, v9
    v_sin_f32 v70, v9
    v_add_f32 v9, v9, v7
    v_cos_f32 v67, v9
    v_sin_f32 v71, v9
    s_nop 0
    v_cvt_pk_bf16_f32 v44, v64, -v68
    v_cvt_pk_bf16_f32 v52, -v68, -v64
    v_cvt_pk_bf16_f32 v45, v65, -v69
    v_cvt_pk_bf16_f32 v53, -v69, -v65
    v_cvt_pk_bf16_f32 v46, v66, -v70
    v_cvt_pk_bf16_f32 v54, -v70, -v66
    v_cvt_pk_bf16_f32 v47, v67, -v71
    v_cvt_pk_bf16_f32 v55, -v71, -v67
    ds_write_b128 v5, v[40:43] offset:42688
    ds_write_b128 v5, v[44:47] offset:43712
    ds_write_b128 v5, v[48:51] offset:44736
    ds_write_b128 v5, v[52:55] offset:45760
    s_mov_b32 m0, 47808
    v_mov_b32 v31, 0
    global_load_dword v30, v31, s[30:31]
    s_mov_b32 s64, 0x9E3779B1
    global_load_lds_dwordx4 v5, s[24:25]
    s_waitcnt vmcnt(0)
    v_mul_lo_u32 v31, v30, s64
    v_add_u32 v31, 0x7F4A7C15, v31
    v_lshlrev_b32 v6, 1, v1
    v_lshrrev_b32 v6, v6, v31
    v_lshlrev_b32 v7, 15, v6
    v_and_b32 v6, 1, v6
    v_and_b32 v7, 0x10000, v7
    v_or_b32 v6, v6, v7
    v_lshlrev_b32 v7, 2, v1
    ds_write_b32 v7, v6 offset:33920
    s_waitcnt lgkmcnt(0)
    s_and_b32 s61, s2, 0
    s_mul_i32 s61, s61, 3072
    s_add_u32 s61, s61, 81920
    s_add_u32 s62, s61, 2048
    s_sleep 32
    s_branch L_poll8_1
L_poll8:
    s_sleep 8
L_poll8_1:
    buffer_load_dwordx4 v[32:35], v5, s[36:39], s61 offen sc1
    s_add_u32 s61, s61, 1024
    s_min_u32 s61, s61, s62
    s_add_u32 s65, s65, 1
    s_lshr_b32 s34, s65, 17
    s_waitcnt vmcnt(0)
    s_cbranch_scc1 L_poll8_ok
    v_cmp_ne_u32 vcc, v31, v33
    v_cmp_ne_u32 s[12:13], v31, v35
    s_or_b64 vcc, vcc, s[12:13]
    s_cbranch_vccnz L_poll8
L_poll8_ok:
    v_max_u32 v32, v32, v34
    s_nop 1
    v_max_u32_dpp v32, v32, v32 row_ror:8 row_mask:0xf bank_mask:0xf
    s_nop 1
    v_max_u32_dpp v32, v32, v32 row_ror:4 row_mask:0xf bank_mask:0xf
    s_nop 1
    v_max_u32_dpp v32, v32, v32 row_ror:2 row_mask:0xf bank_mask:0xf
    s_nop 1
    v_max_u32_dpp v32, v32, v32 row_ror:1 row_mask:0xf bank_mask:0xf
    s_nop 1
    v_max_u32_dpp v32, v32, v32 row_bcast:15 row_mask:0xa bank_mask:0xf
    s_nop 1
    v_max_u32_dpp v32, v32, v32 row_bcast:31 row_mask:0xc bank_mask:0xf
    v_mov_b32 v9, 33792
    s_mov_b32 exec_lo, 0
    s_brev_b32 exec_hi, 1
    ds_write2_b32 v9, v32, v31 offset1:1
    s_mov_b64 exec, -1
    s_waitcnt lgkmcnt(0)
    s_barrier
    s_lshl_b32 s6, s47, 2
    s_add_u32 s6, s6, 4096
    s_mov_b64 exec, 1
    buffer_store_dword v31, v0, s[36:39], s6 offen sc1
    s_mov_b64 exec, -1
    s_cmp_lg_u32 s47, 0
    s_cbranch_scc1 L_zend
    s_mov_b64 exec, 0xffff
    v_lshlrev_b32 v6, 2, v0
    s_mov_b32 s6, 4096
    s_waitcnt vmcnt(0)
    s_sleep 24
L_za:
    buffer_load_dword v7, v6, s[36:39], s6 offen sc1
    s_add_u32 s65, s65, 1
    s_lshr_b32 s34, s65, 17
    s_waitcnt vmcnt(0)
    s_cbranch_scc1 L_za_ok
    v_cmp_ne_u32 vcc, v31, v7
    s_nop 0
    s_cbranch_vccnz L_za
L_za_ok:
    s_mov_b64 exec, 1
    v_add_u32 v9, 1, v30
    s_barrier
    buffer_store_dword v9, v6, s[36:39], 0 offen sc1
    s_mov_b64 exec, -1
    s_branch L_zend
L_F:
    v_lshlrev_b32 v5, 4, v0
    s_cmp_eq_u32 s3, 8
    s_cbranch_scc1 L_fh
    s_and_b32 s6, s60, 3
    s_lshr_b32 s7, s3, 1
    s_lshl2_add_u32 s32, s6, s7
    s_mul_i32 s8, s32, 114688
    s_lshr_b32 s33, s60, 2
    s_lshl_b32 s9, s33, 7
    s_add_u32 s8, s8, s9
    v_lshrrev_b32 v6, 3, v0
    v_mul_u32_u24 v6, 3584, v6
    v_and_b32 v7, 7, v0
    v_bfe_u32 v8, v0, 4, 1
    v_lshlrev_b32 v8, 2, v8
    v_xor_b32 v4, v7, v8
    v_lshl_add_u32 v7, v4, 4, s8
    v_add_u32 v3, v6, v7
    s_lshl_b32 s10, s3, 12
    s_mov_b32 m0, s10
    v_bfe_u32 v6, v0, 2, 2
    v_and_b32 v7, 3, v0
    v_lshlrev_b32 v8, 3, v7
    v_lshl_add_u32 v8, v2, 5, v8
    v_and_b32 v9, 2, v6
    v_lshlrev_b32 v9, 5, v9
    v_xor_b32 v9, v9, v8
    v_lshl_add_u32 v9, v6, 7, v9
    v_add_u32 v9, s10, v9
    s_lshl_b32 s11, s3, 8
    v_lshlrev_b32 v11, 2, v0
    v_add_u32 v11, 49152, v11
    v_add_u32 v12, s11, v11
    s_lshl1_add_u32 s7, s33, s7
    s_lshl_b32 s8, s7, 15
    s_and_b32 s9, s3, 1
    s_lshl1_add_u32 s9, s6, s9
    s_lshl_b32 s11, s9, 7
    s_add_u32 s8, s8, s11
    v_lshrrev_b32 v6, 3, v0
    v_lshl_add_u32 v6, v6, 10, s8
    v_lshl_add_u32 v4, v4, 4, v6
    v_lshrrev_b32 v6, 5, v0
    v_mul_u32_u24 v13, 14336, v6
    v_and_b32 v6, 31, v0
    v_lshl_add_u32 v13, v6, 3, v13
    s_mul_i32 s8, s9, 28672
    s_lshl_b32 s7, s7, 8
    s_add_u32 s8, s8, s7
    s_add_u32 s8, s8, 720896
    s_lshl_b32 s32, s32, 6
    s_lshl_b32 s33, s33, 12
    s_add_u32 s61, s33, 196608
    s_add_u32 s62, s61, 114688
    s_lshl_b32 s7, s6, 10
    s_add_u32 s33, s61, s7
    v_mov_b32 v14, 51200
    s_lshr_b32 s7, s3, 1
    s_lshl_b32 s7, s7, 9
    v_lshl_add_u32 v15, v6, 4, s7
    v_lshrrev_b32 v6, 5, v0
    v_lshl_add_u32 v15, v6, 10, v15
    s_mov_b32 s40, s61
    s_mov_b32 s41, s33
    s_mov_b32 s42, s8
    s_mov_b32 s35, 0
    s_bitcmp1_b32 s3, 0
    s_waitcnt lgkmcnt(0)
    s_cselect_b32 s18, s20, s18
    s_cselect_b32 s19, s21, s19
    global_load_lds_dwordx4 v3, s[18:19]
    s_add_u32 m0, s10, 1024
    v_add_u32 v3, 28672, v3
    global_load_lds_dwordx4 v3, s[18:19]
    s_add_u32 m0, s10, 2048
    v_add_u32 v3, 28672, v3
    global_load_lds_dwordx4 v3, s[18:19]
    s_add_u32 m0, s10, 3072
    v_add_u32 v3, 28672, v3
    global_load_lds_dwordx4 v3, s[18:19]
    s_mov_b32 s36, s30
    s_mov_b32 s37, s31
    s_mov_b32 s38, 0x1000000
    s_mov_b32 s39, 0x20000
    s_mov_b32 s65, 0
    s_cmp_ge_u32 s3, 4
    s_cbranch_scc1 L_nowd9
    s_add_u32 m0, s10, 32768
    s_nop 0
    global_load_lds_dwordx4 v4, s[22:23]
    s_add_u32 m0, s10, 33792
    v_add_u32 v4, 0x2000, v4
    global_load_lds_dwordx4 v4, s[22:23]
    s_add_u32 m0, s10, 34816
    v_add_u32 v4, 0x2000, v4
    global_load_lds_dwordx4 v4, s[22:23]
    s_add_u32 m0, s10, 35840
    v_add_u32 v4, 0x2000, v4
    global_load_lds_dwordx4 v4, s[22:23]
L_nowd9:
    s_waitcnt vmcnt(0)
    ds_read_b64_tr_b16 v[32:33], v9 offset:0
    ds_read_b64_tr_b16 v[34:35], v9 offset:512
    ds_read_b64_tr_b16 v[36:37], v9 offset:1024
    ds_read_b64_tr_b16 v[38:39], v9 offset:1536
    ds_read_b64_tr_b16 v[40:41], v9 offset:2048
    ds_read_b64_tr_b16 v[42:43], v9 offset:2560
    ds_read_b64_tr_b16 v[44:45], v9 offset:3072
    ds_read_b64_tr_b16 v[46:47], v9 offset:3584
    s_mov_b64 exec, 0
    s_sub_u32 s53, s3, 8
L_tfback:
    s_add_u32 s53, s53, 8
    s_cmp_eq_u32 s53, 0
    s_cbranch_scc1 L_tf0
    s_cmp_eq_u32 s53, 1
    s_cbranch_scc1 L_tf1
    s_cmp_eq_u32 s53, 2
    s_cbranch_scc1 L_tf2
    s_cmp_eq_u32 s53, 3
    s_cbranch_scc1 L_tf3
    s_cmp_eq_u32 s53, 4
    s_cbranch_scc1 L_tf4
    s_cmp_eq_u32 s53, 5
    s_cbranch_scc1 L_tf5
    s_cmp_eq_u32 s53, 6
    s_cbranch_scc1 L_tf6
    s_cmp_eq_u32 s53, 7
    s_cbranch_scc1 L_tf7
    s_mov_b64 exec, -1
    s_waitcnt lgkmcnt(0)
    s_barrier
L_tf_start:
    ds_read_b64 v[26:27], v14
    s_waitcnt lgkmcnt(0)
    v_readfirstlane_b32 s43, v26
L_redo:
    s_andn2_b32 s6, 2047, s43
    s_lshl_b32 s7, s6, 10
    s_add_u32 s7, s7, s32
    s_load_dwordx16 s[44:59], s[4:5], s7
    v_xor_b32 v31, s6, v27
    v_xor_b32 v29, s6, v27
    v_mov_b32 v16, 0
    v_mov_b32 v17, 0
    v_mov_b32 v24, 0
L_tf0:
    s_cbranch_execz L_tfback
    v_mov_b32 v25, 0
    s_mov_b32 s61, s40
    s_mov_b32 s33, s41
    s_mov_b32 s8, s42
    s_mov_b32 s64, 0
    s_waitcnt lgkmcnt(0)
    v_dot2c_f32_bf16 v16, s44, v32
    v_dot2c_f32_bf16 v17, s45, v33
    v_dot2c_f32_bf16 v16, s46, v34
    v_dot2c_f32_bf16 v17, s47, v35
    v_dot2c_f32_bf16 v16, s48, v36
    v_dot2c_f32_bf16 v17, s49, v37
    v_dot2c_f32_bf16 v16, s50, v38
    v_dot2c_f32_bf16 v17, s51, v39
    v_dot2c_f32_bf16 v16, s52, v40
    v_dot2c_f32_bf16 v17, s53, v41
    v_dot2c_f32_bf16 v16, s54, v42
    v_dot2c_f32_bf16 v17, s55, v43
    v_dot2c_f32_bf16 v16, s56, v44
    v_dot2c_f32_bf16 v17, s57, v45
    v_dot2c_f32_bf16 v16, s58, v46
    v_dot2c_f32_bf16 v17, s59, v47
    s_nop 2
    v_add_f32 v16, v16, v17
    ds_write_b32 v12, v16
    s_waitcnt lgkmcnt(0)
    s_barrier
    s_lshl_b32 s6, s3, 4
    s_lshl_b64 s[12:13], 0xffff, s6
L_tf1:
    s_cbranch_execz L_tfback
    ds_read2st64_b32 v[16:17], v11 offset0:0 offset1:2
    ds_read2st64_b32 v[18:19], v11 offset0:4 offset1:6
    ds_read2st64_b32 v[20:21], v11 offset0:1 offset1:3
    ds_read2st64_b32 v[22:23], v11 offset0:5 offset1:7
    s_waitcnt lgkmcnt(2)
    v_add_f32 v16, v16, v17
    v_add_f32 v18, v18, v19
    s_waitcnt lgkmcnt(0)
    v_add_f32 v20, v20, v21
    v_add_f32 v22, v22, v23
    v_add_f32 v28, v16, v18
    s_mov_b64 exec, s[12:13]
    v_add_f32 v30, v20, v22
    s_cmp_ge_u32 s3, 4
    s_cbranch_scc1 L_f5
    buffer_store_dwordx4 v[28:31], v5, s[36:39], s33 offen
    s_mov_b64 exec, -1
    s_waitcnt vmcnt(1)
    ds_read_b64_tr_b16 v[48:49], v9 offset:32768
    ds_read_b64_tr_b16 v[50:51], v9 offset:33280
    ds_read_b64_tr_b16 v[52:53], v9 offset:33792
    ds_read_b64_tr_b16 v[54:55], v9 offset:34304
L_tf2:
    s_cbranch_execz L_tfback
    ds_read_b64_tr_b16 v[56:57], v9 offset:34816
    ds_read_b64_tr_b16 v[58:59], v9 offset:35328
    ds_read_b64_tr_b16 v[60:61], v9 offset:35840
    ds_read_b64_tr_b16 v[62:63], v9 offset:36352
    s_sleep 3
L_fx:
    buffer_load_dwordx4 v[64:67], v15, s[36:39], s61 offen offset:0 sc1
    buffer_load_dwordx4 v[68:71], v15, s[36:39], s61 offen offset:2048 sc1
    s_add_u32 s64, s64, 1
    s_cmp_ge_u32 s64, 8
    s_cselect_b32 s6, 114688, 0
    s_add_u32 s61, s61, s6
    s_min_u32 s61, s61, s62
    s_add_u32 s65, s65, 1
    s_lshr_b32 s34, s65, 17
    s_cbranch_scc1 L_fx_ok
    s_waitcnt vmcnt(1)
    v_bitop3_b32 v20, v65, v67, v31 bitop3:0x7e
    s_waitcnt vmcnt(0)
    v_add_f32 v16, v64, v68
    v_add_f32 v18, v66, v70
    v_bitop3_b32 v21, v69, v71, v31 bitop3:0x7e
    v_or_b32 v20, v20, v21
L_tf3:
    s_cbranch_execz L_tfback
    v_cmp_ne_u32 vcc, 0, v20
    v_permlane32_swap_b32 v16, v18
    s_cbranch_vccnz L_fxr
L_fx_ok:
    v_add_f32 v16, v16, v18
    v_cvt_pk_bf16_f32 v16, v16, v16
    v_and_b32 v16, 0xffff0000, v16
    v_mov_b32 v18, v16
    v_mul_f32 v17, 0xbfb8aa3b, v16
    v_exp_f32 v17, v17
    s_nop 0
    v_add_f32 v17, 1.0, v17
    v_rcp_f32 v17, v17
    s_nop 0
    v_permlane32_swap_b32 v16, v18
    v_mul_f32 v17, v17, v16
    v_cvt_pk_bf16_f32 v17, v17, v17
    v_and_b32 v17, 0xffff0000, v17
    v_mul_f32 v17, v17, v18
    s_nop 1
    v_mov_b32_dpp v18, v17 quad_perm:[1,0,3,2] row_mask:0xf bank_mask:0xf
    v_cvt_pk_bf16_f32 v17, v17, v18
    s_nop 0
    v_readlane_b32 s44, v17, 0
L_tf4:
    s_cbranch_execz L_tfback
    v_readlane_b32 s45, v17, 2
    v_readlane_b32 s46, v17, 4
    v_readlane_b32 s47, v17, 6
    v_readlane_b32 s48, v17, 8
    v_readlane_b32 s49, v17, 10
    v_readlane_b32 s50, v17, 12
    v_readlane_b32 s51, v17, 14
    v_readlane_b32 s52, v17, 16
    v_readlane_b32 s53, v17, 18
    v_readlane_b32 s54, v17, 20
    v_readlane_b32 s55, v17, 22
    v_readlane_b32 s56, v17, 24
    v_readlane_b32 s57, v17, 26
    v_readlane_b32 s58, v17, 28
    v_readlane_b32 s59, v17, 30
    s_waitcnt lgkmcnt(0)
L_tf5:
    s_cbranch_execz L_tfback
    v_dot2c_f32_bf16 v24, s44, v48
    v_dot2c_f32_bf16 v25, s45, v49
    v_dot2c_f32_bf16 v24, s46, v50
    v_dot2c_f32_bf16 v25, s47, v51
    v_dot2c_f32_bf16 v24, s48, v52
    v_dot2c_f32_bf16 v25, s49, v53
    v_dot2c_f32_bf16 v24, s50, v54
    v_dot2c_f32_bf16 v25, s51, v55
    v_dot2c_f32_bf16 v24, s52, v56
    v_dot2c_f32_bf16 v25, s53, v57
    v_dot2c_f32_bf16 v24, s54, v58
    v_dot2c_f32_bf16 v25, s55, v59
    v_dot2c_f32_bf16 v24, s56, v60
    v_dot2c_f32_bf16 v25, s57, v61
    v_dot2c_f32_bf16 v24, s58, v62
    v_dot2c_f32_bf16 v25, s59, v63
    s_nop 2
    v_add_f32 v30, v24, v25
    buffer_store_dwordx2 v[30:31], v13, s[36:39], s8 offen sc1
.set L_tf6, L_tfback
.set L_tf7, L_tfback
L_fend:
    s_cmp_lg_u32 s35, 0
    s_cbranch_scc1 L_fexit
    s_barrier
    ds_read_b32 v26, v14 offset:8
    s_mov_b32 s35, 1
    s_waitcnt lgkmcnt(0)
    v_readfirstlane_b32 s6, v26
    s_cmp_eq_u32 s6, s43
    s_mov_b32 s43, s6
    s_cbranch_scc0 L_redo
L_fexit:
    s_endpgm
L_f5:
    s_add_u32 s33, s33, 114688
    buffer_store_dwordx4 v[28:31], v5, s[36:39], s33 offen sc1
    s_mov_b64 exec, -1
    s_branch L_fend
L_fxr:
    ds_read_b32 v26, v14 offset:8
    s_waitcnt lgkmcnt(0)
    v_readfirstlane_b32 s6, v26
    s_cmp_eq_u32 s6, 0
    s_cbranch_scc1 L_fx
    s_cmp_eq_u32 s6, s43
    s_cbranch_scc1 L_fx
    s_branch L_fend
L_fh:
    s_waitcnt lgkmcnt(0)
    v_mov_b32 v31, 0
    global_load_dword v30, v31, s[30:31]
    s_mov_b32 s64, 0x9E3779B1
    s_mov_b32 s36, s30
    s_mov_b32 s37, s31
    s_mov_b32 s38, 0x1000000
    s_mov_b32 s39, 0x20000
    s_mov_b32 s65, 0
    v_mov_b32 v14, 51200
    v_mov_b32 v6, 0
    ds_write_b32 v14, v6 offset:8
    s_and_b32 s61, s2, 7
    s_mul_i32 s61, s61, 2048
    s_add_u32 s61, s61, 65536
    s_add_u32 s62, s61, 1024
    s_sleep 46
    s_waitcnt vmcnt(0)
    v_mul_lo_u32 v31, v30, s64
    v_add_u32 v31, 0x7F4A7C15, v31
    s_branch L_poll10_1
L_poll10:
    s_sleep 4
L_poll10_1:
    buffer_load_dwordx4 v[20:23], v5, s[36:39], s61 offen sc1
    s_add_u32 s61, s61, 1024
    s_min_u32 s61, s61, s62
    s_add_u32 s65, s65, 1
    s_lshr_b32 s34, s65, 17
    s_waitcnt vmcnt(0)
    s_cbranch_scc1 L_poll10_ok
    v_cmp_ne_u32 vcc, v31, v21
    v_cmp_ne_u32 s[12:13], v31, v23
    s_or_b64 vcc, vcc, s[12:13]
    s_cbranch_vccnz L_poll10
L_poll10_ok:
    v_max_u32 v20, v20, v22
    s_nop 1
    v_max_u32_dpp v20, v20, v20 row_ror:8 row_mask:0xf bank_mask:0xf
    s_nop 1
    v_max_u32_dpp v20, v20, v20 row_ror:4 row_mask:0xf bank_mask:0xf
    s_nop 1
    v_max_u32_dpp v20, v20, v20 row_ror:2 row_mask:0xf bank_mask:0xf
    s_nop 1
    v_max_u32_dpp v20, v20, v20 row_ror:1 row_mask:0xf bank_mask:0xf
    s_nop 1
    v_max_u32_dpp v20, v20, v20 row_bcast:15 row_mask:0xa bank_mask:0xf
    s_nop 1
    v_max_u32_dpp v20, v20, v20 row_bcast:31 row_mask:0xc bank_mask:0xf
    v_mov_b32 v9, 51200
    s_mov_b32 exec_lo, 0
    s_brev_b32 exec_hi, 1
    ds_write2_b32 v9, v20, v31 offset1:1
    s_mov_b64 exec, -1
    s_waitcnt lgkmcnt(0)
    s_barrier
    v_mov_b32 v9, 51208
    s_mov_b32 exec_lo, 0
    s_brev_b32 exec_hi, 1
    ds_write_b32 v9, v20
    s_mov_b64 exec, -1
    s_waitcnt lgkmcnt(0)
    s_barrier
    s_endpgm
L_end:
    s_endpgm
.section .rodata,"a"
.p2align 6
.amdhsa_kernel gated_mix__spectral_fnet__moe_arch_mod__prompt_kernel
  .amdhsa_next_free_vgpr 168
  .amdhsa_next_free_sgpr 72
  .amdhsa_accum_offset 168
  .amdhsa_group_segment_fixed_size 0
  .amdhsa_kernarg_size 112
  .amdhsa_user_sgpr_count 2
  .amdhsa_user_sgpr_kernarg_segment_ptr 1
  .amdhsa_system_sgpr_workgroup_id_x 1
.end_amdhsa_kernel
```

```asm
; @launch grid=(256,1,1) block=(576,1,1) lds=86016
.amdgcn_target "amdgcn-amd-amdhsa--gfx950"
.text
.globl gated_mix__spectral_fnet__moe_arch_mod__prompt_kernel
.p2align 8
.type gated_mix__spectral_fnet__moe_arch_mod__prompt_kernel,@function
gated_mix__spectral_fnet__moe_arch_mod__prompt_kernel:
    s_load_dwordx2 s[4:5], s[0:1], 0
    s_load_dwordx16 s[16:31], s[0:1], 48
    s_cmp_ge_u32 s2, 8
    s_cbranch_scc1 L_nocpf0
    s_getpc_b64 s[12:13]
L_pc0:
    v_lshlrev_b32 v6, 7, v0
    v_min_u32 v6, L_end - L_pc0, v6
    v_mov_b32 v13, s13
    v_add_co_u32 v12, vcc, s12, v6
    s_nop 1
    v_addc_co_u32 v13, vcc, 0, v13, vcc
    global_load_dword v164, v[12:13], off
L_nocpf0:
    v_lshrrev_b32 v1, 6, v0
    v_and_b32 v0, 63, v0
    v_readfirstlane_b32 s3, v1
    v_and_b32 v1, 15, v0
    v_lshrrev_b32 v2, 4, v0
    s_and_b32 s6, s2, 7
    s_sub_u32 s3, s3, 1
    s_min_u32 s3, s3, 8
    s_lshr_b32 s7, s2, 3
    s_cmp_ge_u32 s2, 128
    s_cbranch_scc1 L_notA
    s_add_u32 s8, s6, 1
    s_sub_u32 s9, 15, s6
    s_cmp_eq_u32 s3, 8
    s_cbranch_scc1 L_ah
    s_and_b32 s57, s7, 1
    s_bitcmp1_b32 s7, 1
    s_cselect_b32 s10, s9, s8
    s_lshr_b32 s11, s7, 2
    s_lshl4_add_u32 s56, s11, s10
    v_lshlrev_b32 v5, 4, v0
    v_mov_b32 v3, 0
    s_cmp_lg_u32 s6, 7
    s_cbranch_scc1 L_k7
    s_lshr_b32 s11, s7, 1
    s_lshl3_add_u32 s56, s11, 8
    s_mov_b32 s8, 0
    s_cmp_eq_u32 s2, 127
    s_cselect_b32 s56, 0, s56
    s_cselect_b32 s57, 0, s57
L_k7:
    s_lshl3_add_u32 s11, s57, s3
    s_lshl_b32 s11, s11, 7
    s_add_u32 s58, s11, s56
    s_sub_u32 s59, 2048, s58
    s_cmp_eq_u32 s58, 0
    s_cselect_b32 s59, 1024, s59
    s_lshl_b32 s10, s58, 10
    s_lshl_b32 s11, s59, 10
    v_add_u32 v6, s10, v5
    v_add_u32 v7, s11, v5
    s_waitcnt lgkmcnt(0)
    global_load_dwordx4 v[16:19], v6, s[4:5]
    global_load_dwordx4 v[20:23], v7, s[4:5]
L_ta_start:
    s_barrier
    s_bitcmp1_b32 s7, 3
    s_cselect_b32 s8, s9, s8
    s_and_b32 s9, s7, 7
    s_lshl3_add_u32 s51, s8, s9
    s_lshl_b32 s35, s8, 5
    s_add_u32 s35, s35, s9
    s_lshl_b32 s35, s35, 6
    s_lshr_b32 s6, s3, 2
    s_and_b32 s7, s3, 1
    s_bfe_u32 s8, s3, 0x10001
    v_lshl_add_u32 v6, s6, 4, v1
    s_lshl3_add_u32 s9, s8, s7
    s_lshl_b32 s9, s9, 2
    v_cvt_f32_u32 v6, v6
    v_lshl_add_u32 v7, v2, 3, s9
    v_mul_f32 v6, 0x3c000000, v6
    v_cvt_f32_u32 v7, v7
    v_mul_f32 v7, v7, v6
    v_cos_f32 v96, v7
    v_sin_f32 v100, v7
    v_add_f32 v7, v7, v6
    v_cos_f32 v97, v7
    v_sin_f32 v101, v7
    v_add_f32 v7, v7, v6
    v_cos_f32 v98, v7
    v_sin_f32 v102, v7
    v_add_f32 v7, v7, v6
    v_cos_f32 v99, v7
    v_sin_f32 v103, v7
    s_lshl_b32 s10, s6, 13
    s_lshl_b32 s11, s8, 10
    s_lshl3_add_u32 s11, s7, s11
    v_add_u32 v15, s10, v5
    v_add_u32 v9, s11, v15
    v_cvt_pk_bf16_f32 v104, v96, v97
    v_cvt_pk_bf16_f32 v105, v98, v99
    v_cvt_pk_bf16_f32 v106, -v100, -v101
    v_cvt_pk_bf16_f32 v107, -v102, -v103
    v_cmp_eq_f32 vcc, 0, v6
    v_cvt_pk_bf16_f32 v108, v96, -v101
    v_cvt_pk_bf16_f32 v109, -v98, v103
    v_cvt_pk_bf16_f32 v110, -v100, -v97
    v_cvt_pk_bf16_f32 v111, v102, v99
    ds_write_b64 v9, v[104:105] offset:16384
    ds_write_b64 v9, v[108:109] offset:20480
    ds_write_b64 v9, v[110:111] offset:22528
    s_mov_b64 exec, vcc
    v_mov_b32 v106, 0xbf803f80
    v_mov_b32 v107, 0xbf803f80
    s_mov_b64 exec, -1
    ds_write_b64 v9, v[106:107] offset:18432
    global_load_dwordx4 v[24:27], v5, s[16:17]
    s_lshl_b32 s10, s3, 11
    s_add_u32 s11, s10, s51
    s_lshl_b32 s11, s11, 7
    s_mov_b32 m0, s10
    v_and_b32 v9, 7, v0
    v_bfe_u32 v13, v0, 4, 1
    v_xor_b32 v9, v9, v13
    v_lshrrev_b32 v13, 3, v0
    v_lshl_add_u32 v9, v9, 4, s11
    v_lshl_add_u32 v13, v13, 14, v9
    global_load_lds_dwordx4 v13, s[4:5]
    s_add_u32 m0, s10, 1024
    v_add_u32 v13, 0x20000, v13
    global_load_lds_dwordx4 v13, s[4:5]
    v_mov_b32 v12, 0
    v_mov_b32 v13, 0
    s_waitcnt vmcnt(2)
    v_dot2c_f32_bf16 v12, v16, v24
    v_dot2c_f32_bf16 v13, v20, v24
    v_dot2c_f32_bf16 v12, v17, v25
    v_dot2c_f32_bf16 v13, v21, v25
    v_dot2c_f32_bf16 v12, v18, v26
    v_dot2c_f32_bf16 v13, v22, v26
    v_dot2c_f32_bf16 v12, v19, v27
    v_dot2c_f32_bf16 v13, v23, v27
    s_sub_u32 s10, 0xffff, s58
    s_sub_u32 s11, 0xffff, s59
    v_mov_b32 v4, s10
    v_permlane32_swap_b32 v12, v13
    v_add_f32 v12, v12, v13
    v_mov_b32 v13, v12
    v_writelane_b32 v4, s11, 32
    v_mov_b32 v9, 33792
    v_permlane16_swap_b32 v12, v13
    v_add_f32 v12, v12, v13
    v_lshlrev_b32 v8, 31, v1
    v_lshrrev_b32 v7, 16, v8
    v_add_f32_dpp v12, v12, v12 row_ror:8 row_mask:0xf bank_mask:0xf
    v_or_b32 v8, v8, v7
    v_bfe_u32 v6, v0, 2, 2
    v_add_f32_dpp v12, v12, v12 row_ror:4 row_mask:0xf bank_mask:0xf
    v_and_b32 v14, 3, v0
    v_lshl_add_u32 v14, v14, 1, s8
    v_add_f32_dpp v12, v12, v12 row_ror:2 row_mask:0xf bank_mask:0xf
    v_lshl_add_u32 v10, v2, 3, v6
    v_lshrrev_b32 v6, 1, v6
    v_add_f32_dpp v12, v12, v12 row_ror:1 row_mask:0xf bank_mask:0xf
    v_cvt_pk_bf16_f32 v12, v12, v12
    v_and_b32 v12, 0xffff0000, v12
    v_xor_b32 v14, v14, v6
    v_ashrrev_i32 v7, 31, v12
    v_or_b32 v7, 0x80000000, v7
    v_xor_b32 v7, v7, v12
    v_and_b32 v7, 0xffff0000, v7
    v_or_b32 v7, v7, v4
    s_mov_b32 exec_lo, 1
    s_mov_b32 exec_hi, 1
    ds_max_u32 v9, v7
    s_mov_b64 exec, -1
    s_waitcnt lgkmcnt(0)
    s_barrier
    ds_read_b128 v[32:35], v15 offset:16384
    ds_read_b128 v[48:51], v15 offset:18432
    ds_read_b128 v[64:67], v15 offset:20480
    ds_read_b128 v[80:83], v15 offset:22528
    ds_read_b128 v[36:39], v15 offset:17408
    ds_read_b128 v[52:55], v15 offset:19456
    ds_read_b128 v[68:71], v15 offset:21504
    ds_read_b128 v[84:87], v15 offset:23552
    s_lshl_b32 s7, s7, 3
    v_lshl_add_u32 v14, v14, 4, s7
    v_lshl_add_u32 v10, v10, 7, v14
    v_lshlrev_b32 v9, 4, v2
    s_waitcnt vmcnt(0)
    s_barrier
    s_waitcnt lgkmcnt(5)
    ds_read_b128 v[28:31], v9 offset:33920
    ds_read_b64_tr_b16 v[96:97], v10 offset:0
    ds_read_b64_tr_b16 v[98:99], v10 offset:512
    ds_read_b64_tr_b16 v[100:101], v10 offset:4096
    ds_read_b64_tr_b16 v[102:103], v10 offset:4608
    ds_read_b64_tr_b16 v[104:105], v10 offset:8192
    ds_read_b64_tr_b16 v[106:107], v10 offset:8704
    ds_read_b64_tr_b16 v[108:109], v10 offset:12288
    ds_read_b64_tr_b16 v[110:111], v10 offset:12800
    global_load_dwordx4 v[24:27], v5, s[24:25]
    s_waitcnt lgkmcnt(6)
    v_mfma_f32_16x16x32_bf16 v[112:115], v[96:99], v[32:35], 0
    v_xor_b32 v40, v32, v8
    v_xor_b32 v41, v33, v8
    v_xor_b32 v42, v34, v8
    v_xor_b32 v43, v35, v8
    v_mfma_f32_16x16x32_bf16 v[116:119], v[96:99], v[48:51], 0
    v_xor_b32 v56, v48, v8
    v_xor_b32 v57, v49, v8
    v_xor_b32 v58, v50, v8
    v_xor_b32 v59, v51, v8
    v_mfma_f32_16x16x32_bf16 v[120:123], v[96:99], v[64:67], 0
    v_xor_b32 v72, v64, v8
    v_xor_b32 v73, v65, v8
    v_xor_b32 v74, v66, v8
    v_xor_b32 v75, v67, v8
    v_mfma_f32_16x16x32_bf16 v[124:127], v[96:99], v[80:83], 0
    v_xor_b32 v88, v80, v8
    v_xor_b32 v89, v81, v8
    v_xor_b32 v90, v82, v8
    v_xor_b32 v91, v83, v8
    s_waitcnt lgkmcnt(4)
    v_mfma_f32_16x16x32_bf16 v[112:115], v[100:103], v[36:39], v[112:115]
    v_xor_b32 v44, v36, v8
    v_xor_b32 v45, v37, v8
    v_xor_b32 v46, v38, v8
    v_xor_b32 v47, v39, v8
    v_mfma_f32_16x16x32_bf16 v[116:119], v[100:103], v[52:55], v[116:119]
    v_xor_b32 v60, v52, v8
    v_xor_b32 v61, v53, v8
    v_xor_b32 v62, v54, v8
    v_xor_b32 v63, v55, v8
    v_mfma_f32_16x16x32_bf16 v[120:123], v[100:103], v[68:71], v[120:123]
    v_xor_b32 v76, v68, v8
    v_xor_b32 v77, v69, v8
    v_xor_b32 v78, v70, v8
    v_xor_b32 v79, v71, v8
    v_mfma_f32_16x16x32_bf16 v[124:127], v[100:103], v[84:87], v[124:127]
    v_xor_b32 v92, v84, v8
    v_xor_b32 v93, v85, v8
    v_xor_b32 v94, v86, v8
    v_xor_b32 v95, v87, v8
    s_waitcnt lgkmcnt(2)
    v_mfma_f32_16x16x32_bf16 v[112:115], v[104:107], v[40:43], v[112:115]
    s_mul_i32 s44, s6, 528384
    s_add_u32 s44, s44, s35
    v_mfma_f32_16x16x32_bf16 v[116:119], v[104:107], v[56:59], v[116:119]
    s_and_b32 s10, s3, 3
    s_lshl_b32 s10, s10, 9
    v_mfma_f32_16x16x32_bf16 v[120:123], v[104:107], v[72:75], v[120:123]
    s_add_u32 s44, s44, s10
    s_add_u32 s44, s44, 2097152
    v_mfma_f32_16x16x32_bf16 v[124:127], v[104:107], v[88:91], v[124:127]
    s_mov_b32 s36, s30
    s_mov_b32 s37, s31
    s_waitcnt lgkmcnt(0)
    v_mfma_f32_16x16x32_bf16 v[112:115], v[108:111], v[44:47], v[112:115]
    s_mov_b32 s38, 0x1000000
    s_mov_b32 s39, 0x20000
    v_mfma_f32_16x16x32_bf16 v[116:119], v[108:111], v[60:63], v[116:119]
    s_add_u32 s45, s44, 1056768
    s_mov_b32 s11, 0xfffefffe
    v_mfma_f32_16x16x32_bf16 v[120:123], v[108:111], v[76:79], v[120:123]
    s_mov_b32 s10, 0x07060302
    v_mul_u32_u24 v11, 33024, v1
    v_mfma_f32_16x16x32_bf16 v[124:127], v[108:111], v[92:95], v[124:127]
    v_lshl_add_u32 v11, v2, 4, v11
    v_mov_b32 v12, 0
    v_mov_b32 v13, 0
    v_add_u32 v112, 0x10000, v112
    v_add_u32 v113, 0x10000, v113
    v_add_u32 v114, 0x10000, v114
    v_add_u32 v115, 0x10000, v115
    v_add_u32 v116, 0x10000, v116
    v_add_u32 v117, 0x10000, v117
    v_add_u32 v118, 0x10000, v118
    v_add_u32 v119, 0x10000, v119
    v_perm_b32 v96, v116, v112, s10
    v_perm_b32 v97, v117, v113, s10
    v_perm_b32 v98, v118, v114, s10
    v_perm_b32 v99, v119, v115, s10
    v_and_or_b32 v96, v96, s11, v28
    v_and_or_b32 v97, v97, s11, v29
    v_and_or_b32 v98, v98, s11, v30
    v_and_or_b32 v99, v99, s11, v31
    buffer_store_dwordx4 v[96:99], v11, s[36:39], s44 offen sc1
    v_add_u32 v120, 0x10000, v120
    v_add_u32 v121, 0x10000, v121
    v_add_u32 v122, 0x10000, v122
    v_add_u32 v123, 0x10000, v123
    v_add_u32 v124, 0x10000, v124
    v_add_u32 v125, 0x10000, v125
    v_add_u32 v126, 0x10000, v126
    v_add_u32 v127, 0x10000, v127
    v_perm_b32 v100, v124, v120, s10
    v_perm_b32 v101, v125, v121, s10
    v_perm_b32 v102, v126, v122, s10
    v_perm_b32 v103, v127, v123, s10
    v_and_or_b32 v100, v100, s11, v28
    v_and_or_b32 v101, v101, s11, v29
    v_and_or_b32 v102, v102, s11, v30
    v_and_or_b32 v103, v103, s11, v31
    buffer_store_dwordx4 v[100:103], v11, s[36:39], s45 offen sc1
    s_mov_b32 s65, 0
    s_mov_b32 s55, 0
L_ta_end:
    s_mov_b32 s40, s26
    s_mov_b32 s41, s27
    s_mov_b32 s42, 0x200000
    s_mov_b32 s43, 0x20000
    s_cmp_ge_u32 s3, 4
    s_cbranch_scc1 L_hi0
    s_setprio 2
    v_lshlrev_b32 v6, 4, v1
    v_lshl_add_u32 v10, v2, 13, v6
    v_mul_u32_u24 v6, 4352, v2
    v_bfe_u32 v7, v1, 1, 2
    v_xor_b32 v7, s3, v7
    v_lshl_add_u32 v7, v7, 4, v6
    v_lshl_add_u32 v11, v1, 6, v7
    s_lshl4_add_u32 s7, s3, 1024
    v_mov_b32 v9, 17600
    v_lshl_add_u32 v28, v0, 1, v9
    v_lshl_add_u32 v7, v1, 1, s7
    s_mov_b32 exec_lo, 0x00ff00ff
    s_mov_b32 exec_hi, 0x00ff00ff
    v_add_u32 v28, v7, v6
    s_mov_b64 exec, -1
    s_and_b32 s7, s56, 63
    s_mul_i32 s32, s7, 33024
    s_lshl_b32 s7, s3, 9
    s_add_u32 s32, s32, s7
    s_add_u32 s32, s32, 2097152
    s_add_u32 s33, s32, 4096
    v_lshrrev_b32 v6, 1, v1
    s_lshl_b32 s6, s57, 10
    s_add_u32 s6, s6, s56
    v_lshl_add_u32 v6, v6, 7, s6
    v_and_b32 v7, 1, v1
    v_lshlrev_b32 v9, 9, v7
    s_cmp_lg_u32 s56, 0
    s_cbranch_scc1 L_g01
    s_mov_b32 exec_lo, 0x00020002
    s_mov_b32 exec_hi, 0x00020002
    v_mov_b32 v6, 0x400
    v_mov_b32 v9, 0
    s_mov_b64 exec, -1
L_g01:
    v_lshlrev_b32 v7, 2, v2
    v_mad_u32_u24 v9, v7, v6, v9
    v_cvt_f32_u32 v6, v6
    v_cvt_f32_u32 v9, v9
    v_mul_f32 v6, 0x3a000000, v6
    v_mul_f32 v9, 0x3a000000, v9
    v_cos_f32 v64, v9
    v_sin_f32 v68, v9
    v_add_f32 v9, v9, v6
    v_cos_f32 v65, v9
    v_sin_f32 v69, v9
    v_add_f32 v9, v9, v6
    v_cos_f32 v66, v9
    v_sin_f32 v70, v9
    v_add_f32 v9, v9, v6
    v_cos_f32 v67, v9
    v_sin_f32 v71, v9
    s_and_b32 s7, s56, 63
    s_nop 0
    v_cvt_pk_bf16_f32 v148, v64, v68
    v_cvt_pk_bf16_f32 v149, v65, v69
    v_cvt_pk_bf16_f32 v150, v66, v70
    v_cvt_pk_bf16_f32 v151, v67, v71
    s_cmp_lg_u32 s7, 0
    s_cbranch_scc1 L_gd2
    s_lshr_b32 s7, s56, 2
    v_and_b32 v148, 0xffff, v148
    v_lshlrev_b32 v148, s7, v148
    v_and_b32 v149, 0xffff, v149
    v_lshlrev_b32 v149, s7, v149
    v_and_b32 v150, 0xffff, v150
    v_lshlrev_b32 v150, s7, v150
    v_and_b32 v151, 0xffff, v151
    v_lshlrev_b32 v151, s7, v151
L_gd2:
    v_and_b32 v6, 3, v1
    v_lshlrev_b32 v6, 4, v6
    ds_read_b128 v[96:99], v6 offset:33920
    s_waitcnt lgkmcnt(0)
    v_cvt_f32_u32 v6, v1
    s_lshl_b32 s6, s3, 2
    v_lshl_add_u32 v7, v2, 6, s6
    v_mul_f32 v6, 0x3b000000, v6
    v_cvt_f32_u32 v7, v7
    v_mul_f32 v15, 0x41800000, v6
    v_mul_f32 v7, v7, v6
    v_cos_f32 v64, v7
    v_sin_f32 v68, v7
    v_add_f32 v9, v7, v15
    v_cos_f32 v65, v9
    v_sin_f32 v69, v9
    v_add_f32 v9, v9, v15
    v_cos_f32 v66, v9
    v_sin_f32 v70, v9
    v_add_f32 v9, v9, v15
    v_cos_f32 v67, v9
    v_sin_f32 v71, v9
    v_mov_b32 v108, 0
    v_cvt_pk_bf16_f32 v100, v64, v65
    v_cvt_pk_bf16_f32 v104, -v68, -v69
    v_cvt_pk_bf16_f32 v101, v66, v67
    v_cvt_pk_bf16_f32 v105, -v70, -v71
    v_xor_b32 v102, v100, v8
    v_xor_b32 v106, v104, v8
    v_xor_b32 v103, v101, v8
    v_xor_b32 v107, v105, v8
    v_add_f32 v7, v7, v6
    v_cos_f32 v64, v7
    v_sin_f32 v68, v7
    v_add_f32 v9, v7, v15
    v_cos_f32 v65, v9
    v_sin_f32 v69, v9
    v_add_f32 v9, v9, v15
    v_cos_f32 v66, v9
    v_sin_f32 v70, v9
    v_add_f32 v9, v9, v15
    v_cos_f32 v67, v9
    v_sin_f32 v71, v9
    v_mov_b32 v120, 0
    v_cvt_pk_bf16_f32 v112, v64, v65
    v_cvt_pk_bf16_f32 v116, -v68, -v69
    v_cvt_pk_bf16_f32 v113, v66, v67
    v_cvt_pk_bf16_f32 v117, -v70, -v71
    v_xor_b32 v114, v112, v8
    v_xor_b32 v118, v116, v8
    v_xor_b32 v115, v113, v8
    v_xor_b32 v119, v117, v8
    v_add_f32 v7, v7, v6
    v_cos_f32 v64, v7
    v_sin_f32 v68, v7
    v_add_f32 v9, v7, v15
    v_cos_f32 v65, v9
    v_sin_f32 v69, v9
    v_add_f32 v9, v9, v15
    v_cos_f32 v66, v9
    v_sin_f32 v70, v9
    v_add_f32 v9, v9, v15
    v_cos_f32 v67, v9
    v_sin_f32 v71, v9
    v_mov_b32 v132, 0
    v_cvt_pk_bf16_f32 v124, v64, v65
    v_cvt_pk_bf16_f32 v128, -v68, -v69
    v_cvt_pk_bf16_f32 v125, v66, v67
    v_cvt_pk_bf16_f32 v129, -v70, -v71
    v_xor_b32 v126, v124, v8
    v_xor_b32 v130, v128, v8
    v_xor_b32 v127, v125, v8
    v_xor_b32 v131, v129, v8
    v_add_f32 v7, v7, v6
    v_cos_f32 v64, v7
    v_sin_f32 v68, v7
    v_add_f32 v9, v7, v15
    v_cos_f32 v65, v9
    v_sin_f32 v69, v9
    v_add_f32 v9, v9, v15
    v_cos_f32 v66, v9
    v_sin_f32 v70, v9
    v_add_f32 v9, v9, v15
    v_cos_f32 v67, v9
    v_sin_f32 v71, v9
    v_mov_b32 v144, 0
    v_cvt_pk_bf16_f32 v136, v64, v65
    v_cvt_pk_bf16_f32 v140, -v68, -v69
    v_cvt_pk_bf16_f32 v137, v66, v67
    v_cvt_pk_bf16_f32 v141, -v70, -v71
    v_xor_b32 v138, v136, v8
    v_xor_b32 v142, v140, v8
    v_xor_b32 v139, v137, v8
    v_xor_b32 v143, v141, v8
    v_lshrrev_b32 v6, 1, v1
    v_add_u32 v7, s6, v6
    v_and_b32 v9, 1, v1
    v_lshl_add_u32 v7, v9, 3, v7
    v_cvt_f32_u32 v7, v7
    v_mul_f32 v7, 0x3d000000, v7
    v_cos_f32 v7, v7
    s_mov_b32 exec_lo, 0x30003
    s_mov_b32 exec_hi, 0x30003
    v_cvt_pk_bf16_f32 v108, v7, -v7
    s_mov_b32 exec_lo, 0xc000c
    s_mov_b32 exec_hi, 0xc000c
    v_cvt_pk_bf16_f32 v120, v7, -v7
    s_mov_b32 exec_lo, 0x300030
    s_mov_b32 exec_hi, 0x300030
    v_cvt_pk_bf16_f32 v132, v7, -v7
    s_mov_b32 exec_lo, 0xc000c0
    s_mov_b32 exec_hi, 0xc000c0
    v_cvt_pk_bf16_f32 v144, v7, -v7
    s_mov_b64 exec, -1
    v_mov_b32 v109, v108
    v_mov_b32 v110, v108
    v_mov_b32 v111, v108
    v_mov_b32 v121, v120
    v_mov_b32 v122, v120
    v_mov_b32 v123, v120
    v_mov_b32 v133, v132
    v_mov_b32 v134, v132
    v_mov_b32 v135, v132
    v_mov_b32 v145, v144
    v_mov_b32 v146, v144
    v_mov_b32 v147, v144
    s_waitcnt vmcnt(2)
    v_dot2c_f32_bf16 v12, v16, v24
    v_dot2c_f32_bf16 v13, v20, v24
    v_dot2c_f32_bf16 v12, v17, v25
    v_dot2c_f32_bf16 v13, v21, v25
    v_dot2c_f32_bf16 v12, v18, v26
    v_dot2c_f32_bf16 v13, v22, v26
    v_dot2c_f32_bf16 v12, v19, v27
    v_dot2c_f32_bf16 v13, v23, v27
    s_nop 2
    v_permlane32_swap_b32 v12, v13
    v_add_f32 v12, v12, v13
    v_mov_b32 v13, v12
    s_nop 1
    v_permlane16_swap_b32 v12, v13
    v_add_f32 v12, v12, v13
    s_nop 1
    v_add_f32_dpp v12, v12, v12 row_ror:8 row_mask:0xf bank_mask:0xf
    s_nop 1
    v_add_f32_dpp v12, v12, v12 row_ror:4 row_mask:0xf bank_mask:0xf
    s_nop 1
    v_add_f32_dpp v12, v12, v12 row_ror:2 row_mask:0xf bank_mask:0xf
    s_nop 1
    v_add_f32_dpp v12, v12, v12 row_ror:1 row_mask:0xf bank_mask:0xf
    v_cvt_pk_bf16_f32 v12, v12, v12
    v_and_b32 v12, 0xffff0000, v12
    s_lshl_b32 s6, s3, 11
    v_add_u32 v6, s6, v5
    ds_write_b128 v6, v[16:19] offset:48832
    ds_write_b128 v6, v[20:23] offset:49856
    v_lshl_add_u32 v7, v1, 6, s6
    v_lshl_add_u32 v7, v2, 3, v7
    s_waitcnt lgkmcnt(0)
    ds_read_b64 v[16:17], v7 offset:48832
    ds_read_b64 v[18:19], v7 offset:48864
    ds_read_b64 v[20:21], v7 offset:49856
    ds_read_b64 v[22:23], v7 offset:49888
    v_and_b32 v6, 1, v2
    v_lshlrev_b32 v6, 5, v6
    v_lshl_add_u32 v6, v1, 6, v6
    v_lshrrev_b32 v7, 1, v2
    v_lshl_add_u32 v3, v7, 4, v6
    v_mul_f32 v13, 0xbfb8aa3b, v12
    v_exp_f32 v13, v13
    s_nop 0
    v_add_f32 v13, 1.0, v13
    v_rcp_f32 v13, v13
    s_nop 0
    v_cvt_pk_bf16_f32 v13, v13, v13
    v_and_b32 v13, 0xffff0000, v13
    v_sub_f32 v14, 1.0, v13
    v_cvt_pk_bf16_f32 v14, v14, v14
    v_and_b32 v14, 0xffff0000, v14
    v_readlane_b32 s6, v13, 0
    v_readlane_b32 s7, v13, 32
    v_readlane_b32 s8, v14, 0
    v_readlane_b32 s9, v14, 32
    s_xor_b32 s10, s6, 0x80000000
    s_cmp_eq_u32 s58, 0
    s_cselect_b32 s10, 0, s10
    s_cselect_b32 s11, 0, s7
    v_mov_b32 v24, s6
    v_mov_b32 v25, s10
    v_mov_b32 v26, s11
    v_mov_b32 v27, s7
    v_mov_b32 v13, s8
    v_mov_b32 v14, s9
    s_waitcnt lgkmcnt(0)
    v_lshlrev_b32 v152, 16, v16
    v_and_b32 v153, 0xffff0000, v16
    v_lshlrev_b32 v154, 16, v17
    v_and_b32 v155, 0xffff0000, v17
    v_lshlrev_b32 v156, 16, v18
    v_and_b32 v157, 0xffff0000, v18
    v_lshlrev_b32 v158, 16, v19
    v_and_b32 v159, 0xffff0000, v19
    v_mul_f32 v152, v13, v152
    v_mul_f32 v153, v13, v153
    v_mul_f32 v154, v13, v154
    v_mul_f32 v155, v13, v155
    v_mul_f32 v156, v13, v156
    v_mul_f32 v157, v13, v157
    v_mul_f32 v158, v13, v158
    v_mul_f32 v159, v13, v159
    v_lshlrev_b32 v160, 16, v20
    v_and_b32 v161, 0xffff0000, v20
    v_lshlrev_b32 v162, 16, v21
    v_and_b32 v163, 0xffff0000, v21
    v_lshlrev_b32 v164, 16, v22
    v_and_b32 v165, 0xffff0000, v22
    v_lshlrev_b32 v166, 16, v23
    v_and_b32 v167, 0xffff0000, v23
    v_mul_f32 v160, v14, v160
    v_mul_f32 v161, v14, v161
    v_mul_f32 v162, v14, v162
    v_mul_f32 v163, v14, v163
    v_mul_f32 v164, v14, v164
    v_mul_f32 v165, v14, v165
    v_mul_f32 v166, v14, v166
    v_mul_f32 v167, v14, v167
    s_waitcnt vmcnt(2)
    s_barrier
    s_cmp_lg_u32 s57, 0
    s_cbranch_scc1 L_stg1
    buffer_load_dwordx4 v[32:35], v10, s[36:39], s32 offen offset:0 sc1
    buffer_load_dwordx4 v[36:39], v10, s[36:39], s32 offen offset:2048 sc1
    buffer_load_dwordx4 v[40:43], v10, s[36:39], s33 offen offset:0 sc1
    buffer_load_dwordx4 v[44:47], v10, s[36:39], s33 offen offset:2048 sc1
    s_waitcnt vmcnt(2)
    buffer_load_dwordx4 v[48:51], v10, s[36:39], s32 offen offset:256 sc1
    buffer_load_dwordx4 v[52:55], v10, s[36:39], s32 offen offset:2304 sc1
    buffer_load_dwordx4 v[56:59], v10, s[36:39], s33 offen offset:256 sc1
    buffer_load_dwordx4 v[60:63], v10, s[36:39], s33 offen offset:2304 sc1
    s_branch L_stg2
L_stg1:
    buffer_load_dwordx4 v[48:51], v10, s[36:39], s32 offen offset:256 sc1
    buffer_load_dwordx4 v[52:55], v10, s[36:39], s32 offen offset:2304 sc1
    buffer_load_dwordx4 v[56:59], v10, s[36:39], s33 offen offset:256 sc1
    buffer_load_dwordx4 v[60:63], v10, s[36:39], s33 offen offset:2304 sc1
    s_waitcnt vmcnt(2)
    buffer_load_dwordx4 v[32:35], v10, s[36:39], s32 offen offset:0 sc1
    buffer_load_dwordx4 v[36:39], v10, s[36:39], s32 offen offset:2048 sc1
    buffer_load_dwordx4 v[40:43], v10, s[36:39], s33 offen offset:0 sc1
    buffer_load_dwordx4 v[44:47], v10, s[36:39], s33 offen offset:2048 sc1
    s_waitcnt vmcnt(0)
L_stg2:
    s_mul_i32 s7, s3, 2176
    v_bfe_u32 v7, v1, 1, 2
    v_xor_b32 v7, v7, v2
    v_lshl_add_u32 v7, v7, 4, s7
    v_lshl_add_u32 v29, v1, 6, v7
    v_sub_u32 v6, 16, v1
    v_bfe_u32 v7, v6, 1, 2
    v_xor_b32 v7, v7, v2
    v_lshl_add_u32 v7, v7, 4, s7
    v_lshl_add_u32 v30, v6, 6, v7
    s_cmp_eq_u32 s58, 0
    s_cselect_b32 s6, 0, 2048
    v_add_u32 v4, s6, v5
L_zjoin:
    s_waitcnt vmcnt(4)
L_got0:
    v_xor_b32 v80, v32, v96
    v_xor_b32 v81, v36, v96
    v_xor_b32 v82, v40, v96
    v_xor_b32 v83, v44, v96
L_tb0:
    s_cbranch_execz L_tbback
    v_or3_b32 v6, v80, v81, v82
    v_or_b32 v6, v6, v83
    v_mfma_f32_16x16x32_bf16 v[64:67], v[80:83], v[148:151], 0
    v_xor_b32 v84, v33, v97
    v_xor_b32 v85, v37, v97
    v_xor_b32 v86, v41, v97
    v_xor_b32 v87, v45, v97
    v_or3_b32 v6, v6, v84, v85
    v_or3_b32 v6, v6, v86, v87
    v_mfma_f32_16x16x32_bf16 v[68:71], v[84:87], v[148:151], 0
    v_xor_b32 v88, v34, v98
    v_xor_b32 v89, v38, v98
    v_xor_b32 v90, v42, v98
    v_xor_b32 v91, v46, v98
    v_or3_b32 v6, v6, v88, v89
    v_or3_b32 v6, v6, v90, v91
    v_mfma_f32_16x16x32_bf16 v[72:75], v[88:91], v[148:151], 0
    v_xor_b32 v92, v35, v99
    v_xor_b32 v93, v39, v99
    v_xor_b32 v94, v43, v99
    v_xor_b32 v95, v47, v99
    v_or3_b32 v6, v6, v92, v93
L_tb1:
    s_cbranch_execz L_tbback
    v_or3_b32 v6, v6, v94, v95
    v_and_b32 v6, 0x10001, v6
    v_cmp_ne_u32 vcc, 0, v6
    v_mfma_f32_16x16x32_bf16 v[76:79], v[92:95], v[148:151], 0
    s_cbranch_vccnz L_retry0
L_fail0:
    s_waitcnt vmcnt(0)
L_got1:
    v_xor_b32 v80, v48, v96
    v_xor_b32 v81, v52, v96
    v_xor_b32 v82, v56, v96
    v_xor_b32 v83, v60, v96
    v_or3_b32 v6, v80, v81, v82
    v_or_b32 v6, v6, v83
    v_mfma_f32_16x16x32_bf16 v[32:35], v[80:83], v[148:151], 0
    v_xor_b32 v84, v49, v97
    v_xor_b32 v85, v53, v97
    v_xor_b32 v86, v57, v97
    v_xor_b32 v87, v61, v97
    v_or3_b32 v6, v6, v84, v85
    v_or3_b32 v6, v6, v86, v87
    v_mfma_f32_16x16x32_bf16 v[36:39], v[84:87], v[148:151], 0
    v_xor_b32 v88, v50, v98
    v_xor_b32 v89, v54, v98
    v_xor_b32 v90, v58, v98
L_tb2:
    s_cbranch_execz L_tbback
    v_xor_b32 v91, v62, v98
    v_or3_b32 v6, v6, v88, v89
    v_or3_b32 v6, v6, v90, v91
    v_mfma_f32_16x16x32_bf16 v[40:43], v[88:91], v[148:151], 0
    v_xor_b32 v92, v51, v99
    v_xor_b32 v93, v55, v99
    v_xor_b32 v94, v59, v99
    v_xor_b32 v95, v63, v99
    v_or3_b32 v6, v6, v92, v93
    v_or3_b32 v6, v6, v94, v95
    v_and_b32 v6, 0x10001, v6
    v_cmp_ne_u32 vcc, 0, v6
    v_mfma_f32_16x16x32_bf16 v[44:47], v[92:95], v[148:151], 0
    s_cbranch_vccnz L_retry1
L_fail1:
    v_cvt_pk_bf16_f32 v80, v64, v65
    v_cvt_pk_bf16_f32 v81, v66, v67
    v_cvt_pk_bf16_f32 v82, v32, v33
    v_cvt_pk_bf16_f32 v83, v34, v35
    v_cvt_pk_bf16_f32 v84, v68, v69
L_tb3:
    s_cbranch_execz L_tbback
    v_cvt_pk_bf16_f32 v85, v70, v71
    v_cvt_pk_bf16_f32 v86, v36, v37
    v_cvt_pk_bf16_f32 v87, v38, v39
    v_mfma_f32_16x16x32_bf16 v[64:67], v[80:83], v[100:103], 0
    v_mfma_f32_16x16x32_bf16 v[32:35], v[80:83], v[104:107], 0
    v_mfma_f32_16x16x32_bf16 v[96:99], v[80:83], v[108:111], 0
    v_cvt_pk_bf16_f32 v88, v72, v73
    v_cvt_pk_bf16_f32 v89, v74, v75
    v_cvt_pk_bf16_f32 v90, v40, v41
    v_cvt_pk_bf16_f32 v91, v42, v43
    v_mfma_f32_16x16x32_bf16 v[68:71], v[84:87], v[112:115], 0
    v_mfma_f32_16x16x32_bf16 v[36:39], v[84:87], v[116:119], 0
    v_mfma_f32_16x16x32_bf16 v[96:99], v[84:87], v[120:123], v[96:99]
    v_cvt_pk_bf16_f32 v92, v76, v77
    v_cvt_pk_bf16_f32 v93, v78, v79
    v_cvt_pk_bf16_f32 v94, v44, v45
L_tb4:
    s_cbranch_execz L_tbback
    v_cvt_pk_bf16_f32 v95, v46, v47
    v_mfma_f32_16x16x32_bf16 v[72:75], v[88:91], v[124:127], 0
    v_mfma_f32_16x16x32_bf16 v[40:43], v[88:91], v[128:131], 0
    v_mfma_f32_16x16x32_bf16 v[96:99], v[88:91], v[132:135], v[96:99]
    v_mfma_f32_16x16x32_bf16 v[76:79], v[92:95], v[136:139], 0
    v_mfma_f32_16x16x32_bf16 v[44:47], v[92:95], v[140:143], 0
    v_mfma_f32_16x16x32_bf16 v[96:99], v[92:95], v[144:147], v[96:99]
    v_cvt_pk_bf16_f32 v48, v64, v32
    v_cvt_pk_bf16_f32 v52, v65, v33
    v_cvt_pk_bf16_f32 v56, v66, v34
    v_cvt_pk_bf16_f32 v60, v67, v35
    v_cvt_pk_bf16_f32 v49, v68, v36
    v_cvt_pk_bf16_f32 v53, v69, v37
    v_cvt_pk_bf16_f32 v57, v70, v38
    v_cvt_pk_bf16_f32 v61, v71, v39
L_tb5:
    s_cbranch_execz L_tbback
    v_cvt_pk_bf16_f32 v50, v72, v40
    v_cvt_pk_bf16_f32 v54, v73, v41
    v_cvt_pk_bf16_f32 v58, v74, v42
    v_cvt_pk_bf16_f32 v62, v75, v43
    v_cvt_pk_bf16_f32 v51, v76, v44
    ds_write_b128 v11, v[48:51] offset:16384
    v_cvt_pk_bf16_f32 v55, v77, v45
    ds_write_b128 v11, v[52:55] offset:17472
    v_cvt_pk_bf16_f32 v59, v78, v46
    ds_write_b128 v11, v[56:59] offset:18560
    v_cvt_pk_bf16_f32 v63, v79, v47
    ds_write_b128 v11, v[60:63] offset:19648
    v_cvt_pk_bf16_f32 v96, v96, v97
    v_cvt_pk_bf16_f32 v98, v98, v99
    ds_write_b16 v28, v96 offset:16384
    ds_write_b16_d16_hi v28, v96 offset:17472
L_tb6:
    s_cbranch_execz L_tbback
    ds_write_b16 v28, v98 offset:18560
    ds_write_b16_d16_hi v28, v98 offset:19648
L_d2:
    ds_read_b128 v[64:67], v5 offset:42688
    ds_read_b128 v[68:71], v5 offset:43712
    ds_read_b128 v[72:75], v4 offset:42688
    ds_read_b128 v[76:79], v4 offset:43712
    v_mov_b32 v9, 33856
    s_cmp_lg_u32 s55, 0
    s_waitcnt lgkmcnt(0)
    s_cbranch_scc1 L_zsync
    s_barrier
    ds_read_b32 v6, v9
    ds_read_b128 v[32:35], v29 offset:16384
    ds_read_b128 v[36:39], v30 offset:16384
    ds_read_b128 v[40:43], v29 offset:17472
    ds_read_b128 v[44:47], v30 offset:17472
    s_lshl_b32 s6, s58, 10
    s_lshl_b32 s7, s59, 10
L_tb7:
    s_cbranch_execz L_tbback
    s_waitcnt lgkmcnt(3)
    v_mfma_f32_16x16x32_bf16 v[48:51], v[32:35], v[64:67], 0
    s_waitcnt lgkmcnt(2)
    v_mfma_f32_16x16x32_bf16 v[52:55], v[36:39], v[68:71], 0
    s_waitcnt lgkmcnt(1)
    v_mfma_f32_16x16x32_bf16 v[56:59], v[40:43], v[72:75], 0
    s_waitcnt lgkmcnt(0)
    v_mfma_f32_16x16x32_bf16 v[60:63], v[44:47], v[76:79], 0
    v_readfirstlane_b32 s44, v6
    s_andn2_b32 s54, 0xffff, s44
    v_fmac_f32 v152, v24, v48
    v_fmac_f32 v153, v24, v49
    v_fmac_f32 v154, v24, v50
    v_fmac_f32 v155, v24, v51
    v_fmac_f32 v156, v24, v52
    v_fmac_f32 v157, v24, v53
    v_fmac_f32 v158, v24, v54
    v_fmac_f32 v159, v24, v55
    v_fmac_f32 v160, v26, v48
    v_fmac_f32 v161, v26, v49
    v_fmac_f32 v162, v26, v50
    v_fmac_f32 v163, v26, v51
    v_fmac_f32 v164, v26, v52
    v_fmac_f32 v165, v26, v53
    v_fmac_f32 v166, v26, v54
    v_fmac_f32 v167, v26, v55
L_tb8:
    s_cbranch_execz L_tbback
    v_fmac_f32 v152, v25, v56
    v_fmac_f32 v153, v25, v57
    v_fmac_f32 v154, v25, v58
    v_fmac_f32 v155, v25, v59
    v_fmac_f32 v156, v25, v60
    v_fmac_f32 v157, v25, v61
    v_fmac_f32 v158, v25, v62
    v_fmac_f32 v159, v25, v63
    v_cvt_pk_bf16_f32 v32, v152, v153
    v_cvt_pk_bf16_f32 v33, v154, v155
    v_cvt_pk_bf16_f32 v34, v156, v157
    v_cvt_pk_bf16_f32 v35, v158, v159
    s_cmp_eq_u32 s58, s54
    s_cbranch_scc1 L_skip3
    v_permlane16_swap_b32 v32, v34
    v_permlane16_swap_b32 v33, v35
    buffer_store_dwordx4 v[32:35], v3, s[40:43], s6 offen nt
L_skip3:
    v_fmac_f32 v160, v27, v56
    v_fmac_f32 v161, v27, v57
    v_fmac_f32 v162, v27, v58
    v_fmac_f32 v163, v27, v59
    v_fmac_f32 v164, v27, v60
    v_fmac_f32 v165, v27, v61
    v_fmac_f32 v166, v27, v62
    v_fmac_f32 v167, v27, v63
    v_cvt_pk_bf16_f32 v36, v160, v161
L_tb9:
    s_cbranch_execz L_tbback
    v_cvt_pk_bf16_f32 v37, v162, v163
    v_cvt_pk_bf16_f32 v38, v164, v165
    v_cvt_pk_bf16_f32 v39, v166, v167
    s_cmp_eq_u32 s59, s54
    s_cbranch_scc1 L_skip4
    v_permlane16_swap_b32 v36, v38
    v_permlane16_swap_b32 v37, v39
    buffer_store_dwordx4 v[36:39], v3, s[40:43], s7 offen nt
L_skip4:
L_tb_end:
    s_endpgm
L_retry0:
    s_sleep 3
    s_add_u32 s65, s65, 1
    s_lshr_b32 s34, s65, 17
    s_cbranch_scc1 L_fail0
    buffer_load_dwordx4 v[32:35], v10, s[36:39], s32 offen offset:0 sc1
    buffer_load_dwordx4 v[36:39], v10, s[36:39], s32 offen offset:2048 sc1
    buffer_load_dwordx4 v[40:43], v10, s[36:39], s33 offen offset:0 sc1
    buffer_load_dwordx4 v[44:47], v10, s[36:39], s33 offen offset:2048 sc1
    s_waitcnt vmcnt(0)
    s_branch L_got0
L_retry1:
    s_sleep 3
    s_add_u32 s65, s65, 1
    s_lshr_b32 s34, s65, 17
    s_cbranch_scc1 L_fail1
    buffer_load_dwordx4 v[48:51], v10, s[36:39], s32 offen offset:256 sc1
    buffer_load_dwordx4 v[52:55], v10, s[36:39], s32 offen offset:2304 sc1
    buffer_load_dwordx4 v[56:59], v10, s[36:39], s33 offen offset:256 sc1
    buffer_load_dwordx4 v[60:63], v10, s[36:39], s33 offen offset:2304 sc1
    s_waitcnt vmcnt(0)
    s_branch L_got1
L_hi0:
    s_barrier
L_hi1:
    s_mov_b64 exec, 0
    s_sub_u32 s53, s3, 8
L_tbback:
    s_add_u32 s53, s53, 4
    s_cmp_eq_u32 s53, 0
    s_cbranch_scc1 L_tb0
    s_cmp_eq_u32 s53, 1
    s_cbranch_scc1 L_tb1
    s_cmp_eq_u32 s53, 2
    s_cbranch_scc1 L_tb2
    s_cmp_eq_u32 s53, 3
    s_cbranch_scc1 L_tb3
    s_cmp_eq_u32 s53, 4
    s_cbranch_scc1 L_tb4
    s_cmp_eq_u32 s53, 5
    s_cbranch_scc1 L_tb5
    s_cmp_eq_u32 s53, 6
    s_cbranch_scc1 L_tb6
    s_cmp_eq_u32 s53, 7
    s_cbranch_scc1 L_tb7
    s_cmp_eq_u32 s53, 8
    s_cbranch_scc1 L_tb8
    s_cmp_eq_u32 s53, 9
    s_cbranch_scc1 L_tb9
    s_mov_b64 exec, -1
    s_cmp_lg_u32 s55, 0
    s_cbranch_scc1 L_z0b
    s_waitcnt vmcnt(2)
    v_dot2c_f32_bf16 v12, v16, v24
    v_dot2c_f32_bf16 v13, v20, v24
    v_dot2c_f32_bf16 v12, v17, v25
    v_dot2c_f32_bf16 v13, v21, v25
    v_dot2c_f32_bf16 v12, v18, v26
    v_dot2c_f32_bf16 v13, v22, v26
    v_dot2c_f32_bf16 v12, v19, v27
    v_dot2c_f32_bf16 v13, v23, v27
    s_nop 2
    v_permlane32_swap_b32 v12, v13
    v_add_f32 v12, v12, v13
    v_mov_b32 v13, v12
    s_nop 1
    v_permlane16_swap_b32 v12, v13
    v_add_f32 v12, v12, v13
    s_nop 1
    v_add_f32_dpp v12, v12, v12 row_ror:8 row_mask:0xf bank_mask:0xf
    s_nop 1
    v_add_f32_dpp v12, v12, v12 row_ror:4 row_mask:0xf bank_mask:0xf
    s_nop 1
    v_add_f32_dpp v12, v12, v12 row_ror:2 row_mask:0xf bank_mask:0xf
    s_nop 1
    v_add_f32_dpp v12, v12, v12 row_ror:1 row_mask:0xf bank_mask:0xf
    v_cvt_pk_bf16_f32 v12, v12, v12
    v_and_b32 v12, 0xffff0000, v12
    s_lshl_b32 s6, s3, 11
    v_add_u32 v6, s6, v5
    ds_write_b128 v6, v[16:19] offset:48832
    ds_write_b128 v6, v[20:23] offset:49856
    v_lshl_add_u32 v7, v1, 6, s6
    v_lshl_add_u32 v7, v2, 3, v7
    s_waitcnt lgkmcnt(0)
    ds_read_b64 v[16:17], v7 offset:48832
    ds_read_b64 v[18:19], v7 offset:48864
    ds_read_b64 v[20:21], v7 offset:49856
    ds_read_b64 v[22:23], v7 offset:49888
    v_and_b32 v6, 1, v2
    v_lshlrev_b32 v6, 5, v6
    v_lshl_add_u32 v6, v1, 6, v6
    v_lshrrev_b32 v7, 1, v2
    v_lshl_add_u32 v3, v7, 4, v6
    v_mul_f32 v13, 0xbfb8aa3b, v12
    v_exp_f32 v13, v13
    s_nop 0
    v_add_f32 v13, 1.0, v13
    v_rcp_f32 v13, v13
    s_nop 0
    v_cvt_pk_bf16_f32 v13, v13, v13
    v_and_b32 v13, 0xffff0000, v13
    v_sub_f32 v14, 1.0, v13
    v_cvt_pk_bf16_f32 v14, v14, v14
    v_and_b32 v14, 0xffff0000, v14
    v_readlane_b32 s6, v13, 0
    v_readlane_b32 s7, v13, 32
    v_readlane_b32 s8, v14, 0
    v_readlane_b32 s9, v14, 32
    s_xor_b32 s10, s6, 0x80000000
    s_cmp_eq_u32 s58, 0
    s_cselect_b32 s10, 0, s10
    s_cselect_b32 s11, 0, s7
    v_mov_b32 v24, s6
    v_mov_b32 v25, s10
    v_mov_b32 v26, s11
    v_mov_b32 v27, s7
    v_mov_b32 v13, s8
    v_mov_b32 v14, s9
    s_waitcnt lgkmcnt(0)
    v_lshlrev_b32 v152, 16, v16
    v_and_b32 v153, 0xffff0000, v16
    v_lshlrev_b32 v154, 16, v17
    v_and_b32 v155, 0xffff0000, v17
    v_lshlrev_b32 v156, 16, v18
    v_and_b32 v157, 0xffff0000, v18
    v_lshlrev_b32 v158, 16, v19
    v_and_b32 v159, 0xffff0000, v19
    v_mul_f32 v152, v13, v152
    v_mul_f32 v153, v13, v153
    v_mul_f32 v154, v13, v154
    v_mul_f32 v155, v13, v155
    v_mul_f32 v156, v13, v156
    v_mul_f32 v157, v13, v157
    v_mul_f32 v158, v13, v158
    v_mul_f32 v159, v13, v159
    v_lshlrev_b32 v160, 16, v20
    v_and_b32 v161, 0xffff0000, v20
    v_lshlrev_b32 v162, 16, v21
    v_and_b32 v163, 0xffff0000, v21
    v_lshlrev_b32 v164, 16, v22
    v_and_b32 v165, 0xffff0000, v22
    v_lshlrev_b32 v166, 16, v23
    v_and_b32 v167, 0xffff0000, v23
    v_mul_f32 v160, v14, v160
    v_mul_f32 v161, v14, v161
    v_mul_f32 v162, v14, v162
    v_mul_f32 v163, v14, v163
    v_mul_f32 v164, v14, v164
    v_mul_f32 v165, v14, v165
    v_mul_f32 v166, v14, v166
    v_mul_f32 v167, v14, v167
    s_mul_i32 s7, s3, 2176
    v_bfe_u32 v7, v1, 1, 2
    v_xor_b32 v7, v7, v2
    v_lshl_add_u32 v7, v7, 4, s7
    v_lshl_add_u32 v29, v1, 6, v7
    v_sub_u32 v6, 16, v1
    v_bfe_u32 v7, v6, 1, 2
    v_xor_b32 v7, v7, v2
    v_lshl_add_u32 v7, v7, 4, s7
    v_lshl_add_u32 v30, v6, 6, v7
    s_cmp_eq_u32 s58, 0
    s_cselect_b32 s6, 0, 2048
    v_add_u32 v4, s6, v5
    s_branch L_d2
L_ah:
    v_lshlrev_b32 v5, 4, v0
    v_mov_b32 v31, 0
    v_mov_b32 v9, 33792
    ds_write_b32 v9, v31
    s_mov_b32 s64, 0x9E3779B1
    s_cmp_ge_u32 s7, 2
    s_waitcnt lgkmcnt(0)
    s_cbranch_scc1 L_nowpf
    global_load_dwordx4 v[32:35], v5, s[16:17]
    global_load_dword v30, v31, s[30:31]
    global_load_dwordx4 v[36:39], v5, s[24:25]
L_nowpf:
    v_lshlrev_b32 v14, 10, v0
    s_lshl_b32 s50, s2, 3
    s_add_u32 s50, s50, 65536
    s_mov_b32 s36, s30
    s_mov_b32 s37, s31
    s_mov_b32 s38, 0x1000000
    s_mov_b32 s39, 0x20000
    s_mov_b32 s65, 0
    s_barrier
    v_lshlrev_b32 v6, 2, v2
    v_cvt_f32_u32 v7, v1
    v_cvt_f32_u32 v6, v6
    v_mul_f32 v7, 0x3d800000, v7
    v_mul_f32 v9, v6, v7
    v_cos_f32 v64, v9
    v_sin_f32 v68, v9
    v_add_f32 v9, v9, v7
    v_cos_f32 v65, v9
    v_sin_f32 v69, v9
    v_add_f32 v9, v9, v7
    v_cos_f32 v66, v9
    v_sin_f32 v70, v9
    v_add_f32 v9, v9, v7
    v_cos_f32 v67, v9
    v_sin_f32 v71, v9
    s_nop 0
    v_cvt_pk_bf16_f32 v40, v64, v68
    v_cvt_pk_bf16_f32 v48, -v68, v64
    v_cvt_pk_bf16_f32 v41, v65, v69
    v_cvt_pk_bf16_f32 v49, -v69, v65
    v_cvt_pk_bf16_f32 v42, v66, v70
    v_cvt_pk_bf16_f32 v50, -v70, v66
    v_cvt_pk_bf16_f32 v43, v67, v71
    v_cvt_pk_bf16_f32 v51, -v71, v67
    v_add_f32 v7, 0x3d800000, v7
    v_mul_f32 v9, v6, v7
    v_cos_f32 v64, v9
    v_sin_f32 v68, v9
    v_add_f32 v9, v9, v7
    v_cos_f32 v65, v9
    v_sin_f32 v69, v9
    v_add_f32 v9, v9, v7
    v_cos_f32 v66, v9
    v_sin_f32 v70, v9
    v_add_f32 v9, v9, v7
    v_cos_f32 v67, v9
    v_sin_f32 v71, v9
    s_nop 0
    v_cvt_pk_bf16_f32 v44, v64, -v68
    v_cvt_pk_bf16_f32 v52, -v68, -v64
    v_cvt_pk_bf16_f32 v45, v65, -v69
    v_cvt_pk_bf16_f32 v53, -v69, -v65
    v_cvt_pk_bf16_f32 v46, v66, -v70
    v_cvt_pk_bf16_f32 v54, -v70, -v66
    v_cvt_pk_bf16_f32 v47, v67, -v71
    v_cvt_pk_bf16_f32 v55, -v71, -v67
    ds_write_b128 v5, v[40:43] offset:42688
    ds_write_b128 v5, v[44:47] offset:43712
    ds_write_b128 v5, v[48:51] offset:44736
    ds_write_b128 v5, v[52:55] offset:45760
    global_load_dword v30, v31, s[30:31]
    s_waitcnt lgkmcnt(0)
    v_mov_b32 v9, 33792
    s_waitcnt vmcnt(0)
    v_mul_lo_u32 v31, v30, s64
    v_add_u32 v31, 0x7F4A7C15, v31
    v_lshlrev_b32 v6, 1, v1
    v_lshrrev_b32 v6, v6, v31
    v_lshlrev_b32 v7, 15, v6
    v_and_b32 v6, 1, v6
    v_and_b32 v7, 0x10000, v7
    v_or_b32 v6, v6, v7
    v_lshlrev_b32 v7, 2, v1
    ds_write_b32 v7, v6 offset:33920
    s_waitcnt lgkmcnt(0)
    v_mov_b32 v9, 33792
    s_barrier
    ds_read_b32 v30, v9
    s_mov_b32 exec_lo, -1
    s_mov_b32 exec_hi, 0x7
    s_waitcnt lgkmcnt(0)
    buffer_store_dwordx2 v[30:31], v14, s[36:39], s50 offen sc1
    s_mov_b64 exec, -1
    s_barrier
    s_and_b32 s61, s2, 7
    s_mul_i32 s61, s61, 2048
    s_add_u32 s61, s61, 84992
    s_add_u32 s62, s61, 1024
    s_waitcnt vmcnt(0)
    s_sleep 6
    s_branch L_poll5_1
L_poll5:
    s_sleep 5
L_poll5_1:
    buffer_load_dwordx4 v[32:35], v5, s[36:39], s61 offen sc1
    s_add_u32 s61, s61, 1024
    s_min_u32 s61, s61, s62
    s_add_u32 s65, s65, 1
    s_lshr_b32 s34, s65, 17
    s_waitcnt vmcnt(0)
    s_cbranch_scc1 L_poll5_ok
    v_cmp_ne_u32 vcc, v31, v33
    v_cmp_ne_u32 s[12:13], v31, v35
    s_or_b64 vcc, vcc, s[12:13]
    s_cbranch_vccnz L_poll5
L_poll5_ok:
    v_max_u32 v32, v32, v34
    s_nop 1
    v_max_u32_dpp v32, v32, v32 row_ror:8 row_mask:0xf bank_mask:0xf
    s_nop 1
    v_max_u32_dpp v32, v32, v32 row_ror:4 row_mask:0xf bank_mask:0xf
    s_nop 1
    v_max_u32_dpp v32, v32, v32 row_ror:2 row_mask:0xf bank_mask:0xf
    s_nop 1
    v_max_u32_dpp v32, v32, v32 row_ror:1 row_mask:0xf bank_mask:0xf
    s_nop 1
    v_max_u32_dpp v32, v32, v32 row_bcast:15 row_mask:0xa bank_mask:0xf
    s_nop 1
    v_max_u32_dpp v32, v32, v32 row_bcast:31 row_mask:0xc bank_mask:0xf
    v_mov_b32 v9, 33856
    s_mov_b32 exec_lo, 0
    s_brev_b32 exec_hi, 1
    ds_write_b32 v9, v32
    s_mov_b64 exec, -1
    s_waitcnt lgkmcnt(0)
    s_sleep 8
    s_barrier
    s_endpgm
    s_barrier
    s_endpgm
L_notA:
    s_sub_u32 s8, s6, 0
    s_and_b32 s8, s8, 7
    s_lshl4_add_u32 s60, s8, s7
    s_sub_u32 s60, s60, 32
    s_cmp_ge_u32 s2, 256
    s_cbranch_scc1 L_end
    s_cmp_lg_u32 s8, 0
    s_cbranch_scc1 L_F
    s_mov_b32 s55, 1
    s_sub_u32 s47, s7, 16
    v_and_b32 v6, 1, v2
    v_lshlrev_b32 v6, 5, v6
    v_lshl_add_u32 v6, v1, 6, v6
    v_lshrrev_b32 v7, 1, v2
    v_lshl_add_u32 v3, v7, 4, v6
    v_lshlrev_b32 v5, 4, v0
    v_lshlrev_b32 v8, 31, v1
    v_lshrrev_b32 v9, 16, v8
    v_or_b32 v8, v8, v9
    s_waitcnt lgkmcnt(0)
    s_mov_b32 s36, s30
    s_mov_b32 s37, s31
    s_mov_b32 s38, 0x1000000
    s_mov_b32 s39, 0x20000
    s_mov_b32 s65, 0
    s_mov_b32 s40, s26
    s_mov_b32 s41, s27
    s_mov_b32 s42, 0x200000
    s_mov_b32 s43, 0x20000
    v_lshlrev_b32 v6, 4, v1
    v_lshl_add_u32 v10, v2, 13, v6
    v_mul_u32_u24 v6, 4352, v2
    v_bfe_u32 v7, v1, 1, 2
    v_xor_b32 v7, s3, v7
    v_lshl_add_u32 v7, v7, 4, v6
    v_lshl_add_u32 v11, v1, 6, v7
    s_lshl4_add_u32 s7, s3, 1024
    v_mov_b32 v9, 17600
    v_lshl_add_u32 v28, v0, 1, v9
    v_lshl_add_u32 v7, v1, 1, s7
    s_mov_b32 exec_lo, 0x00ff00ff
    s_mov_b32 exec_hi, 0x00ff00ff
    v_add_u32 v28, v7, v6
    s_mov_b64 exec, -1
    s_cmp_eq_u32 s3, 8
    s_cbranch_scc1 L_zh
    s_cmp_ge_u32 s3, 4
    s_cbranch_scc1 L_z0
    v_cvt_f32_u32 v6, v1
    s_lshl_b32 s6, s3, 2
    v_lshl_add_u32 v7, v2, 6, s6
    v_mul_f32 v6, 0x3b000000, v6
    v_cvt_f32_u32 v7, v7
    v_mul_f32 v15, 0x41800000, v6
    v_mul_f32 v7, v7, v6
    v_cos_f32 v64, v7
    v_sin_f32 v68, v7
    v_add_f32 v9, v7, v15
    v_cos_f32 v65, v9
    v_sin_f32 v69, v9
    v_add_f32 v9, v9, v15
    v_cos_f32 v66, v9
    v_sin_f32 v70, v9
    v_add_f32 v9, v9, v15
    v_cos_f32 v67, v9
    v_sin_f32 v71, v9
    v_mov_b32 v108, 0
    v_cvt_pk_bf16_f32 v100, v64, v65
    v_cvt_pk_bf16_f32 v104, -v68, -v69
    v_cvt_pk_bf16_f32 v101, v66, v67
    v_cvt_pk_bf16_f32 v105, -v70, -v71
    v_xor_b32 v102, v100, v8
    v_xor_b32 v106, v104, v8
    v_xor_b32 v103, v101, v8
    v_xor_b32 v107, v105, v8
    v_add_f32 v7, v7, v6
    v_cos_f32 v64, v7
    v_sin_f32 v68, v7
    v_add_f32 v9, v7, v15
    v_cos_f32 v65, v9
    v_sin_f32 v69, v9
    v_add_f32 v9, v9, v15
    v_cos_f32 v66, v9
    v_sin_f32 v70, v9
    v_add_f32 v9, v9, v15
    v_cos_f32 v67, v9
    v_sin_f32 v71, v9
    v_mov_b32 v120, 0
    v_cvt_pk_bf16_f32 v112, v64, v65
    v_cvt_pk_bf16_f32 v116, -v68, -v69
    v_cvt_pk_bf16_f32 v113, v66, v67
    v_cvt_pk_bf16_f32 v117, -v70, -v71
    v_xor_b32 v114, v112, v8
    v_xor_b32 v118, v116, v8
    v_xor_b32 v115, v113, v8
    v_xor_b32 v119, v117, v8
    v_add_f32 v7, v7, v6
    v_cos_f32 v64, v7
    v_sin_f32 v68, v7
    v_add_f32 v9, v7, v15
    v_cos_f32 v65, v9
    v_sin_f32 v69, v9
    v_add_f32 v9, v9, v15
    v_cos_f32 v66, v9
    v_sin_f32 v70, v9
    v_add_f32 v9, v9, v15
    v_cos_f32 v67, v9
    v_sin_f32 v71, v9
    v_mov_b32 v132, 0
    v_cvt_pk_bf16_f32 v124, v64, v65
    v_cvt_pk_bf16_f32 v128, -v68, -v69
    v_cvt_pk_bf16_f32 v125, v66, v67
    v_cvt_pk_bf16_f32 v129, -v70, -v71
    v_xor_b32 v126, v124, v8
    v_xor_b32 v130, v128, v8
    v_xor_b32 v127, v125, v8
    v_xor_b32 v131, v129, v8
    v_add_f32 v7, v7, v6
    v_cos_f32 v64, v7
    v_sin_f32 v68, v7
    v_add_f32 v9, v7, v15
    v_cos_f32 v65, v9
    v_sin_f32 v69, v9
    v_add_f32 v9, v9, v15
    v_cos_f32 v66, v9
    v_sin_f32 v70, v9
    v_add_f32 v9, v9, v15
    v_cos_f32 v67, v9
    v_sin_f32 v71, v9
    v_mov_b32 v144, 0
    v_cvt_pk_bf16_f32 v136, v64, v65
    v_cvt_pk_bf16_f32 v140, -v68, -v69
    v_cvt_pk_bf16_f32 v137, v66, v67
    v_cvt_pk_bf16_f32 v141, -v70, -v71
    v_xor_b32 v138, v136, v8
    v_xor_b32 v142, v140, v8
    v_xor_b32 v139, v137, v8
    v_xor_b32 v143, v141, v8
    v_lshrrev_b32 v6, 1, v1
    v_add_u32 v7, s6, v6
    v_and_b32 v9, 1, v1
    v_lshl_add_u32 v7, v9, 3, v7
    v_cvt_f32_u32 v7, v7
    v_mul_f32 v7, 0x3d000000, v7
    v_cos_f32 v7, v7
    s_mov_b32 exec_lo, 0x30003
    s_mov_b32 exec_hi, 0x30003
    v_cvt_pk_bf16_f32 v108, v7, -v7
    s_mov_b32 exec_lo, 0xc000c
    s_mov_b32 exec_hi, 0xc000c
    v_cvt_pk_bf16_f32 v120, v7, -v7
    s_mov_b32 exec_lo, 0x300030
    s_mov_b32 exec_hi, 0x300030
    v_cvt_pk_bf16_f32 v132, v7, -v7
    s_mov_b32 exec_lo, 0xc000c0
    s_mov_b32 exec_hi, 0xc000c0
    v_cvt_pk_bf16_f32 v144, v7, -v7
    s_mov_b64 exec, -1
    v_mov_b32 v109, v108
    v_mov_b32 v110, v108
    v_mov_b32 v111, v108
    v_mov_b32 v121, v120
    v_mov_b32 v122, v120
    v_mov_b32 v123, v120
    v_mov_b32 v133, v132
    v_mov_b32 v134, v132
    v_mov_b32 v135, v132
    v_mov_b32 v145, v144
    v_mov_b32 v146, v144
    v_mov_b32 v147, v144
    s_branch L_z1
L_z0:
    s_branch L_hi1
L_z0b:
    s_mov_b64 exec, 0
    s_sub_u32 s53, s3, 8
L_tzback:
    s_add_u32 s53, s53, 4
    s_cmp_eq_u32 s53, 0
    s_cbranch_scc1 L_tz0
    s_cmp_eq_u32 s53, 1
    s_cbranch_scc1 L_tz1
    s_cmp_eq_u32 s53, 2
    s_cbranch_scc1 L_tz2
    s_cmp_eq_u32 s53, 3
    s_cbranch_scc1 L_tz3
    s_cmp_eq_u32 s53, 4
    s_cbranch_scc1 L_tz4
    s_cmp_eq_u32 s53, 5
    s_cbranch_scc1 L_tz5
    s_cmp_eq_u32 s53, 6
    s_cbranch_scc1 L_tz6
    s_cmp_eq_u32 s53, 7
    s_cbranch_scc1 L_tz7
    s_mov_b64 exec, -1
L_z1:
    v_mov_b32 v9, 33792
    v_mov_b32 v12, 0
    v_mov_b32 v13, 0
    s_barrier
    ds_read_b64 v[30:31], v9
    ds_read_b128 v[24:27], v5 offset:47808
    s_waitcnt lgkmcnt(0)
    v_readfirstlane_b32 s44, v30
    s_andn2_b32 s54, 2047, s44
    s_and_b32 s6, s54, 127
    s_cmp_gt_u32 s6, 64
    s_cselect_b32 s46, 1, 0
    s_and_b32 s6, s54, 1087
    s_cmp_eq_u32 s6, 1024
    s_cselect_b32 s46, 1, s46
    s_sub_u32 s6, 2048, s54
    s_cmp_lg_u32 s46, 0
    s_cselect_b32 s6, s6, s54
    s_cmp_eq_u32 s6, 1024
    s_cselect_b32 s6, 0, s6
    s_and_b32 s56, s6, 127
    s_lshr_b32 s57, s6, 10
    s_bfe_u32 s45, s6, 0x30007
    s_lshl3_add_u32 s11, s57, s45
    s_lshl_b32 s11, s11, 7
    s_add_u32 s58, s11, s56
    s_sub_u32 s59, 2048, s58
    s_cmp_eq_u32 s58, 0
    s_cselect_b32 s59, 1024, s59
    s_lshl_b32 s10, s58, 10
    s_lshl_b32 s11, s59, 10
    v_add_u32 v6, s10, v5
    v_add_u32 v7, s11, v5
    s_cmp_ge_u32 s3, 4
    s_cbranch_scc1 L_z4
    s_and_b32 s7, s56, 63
    s_mul_i32 s32, s7, 33024
    s_lshl_b32 s7, s3, 9
    s_add_u32 s32, s32, s7
    s_add_u32 s32, s32, 2097152
    s_add_u32 s33, s32, 4096
    s_sleep 16
    buffer_load_dwordx4 v[32:35], v10, s[36:39], s32 offen offset:0 sc1
    buffer_load_dwordx4 v[36:39], v10, s[36:39], s32 offen offset:2048 sc1
    buffer_load_dwordx4 v[40:43], v10, s[36:39], s33 offen offset:0 sc1
    buffer_load_dwordx4 v[44:47], v10, s[36:39], s33 offen offset:2048 sc1
    buffer_load_dwordx4 v[48:51], v10, s[36:39], s32 offen offset:256 sc1
    buffer_load_dwordx4 v[52:55], v10, s[36:39], s32 offen offset:2304 sc1
    buffer_load_dwordx4 v[56:59], v10, s[36:39], s33 offen offset:256 sc1
    buffer_load_dwordx4 v[60:63], v10, s[36:39], s33 offen offset:2304 sc1
    v_lshrrev_b32 v6, 1, v1
    s_lshl_b32 s6, s57, 10
    s_add_u32 s6, s6, s56
    v_lshl_add_u32 v6, v6, 7, s6
    v_and_b32 v7, 1, v1
    v_lshlrev_b32 v9, 9, v7
    s_cmp_lg_u32 s56, 0
    s_cbranch_scc1 L_g06
    s_mov_b32 exec_lo, 0x00020002
    s_mov_b32 exec_hi, 0x00020002
    v_mov_b32 v6, 0x400
    v_mov_b32 v9, 0
    s_mov_b64 exec, -1
L_g06:
    v_lshlrev_b32 v7, 2, v2
    v_mad_u32_u24 v9, v7, v6, v9
    v_cvt_f32_u32 v6, v6
    v_cvt_f32_u32 v9, v9
    v_mul_f32 v6, 0x3a000000, v6
    v_mul_f32 v9, 0x3a000000, v9
    v_cos_f32 v64, v9
    v_sin_f32 v68, v9
    v_add_f32 v9, v9, v6
    v_cos_f32 v65, v9
    v_sin_f32 v69, v9
    v_add_f32 v9, v9, v6
    v_cos_f32 v66, v9
    v_sin_f32 v70, v9
    v_add_f32 v9, v9, v6
    v_cos_f32 v67, v9
    v_sin_f32 v71, v9
    s_and_b32 s7, s56, 63
    s_nop 0
    v_cvt_pk_bf16_f32 v148, v64, v68
    v_cvt_pk_bf16_f32 v149, v65, v69
    v_cvt_pk_bf16_f32 v150, v66, v70
    v_cvt_pk_bf16_f32 v151, v67, v71
    s_cmp_lg_u32 s7, 0
    s_cbranch_scc1 L_gd7
    s_lshr_b32 s7, s56, 2
    v_and_b32 v148, 0xffff, v148
    v_lshlrev_b32 v148, s7, v148
    v_and_b32 v149, 0xffff, v149
    v_lshlrev_b32 v149, s7, v149
    v_and_b32 v150, 0xffff, v150
    v_lshlrev_b32 v150, s7, v150
    v_and_b32 v151, 0xffff, v151
    v_lshlrev_b32 v151, s7, v151
L_gd7:
    v_and_b32 v6, 3, v1
    v_lshlrev_b32 v6, 4, v6
    ds_read_b128 v[96:99], v6 offset:33920
    s_waitcnt lgkmcnt(0)
    s_mul_i32 s7, s45, 2176
    v_bfe_u32 v7, v1, 1, 2
    v_xor_b32 v7, v7, v2
    v_lshl_add_u32 v7, v7, 4, s7
    v_lshl_add_u32 v29, v1, 6, v7
    v_sub_u32 v6, 16, v1
    v_bfe_u32 v7, v6, 1, 2
    v_xor_b32 v7, v7, v2
    v_lshl_add_u32 v7, v7, 4, s7
    v_lshl_add_u32 v30, v6, 6, v7
    s_cmp_eq_u32 s58, 0
    s_cselect_b32 s6, 0, 2048
    v_add_u32 v4, s6, v5
    v_lshlrev_b32 v6, 7, v1
    v_lshl_add_u32 v15, v2, 4, v6
    s_branch L_zjoin
L_z4:
    s_cmp_ge_u32 s3, 6
    s_cbranch_scc1 L_zend2
    global_load_dwordx4 v[16:19], v6, s[4:5]
    global_load_dwordx4 v[20:23], v7, s[4:5]
    s_sub_u32 s6, s3, 4
    s_lshl1_add_u32 s7, s47, s6
    s_lshl_b32 s7, s7, 5
    v_and_b32 v6, 7, v0
    v_lshl_add_u32 v10, v6, 2, s7
    s_lshl_b32 s8, s54, 10
    v_add_u32 v7, s8, v10
    global_load_dword v35, v7, s[4:5]
    v_lshlrev_b32 v10, 1, v10
    v_lshrrev_b32 v7, 3, v0
    v_lshlrev_b32 v7, 8, v7
    v_lshl_add_u32 v11, v6, 4, v7
    s_mul_i32 s48, s47, 14336
    s_lshl_b32 s6, s6, 7
    s_add_u32 s48, s48, s6
    s_add_u32 s48, s48, 720896
    s_add_u32 s49, s48, 0
    s_and_b32 s6, s44, 0xffff0000
    s_xor_b32 s7, s6, 0x80000000
    s_xor_b32 s9, s6, 0xffff0000
    s_bitcmp1_b32 s6, 31
    s_cselect_b32 s6, s7, s9
    v_mov_b32 v15, s6
    v_mul_f32 v15, 0xbfb8aa3b, v15
    v_exp_f32 v15, v15
    s_nop 0
    v_add_f32 v15, 1.0, v15
    v_rcp_f32 v15, v15
    s_nop 0
    v_cvt_pk_bf16_f32 v15, v15, v15
    v_and_b32 v15, 0xffff0000, v15
    s_waitcnt vmcnt(0)
    v_dot2c_f32_bf16 v12, v16, v24
    v_dot2c_f32_bf16 v13, v20, v24
    v_dot2c_f32_bf16 v12, v17, v25
    v_dot2c_f32_bf16 v13, v21, v25
    v_dot2c_f32_bf16 v12, v18, v26
    v_dot2c_f32_bf16 v13, v22, v26
    v_dot2c_f32_bf16 v12, v19, v27
    v_dot2c_f32_bf16 v13, v23, v27
    s_nop 2
    v_permlane32_swap_b32 v12, v13
    v_add_f32 v12, v12, v13
    v_mov_b32 v13, v12
    s_nop 1
    v_permlane16_swap_b32 v12, v13
    v_add_f32 v12, v12, v13
    s_nop 1
    v_add_f32_dpp v12, v12, v12 row_ror:8 row_mask:0xf bank_mask:0xf
    s_nop 1
    v_add_f32_dpp v12, v12, v12 row_ror:4 row_mask:0xf bank_mask:0xf
    s_nop 1
    v_add_f32_dpp v12, v12, v12 row_ror:2 row_mask:0xf bank_mask:0xf
    s_nop 1
    v_add_f32_dpp v12, v12, v12 row_ror:1 row_mask:0xf bank_mask:0xf
    v_cvt_pk_bf16_f32 v12, v12, v12
    v_and_b32 v12, 0xffff0000, v12
    v_mul_f32 v13, 0xbfb8aa3b, v12
    v_exp_f32 v13, v13
    s_nop 0
    v_add_f32 v13, 1.0, v13
    v_rcp_f32 v13, v13
    s_nop 0
    v_cvt_pk_bf16_f32 v13, v13, v13
    v_and_b32 v13, 0xffff0000, v13
    v_sub_f32 v14, 1.0, v13
    v_cvt_pk_bf16_f32 v14, v14, v14
    v_and_b32 v14, 0xffff0000, v14
    v_readlane_b32 s6, v13, 0
    v_readlane_b32 s7, v13, 32
    v_readlane_b32 s8, v14, 0
    v_readlane_b32 s9, v14, 32
    s_xor_b32 s10, s6, 0x80000000
    s_cmp_eq_u32 s58, 0
    s_cselect_b32 s10, 0, s10
    s_cselect_b32 s11, 0, s7
    s_cmp_lg_u32 s46, 0
    s_cselect_b32 s8, s9, s8
    s_cselect_b32 s6, s11, s6
    s_cselect_b32 s10, s7, s10
    v_xor_b32 v31, s54, v31
    v_mov_b32 v36, s8
    v_mov_b32 v24, s6
    v_mov_b32 v25, s10
    v_lshlrev_b32 v34, 16, v35
    v_and_b32 v35, 0xffff0000, v35
    s_sleep 20
    v_mov_b32 v9, 33864
L_tz_start:
L_zp:
    buffer_load_dwordx4 v[40:43], v11, s[36:39], s48 offen offset:0 sc1
    buffer_load_dwordx4 v[44:47], v11, s[36:39], s48 offen offset:2048 sc1
    s_add_u32 s6, s48, 4096
    buffer_load_dwordx4 v[48:51], v11, s[36:39], s6 offen offset:0 sc1
    buffer_load_dwordx4 v[52:55], v11, s[36:39], s6 offen offset:2048 sc1
L_tz0:
    s_cbranch_execz L_tzback
    s_add_u32 s6, s48, 8192
    buffer_load_dwordx4 v[56:59], v11, s[36:39], s6 offen offset:0 sc1
    buffer_load_dwordx4 v[60:63], v11, s[36:39], s6 offen offset:2048 sc1
    s_add_u32 s6, s48, 12288
    buffer_load_dwordx4 v[64:67], v11, s[36:39], s6 offen offset:0 sc1
    s_add_u32 s48, s48, 229376
    s_min_u32 s48, s48, s49
    s_add_u32 s65, s65, 1
    s_lshr_b32 s34, s65, 17
    s_cbranch_scc1 L_zp_ok
    s_waitcnt vmcnt(6)
    v_bitop3_b32 v37, v41, v43, v31 bitop3:0x7e
    s_waitcnt vmcnt(5)
    v_bitop3_b32 v39, v45, v47, v31 bitop3:0x7e
    v_add_f32 v40, v40, v44
    v_add_f32 v42, v42, v46
    s_waitcnt vmcnt(4)
    v_bitop3_b32 v38, v49, v51, v31 bitop3:0x7e
    v_add_f32 v40, v40, v48
    v_add_f32 v42, v42, v50
    v_or3_b32 v37, v37, v38, v39
L_tz1:
    s_cbranch_execz L_tzback
    s_waitcnt vmcnt(3)
    v_bitop3_b32 v39, v53, v55, v31 bitop3:0x7e
    v_add_f32 v40, v40, v52
    v_add_f32 v42, v42, v54
    s_waitcnt vmcnt(2)
    v_bitop3_b32 v38, v57, v59, v31 bitop3:0x7e
    v_add_f32 v40, v40, v56
    v_add_f32 v42, v42, v58
    v_or3_b32 v37, v37, v38, v39
    s_waitcnt vmcnt(1)
    v_bitop3_b32 v39, v61, v63, v31 bitop3:0x7e
    v_add_f32 v40, v40, v60
    v_add_f32 v42, v42, v62
    s_waitcnt vmcnt(0)
    v_bitop3_b32 v38, v65, v67, v31 bitop3:0x7e
    v_add_f32 v40, v40, v64
    v_add_f32 v42, v42, v66
    v_or3_b32 v37, v37, v38, v39
    v_cmp_ne_u32 vcc, 0, v37
    s_nop 0
    s_cbranch_vccnz L_zp
L_zp_ok:
    ds_read_b32 v12, v9
    ds_read_b64 v[32:33], v10 offset:38592
L_tz2:
    s_cbranch_execz L_tzback
    ds_read_b64 v[16:17], v10 offset:40640
    v_lshrrev_b32 v11, 1, v10
    s_lshl_b32 s8, s54, 10
    s_waitcnt vmcnt(0)
    v_add_f32_dpp v40, v40, v40 row_ror:8 row_mask:0xf bank_mask:0xf
    v_add_f32_dpp v42, v42, v42 row_ror:8 row_mask:0xf bank_mask:0xf
    s_nop 0
    s_nop 0
    v_permlane16_swap_b32 v40, v42
    v_add_f32 v40, v40, v42
    v_mov_b32 v42, v40
    s_nop 1
    v_permlane32_swap_b32 v40, v42
    v_add_f32 v40, v40, v42
    v_mov_b32 v42, v40
    s_nop 1
    v_permlane16_swap_b32 v40, v42
    v_cvt_pk_bf16_f32 v41, v40, v42
    v_lshlrev_b32 v40, 16, v41
    v_and_b32 v42, 0xffff0000, v41
    v_mul_f32 v40, v40, v15
    v_mul_f32 v42, v42, v15
    v_cvt_pk_bf16_f32 v41, v40, v42
    v_lshlrev_b32 v40, 16, v41
    v_and_b32 v42, 0xffff0000, v41
L_tz3:
    s_cbranch_execz L_tzback
    v_add_f32 v40, v40, v34
    v_add_f32 v42, v42, v35
    v_cvt_pk_bf16_f32 v41, v40, v42
    v_lshlrev_b32 v40, 16, v41
    v_and_b32 v42, 0xffff0000, v41
L_zw:
    s_waitcnt lgkmcnt(0)
    v_cmp_eq_u32 vcc, 0, v12
    v_mul_f32 v32, v24, v32
    v_mul_f32 v33, v24, v33
    s_cbranch_vccz L_zw_ok
    s_add_u32 s65, s65, 1
    s_lshr_b32 s34, s65, 17
    s_cbranch_scc1 L_zw_ok
    ds_read_b32 v12, v9
    ds_read_b64 v[32:33], v10 offset:38592
    ds_read_b64 v[16:17], v10 offset:40640
    s_branch L_zw
L_zw_ok:
    v_fmac_f32 v32, v25, v16
    v_fmac_f32 v33, v25, v17
    v_fmac_f32 v32, v40, v36
    v_fmac_f32 v33, v42, v36
    v_cvt_pk_bf16_f32 v32, v32, v33
    s_mov_b64 exec, 0xff
    buffer_store_dword v32, v11, s[40:43], s8 offen
    s_mov_b64 exec, -1
L_tz4:
    s_cbranch_execz L_tzback
    s_barrier
    s_endpgm
L_zsync:
    v_mov_b32 v9, 33868
    v_mov_b32 v6, 1
    s_mov_b64 exec, 1
    ds_add_u32 v9, v6
    s_mov_b64 exec, -1
    s_cmp_lg_u32 s3, 0
    s_cbranch_scc1 L_zend
L_zs:
    ds_read_b32 v6, v9
    s_add_u32 s65, s65, 1
    s_lshr_b32 s34, s65, 17
    s_waitcnt lgkmcnt(0)
    s_cbranch_scc1 L_zs_ok
    v_cmp_ne_u32 vcc, 4, v6
    s_nop 0
    s_cbranch_vccnz L_zs
L_zs_ok:
    ds_read_b128 v[32:35], v29 offset:16384
    ds_read_b128 v[36:39], v30 offset:16384
    ds_read_b128 v[40:43], v29 offset:17472
    ds_read_b128 v[44:47], v30 offset:17472
L_tz5:
    s_cbranch_execz L_tzback
    s_waitcnt lgkmcnt(3)
    v_mfma_f32_16x16x32_bf16 v[48:51], v[32:35], v[64:67], 0
    s_waitcnt lgkmcnt(2)
    v_mfma_f32_16x16x32_bf16 v[52:55], v[36:39], v[68:71], 0
    s_waitcnt lgkmcnt(1)
    v_mfma_f32_16x16x32_bf16 v[56:59], v[40:43], v[72:75], 0
    s_waitcnt lgkmcnt(0)
    v_mfma_f32_16x16x32_bf16 v[60:63], v[44:47], v[76:79], 0
    s_nop 2
    ds_write_b128 v15, v[48:51] offset:38592
    ds_write_b128 v15, v[52:55] offset:38656
    s_nop 1
    ds_write_b128 v15, v[56:59] offset:40640
    ds_write_b128 v15, v[60:63] offset:40704
    v_mov_b32 v9, 33864
    s_waitcnt lgkmcnt(0)
    ds_write_b32 v9, v9
    s_waitcnt lgkmcnt(0)
.set L_tz6, L_tzback
.set L_tz7, L_tzback
L_zend:
    s_endpgm
L_zend2:
    s_endpgm
L_zh:
    v_mov_b32 v9, 33864
    v_mov_b32 v6, 0
    ds_write2_b32 v9, v6, v6 offset1:1
    v_lshlrev_b32 v6, 2, v2
    v_cvt_f32_u32 v7, v1
    v_cvt_f32_u32 v6, v6
    v_mul_f32 v7, 0x3d800000, v7
    v_mul_f32 v9, v6, v7
    v_cos_f32 v64, v9
    v_sin_f32 v68, v9
    v_add_f32 v9, v9, v7
    v_cos_f32 v65, v9
    v_sin_f32 v69, v9
    v_add_f32 v9, v9, v7
    v_cos_f32 v66, v9
    v_sin_f32 v70, v9
    v_add_f32 v9, v9, v7
    v_cos_f32 v67, v9
    v_sin_f32 v71, v9
    s_nop 0
    v_cvt_pk_bf16_f32 v40, v64, v68
    v_cvt_pk_bf16_f32 v48, -v68, v64
    v_cvt_pk_bf16_f32 v41, v65, v69
    v_cvt_pk_bf16_f32 v49, -v69, v65
    v_cvt_pk_bf16_f32 v42, v66, v70
    v_cvt_pk_bf16_f32 v50, -v70, v66
    v_cvt_pk_bf16_f32 v43, v67, v71
    v_cvt_pk_bf16_f32 v51, -v71, v67
    v_add_f32 v7, 0x3d800000, v7
    v_mul_f32 v9, v6, v7
    v_cos_f32 v64, v9
    v_sin_f32 v68, v9
    v_add_f32 v9, v9, v7
    v_cos_f32 v65, v9
    v_sin_f32 v69, v9
    v_add_f32 v9, v9, v7
    v_cos_f32 v66, v9
    v_sin_f32 v70, v9
    v_add_f32 v9, v9, v7
    v_cos_f32 v67, v9
    v_sin_f32 v71, v9
    s_nop 0
    v_cvt_pk_bf16_f32 v44, v64, -v68
    v_cvt_pk_bf16_f32 v52, -v68, -v64
    v_cvt_pk_bf16_f32 v45, v65, -v69
    v_cvt_pk_bf16_f32 v53, -v69, -v65
    v_cvt_pk_bf16_f32 v46, v66, -v70
    v_cvt_pk_bf16_f32 v54, -v70, -v66
    v_cvt_pk_bf16_f32 v47, v67, -v71
    v_cvt_pk_bf16_f32 v55, -v71, -v67
    ds_write_b128 v5, v[40:43] offset:42688
    ds_write_b128 v5, v[44:47] offset:43712
    ds_write_b128 v5, v[48:51] offset:44736
    ds_write_b128 v5, v[52:55] offset:45760
    s_mov_b32 m0, 47808
    v_mov_b32 v31, 0
    global_load_dword v30, v31, s[30:31]
    s_mov_b32 s64, 0x9E3779B1
    global_load_lds_dwordx4 v5, s[24:25]
    s_waitcnt vmcnt(0)
    v_mul_lo_u32 v31, v30, s64
    v_add_u32 v31, 0x7F4A7C15, v31
    v_lshlrev_b32 v6, 1, v1
    v_lshrrev_b32 v6, v6, v31
    v_lshlrev_b32 v7, 15, v6
    v_and_b32 v6, 1, v6
    v_and_b32 v7, 0x10000, v7
    v_or_b32 v6, v6, v7
    v_lshlrev_b32 v7, 2, v1
    ds_write_b32 v7, v6 offset:33920
    s_waitcnt lgkmcnt(0)
    s_and_b32 s61, s2, 0
    s_mul_i32 s61, s61, 3072
    s_add_u32 s61, s61, 81920
    s_add_u32 s62, s61, 2048
    s_sleep 32
    s_branch L_poll8_1
L_poll8:
    s_sleep 8
L_poll8_1:
    buffer_load_dwordx4 v[32:35], v5, s[36:39], s61 offen sc1
    s_add_u32 s61, s61, 1024
    s_min_u32 s61, s61, s62
    s_add_u32 s65, s65, 1
    s_lshr_b32 s34, s65, 17
    s_waitcnt vmcnt(0)
    s_cbranch_scc1 L_poll8_ok
    v_cmp_ne_u32 vcc, v31, v33
    v_cmp_ne_u32 s[12:13], v31, v35
    s_or_b64 vcc, vcc, s[12:13]
    s_cbranch_vccnz L_poll8
L_poll8_ok:
    v_max_u32 v32, v32, v34
    s_nop 1
    v_max_u32_dpp v32, v32, v32 row_ror:8 row_mask:0xf bank_mask:0xf
    s_nop 1
    v_max_u32_dpp v32, v32, v32 row_ror:4 row_mask:0xf bank_mask:0xf
    s_nop 1
    v_max_u32_dpp v32, v32, v32 row_ror:2 row_mask:0xf bank_mask:0xf
    s_nop 1
    v_max_u32_dpp v32, v32, v32 row_ror:1 row_mask:0xf bank_mask:0xf
    s_nop 1
    v_max_u32_dpp v32, v32, v32 row_bcast:15 row_mask:0xa bank_mask:0xf
    s_nop 1
    v_max_u32_dpp v32, v32, v32 row_bcast:31 row_mask:0xc bank_mask:0xf
    v_mov_b32 v9, 33792
    s_mov_b32 exec_lo, 0
    s_brev_b32 exec_hi, 1
    ds_write2_b32 v9, v32, v31 offset1:1
    s_mov_b64 exec, -1
    s_waitcnt lgkmcnt(0)
    s_barrier
    s_lshl_b32 s6, s47, 2
    s_add_u32 s6, s6, 4096
    s_mov_b64 exec, 1
    buffer_store_dword v31, v0, s[36:39], s6 offen sc1
    s_mov_b64 exec, -1
    s_cmp_lg_u32 s47, 0
    s_cbranch_scc1 L_zend
    s_mov_b64 exec, 0xffff
    v_lshlrev_b32 v6, 2, v0
    s_mov_b32 s6, 4096
    s_waitcnt vmcnt(0)
    s_sleep 24
L_za:
    buffer_load_dword v7, v6, s[36:39], s6 offen sc1
    s_add_u32 s65, s65, 1
    s_lshr_b32 s34, s65, 17
    s_waitcnt vmcnt(0)
    s_cbranch_scc1 L_za_ok
    v_cmp_ne_u32 vcc, v31, v7
    s_nop 0
    s_cbranch_vccnz L_za
L_za_ok:
    s_mov_b64 exec, 1
    v_add_u32 v9, 1, v30
    s_barrier
    buffer_store_dword v9, v6, s[36:39], 0 offen sc1
    s_mov_b64 exec, -1
    s_branch L_zend
L_F:
    v_lshlrev_b32 v5, 4, v0
    s_cmp_eq_u32 s3, 8
    s_cbranch_scc1 L_fh
    s_and_b32 s6, s60, 3
    s_lshr_b32 s7, s3, 1
    s_lshl2_add_u32 s32, s6, s7
    s_mul_i32 s8, s32, 114688
    s_lshr_b32 s33, s60, 2
    s_lshl_b32 s9, s33, 7
    s_add_u32 s8, s8, s9
    v_lshrrev_b32 v6, 3, v0
    v_mul_u32_u24 v6, 3584, v6
    v_and_b32 v7, 7, v0
    v_bfe_u32 v8, v0, 4, 1
    v_lshlrev_b32 v8, 2, v8
    v_xor_b32 v4, v7, v8
    v_lshl_add_u32 v7, v4, 4, s8
    v_add_u32 v3, v6, v7
    s_lshl_b32 s10, s3, 12
    s_mov_b32 m0, s10
    v_bfe_u32 v6, v0, 2, 2
    v_and_b32 v7, 3, v0
    v_lshlrev_b32 v8, 3, v7
    v_lshl_add_u32 v8, v2, 5, v8
    v_and_b32 v9, 2, v6
    v_lshlrev_b32 v9, 5, v9
    v_xor_b32 v9, v9, v8
    v_lshl_add_u32 v9, v6, 7, v9
    v_add_u32 v9, s10, v9
    s_lshl_b32 s11, s3, 8
    v_lshlrev_b32 v11, 2, v0
    v_add_u32 v11, 49152, v11
    v_add_u32 v12, s11, v11
    s_lshl1_add_u32 s7, s33, s7
    s_lshl_b32 s8, s7, 15
    s_and_b32 s9, s3, 1
    s_lshl1_add_u32 s9, s6, s9
    s_lshl_b32 s11, s9, 7
    s_add_u32 s8, s8, s11
    v_lshrrev_b32 v6, 3, v0
    v_lshl_add_u32 v6, v6, 10, s8
    v_lshl_add_u32 v4, v4, 4, v6
    v_lshrrev_b32 v6, 5, v0
    v_mul_u32_u24 v13, 14336, v6
    v_and_b32 v6, 31, v0
    v_lshl_add_u32 v13, v6, 3, v13
    s_mul_i32 s8, s9, 28672
    s_lshl_b32 s7, s7, 8
    s_add_u32 s8, s8, s7
    s_add_u32 s8, s8, 720896
    s_lshl_b32 s32, s32, 6
    s_lshl_b32 s33, s33, 12
    s_add_u32 s61, s33, 196608
    s_add_u32 s62, s61, 114688
    s_lshl_b32 s7, s6, 10
    s_add_u32 s33, s61, s7
    v_mov_b32 v14, 51200
    s_lshr_b32 s7, s3, 1
    s_lshl_b32 s7, s7, 9
    v_lshl_add_u32 v15, v6, 4, s7
    v_lshrrev_b32 v6, 5, v0
    v_lshl_add_u32 v15, v6, 10, v15
    s_mov_b32 s40, s61
    s_mov_b32 s41, s33
    s_mov_b32 s42, s8
    s_mov_b32 s35, 0
    s_bitcmp1_b32 s3, 0
    s_waitcnt lgkmcnt(0)
    s_cselect_b32 s18, s20, s18
    s_cselect_b32 s19, s21, s19
    global_load_lds_dwordx4 v3, s[18:19]
    s_add_u32 m0, s10, 1024
    v_add_u32 v3, 28672, v3
    global_load_lds_dwordx4 v3, s[18:19]
    s_add_u32 m0, s10, 2048
    v_add_u32 v3, 28672, v3
    global_load_lds_dwordx4 v3, s[18:19]
    s_add_u32 m0, s10, 3072
    v_add_u32 v3, 28672, v3
    global_load_lds_dwordx4 v3, s[18:19]
    s_mov_b32 s36, s30
    s_mov_b32 s37, s31
    s_mov_b32 s38, 0x1000000
    s_mov_b32 s39, 0x20000
    s_mov_b32 s65, 0
    s_cmp_ge_u32 s3, 4
    s_cbranch_scc1 L_nowd9
    s_add_u32 m0, s10, 32768
    s_nop 0
    global_load_lds_dwordx4 v4, s[22:23]
    s_add_u32 m0, s10, 33792
    v_add_u32 v4, 0x2000, v4
    global_load_lds_dwordx4 v4, s[22:23]
    s_add_u32 m0, s10, 34816
    v_add_u32 v4, 0x2000, v4
    global_load_lds_dwordx4 v4, s[22:23]
    s_add_u32 m0, s10, 35840
    v_add_u32 v4, 0x2000, v4
    global_load_lds_dwordx4 v4, s[22:23]
L_nowd9:
    s_waitcnt vmcnt(0)
    ds_read_b64_tr_b16 v[32:33], v9 offset:0
    ds_read_b64_tr_b16 v[34:35], v9 offset:512
    ds_read_b64_tr_b16 v[36:37], v9 offset:1024
    ds_read_b64_tr_b16 v[38:39], v9 offset:1536
    ds_read_b64_tr_b16 v[40:41], v9 offset:2048
    ds_read_b64_tr_b16 v[42:43], v9 offset:2560
    ds_read_b64_tr_b16 v[44:45], v9 offset:3072
    ds_read_b64_tr_b16 v[46:47], v9 offset:3584
    s_mov_b64 exec, 0
    s_sub_u32 s53, s3, 8
L_tfback:
    s_add_u32 s53, s53, 8
    s_cmp_eq_u32 s53, 0
    s_cbranch_scc1 L_tf0
    s_cmp_eq_u32 s53, 1
    s_cbranch_scc1 L_tf1
    s_cmp_eq_u32 s53, 2
    s_cbranch_scc1 L_tf2
    s_cmp_eq_u32 s53, 3
    s_cbranch_scc1 L_tf3
    s_cmp_eq_u32 s53, 4
    s_cbranch_scc1 L_tf4
    s_cmp_eq_u32 s53, 5
    s_cbranch_scc1 L_tf5
    s_cmp_eq_u32 s53, 6
    s_cbranch_scc1 L_tf6
    s_cmp_eq_u32 s53, 7
    s_cbranch_scc1 L_tf7
    s_mov_b64 exec, -1
    s_waitcnt lgkmcnt(0)
    s_barrier
L_tf_start:
    ds_read_b64 v[26:27], v14
    s_waitcnt lgkmcnt(0)
    v_readfirstlane_b32 s43, v26
L_redo:
    s_andn2_b32 s6, 2047, s43
    s_lshl_b32 s7, s6, 10
    s_add_u32 s7, s7, s32
    s_load_dwordx16 s[44:59], s[4:5], s7
    v_xor_b32 v31, s6, v27
    v_xor_b32 v29, s6, v27
    v_mov_b32 v16, 0
    v_mov_b32 v17, 0
    v_mov_b32 v24, 0
    v_mov_b32 v25, 0
    s_mov_b32 s61, s40
    s_mov_b32 s33, s41
L_tf0:
    s_cbranch_execz L_tfback
    s_mov_b32 s8, s42
    s_mov_b32 s64, 0
    s_waitcnt lgkmcnt(0)
    v_dot2c_f32_bf16 v16, s44, v32
    v_dot2c_f32_bf16 v17, s45, v33
    v_dot2c_f32_bf16 v16, s46, v34
    v_dot2c_f32_bf16 v17, s47, v35
    v_dot2c_f32_bf16 v16, s48, v36
    v_dot2c_f32_bf16 v17, s49, v37
    v_dot2c_f32_bf16 v16, s50, v38
    v_dot2c_f32_bf16 v17, s51, v39
    v_dot2c_f32_bf16 v16, s52, v40
    v_dot2c_f32_bf16 v17, s53, v41
    v_dot2c_f32_bf16 v16, s54, v42
    v_dot2c_f32_bf16 v17, s55, v43
    v_dot2c_f32_bf16 v16, s56, v44
    v_dot2c_f32_bf16 v17, s57, v45
    v_dot2c_f32_bf16 v16, s58, v46
    v_dot2c_f32_bf16 v17, s59, v47
    s_nop 2
    v_add_f32 v16, v16, v17
    ds_write_b32 v12, v16
    s_waitcnt lgkmcnt(0)
    s_barrier
    s_lshl_b32 s6, s3, 4
    s_lshl_b64 s[12:13], 0xffff, s6
    ds_read2st64_b32 v[16:17], v11 offset0:0 offset1:2
    ds_read2st64_b32 v[18:19], v11 offset0:4 offset1:6
L_tf1:
    s_cbranch_execz L_tfback
    ds_read2st64_b32 v[20:21], v11 offset0:1 offset1:3
    ds_read2st64_b32 v[22:23], v11 offset0:5 offset1:7
    s_waitcnt lgkmcnt(2)
    v_add_f32 v16, v16, v17
    v_add_f32 v18, v18, v19
    s_waitcnt lgkmcnt(0)
    v_add_f32 v20, v20, v21
    v_add_f32 v22, v22, v23
    v_add_f32 v28, v16, v18
    s_mov_b64 exec, s[12:13]
    v_add_f32 v30, v20, v22
    s_cmp_ge_u32 s3, 4
    s_cbranch_scc1 L_f5
    buffer_store_dwordx4 v[28:31], v5, s[36:39], s33 offen
    s_mov_b64 exec, -1
    s_waitcnt vmcnt(1)
    ds_read_b64_tr_b16 v[48:49], v9 offset:32768
    ds_read_b64_tr_b16 v[50:51], v9 offset:33280
    ds_read_b64_tr_b16 v[52:53], v9 offset:33792
    ds_read_b64_tr_b16 v[54:55], v9 offset:34304
    ds_read_b64_tr_b16 v[56:57], v9 offset:34816
    ds_read_b64_tr_b16 v[58:59], v9 offset:35328
L_tf2:
    s_cbranch_execz L_tfback
    ds_read_b64_tr_b16 v[60:61], v9 offset:35840
    ds_read_b64_tr_b16 v[62:63], v9 offset:36352
    s_sleep 3
L_fx:
    buffer_load_dwordx4 v[64:67], v15, s[36:39], s61 offen offset:0 sc1
    buffer_load_dwordx4 v[68:71], v15, s[36:39], s61 offen offset:2048 sc1
    s_add_u32 s64, s64, 1
    s_cmp_ge_u32 s64, 8
    s_cselect_b32 s6, 114688, 0
    s_add_u32 s61, s61, s6
    s_min_u32 s61, s61, s62
    s_add_u32 s65, s65, 1
    s_lshr_b32 s34, s65, 17
    s_cbranch_scc1 L_fx_ok
    s_waitcnt vmcnt(1)
    v_bitop3_b32 v20, v65, v67, v31 bitop3:0x7e
    s_waitcnt vmcnt(0)
    v_add_f32 v16, v64, v68
    v_add_f32 v18, v66, v70
    v_bitop3_b32 v21, v69, v71, v31 bitop3:0x7e
    v_or_b32 v20, v20, v21
    v_cmp_ne_u32 vcc, 0, v20
    v_permlane32_swap_b32 v16, v18
    s_cbranch_vccnz L_fxr
L_fx_ok:
L_tf3:
    s_cbranch_execz L_tfback
    v_add_f32 v16, v16, v18
    v_cvt_pk_bf16_f32 v16, v16, v16
    v_and_b32 v16, 0xffff0000, v16
    v_mov_b32 v18, v16
    v_mul_f32 v17, 0xbfb8aa3b, v16
    v_exp_f32 v17, v17
    s_nop 0
    v_add_f32 v17, 1.0, v17
    v_rcp_f32 v17, v17
    s_nop 0
    v_permlane32_swap_b32 v16, v18
    v_mul_f32 v17, v17, v16
    v_cvt_pk_bf16_f32 v17, v17, v17
    v_and_b32 v17, 0xffff0000, v17
    v_mul_f32 v17, v17, v18
    s_nop 1
    v_mov_b32_dpp v18, v17 quad_perm:[1,0,3,2] row_mask:0xf bank_mask:0xf
    v_cvt_pk_bf16_f32 v17, v17, v18
    s_nop 0
    v_readlane_b32 s44, v17, 0
    v_readlane_b32 s45, v17, 2
    v_readlane_b32 s46, v17, 4
L_tf4:
    s_cbranch_execz L_tfback
    v_readlane_b32 s47, v17, 6
    v_readlane_b32 s48, v17, 8
    v_readlane_b32 s49, v17, 10
    v_readlane_b32 s50, v17, 12
    v_readlane_b32 s51, v17, 14
    v_readlane_b32 s52, v17, 16
    v_readlane_b32 s53, v17, 18
    v_readlane_b32 s54, v17, 20
    v_readlane_b32 s55, v17, 22
    v_readlane_b32 s56, v17, 24
    v_readlane_b32 s57, v17, 26
    v_readlane_b32 s58, v17, 28
    v_readlane_b32 s59, v17, 30
    s_waitcnt lgkmcnt(0)
    v_dot2c_f32_bf16 v24, s44, v48
    v_dot2c_f32_bf16 v25, s45, v49
    v_dot2c_f32_bf16 v24, s46, v50
L_tf5:
    s_cbranch_execz L_tfback
    v_dot2c_f32_bf16 v25, s47, v51
    v_dot2c_f32_bf16 v24, s48, v52
    v_dot2c_f32_bf16 v25, s49, v53
    v_dot2c_f32_bf16 v24, s50, v54
    v_dot2c_f32_bf16 v25, s51, v55
    v_dot2c_f32_bf16 v24, s52, v56
    v_dot2c_f32_bf16 v25, s53, v57
    v_dot2c_f32_bf16 v24, s54, v58
    v_dot2c_f32_bf16 v25, s55, v59
    v_dot2c_f32_bf16 v24, s56, v60
    v_dot2c_f32_bf16 v25, s57, v61
    v_dot2c_f32_bf16 v24, s58, v62
    v_dot2c_f32_bf16 v25, s59, v63
    s_nop 2
    v_add_f32 v30, v24, v25
    buffer_store_dwordx2 v[30:31], v13, s[36:39], s8 offen sc1
.set L_tf6, L_tfback
.set L_tf7, L_tfback
L_fend:
    s_cmp_lg_u32 s35, 0
    s_cbranch_scc1 L_fexit
    s_barrier
    ds_read_b32 v26, v14 offset:8
    s_mov_b32 s35, 1
    s_waitcnt lgkmcnt(0)
    v_readfirstlane_b32 s6, v26
    s_cmp_eq_u32 s6, s43
    s_mov_b32 s43, s6
    s_cbranch_scc0 L_redo
L_fexit:
    s_endpgm
L_f5:
    s_add_u32 s33, s33, 114688
    buffer_store_dwordx4 v[28:31], v5, s[36:39], s33 offen sc1
    s_mov_b64 exec, -1
    s_branch L_fend
L_fxr:
    ds_read_b32 v26, v14 offset:8
    s_waitcnt lgkmcnt(0)
    v_readfirstlane_b32 s6, v26
    s_cmp_eq_u32 s6, 0
    s_cbranch_scc1 L_fx
    s_cmp_eq_u32 s6, s43
    s_cbranch_scc1 L_fx
    s_branch L_fend
L_fh:
    s_waitcnt lgkmcnt(0)
    v_mov_b32 v31, 0
    global_load_dword v30, v31, s[30:31]
    s_mov_b32 s64, 0x9E3779B1
    s_mov_b32 s36, s30
    s_mov_b32 s37, s31
    s_mov_b32 s38, 0x1000000
    s_mov_b32 s39, 0x20000
    s_mov_b32 s65, 0
    v_mov_b32 v14, 51200
    v_mov_b32 v6, 0
    ds_write_b32 v14, v6 offset:8
    s_and_b32 s61, s2, 7
    s_mul_i32 s61, s61, 2048
    s_add_u32 s61, s61, 65536
    s_add_u32 s62, s61, 1024
    s_sleep 46
    s_waitcnt vmcnt(0)
    v_mul_lo_u32 v31, v30, s64
    v_add_u32 v31, 0x7F4A7C15, v31
    s_branch L_poll10_1
L_poll10:
    s_sleep 4
L_poll10_1:
    buffer_load_dwordx4 v[20:23], v5, s[36:39], s61 offen sc1
    s_add_u32 s61, s61, 1024
    s_min_u32 s61, s61, s62
    s_add_u32 s65, s65, 1
    s_lshr_b32 s34, s65, 17
    s_waitcnt vmcnt(0)
    s_cbranch_scc1 L_poll10_ok
    v_cmp_ne_u32 vcc, v31, v21
    v_cmp_ne_u32 s[12:13], v31, v23
    s_or_b64 vcc, vcc, s[12:13]
    s_cbranch_vccnz L_poll10
L_poll10_ok:
    v_max_u32 v20, v20, v22
    s_nop 1
    v_max_u32_dpp v20, v20, v20 row_ror:8 row_mask:0xf bank_mask:0xf
    s_nop 1
    v_max_u32_dpp v20, v20, v20 row_ror:4 row_mask:0xf bank_mask:0xf
    s_nop 1
    v_max_u32_dpp v20, v20, v20 row_ror:2 row_mask:0xf bank_mask:0xf
    s_nop 1
    v_max_u32_dpp v20, v20, v20 row_ror:1 row_mask:0xf bank_mask:0xf
    s_nop 1
    v_max_u32_dpp v20, v20, v20 row_bcast:15 row_mask:0xa bank_mask:0xf
    s_nop 1
    v_max_u32_dpp v20, v20, v20 row_bcast:31 row_mask:0xc bank_mask:0xf
    v_mov_b32 v9, 51200
    s_mov_b32 exec_lo, 0
    s_brev_b32 exec_hi, 1
    ds_write2_b32 v9, v20, v31 offset1:1
    s_mov_b64 exec, -1
    s_waitcnt lgkmcnt(0)
    s_barrier
    v_mov_b32 v9, 51208
    s_mov_b32 exec_lo, 0
    s_brev_b32 exec_hi, 1
    ds_write_b32 v9, v20
    s_mov_b64 exec, -1
    s_waitcnt lgkmcnt(0)
    s_barrier
    s_endpgm
L_end:
    s_endpgm
.section .rodata,"a"
.p2align 6
.amdhsa_kernel gated_mix__spectral_fnet__moe_arch_mod__prompt_kernel
  .amdhsa_next_free_vgpr 168
  .amdhsa_next_free_sgpr 72
  .amdhsa_accum_offset 168
  .amdhsa_group_segment_fixed_size 0
  .amdhsa_kernarg_size 112
  .amdhsa_user_sgpr_count 2
  .amdhsa_user_sgpr_kernarg_segment_ptr 1
  .amdhsa_system_sgpr_workgroup_id_x 1
.end_amdhsa_kernel
```
